```python
import torch

def _softmax(x, axis=-1):
    return torch.softmax(x, dim=axis)
def _gelu(x):
    return torch.nn.functional.gelu(x, approximate="tanh")
def _silu(x):
    return torch.nn.functional.silu(x)
def _sigmoid(x):
    return torch.sigmoid(x)
def _layernorm(x, axis=-1, eps=1e-5):
    m = x.mean(dim=axis, keepdim=True)
    v = x.var(dim=axis, keepdim=True, unbiased=False)
    return (x - m) / torch.sqrt(v + eps)
def _scatter_add(tgt, idx, src, axis=0):
    return tgt.clone().index_add_(axis, idx, src)
def _segment_sum(src, seg, n):
    out = torch.zeros((n,) + src.shape[1:], dtype=src.dtype)
    return out.index_add_(0, seg, src)
def _pad(x, pw):
    flat = tuple(v for pair in reversed(pw) for v in pair)
    return torch.nn.functional.pad(x, flat)

kernel_name = 'standalone__gqa_softmax__near_ridge'

def setup_inputs():

    _w = (lambda a: (lambda t: t.to(torch.bfloat16) if t.is_floating_point() else t)(torch.as_tensor(a)))
    B, Hq, Hkv, Sq, Sk, D = 8, 32, 32, 608, 1024, 128
    return {
        "q": _w((lambda *s: torch.randn(*s, dtype=torch.bfloat16) * 0.8)(B, Hq, Sq, D)),
        "k": _w((lambda *s: torch.randn(*s, dtype=torch.bfloat16) * 0.8)(B, Hkv, Sk, D)),
        "v": _w((lambda *s: torch.randn(*s, dtype=torch.bfloat16) * 0.05)(B, Hkv, Sk, D)),
    }

def reference(q, k, v):
    B, Hq, Sq, D = q.shape
    Hkv = k.shape[1]
    rep = Hq // Hkv
    k = (lambda x, n, axis: torch.repeat_interleave(x, n, dim=axis))(k, rep, axis=1)
    v = (lambda x, n, axis: torch.repeat_interleave(x, n, dim=axis))(v, rep, axis=1)
    scale = D ** -0.5
    scores = torch.einsum("bhqd,bhkd->bhqk", q, k) * scale
    p = _softmax(scores, axis=-1)
    return torch.einsum("bhqk,bhkd->bhqd", p, v)
```

```asm
; @launch grid=(256,1,1) block=(256,1,1) lds=131328
.amdgcn_target "amdgcn-amd-amdhsa--gfx950"
.text
.globl standalone__gqa_softmax__near_ridge_kernel
.p2align 8
.type standalone__gqa_softmax__near_ridge_kernel,@function
standalone__gqa_softmax__near_ridge_kernel:

    s_cmp_ge_u32 s2, 256
    s_cbranch_scc1 L_exit

    s_load_dwordx4 s[4:7], s[0:1], 0
    s_load_dwordx4 s[8:11], s[0:1], 16
    s_and_b32 s38, s2, 7
    s_lshr_b32 s39, s2, 3
    s_and_b32 s29, s39, 1
    s_lshr_b32 s39, s39, 1
    s_lshl_b32 s39, s39, 3
    s_add_u32 s28, s39, s38
    s_lshl_b32 s33, s28, 18
    s_mov_b32 s30, s33
    v_lshrrev_b32 v236, 6, v0
    v_and_b32 v237, 63, v0
    v_readfirstlane_b32 s31, v236
    v_lshrrev_b32 v238, 4, v237
    v_and_b32 v239, 15, v237
    s_mul_i32 s32, s28, 155648
    s_mul_i32 s38, s29, 77824
    s_add_u32 s32, s32, s38
    s_mul_i32 s38, s31, 20480
    s_add_u32 s32, s32, s38
    s_lshl_b32 s34, s31, 11
    s_add_u32 s44, s32, 19922944
    s_add_u32 s45, s33, 33554432
    s_mov_b32 s46, 0
    s_mov_b32 s36, 0x3e0293ee
    s_mov_b32 s37, 0x3e0293ee
    s_mov_b32 s40, 0x5f800000
    v_mov_b32 v248, 0x3f803f80
    v_mov_b32 v249, 0x3f803f80
    v_mov_b32 v250, 0x3f803f80
    v_mov_b32 v251, 0x3f803f80
    v_mov_b32 v252, 0
    v_mov_b32 v253, 0
    v_mov_b32 v254, 0
    v_mov_b32 v255, 0
    v_lshlrev_b32 v16, 8, v239
    v_lshl_add_u32 v16, v238, 4, v16
    v_lshlrev_b32 v17, 8, v239
    v_and_b32 v240, 1, v238
    v_lshl_add_u32 v17, v240, 5, v17
    v_lshrrev_b32 v240, 1, v238
    v_lshl_add_u32 v17, v240, 4, v17
    v_lshlrev_b32 v240, 1, v238
    v_xor_b32 v241, v239, v240
    v_lshlrev_b32 v241, 4, v241
    v_lshl_add_u32 v241, v238, 8, v241
    v_add_u32 v1, s34, v241
    v_xor_b32 v2, 0x80, v1
    v_and_b32 v240, 7, v239
    v_lshlrev_b32 v240, 1, v240
    v_lshlrev_b32 v242, 8, v239
    v_add_u32 v241, 0, v238
    v_xor_b32 v241, v241, v240
    v_lshl_add_u32 v4, v241, 4, v242
    v_add_u32 v241, 4, v238
    v_xor_b32 v241, v241, v240
    v_lshl_add_u32 v5, v241, 4, v242
    v_add_u32 v241, 8, v238
    v_xor_b32 v241, v241, v240
    v_lshl_add_u32 v6, v241, 4, v242
    v_add_u32 v241, 12, v238
    v_xor_b32 v241, v241, v240
    v_lshl_add_u32 v7, v241, 4, v242
    v_lshrrev_b32 v240, 2, v237
    v_and_b32 v240, 3, v240
    v_and_b32 v241, 3, v237
    v_lshl_add_u32 v242, v238, 2, v240
    v_and_b32 v243, 7, v242
    v_lshlrev_b32 v242, 8, v242
    v_lshl_add_u32 v242, v241, 3, v242
    v_add_u32 v242, 65536, v242
    v_xor_b32 v241, 0, v243
    v_lshl_add_u32 v8, v241, 5, v242
    v_xor_b32 v241, 1, v243
    v_lshl_add_u32 v9, v241, 5, v242
    v_xor_b32 v241, 2, v243
    v_lshl_add_u32 v10, v241, 5, v242
    v_xor_b32 v241, 3, v243
    v_lshl_add_u32 v11, v241, 5, v242
    v_xor_b32 v241, 4, v243
    v_lshl_add_u32 v12, v241, 5, v242
    v_xor_b32 v241, 5, v243
    v_lshl_add_u32 v13, v241, 5, v242
    v_xor_b32 v241, 6, v243
    v_lshl_add_u32 v14, v241, 5, v242
    v_xor_b32 v241, 7, v243
    v_lshl_add_u32 v15, v241, 5, v242
    v_mov_b32 v19, 131072
    v_lshl_add_u32 v18, v236, 2, v19
    s_waitcnt lgkmcnt(0)
    s_mov_b32 s12, s4
    s_mov_b32 s13, s5
    s_mov_b32 s14, 39845888
    s_mov_b32 s15, 0x00020000
    s_mov_b32 s16, s6
    s_mov_b32 s17, s7
    s_mov_b32 s18, 67108864
    s_mov_b32 s19, 0x00020000
    s_mov_b32 s20, s8
    s_mov_b32 s21, s9
    s_mov_b32 s22, 67108864
    s_mov_b32 s23, 0x00020000
    s_mov_b32 s24, s10
    s_mov_b32 s25, s11
    s_mov_b32 s26, 39845888
    s_mov_b32 s27, 0x00020000
    s_cmp_ge_u32 s31, 3
    s_cbranch_scc1 L_c4_start

L_c5_start:
    s_add_u32 m0, s34, 0
    s_nop 0
    buffer_load_dwordx4 v1, s[16:19], s33 offen lds
    buffer_load_dwordx4 v2, s[16:19], s33 offen offset:1024 lds
    s_add_u32 m0, s34, 65536
    s_nop 0
    buffer_load_dwordx4 v1, s[20:23], s33 offen lds
    buffer_load_dwordx4 v2, s[20:23], s33 offen offset:1024 lds
    s_add_u32 s33, s33, 8192
    s_add_u32 s38, s32, 0
    buffer_load_dwordx4 v[156:159], v16, s[12:15], s38 offen offset:0
    buffer_load_dwordx4 v[160:163], v16, s[12:15], s38 offen offset:64
    buffer_load_dwordx4 v[164:167], v16, s[12:15], s38 offen offset:128
    buffer_load_dwordx4 v[168:171], v16, s[12:15], s38 offen offset:192
    s_add_u32 m0, s34, 8192
    s_nop 0
    buffer_load_dwordx4 v1, s[16:19], s33 offen lds
    buffer_load_dwordx4 v2, s[16:19], s33 offen offset:1024 lds
    s_add_u32 m0, s34, 73728
    s_nop 0
    buffer_load_dwordx4 v1, s[20:23], s33 offen lds
    buffer_load_dwordx4 v2, s[20:23], s33 offen offset:1024 lds
    s_add_u32 s33, s33, 8192
    s_add_u32 s38, s32, 4096
    buffer_load_dwordx4 v[172:175], v16, s[12:15], s38 offen offset:0
    buffer_load_dwordx4 v[176:179], v16, s[12:15], s38 offen offset:64
    buffer_load_dwordx4 v[180:183], v16, s[12:15], s38 offen offset:128
    buffer_load_dwordx4 v[184:187], v16, s[12:15], s38 offen offset:192
    s_waitcnt vmcnt(4)
    s_barrier
    ds_read_b128 v[44:47], v4 offset:0
    ds_read_b128 v[48:51], v5 offset:0
    ds_read_b128 v[52:55], v6 offset:0
    ds_read_b128 v[56:59], v7 offset:0
    ds_read_b128 v[60:63], v4 offset:4096
    ds_read_b128 v[64:67], v5 offset:4096
    ds_read_b128 v[68:71], v6 offset:4096
    ds_read_b128 v[72:75], v7 offset:4096
    ds_read_b128 a[0:3], v4 offset:8192
    ds_read_b128 a[4:7], v5 offset:8192
    ds_read_b128 a[8:11], v6 offset:8192
    ds_read_b128 a[12:15], v7 offset:8192
    ds_read_b128 a[16:19], v4 offset:12288
    ds_read_b128 a[20:23], v5 offset:12288
    ds_read_b128 a[24:27], v6 offset:12288
    ds_read_b128 a[28:31], v7 offset:12288
    s_waitcnt lgkmcnt(0)
    s_add_u32 s38, s32, 8192
    buffer_load_dwordx4 v[188:191], v16, s[12:15], s38 offen offset:0
    buffer_load_dwordx4 v[192:195], v16, s[12:15], s38 offen offset:64
    buffer_load_dwordx4 v[196:199], v16, s[12:15], s38 offen offset:128
    buffer_load_dwordx4 v[200:203], v16, s[12:15], s38 offen offset:192
    s_waitcnt vmcnt(12)
    v_lshlrev_b32 v236, 16, v156
    v_and_b32 v237, 0xffff0000, v156
    v_lshlrev_b32 v238, 16, v157
    v_and_b32 v239, 0xffff0000, v157
    v_pk_mul_f32 v[236:237], v[236:237], s[36:37]
    v_pk_mul_f32 v[238:239], v[238:239], s[36:37]
    v_cvt_pk_bf16_f32 v156, v236, v237
    v_cvt_pk_bf16_f32 v157, v238, v239
    v_lshlrev_b32 v240, 16, v158
    v_and_b32 v241, 0xffff0000, v158
    v_lshlrev_b32 v242, 16, v159
    v_and_b32 v243, 0xffff0000, v159
    v_pk_mul_f32 v[240:241], v[240:241], s[36:37]
    v_pk_mul_f32 v[242:243], v[242:243], s[36:37]
    v_cvt_pk_bf16_f32 v158, v240, v241
    v_cvt_pk_bf16_f32 v159, v242, v243
    v_lshlrev_b32 v236, 16, v160
    v_and_b32 v237, 0xffff0000, v160
    v_lshlrev_b32 v238, 16, v161
    v_and_b32 v239, 0xffff0000, v161
    v_pk_mul_f32 v[236:237], v[236:237], s[36:37]
    v_pk_mul_f32 v[238:239], v[238:239], s[36:37]
    v_cvt_pk_bf16_f32 v160, v236, v237
    v_cvt_pk_bf16_f32 v161, v238, v239
    v_lshlrev_b32 v240, 16, v162
    v_and_b32 v241, 0xffff0000, v162
    v_lshlrev_b32 v242, 16, v163
    v_and_b32 v243, 0xffff0000, v163
    v_pk_mul_f32 v[240:241], v[240:241], s[36:37]
    v_pk_mul_f32 v[242:243], v[242:243], s[36:37]
    v_cvt_pk_bf16_f32 v162, v240, v241
    v_cvt_pk_bf16_f32 v163, v242, v243
    v_lshlrev_b32 v236, 16, v164
    v_and_b32 v237, 0xffff0000, v164
    v_lshlrev_b32 v238, 16, v165
    v_and_b32 v239, 0xffff0000, v165
    v_pk_mul_f32 v[236:237], v[236:237], s[36:37]
    v_pk_mul_f32 v[238:239], v[238:239], s[36:37]
    v_cvt_pk_bf16_f32 v164, v236, v237
    v_cvt_pk_bf16_f32 v165, v238, v239
    v_lshlrev_b32 v240, 16, v166
    v_and_b32 v241, 0xffff0000, v166
    v_lshlrev_b32 v242, 16, v167
    v_and_b32 v243, 0xffff0000, v167
    v_pk_mul_f32 v[240:241], v[240:241], s[36:37]
    v_pk_mul_f32 v[242:243], v[242:243], s[36:37]
    v_cvt_pk_bf16_f32 v166, v240, v241
    v_cvt_pk_bf16_f32 v167, v242, v243
    v_lshlrev_b32 v236, 16, v168
    v_and_b32 v237, 0xffff0000, v168
    v_lshlrev_b32 v238, 16, v169
    v_and_b32 v239, 0xffff0000, v169
    v_pk_mul_f32 v[236:237], v[236:237], s[36:37]
    v_pk_mul_f32 v[238:239], v[238:239], s[36:37]
    v_cvt_pk_bf16_f32 v168, v236, v237
    v_cvt_pk_bf16_f32 v169, v238, v239
    v_lshlrev_b32 v240, 16, v170
    v_and_b32 v241, 0xffff0000, v170
    v_lshlrev_b32 v242, 16, v171
    v_and_b32 v243, 0xffff0000, v171
    v_pk_mul_f32 v[240:241], v[240:241], s[36:37]
    v_pk_mul_f32 v[242:243], v[242:243], s[36:37]
    v_cvt_pk_bf16_f32 v170, v240, v241
    v_cvt_pk_bf16_f32 v171, v242, v243
    v_accvgpr_write_b32 a160, v156
    v_accvgpr_write_b32 a161, v157
    v_accvgpr_write_b32 a162, v158
    v_accvgpr_write_b32 a163, v159
    v_accvgpr_write_b32 a164, v160
    v_accvgpr_write_b32 a165, v161
    v_accvgpr_write_b32 a166, v162
    v_accvgpr_write_b32 a167, v163
    v_accvgpr_write_b32 a168, v164
    v_accvgpr_write_b32 a169, v165
    v_accvgpr_write_b32 a170, v166
    v_accvgpr_write_b32 a171, v167
    v_accvgpr_write_b32 a172, v168
    v_accvgpr_write_b32 a173, v169
    v_accvgpr_write_b32 a174, v170
    v_accvgpr_write_b32 a175, v171
    s_nop 1
    v_mfma_f32_16x16x32_bf16 v[76:79], v[44:47], a[160:163], 0
    v_mfma_f32_16x16x32_bf16 v[80:83], v[60:63], a[160:163], 0
    v_mfma_f32_16x16x32_bf16 v[76:79], v[48:51], a[164:167], v[76:79]
    v_mfma_f32_16x16x32_bf16 v[80:83], v[64:67], a[164:167], v[80:83]
    v_mfma_f32_16x16x32_bf16 v[76:79], v[52:55], a[168:171], v[76:79]
    v_mfma_f32_16x16x32_bf16 v[80:83], v[68:71], a[168:171], v[80:83]
    v_mfma_f32_16x16x32_bf16 v[76:79], v[56:59], a[172:175], v[76:79]
    v_mfma_f32_16x16x32_bf16 v[80:83], v[72:75], a[172:175], v[80:83]
    s_nop 7
    v_max3_f32 v244, v76, v77, v78
    v_max3_f32 v245, v79, v80, v81
    v_max3_f32 v244, v244, v82, v83
    v_max_f32 v244, v244, v245
    v_mov_b32 v245, v244
    s_nop 1
    v_permlane16_swap_b32 v244, v245
    v_max_f32 v244, v244, v245
    v_mov_b32 v245, v244
    s_nop 1
    v_permlane32_swap_b32 v244, v245
    v_max_f32 v244, v244, v245
    v_sub_f32 v24, 0, v244
    v_sub_f32 v25, 0, v244
    v_sub_f32 v26, 0, v244
    v_sub_f32 v27, 0, v244
    s_nop 1
    v_mfma_f32_16x16x32_bf16 v[116:119], a[0:3], a[160:163], v[24:27]
    v_sub_f32 v76, v76, v244
    v_sub_f32 v77, v77, v244
    v_mfma_f32_16x16x32_bf16 v[120:123], a[16:19], a[160:163], v[24:27]
    v_sub_f32 v78, v78, v244
    v_sub_f32 v79, v79, v244
    v_sub_f32 v80, v80, v244
    v_mfma_f32_16x16x32_bf16 v[116:119], a[4:7], a[164:167], v[116:119]
    v_sub_f32 v81, v81, v244
    v_sub_f32 v82, v82, v244
    v_mfma_f32_16x16x32_bf16 v[120:123], a[20:23], a[164:167], v[120:123]
    v_sub_f32 v83, v83, v244
    v_exp_f32 v76, v76
    v_exp_f32 v77, v77
    v_mfma_f32_16x16x32_bf16 v[116:119], a[8:11], a[168:171], v[116:119]
    v_exp_f32 v78, v78
    v_exp_f32 v79, v79
    v_mfma_f32_16x16x32_bf16 v[120:123], a[24:27], a[168:171], v[120:123]
    v_exp_f32 v80, v80
    v_cvt_pk_bf16_f32 v76, v76, v77
    v_cvt_pk_bf16_f32 v77, v78, v79
    v_mfma_f32_16x16x32_bf16 v[116:119], a[12:15], a[172:175], v[116:119]
    v_exp_f32 v81, v81
    v_exp_f32 v82, v82
    v_mfma_f32_16x16x32_bf16 v[120:123], a[28:31], a[172:175], v[120:123]
    v_exp_f32 v83, v83
    v_cvt_pk_bf16_f32 v78, v80, v81
    v_cvt_pk_bf16_f32 v79, v82, v83
    s_add_u32 s38, s32, 12288
    buffer_load_dwordx4 v[204:207], v16, s[12:15], s38 offen offset:0
    buffer_load_dwordx4 v[208:211], v16, s[12:15], s38 offen offset:64
    buffer_load_dwordx4 v[212:215], v16, s[12:15], s38 offen offset:128
    buffer_load_dwordx4 v[216:219], v16, s[12:15], s38 offen offset:192
    s_waitcnt vmcnt(8)
    v_lshlrev_b32 v236, 16, v172
    v_and_b32 v237, 0xffff0000, v172
    v_lshlrev_b32 v238, 16, v173
    v_and_b32 v239, 0xffff0000, v173
    v_pk_mul_f32 v[236:237], v[236:237], s[36:37]
    v_pk_mul_f32 v[238:239], v[238:239], s[36:37]
    v_cvt_pk_bf16_f32 v172, v236, v237
    v_cvt_pk_bf16_f32 v173, v238, v239
    v_lshlrev_b32 v240, 16, v174
    v_and_b32 v241, 0xffff0000, v174
    v_lshlrev_b32 v242, 16, v175
    v_and_b32 v243, 0xffff0000, v175
    v_pk_mul_f32 v[240:241], v[240:241], s[36:37]
    v_pk_mul_f32 v[242:243], v[242:243], s[36:37]
    v_cvt_pk_bf16_f32 v174, v240, v241
    v_cvt_pk_bf16_f32 v175, v242, v243
    v_lshlrev_b32 v236, 16, v176
    v_and_b32 v237, 0xffff0000, v176
    v_lshlrev_b32 v238, 16, v177
    v_and_b32 v239, 0xffff0000, v177
    v_pk_mul_f32 v[236:237], v[236:237], s[36:37]
    v_pk_mul_f32 v[238:239], v[238:239], s[36:37]
    v_cvt_pk_bf16_f32 v176, v236, v237
    v_cvt_pk_bf16_f32 v177, v238, v239
    v_lshlrev_b32 v240, 16, v178
    v_and_b32 v241, 0xffff0000, v178
    v_lshlrev_b32 v242, 16, v179
    v_and_b32 v243, 0xffff0000, v179
    v_pk_mul_f32 v[240:241], v[240:241], s[36:37]
    v_pk_mul_f32 v[242:243], v[242:243], s[36:37]
    v_cvt_pk_bf16_f32 v178, v240, v241
    v_cvt_pk_bf16_f32 v179, v242, v243
    v_lshlrev_b32 v236, 16, v180
    v_and_b32 v237, 0xffff0000, v180
    v_lshlrev_b32 v238, 16, v181
    v_and_b32 v239, 0xffff0000, v181
    v_pk_mul_f32 v[236:237], v[236:237], s[36:37]
    v_pk_mul_f32 v[238:239], v[238:239], s[36:37]
    v_cvt_pk_bf16_f32 v180, v236, v237
    v_cvt_pk_bf16_f32 v181, v238, v239
    v_lshlrev_b32 v240, 16, v182
    v_and_b32 v241, 0xffff0000, v182
    v_lshlrev_b32 v242, 16, v183
    v_and_b32 v243, 0xffff0000, v183
    v_pk_mul_f32 v[240:241], v[240:241], s[36:37]
    v_pk_mul_f32 v[242:243], v[242:243], s[36:37]
    v_cvt_pk_bf16_f32 v182, v240, v241
    v_cvt_pk_bf16_f32 v183, v242, v243
    v_lshlrev_b32 v236, 16, v184
    v_and_b32 v237, 0xffff0000, v184
    v_lshlrev_b32 v238, 16, v185
    v_and_b32 v239, 0xffff0000, v185
    v_pk_mul_f32 v[236:237], v[236:237], s[36:37]
    v_pk_mul_f32 v[238:239], v[238:239], s[36:37]
    v_cvt_pk_bf16_f32 v184, v236, v237
    v_cvt_pk_bf16_f32 v185, v238, v239
    v_lshlrev_b32 v240, 16, v186
    v_and_b32 v241, 0xffff0000, v186
    v_lshlrev_b32 v242, 16, v187
    v_and_b32 v243, 0xffff0000, v187
    v_pk_mul_f32 v[240:241], v[240:241], s[36:37]
    v_pk_mul_f32 v[242:243], v[242:243], s[36:37]
    v_cvt_pk_bf16_f32 v186, v240, v241
    v_cvt_pk_bf16_f32 v187, v242, v243
    v_accvgpr_write_b32 a176, v172
    v_accvgpr_write_b32 a177, v173
    v_accvgpr_write_b32 a178, v174
    v_accvgpr_write_b32 a179, v175
    v_accvgpr_write_b32 a180, v176
    v_accvgpr_write_b32 a181, v177
    v_accvgpr_write_b32 a182, v178
    v_accvgpr_write_b32 a183, v179
    v_accvgpr_write_b32 a184, v180
    v_accvgpr_write_b32 a185, v181
    v_accvgpr_write_b32 a186, v182
    v_accvgpr_write_b32 a187, v183
    v_accvgpr_write_b32 a188, v184
    v_accvgpr_write_b32 a189, v185
    v_accvgpr_write_b32 a190, v186
    v_accvgpr_write_b32 a191, v187
    s_nop 1
    v_mfma_f32_16x16x32_bf16 v[84:87], v[44:47], a[176:179], 0
    v_mfma_f32_16x16x32_bf16 v[88:91], v[60:63], a[176:179], 0
    v_mfma_f32_16x16x32_bf16 v[84:87], v[48:51], a[180:183], v[84:87]
    v_mfma_f32_16x16x32_bf16 v[88:91], v[64:67], a[180:183], v[88:91]
    v_mfma_f32_16x16x32_bf16 v[84:87], v[52:55], a[184:187], v[84:87]
    v_mfma_f32_16x16x32_bf16 v[88:91], v[68:71], a[184:187], v[88:91]
    v_mfma_f32_16x16x32_bf16 v[84:87], v[56:59], a[188:191], v[84:87]
    v_mfma_f32_16x16x32_bf16 v[88:91], v[72:75], a[188:191], v[88:91]
    s_nop 7
    v_max3_f32 v244, v84, v85, v86
    v_max3_f32 v245, v87, v88, v89
    v_max3_f32 v244, v244, v90, v91
    v_max_f32 v244, v244, v245
    v_mov_b32 v245, v244
    s_nop 1
    v_permlane16_swap_b32 v244, v245
    v_max_f32 v244, v244, v245
    v_mov_b32 v245, v244
    s_nop 1
    v_permlane32_swap_b32 v244, v245
    v_max_f32 v244, v244, v245
    v_sub_f32 v28, 0, v244
    v_sub_f32 v29, 0, v244
    v_sub_f32 v30, 0, v244
    v_sub_f32 v31, 0, v244
    s_nop 1
    v_mfma_f32_16x16x32_bf16 v[124:127], a[0:3], a[176:179], v[28:31]
    v_sub_f32 v84, v84, v244
    v_sub_f32 v85, v85, v244
    v_mfma_f32_16x16x32_bf16 v[128:131], a[16:19], a[176:179], v[28:31]
    v_sub_f32 v86, v86, v244
    v_sub_f32 v87, v87, v244
    v_sub_f32 v88, v88, v244
    v_mfma_f32_16x16x32_bf16 v[124:127], a[4:7], a[180:183], v[124:127]
    v_sub_f32 v89, v89, v244
    v_sub_f32 v90, v90, v244
    v_mfma_f32_16x16x32_bf16 v[128:131], a[20:23], a[180:183], v[128:131]
    v_sub_f32 v91, v91, v244
    v_exp_f32 v84, v84
    v_exp_f32 v85, v85
    v_mfma_f32_16x16x32_bf16 v[124:127], a[8:11], a[184:187], v[124:127]
    v_exp_f32 v86, v86
    v_exp_f32 v87, v87
    v_mfma_f32_16x16x32_bf16 v[128:131], a[24:27], a[184:187], v[128:131]
    v_exp_f32 v88, v88
    v_cvt_pk_bf16_f32 v84, v84, v85
    v_cvt_pk_bf16_f32 v85, v86, v87
    v_mfma_f32_16x16x32_bf16 v[124:127], a[12:15], a[188:191], v[124:127]
    v_exp_f32 v89, v89
    v_exp_f32 v90, v90
    v_mfma_f32_16x16x32_bf16 v[128:131], a[28:31], a[188:191], v[128:131]
    v_exp_f32 v91, v91
    v_cvt_pk_bf16_f32 v86, v88, v89
    v_cvt_pk_bf16_f32 v87, v90, v91
    s_add_u32 s38, s32, 16384
    buffer_load_dwordx4 v[220:223], v16, s[12:15], s38 offen offset:0
    buffer_load_dwordx4 v[224:227], v16, s[12:15], s38 offen offset:64
    buffer_load_dwordx4 v[228:231], v16, s[12:15], s38 offen offset:128
    buffer_load_dwordx4 v[232:235], v16, s[12:15], s38 offen offset:192
    s_waitcnt vmcnt(8)
    v_lshlrev_b32 v236, 16, v188
    v_and_b32 v237, 0xffff0000, v188
    v_lshlrev_b32 v238, 16, v189
    v_and_b32 v239, 0xffff0000, v189
    v_pk_mul_f32 v[236:237], v[236:237], s[36:37]
    v_pk_mul_f32 v[238:239], v[238:239], s[36:37]
    v_cvt_pk_bf16_f32 v188, v236, v237
    v_cvt_pk_bf16_f32 v189, v238, v239
    v_lshlrev_b32 v240, 16, v190
    v_and_b32 v241, 0xffff0000, v190
    v_lshlrev_b32 v242, 16, v191
    v_and_b32 v243, 0xffff0000, v191
    v_pk_mul_f32 v[240:241], v[240:241], s[36:37]
    v_pk_mul_f32 v[242:243], v[242:243], s[36:37]
    v_cvt_pk_bf16_f32 v190, v240, v241
    v_cvt_pk_bf16_f32 v191, v242, v243
    v_lshlrev_b32 v236, 16, v192
    v_and_b32 v237, 0xffff0000, v192
    v_lshlrev_b32 v238, 16, v193
    v_and_b32 v239, 0xffff0000, v193
    v_pk_mul_f32 v[236:237], v[236:237], s[36:37]
    v_pk_mul_f32 v[238:239], v[238:239], s[36:37]
    v_cvt_pk_bf16_f32 v192, v236, v237
    v_cvt_pk_bf16_f32 v193, v238, v239
    v_lshlrev_b32 v240, 16, v194
    v_and_b32 v241, 0xffff0000, v194
    v_lshlrev_b32 v242, 16, v195
    v_and_b32 v243, 0xffff0000, v195
    v_pk_mul_f32 v[240:241], v[240:241], s[36:37]
    v_pk_mul_f32 v[242:243], v[242:243], s[36:37]
    v_cvt_pk_bf16_f32 v194, v240, v241
    v_cvt_pk_bf16_f32 v195, v242, v243
    v_lshlrev_b32 v236, 16, v196
    v_and_b32 v237, 0xffff0000, v196
    v_lshlrev_b32 v238, 16, v197
    v_and_b32 v239, 0xffff0000, v197
    v_pk_mul_f32 v[236:237], v[236:237], s[36:37]
    v_pk_mul_f32 v[238:239], v[238:239], s[36:37]
    v_cvt_pk_bf16_f32 v196, v236, v237
    v_cvt_pk_bf16_f32 v197, v238, v239
    v_lshlrev_b32 v240, 16, v198
    v_and_b32 v241, 0xffff0000, v198
    v_lshlrev_b32 v242, 16, v199
    v_and_b32 v243, 0xffff0000, v199
    v_pk_mul_f32 v[240:241], v[240:241], s[36:37]
    v_pk_mul_f32 v[242:243], v[242:243], s[36:37]
    v_cvt_pk_bf16_f32 v198, v240, v241
    v_cvt_pk_bf16_f32 v199, v242, v243
    v_lshlrev_b32 v236, 16, v200
    v_and_b32 v237, 0xffff0000, v200
    v_lshlrev_b32 v238, 16, v201
    v_and_b32 v239, 0xffff0000, v201
    v_pk_mul_f32 v[236:237], v[236:237], s[36:37]
    v_pk_mul_f32 v[238:239], v[238:239], s[36:37]
    v_cvt_pk_bf16_f32 v200, v236, v237
    v_cvt_pk_bf16_f32 v201, v238, v239
    v_lshlrev_b32 v240, 16, v202
    v_and_b32 v241, 0xffff0000, v202
    v_lshlrev_b32 v242, 16, v203
    v_and_b32 v243, 0xffff0000, v203
    v_pk_mul_f32 v[240:241], v[240:241], s[36:37]
    v_pk_mul_f32 v[242:243], v[242:243], s[36:37]
    v_cvt_pk_bf16_f32 v202, v240, v241
    v_cvt_pk_bf16_f32 v203, v242, v243
    v_accvgpr_write_b32 a192, v188
    v_accvgpr_write_b32 a193, v189
    v_accvgpr_write_b32 a194, v190
    v_accvgpr_write_b32 a195, v191
    v_accvgpr_write_b32 a196, v192
    v_accvgpr_write_b32 a197, v193
    v_accvgpr_write_b32 a198, v194
    v_accvgpr_write_b32 a199, v195
    v_accvgpr_write_b32 a200, v196
    v_accvgpr_write_b32 a201, v197
    v_accvgpr_write_b32 a202, v198
    v_accvgpr_write_b32 a203, v199
    v_accvgpr_write_b32 a204, v200
    v_accvgpr_write_b32 a205, v201
    v_accvgpr_write_b32 a206, v202
    v_accvgpr_write_b32 a207, v203
    s_nop 1
    v_mfma_f32_16x16x32_bf16 v[92:95], v[44:47], a[192:195], 0
    v_mfma_f32_16x16x32_bf16 v[96:99], v[60:63], a[192:195], 0
    v_mfma_f32_16x16x32_bf16 v[92:95], v[48:51], a[196:199], v[92:95]
    v_mfma_f32_16x16x32_bf16 v[96:99], v[64:67], a[196:199], v[96:99]
    v_mfma_f32_16x16x32_bf16 v[92:95], v[52:55], a[200:203], v[92:95]
    v_mfma_f32_16x16x32_bf16 v[96:99], v[68:71], a[200:203], v[96:99]
    v_mfma_f32_16x16x32_bf16 v[92:95], v[56:59], a[204:207], v[92:95]
    v_mfma_f32_16x16x32_bf16 v[96:99], v[72:75], a[204:207], v[96:99]
    s_nop 7
    v_max3_f32 v244, v92, v93, v94
    v_max3_f32 v245, v95, v96, v97
    v_max3_f32 v244, v244, v98, v99
    v_max_f32 v244, v244, v245
    v_mov_b32 v245, v244
    s_nop 1
    v_permlane16_swap_b32 v244, v245
    v_max_f32 v244, v244, v245
    v_mov_b32 v245, v244
    s_nop 1
    v_permlane32_swap_b32 v244, v245
    v_max_f32 v244, v244, v245
    v_sub_f32 v32, 0, v244
    v_sub_f32 v33, 0, v244
    v_sub_f32 v34, 0, v244
    v_sub_f32 v35, 0, v244
    s_nop 1
    v_mfma_f32_16x16x32_bf16 v[132:135], a[0:3], a[192:195], v[32:35]
    v_sub_f32 v92, v92, v244
    v_sub_f32 v93, v93, v244
    v_mfma_f32_16x16x32_bf16 v[136:139], a[16:19], a[192:195], v[32:35]
    v_sub_f32 v94, v94, v244
    v_sub_f32 v95, v95, v244
    v_sub_f32 v96, v96, v244
    v_mfma_f32_16x16x32_bf16 v[132:135], a[4:7], a[196:199], v[132:135]
    v_sub_f32 v97, v97, v244
    v_sub_f32 v98, v98, v244
    v_mfma_f32_16x16x32_bf16 v[136:139], a[20:23], a[196:199], v[136:139]
    v_sub_f32 v99, v99, v244
    v_exp_f32 v92, v92
    v_exp_f32 v93, v93
    v_mfma_f32_16x16x32_bf16 v[132:135], a[8:11], a[200:203], v[132:135]
    v_exp_f32 v94, v94
    v_exp_f32 v95, v95
    v_mfma_f32_16x16x32_bf16 v[136:139], a[24:27], a[200:203], v[136:139]
    v_exp_f32 v96, v96
    v_cvt_pk_bf16_f32 v92, v92, v93
    v_cvt_pk_bf16_f32 v93, v94, v95
    v_mfma_f32_16x16x32_bf16 v[132:135], a[12:15], a[204:207], v[132:135]
    v_exp_f32 v97, v97
    v_exp_f32 v98, v98
    v_mfma_f32_16x16x32_bf16 v[136:139], a[28:31], a[204:207], v[136:139]
    v_exp_f32 v99, v99
    v_cvt_pk_bf16_f32 v94, v96, v97
    v_cvt_pk_bf16_f32 v95, v98, v99
    s_add_u32 m0, s34, 16384
    s_nop 0
    buffer_load_dwordx4 v1, s[16:19], s33 offen lds
    buffer_load_dwordx4 v2, s[16:19], s33 offen offset:1024 lds
    s_add_u32 m0, s34, 81920
    s_nop 0
    buffer_load_dwordx4 v1, s[20:23], s33 offen lds
    buffer_load_dwordx4 v2, s[20:23], s33 offen offset:1024 lds
    s_add_u32 s33, s33, 8192
    s_waitcnt vmcnt(8)
    v_lshlrev_b32 v236, 16, v204
    v_and_b32 v237, 0xffff0000, v204
    v_lshlrev_b32 v238, 16, v205
    v_and_b32 v239, 0xffff0000, v205
    v_pk_mul_f32 v[236:237], v[236:237], s[36:37]
    v_pk_mul_f32 v[238:239], v[238:239], s[36:37]
    v_cvt_pk_bf16_f32 v204, v236, v237
    v_cvt_pk_bf16_f32 v205, v238, v239
    v_lshlrev_b32 v240, 16, v206
    v_and_b32 v241, 0xffff0000, v206
    v_lshlrev_b32 v242, 16, v207
    v_and_b32 v243, 0xffff0000, v207
    v_pk_mul_f32 v[240:241], v[240:241], s[36:37]
    v_pk_mul_f32 v[242:243], v[242:243], s[36:37]
    v_cvt_pk_bf16_f32 v206, v240, v241
    v_cvt_pk_bf16_f32 v207, v242, v243
    v_lshlrev_b32 v236, 16, v208
    v_and_b32 v237, 0xffff0000, v208
    v_lshlrev_b32 v238, 16, v209
    v_and_b32 v239, 0xffff0000, v209
    v_pk_mul_f32 v[236:237], v[236:237], s[36:37]
    v_pk_mul_f32 v[238:239], v[238:239], s[36:37]
    v_cvt_pk_bf16_f32 v208, v236, v237
    v_cvt_pk_bf16_f32 v209, v238, v239
    v_lshlrev_b32 v240, 16, v210
    v_and_b32 v241, 0xffff0000, v210
    v_lshlrev_b32 v242, 16, v211
    v_and_b32 v243, 0xffff0000, v211
    v_pk_mul_f32 v[240:241], v[240:241], s[36:37]
    v_pk_mul_f32 v[242:243], v[242:243], s[36:37]
    v_cvt_pk_bf16_f32 v210, v240, v241
    v_cvt_pk_bf16_f32 v211, v242, v243
    v_lshlrev_b32 v236, 16, v212
    v_and_b32 v237, 0xffff0000, v212
    v_lshlrev_b32 v238, 16, v213
    v_and_b32 v239, 0xffff0000, v213
    v_pk_mul_f32 v[236:237], v[236:237], s[36:37]
    v_pk_mul_f32 v[238:239], v[238:239], s[36:37]
    v_cvt_pk_bf16_f32 v212, v236, v237
    v_cvt_pk_bf16_f32 v213, v238, v239
    v_lshlrev_b32 v240, 16, v214
    v_and_b32 v241, 0xffff0000, v214
    v_lshlrev_b32 v242, 16, v215
    v_and_b32 v243, 0xffff0000, v215
    v_pk_mul_f32 v[240:241], v[240:241], s[36:37]
    v_pk_mul_f32 v[242:243], v[242:243], s[36:37]
    v_cvt_pk_bf16_f32 v214, v240, v241
    v_cvt_pk_bf16_f32 v215, v242, v243
    v_lshlrev_b32 v236, 16, v216
    v_and_b32 v237, 0xffff0000, v216
    v_lshlrev_b32 v238, 16, v217
    v_and_b32 v239, 0xffff0000, v217
    v_pk_mul_f32 v[236:237], v[236:237], s[36:37]
    v_pk_mul_f32 v[238:239], v[238:239], s[36:37]
    v_cvt_pk_bf16_f32 v216, v236, v237
    v_cvt_pk_bf16_f32 v217, v238, v239
    v_lshlrev_b32 v240, 16, v218
    v_and_b32 v241, 0xffff0000, v218
    v_lshlrev_b32 v242, 16, v219
    v_and_b32 v243, 0xffff0000, v219
    v_pk_mul_f32 v[240:241], v[240:241], s[36:37]
    v_pk_mul_f32 v[242:243], v[242:243], s[36:37]
    v_cvt_pk_bf16_f32 v218, v240, v241
    v_cvt_pk_bf16_f32 v219, v242, v243
    v_accvgpr_write_b32 a208, v204
    v_accvgpr_write_b32 a209, v205
    v_accvgpr_write_b32 a210, v206
    v_accvgpr_write_b32 a211, v207
    v_accvgpr_write_b32 a212, v208
    v_accvgpr_write_b32 a213, v209
    v_accvgpr_write_b32 a214, v210
    v_accvgpr_write_b32 a215, v211
    v_accvgpr_write_b32 a216, v212
    v_accvgpr_write_b32 a217, v213
    v_accvgpr_write_b32 a218, v214
    v_accvgpr_write_b32 a219, v215
    v_accvgpr_write_b32 a220, v216
    v_accvgpr_write_b32 a221, v217
    v_accvgpr_write_b32 a222, v218
    v_accvgpr_write_b32 a223, v219
    s_nop 1
    v_mfma_f32_16x16x32_bf16 v[100:103], v[44:47], a[208:211], 0
    v_mfma_f32_16x16x32_bf16 v[104:107], v[60:63], a[208:211], 0
    v_mfma_f32_16x16x32_bf16 v[100:103], v[48:51], a[212:215], v[100:103]
    v_mfma_f32_16x16x32_bf16 v[104:107], v[64:67], a[212:215], v[104:107]
    v_mfma_f32_16x16x32_bf16 v[100:103], v[52:55], a[216:219], v[100:103]
    v_mfma_f32_16x16x32_bf16 v[104:107], v[68:71], a[216:219], v[104:107]
    v_mfma_f32_16x16x32_bf16 v[100:103], v[56:59], a[220:223], v[100:103]
    v_mfma_f32_16x16x32_bf16 v[104:107], v[72:75], a[220:223], v[104:107]
    s_nop 7
    v_max3_f32 v244, v100, v101, v102
    v_max3_f32 v245, v103, v104, v105
    v_max3_f32 v244, v244, v106, v107
    v_max_f32 v244, v244, v245
    v_mov_b32 v245, v244
    s_nop 1
    v_permlane16_swap_b32 v244, v245
    v_max_f32 v244, v244, v245
    v_mov_b32 v245, v244
    s_nop 1
    v_permlane32_swap_b32 v244, v245
    v_max_f32 v244, v244, v245
    v_sub_f32 v36, 0, v244
    v_sub_f32 v37, 0, v244
    v_sub_f32 v38, 0, v244
    v_sub_f32 v39, 0, v244
    s_nop 1
    v_mfma_f32_16x16x32_bf16 v[140:143], a[0:3], a[208:211], v[36:39]
    v_sub_f32 v100, v100, v244
    v_sub_f32 v101, v101, v244
    v_mfma_f32_16x16x32_bf16 v[144:147], a[16:19], a[208:211], v[36:39]
    v_sub_f32 v102, v102, v244
    v_sub_f32 v103, v103, v244
    v_sub_f32 v104, v104, v244
    v_mfma_f32_16x16x32_bf16 v[140:143], a[4:7], a[212:215], v[140:143]
    v_sub_f32 v105, v105, v244
    v_sub_f32 v106, v106, v244
    v_mfma_f32_16x16x32_bf16 v[144:147], a[20:23], a[212:215], v[144:147]
    v_sub_f32 v107, v107, v244
    v_exp_f32 v100, v100
    v_exp_f32 v101, v101
    v_mfma_f32_16x16x32_bf16 v[140:143], a[8:11], a[216:219], v[140:143]
    v_exp_f32 v102, v102
    v_exp_f32 v103, v103
    v_mfma_f32_16x16x32_bf16 v[144:147], a[24:27], a[216:219], v[144:147]
    v_exp_f32 v104, v104
    v_cvt_pk_bf16_f32 v100, v100, v101
    v_cvt_pk_bf16_f32 v101, v102, v103
    v_mfma_f32_16x16x32_bf16 v[140:143], a[12:15], a[220:223], v[140:143]
    v_exp_f32 v105, v105
    v_exp_f32 v106, v106
    v_mfma_f32_16x16x32_bf16 v[144:147], a[28:31], a[220:223], v[144:147]
    v_exp_f32 v107, v107
    v_cvt_pk_bf16_f32 v102, v104, v105
    v_cvt_pk_bf16_f32 v103, v106, v107
    s_add_u32 m0, s34, 24576
    s_nop 0
    buffer_load_dwordx4 v1, s[16:19], s33 offen lds
    buffer_load_dwordx4 v2, s[16:19], s33 offen offset:1024 lds
    s_add_u32 m0, s34, 90112
    s_nop 0
    buffer_load_dwordx4 v1, s[20:23], s33 offen lds
    buffer_load_dwordx4 v2, s[20:23], s33 offen offset:1024 lds
    s_add_u32 s33, s33, 8192
    s_waitcnt vmcnt(8)
    v_lshlrev_b32 v236, 16, v220
    v_and_b32 v237, 0xffff0000, v220
    v_lshlrev_b32 v238, 16, v221
    v_and_b32 v239, 0xffff0000, v221
    v_pk_mul_f32 v[236:237], v[236:237], s[36:37]
    v_pk_mul_f32 v[238:239], v[238:239], s[36:37]
    v_cvt_pk_bf16_f32 v220, v236, v237
    v_cvt_pk_bf16_f32 v221, v238, v239
    v_lshlrev_b32 v240, 16, v222
    v_and_b32 v241, 0xffff0000, v222
    v_lshlrev_b32 v242, 16, v223
    v_and_b32 v243, 0xffff0000, v223
    v_pk_mul_f32 v[240:241], v[240:241], s[36:37]
    v_pk_mul_f32 v[242:243], v[242:243], s[36:37]
    v_cvt_pk_bf16_f32 v222, v240, v241
    v_cvt_pk_bf16_f32 v223, v242, v243
    v_lshlrev_b32 v236, 16, v224
    v_and_b32 v237, 0xffff0000, v224
    v_lshlrev_b32 v238, 16, v225
    v_and_b32 v239, 0xffff0000, v225
    v_pk_mul_f32 v[236:237], v[236:237], s[36:37]
    v_pk_mul_f32 v[238:239], v[238:239], s[36:37]
    v_cvt_pk_bf16_f32 v224, v236, v237
    v_cvt_pk_bf16_f32 v225, v238, v239
    v_lshlrev_b32 v240, 16, v226
    v_and_b32 v241, 0xffff0000, v226
    v_lshlrev_b32 v242, 16, v227
    v_and_b32 v243, 0xffff0000, v227
    v_pk_mul_f32 v[240:241], v[240:241], s[36:37]
    v_pk_mul_f32 v[242:243], v[242:243], s[36:37]
    v_cvt_pk_bf16_f32 v226, v240, v241
    v_cvt_pk_bf16_f32 v227, v242, v243
    v_lshlrev_b32 v236, 16, v228
    v_and_b32 v237, 0xffff0000, v228
    v_lshlrev_b32 v238, 16, v229
    v_and_b32 v239, 0xffff0000, v229
    v_pk_mul_f32 v[236:237], v[236:237], s[36:37]
    v_pk_mul_f32 v[238:239], v[238:239], s[36:37]
    v_cvt_pk_bf16_f32 v228, v236, v237
    v_cvt_pk_bf16_f32 v229, v238, v239
    v_lshlrev_b32 v240, 16, v230
    v_and_b32 v241, 0xffff0000, v230
    v_lshlrev_b32 v242, 16, v231
    v_and_b32 v243, 0xffff0000, v231
    v_pk_mul_f32 v[240:241], v[240:241], s[36:37]
    v_pk_mul_f32 v[242:243], v[242:243], s[36:37]
    v_cvt_pk_bf16_f32 v230, v240, v241
    v_cvt_pk_bf16_f32 v231, v242, v243
    v_lshlrev_b32 v236, 16, v232
    v_and_b32 v237, 0xffff0000, v232
    v_lshlrev_b32 v238, 16, v233
    v_and_b32 v239, 0xffff0000, v233
    v_pk_mul_f32 v[236:237], v[236:237], s[36:37]
    v_pk_mul_f32 v[238:239], v[238:239], s[36:37]
    v_cvt_pk_bf16_f32 v232, v236, v237
    v_cvt_pk_bf16_f32 v233, v238, v239
    v_lshlrev_b32 v240, 16, v234
    v_and_b32 v241, 0xffff0000, v234
    v_lshlrev_b32 v242, 16, v235
    v_and_b32 v243, 0xffff0000, v235
    v_pk_mul_f32 v[240:241], v[240:241], s[36:37]
    v_pk_mul_f32 v[242:243], v[242:243], s[36:37]
    v_cvt_pk_bf16_f32 v234, v240, v241
    v_cvt_pk_bf16_f32 v235, v242, v243
    v_accvgpr_write_b32 a224, v220
    v_accvgpr_write_b32 a225, v221
    v_accvgpr_write_b32 a226, v222
    v_accvgpr_write_b32 a227, v223
    v_accvgpr_write_b32 a228, v224
    v_accvgpr_write_b32 a229, v225
    v_accvgpr_write_b32 a230, v226
    v_accvgpr_write_b32 a231, v227
    v_accvgpr_write_b32 a232, v228
    v_accvgpr_write_b32 a233, v229
    v_accvgpr_write_b32 a234, v230
    v_accvgpr_write_b32 a235, v231
    v_accvgpr_write_b32 a236, v232
    v_accvgpr_write_b32 a237, v233
    v_accvgpr_write_b32 a238, v234
    v_accvgpr_write_b32 a239, v235
    s_nop 1
    v_mfma_f32_16x16x32_bf16 v[108:111], v[44:47], a[224:227], 0
    v_mfma_f32_16x16x32_bf16 v[112:115], v[60:63], a[224:227], 0
    v_mfma_f32_16x16x32_bf16 v[108:111], v[48:51], a[228:231], v[108:111]
    v_mfma_f32_16x16x32_bf16 v[112:115], v[64:67], a[228:231], v[112:115]
    v_mfma_f32_16x16x32_bf16 v[108:111], v[52:55], a[232:235], v[108:111]
    v_mfma_f32_16x16x32_bf16 v[112:115], v[68:71], a[232:235], v[112:115]
    v_mfma_f32_16x16x32_bf16 v[108:111], v[56:59], a[236:239], v[108:111]
    v_mfma_f32_16x16x32_bf16 v[112:115], v[72:75], a[236:239], v[112:115]
    s_nop 7
    v_max3_f32 v244, v108, v109, v110
    v_max3_f32 v245, v111, v112, v113
    v_max3_f32 v244, v244, v114, v115
    v_max_f32 v244, v244, v245
    v_mov_b32 v245, v244
    s_nop 1
    v_permlane16_swap_b32 v244, v245
    v_max_f32 v244, v244, v245
    v_mov_b32 v245, v244
    s_nop 1
    v_permlane32_swap_b32 v244, v245
    v_max_f32 v244, v244, v245
    v_sub_f32 v40, 0, v244
    v_sub_f32 v41, 0, v244
    v_sub_f32 v42, 0, v244
    v_sub_f32 v43, 0, v244
    s_nop 1
    v_mfma_f32_16x16x32_bf16 v[148:151], a[0:3], a[224:227], v[40:43]
    v_sub_f32 v108, v108, v244
    v_sub_f32 v109, v109, v244
    v_mfma_f32_16x16x32_bf16 v[152:155], a[16:19], a[224:227], v[40:43]
    v_sub_f32 v110, v110, v244
    v_sub_f32 v111, v111, v244
    v_sub_f32 v112, v112, v244
    v_mfma_f32_16x16x32_bf16 v[148:151], a[4:7], a[228:231], v[148:151]
    v_sub_f32 v113, v113, v244
    v_sub_f32 v114, v114, v244
    v_mfma_f32_16x16x32_bf16 v[152:155], a[20:23], a[228:231], v[152:155]
    v_sub_f32 v115, v115, v244
    v_exp_f32 v108, v108
    v_exp_f32 v109, v109
    v_mfma_f32_16x16x32_bf16 v[148:151], a[8:11], a[232:235], v[148:151]
    v_exp_f32 v110, v110
    v_exp_f32 v111, v111
    v_mfma_f32_16x16x32_bf16 v[152:155], a[24:27], a[232:235], v[152:155]
    v_exp_f32 v112, v112
    v_cvt_pk_bf16_f32 v108, v108, v109
    v_cvt_pk_bf16_f32 v109, v110, v111
    v_mfma_f32_16x16x32_bf16 v[148:151], a[12:15], a[236:239], v[148:151]
    v_exp_f32 v113, v113
    v_exp_f32 v114, v114
    v_mfma_f32_16x16x32_bf16 v[152:155], a[28:31], a[236:239], v[152:155]
    v_exp_f32 v115, v115
    v_cvt_pk_bf16_f32 v110, v112, v113
    v_cvt_pk_bf16_f32 v111, v114, v115
    s_add_u32 m0, s34, 32768
    s_nop 0
    buffer_load_dwordx4 v1, s[16:19], s33 offen lds
    buffer_load_dwordx4 v2, s[16:19], s33 offen offset:1024 lds
    s_add_u32 m0, s34, 98304
    s_nop 0
    buffer_load_dwordx4 v1, s[20:23], s33 offen lds
    buffer_load_dwordx4 v2, s[20:23], s33 offen offset:1024 lds
    s_add_u32 s33, s33, 8192
    s_add_u32 m0, s34, 40960
    s_nop 0
    buffer_load_dwordx4 v1, s[16:19], s33 offen lds
    buffer_load_dwordx4 v2, s[16:19], s33 offen offset:1024 lds
    s_add_u32 m0, s34, 106496
    s_nop 0
    buffer_load_dwordx4 v1, s[20:23], s33 offen lds
    buffer_load_dwordx4 v2, s[20:23], s33 offen offset:1024 lds
    s_add_u32 s33, s33, 8192
    v_mfma_f32_32x32x16_bf16 a[0:15], v[252:255], v[252:255], 0
    v_mfma_f32_32x32x16_bf16 a[16:31], v[252:255], v[252:255], 0
    v_mfma_f32_32x32x16_bf16 a[32:47], v[252:255], v[252:255], 0
    v_mfma_f32_32x32x16_bf16 a[48:63], v[252:255], v[252:255], 0
    v_mfma_f32_32x32x16_bf16 a[64:79], v[252:255], v[252:255], 0
    v_mfma_f32_32x32x16_bf16 a[80:95], v[252:255], v[252:255], 0
    v_mfma_f32_32x32x16_bf16 a[96:111], v[252:255], v[252:255], 0
    v_mfma_f32_32x32x16_bf16 a[112:127], v[252:255], v[252:255], 0
    v_mfma_f32_32x32x16_bf16 a[128:143], v[252:255], v[252:255], 0
    v_mfma_f32_32x32x16_bf16 a[144:159], v[252:255], v[252:255], 0
    v_mfma_f32_32x32x16_bf16 a[240:255], v[252:255], v[252:255], 0
    v_mov_b32 v20, 0
    v_mov_b32 v21, 0
    v_mov_b32 v22, 0
    v_mov_b32 v23, 0
    s_waitcnt vmcnt(12)
    s_barrier
    ds_read_b64_tr_b16 v[44:45], v8 offset:0
    ds_read_b64_tr_b16 v[46:47], v8 offset:4096
    ds_read_b64_tr_b16 v[48:49], v9 offset:0
    ds_read_b64_tr_b16 v[50:51], v9 offset:4096
L_c5_go:
    s_mov_b32 s35, 0
    s_lshl_b32 s50, s46, 4
L_c5_loop:
    s_waitcnt lgkmcnt(2)
    v_mfma_f32_16x16x32_bf16 a[0:3], v[44:47], v[76:79], a[0:3]
    ds_read_b64_tr_b16 v[52:53], v10 offset:0
    ds_read_b64_tr_b16 v[54:55], v10 offset:4096
    v_mfma_f32_16x16x32_bf16 a[32:35], v[44:47], v[84:87], a[32:35]
    v_mfma_f32_16x16x32_bf16 a[64:67], v[44:47], v[92:95], a[64:67]
    v_exp_f32 v116, v116
    v_mfma_f32_16x16x32_bf16 a[96:99], v[44:47], v[100:103], a[96:99]
    v_exp_f32 v117, v117
    v_mfma_f32_16x16x32_bf16 a[128:131], v[44:47], v[108:111], a[128:131]
    v_exp_f32 v118, v118
    s_waitcnt lgkmcnt(2)
    v_mfma_f32_16x16x32_bf16 a[4:7], v[48:51], v[76:79], a[4:7]
    ds_read_b64_tr_b16 v[56:57], v11 offset:0
    ds_read_b64_tr_b16 v[58:59], v11 offset:4096
    v_mfma_f32_16x16x32_bf16 a[36:39], v[48:51], v[84:87], a[36:39]
    v_exp_f32 v119, v119
    v_mfma_f32_16x16x32_bf16 a[68:71], v[48:51], v[92:95], a[68:71]
    v_mfma_f32_16x16x32_bf16 a[100:103], v[48:51], v[100:103], a[100:103]
    v_exp_f32 v120, v120
    v_mfma_f32_16x16x32_bf16 a[132:135], v[48:51], v[108:111], a[132:135]
    v_cvt_pk_bf16_f32 v116, v116, v117
    v_cvt_pk_bf16_f32 v117, v118, v119
    s_waitcnt lgkmcnt(2)
    v_mfma_f32_16x16x32_bf16 a[8:11], v[52:55], v[76:79], a[8:11]
    ds_read_b64_tr_b16 v[60:61], v12 offset:0
    ds_read_b64_tr_b16 v[62:63], v12 offset:4096
    v_mfma_f32_16x16x32_bf16 a[40:43], v[52:55], v[84:87], a[40:43]
    v_exp_f32 v121, v121
    v_mfma_f32_16x16x32_bf16 a[72:75], v[52:55], v[92:95], a[72:75]
    v_mfma_f32_16x16x32_bf16 a[104:107], v[52:55], v[100:103], a[104:107]
    v_exp_f32 v122, v122
    v_mfma_f32_16x16x32_bf16 a[136:139], v[52:55], v[108:111], a[136:139]
    v_exp_f32 v123, v123
    s_waitcnt lgkmcnt(2)
    v_mfma_f32_16x16x32_bf16 a[12:15], v[56:59], v[76:79], a[12:15]
    ds_read_b64_tr_b16 v[64:65], v13 offset:0
    ds_read_b64_tr_b16 v[66:67], v13 offset:4096
    v_mfma_f32_16x16x32_bf16 a[44:47], v[56:59], v[84:87], a[44:47]
    v_cvt_pk_bf16_f32 v118, v120, v121
    v_cvt_pk_bf16_f32 v119, v122, v123
    v_mfma_f32_16x16x32_bf16 a[76:79], v[56:59], v[92:95], a[76:79]
    v_mfma_f32_16x16x32_bf16 a[108:111], v[56:59], v[100:103], a[108:111]
    v_exp_f32 v124, v124
    v_mfma_f32_16x16x32_bf16 a[140:143], v[56:59], v[108:111], a[140:143]
    v_exp_f32 v125, v125
    s_waitcnt lgkmcnt(2)
    v_mfma_f32_16x16x32_bf16 a[16:19], v[60:63], v[76:79], a[16:19]
    ds_read_b64_tr_b16 v[68:69], v14 offset:0
    ds_read_b64_tr_b16 v[70:71], v14 offset:4096
    v_mfma_f32_16x16x32_bf16 a[48:51], v[60:63], v[84:87], a[48:51]
    v_exp_f32 v126, v126
    v_mfma_f32_16x16x32_bf16 a[80:83], v[60:63], v[92:95], a[80:83]
    v_mfma_f32_16x16x32_bf16 a[112:115], v[60:63], v[100:103], a[112:115]
    v_exp_f32 v127, v127
    v_mfma_f32_16x16x32_bf16 a[144:147], v[60:63], v[108:111], a[144:147]
    v_exp_f32 v128, v128
    s_waitcnt lgkmcnt(2)
    v_mfma_f32_16x16x32_bf16 a[20:23], v[64:67], v[76:79], a[20:23]
    ds_read_b64_tr_b16 v[72:73], v15 offset:0
    ds_read_b64_tr_b16 v[74:75], v15 offset:4096
    v_mfma_f32_16x16x32_bf16 a[52:55], v[64:67], v[84:87], a[52:55]
    v_cvt_pk_bf16_f32 v124, v124, v125
    v_cvt_pk_bf16_f32 v125, v126, v127
    v_mfma_f32_16x16x32_bf16 a[84:87], v[64:67], v[92:95], a[84:87]
    v_mfma_f32_16x16x32_bf16 a[116:119], v[64:67], v[100:103], a[116:119]
    v_exp_f32 v129, v129
    v_mfma_f32_16x16x32_bf16 a[148:151], v[64:67], v[108:111], a[148:151]
    v_exp_f32 v130, v130
    s_waitcnt lgkmcnt(2)
    v_mfma_f32_16x16x32_bf16 a[24:27], v[68:71], v[76:79], a[24:27]
    ds_read_b128 v[44:47], v4 offset:16384
    ds_read_b128 v[48:51], v5 offset:16384
    v_mfma_f32_16x16x32_bf16 a[56:59], v[68:71], v[84:87], a[56:59]
    v_exp_f32 v131, v131
    v_mfma_f32_16x16x32_bf16 a[88:91], v[68:71], v[92:95], a[88:91]
    v_mfma_f32_16x16x32_bf16 a[120:123], v[68:71], v[100:103], a[120:123]
    v_cvt_pk_bf16_f32 v126, v128, v129
    v_cvt_pk_bf16_f32 v127, v130, v131
    v_mfma_f32_16x16x32_bf16 a[152:155], v[68:71], v[108:111], a[152:155]
    v_exp_f32 v132, v132
    s_waitcnt lgkmcnt(2)
    v_mfma_f32_16x16x32_bf16 a[28:31], v[72:75], v[76:79], a[28:31]
    v_exp_f32 v133, v133
    v_mfma_f32_16x16x32_bf16 a[60:63], v[72:75], v[84:87], a[60:63]
    v_mfma_f32_16x16x32_bf16 a[92:95], v[72:75], v[92:95], a[92:95]
    v_exp_f32 v134, v134
    v_mfma_f32_16x16x32_bf16 a[124:127], v[72:75], v[100:103], a[124:127]
    v_exp_f32 v135, v135
    v_mfma_f32_16x16x32_bf16 a[156:159], v[72:75], v[108:111], a[156:159]
    v_exp_f32 v136, v136
    v_mfma_f32_16x16x32_bf16 a[240:243], v[248:251], v[76:79], a[240:243]
    v_mfma_f32_16x16x32_bf16 a[244:247], v[248:251], v[84:87], a[244:247]
    v_cvt_pk_bf16_f32 v132, v132, v133
    v_cvt_pk_bf16_f32 v133, v134, v135
    s_waitcnt vmcnt(8)
    s_barrier
    v_mfma_f32_16x16x32_bf16 a[248:251], v[248:251], v[92:95], a[248:251]
    s_add_u32 m0, s34, 49152
    s_nop 0
    buffer_load_dwordx4 v1, s[16:19], s33 offen lds
    v_mfma_f32_16x16x32_bf16 a[252:255], v[248:251], v[100:103], a[252:255]
    buffer_load_dwordx4 v2, s[16:19], s33 offen offset:1024 lds
    v_mfma_f32_16x16x32_bf16 v[20:23], v[248:251], v[108:111], v[20:23]
    s_add_u32 m0, s34, 114688
    s_nop 0
    buffer_load_dwordx4 v1, s[20:23], s33 offen lds
    s_waitcnt lgkmcnt(1)
    v_mfma_f32_16x16x32_bf16 v[76:79], v[44:47], a[160:163], v[24:27]
    ds_read_b128 v[52:55], v6 offset:16384
    ds_read_b128 v[56:59], v7 offset:16384
    v_mfma_f32_16x16x32_bf16 v[84:87], v[44:47], a[176:179], v[28:31]
    buffer_load_dwordx4 v2, s[20:23], s33 offen offset:1024 lds
    s_add_u32 s33, s33, 8192
    v_mfma_f32_16x16x32_bf16 v[92:95], v[44:47], a[192:195], v[32:35]
    s_cmp_eq_u32 s50, 1
    s_cbranch_scc1 L_c5_q0a
    s_cmp_eq_u32 s50, 2
    s_cbranch_scc0 L_c5_q0e
    s_add_u32 s38, s44, 8192
    buffer_load_dwordx4 v[188:191], v16, s[12:15], s38 offen offset:0
    s_branch L_c5_q0e
L_c5_q0a:
    s_add_u32 s38, s44, 0
    buffer_load_dwordx4 v[156:159], v16, s[12:15], s38 offen offset:0
L_c5_q0e:
    v_mfma_f32_16x16x32_bf16 v[100:103], v[44:47], a[208:211], v[36:39]
    v_exp_f32 v137, v137
    v_mfma_f32_16x16x32_bf16 v[108:111], v[44:47], a[224:227], v[40:43]
    v_exp_f32 v138, v138
    s_waitcnt lgkmcnt(2)
    v_mfma_f32_16x16x32_bf16 v[76:79], v[48:51], a[164:167], v[76:79]
    v_exp_f32 v139, v139
    v_mfma_f32_16x16x32_bf16 v[84:87], v[48:51], a[180:183], v[84:87]
    v_mfma_f32_16x16x32_bf16 v[92:95], v[48:51], a[196:199], v[92:95]
    v_cvt_pk_bf16_f32 v134, v136, v137
    v_cvt_pk_bf16_f32 v135, v138, v139
    v_mfma_f32_16x16x32_bf16 v[100:103], v[48:51], a[212:215], v[100:103]
    v_exp_f32 v140, v140
    v_mfma_f32_16x16x32_bf16 v[108:111], v[48:51], a[228:231], v[108:111]
    v_exp_f32 v141, v141
    s_waitcnt lgkmcnt(1)
    v_mfma_f32_16x16x32_bf16 v[76:79], v[52:55], a[168:171], v[76:79]
    ds_read_b128 v[60:63], v4 offset:20480
    ds_read_b128 v[64:67], v5 offset:20480
    v_mfma_f32_16x16x32_bf16 v[84:87], v[52:55], a[184:187], v[84:87]
    v_mfma_f32_16x16x32_bf16 v[92:95], v[52:55], a[200:203], v[92:95]
    v_exp_f32 v142, v142
    v_mfma_f32_16x16x32_bf16 v[100:103], v[52:55], a[216:219], v[100:103]
    v_exp_f32 v143, v143
    v_mfma_f32_16x16x32_bf16 v[108:111], v[52:55], a[232:235], v[108:111]
    v_exp_f32 v144, v144
    s_waitcnt lgkmcnt(2)
    v_mfma_f32_16x16x32_bf16 v[76:79], v[56:59], a[172:175], v[76:79]
    v_mfma_f32_16x16x32_bf16 v[84:87], v[56:59], a[188:191], v[84:87]
    v_cvt_pk_bf16_f32 v140, v140, v141
    v_cvt_pk_bf16_f32 v141, v142, v143
    v_mfma_f32_16x16x32_bf16 v[92:95], v[56:59], a[204:207], v[92:95]
    v_exp_f32 v145, v145
    v_mfma_f32_16x16x32_bf16 v[100:103], v[56:59], a[220:223], v[100:103]
    v_exp_f32 v146, v146
    v_mfma_f32_16x16x32_bf16 v[108:111], v[56:59], a[236:239], v[108:111]
    s_waitcnt lgkmcnt(1)
    v_mfma_f32_16x16x32_bf16 v[80:83], v[60:63], a[160:163], v[24:27]
    ds_read_b128 v[68:71], v6 offset:20480
    ds_read_b128 v[72:75], v7 offset:20480
    v_mfma_f32_16x16x32_bf16 v[88:91], v[60:63], a[176:179], v[28:31]
    v_exp_f32 v147, v147
    v_mfma_f32_16x16x32_bf16 v[96:99], v[60:63], a[192:195], v[32:35]
    v_cvt_pk_bf16_f32 v142, v144, v145
    v_cvt_pk_bf16_f32 v143, v146, v147
    v_mfma_f32_16x16x32_bf16 v[104:107], v[60:63], a[208:211], v[36:39]
    v_exp_f32 v148, v148
    v_mfma_f32_16x16x32_bf16 v[112:115], v[60:63], a[224:227], v[40:43]
    s_waitcnt lgkmcnt(2)
    v_mfma_f32_16x16x32_bf16 v[80:83], v[64:67], a[164:167], v[80:83]
    v_exp_f32 v149, v149
    v_mfma_f32_16x16x32_bf16 v[88:91], v[64:67], a[180:183], v[88:91]
    v_exp_f32 v150, v150
    v_mfma_f32_16x16x32_bf16 v[96:99], v[64:67], a[196:199], v[96:99]
    v_exp_f32 v151, v151
    v_mfma_f32_16x16x32_bf16 v[104:107], v[64:67], a[212:215], v[104:107]
    v_mfma_f32_16x16x32_bf16 v[112:115], v[64:67], a[228:231], v[112:115]
    v_exp_f32 v152, v152
    s_waitcnt lgkmcnt(1)
    v_mfma_f32_16x16x32_bf16 v[80:83], v[68:71], a[168:171], v[80:83]
    ds_read_b64_tr_b16 v[44:45], v8 offset:8192
    ds_read_b64_tr_b16 v[46:47], v8 offset:12288
    v_mfma_f32_16x16x32_bf16 v[88:91], v[68:71], a[184:187], v[88:91]
    v_cvt_pk_bf16_f32 v148, v148, v149
    v_cvt_pk_bf16_f32 v149, v150, v151
    v_mfma_f32_16x16x32_bf16 v[96:99], v[68:71], a[200:203], v[96:99]
    v_exp_f32 v153, v153
    v_mfma_f32_16x16x32_bf16 v[104:107], v[68:71], a[216:219], v[104:107]
    v_mfma_f32_16x16x32_bf16 v[112:115], v[68:71], a[232:235], v[112:115]
    v_exp_f32 v154, v154
    s_waitcnt lgkmcnt(2)
    v_mfma_f32_16x16x32_bf16 v[80:83], v[72:75], a[172:175], v[80:83]
    ds_read_b64_tr_b16 v[48:49], v9 offset:8192
    ds_read_b64_tr_b16 v[50:51], v9 offset:12288
    v_mfma_f32_16x16x32_bf16 v[88:91], v[72:75], a[188:191], v[88:91]
    v_exp_f32 v155, v155
    v_mfma_f32_16x16x32_bf16 v[96:99], v[72:75], a[204:207], v[96:99]
    v_cvt_pk_bf16_f32 v150, v152, v153
    v_cvt_pk_bf16_f32 v151, v154, v155
    v_mfma_f32_16x16x32_bf16 v[104:107], v[72:75], a[220:223], v[104:107]
    v_mfma_f32_16x16x32_bf16 v[112:115], v[72:75], a[236:239], v[112:115]
    s_waitcnt lgkmcnt(2)
    v_mfma_f32_16x16x32_bf16 a[0:3], v[44:47], v[116:119], a[0:3]
    ds_read_b64_tr_b16 v[52:53], v10 offset:8192
    ds_read_b64_tr_b16 v[54:55], v10 offset:12288
    v_mfma_f32_16x16x32_bf16 a[32:35], v[44:47], v[124:127], a[32:35]
    v_mfma_f32_16x16x32_bf16 a[64:67], v[44:47], v[132:135], a[64:67]
    v_exp_f32 v76, v76
    v_mfma_f32_16x16x32_bf16 a[96:99], v[44:47], v[140:143], a[96:99]
    v_exp_f32 v77, v77
    v_mfma_f32_16x16x32_bf16 a[128:131], v[44:47], v[148:151], a[128:131]
    v_exp_f32 v78, v78
    s_waitcnt lgkmcnt(2)
    v_mfma_f32_16x16x32_bf16 a[4:7], v[48:51], v[116:119], a[4:7]
    ds_read_b64_tr_b16 v[56:57], v11 offset:8192
    ds_read_b64_tr_b16 v[58:59], v11 offset:12288
    v_mfma_f32_16x16x32_bf16 a[36:39], v[48:51], v[124:127], a[36:39]
    v_exp_f32 v79, v79
    v_mfma_f32_16x16x32_bf16 a[68:71], v[48:51], v[132:135], a[68:71]
    v_mfma_f32_16x16x32_bf16 a[100:103], v[48:51], v[140:143], a[100:103]
    v_exp_f32 v80, v80
    v_mfma_f32_16x16x32_bf16 a[132:135], v[48:51], v[148:151], a[132:135]
    v_cvt_pk_bf16_f32 v76, v76, v77
    v_cvt_pk_bf16_f32 v77, v78, v79
    s_waitcnt lgkmcnt(2)
    v_mfma_f32_16x16x32_bf16 a[8:11], v[52:55], v[116:119], a[8:11]
    ds_read_b64_tr_b16 v[60:61], v12 offset:8192
    ds_read_b64_tr_b16 v[62:63], v12 offset:12288
    v_mfma_f32_16x16x32_bf16 a[40:43], v[52:55], v[124:127], a[40:43]
    v_exp_f32 v81, v81
    v_mfma_f32_16x16x32_bf16 a[72:75], v[52:55], v[132:135], a[72:75]
    v_mfma_f32_16x16x32_bf16 a[104:107], v[52:55], v[140:143], a[104:107]
    v_exp_f32 v82, v82
    v_mfma_f32_16x16x32_bf16 a[136:139], v[52:55], v[148:151], a[136:139]
    v_exp_f32 v83, v83
    s_waitcnt lgkmcnt(2)
    v_mfma_f32_16x16x32_bf16 a[12:15], v[56:59], v[116:119], a[12:15]
    ds_read_b64_tr_b16 v[64:65], v13 offset:8192
    ds_read_b64_tr_b16 v[66:67], v13 offset:12288
    v_mfma_f32_16x16x32_bf16 a[44:47], v[56:59], v[124:127], a[44:47]
    v_cvt_pk_bf16_f32 v78, v80, v81
    v_cvt_pk_bf16_f32 v79, v82, v83
    s_nop 1
    v_mfma_f32_16x16x32_bf16 a[76:79], v[56:59], v[132:135], a[76:79]
    v_mfma_f32_16x16x32_bf16 a[108:111], v[56:59], v[140:143], a[108:111]
    v_exp_f32 v84, v84
    v_mfma_f32_16x16x32_bf16 a[140:143], v[56:59], v[148:151], a[140:143]
    v_exp_f32 v85, v85
    s_waitcnt lgkmcnt(2)
    v_mfma_f32_16x16x32_bf16 a[16:19], v[60:63], v[116:119], a[16:19]
    ds_read_b64_tr_b16 v[68:69], v14 offset:8192
    ds_read_b64_tr_b16 v[70:71], v14 offset:12288
    v_mfma_f32_16x16x32_bf16 a[48:51], v[60:63], v[124:127], a[48:51]
    v_exp_f32 v86, v86
    v_mfma_f32_16x16x32_bf16 a[80:83], v[60:63], v[132:135], a[80:83]
    v_mfma_f32_16x16x32_bf16 a[112:115], v[60:63], v[140:143], a[112:115]
    v_exp_f32 v87, v87
    v_mfma_f32_16x16x32_bf16 a[144:147], v[60:63], v[148:151], a[144:147]
    v_exp_f32 v88, v88
    s_waitcnt lgkmcnt(2)
    v_mfma_f32_16x16x32_bf16 a[20:23], v[64:67], v[116:119], a[20:23]
    ds_read_b64_tr_b16 v[72:73], v15 offset:8192
    ds_read_b64_tr_b16 v[74:75], v15 offset:12288
    v_mfma_f32_16x16x32_bf16 a[52:55], v[64:67], v[124:127], a[52:55]
    v_cvt_pk_bf16_f32 v84, v84, v85
    v_cvt_pk_bf16_f32 v85, v86, v87
    s_nop 1
    v_mfma_f32_16x16x32_bf16 a[84:87], v[64:67], v[132:135], a[84:87]
    v_mfma_f32_16x16x32_bf16 a[116:119], v[64:67], v[140:143], a[116:119]
    v_exp_f32 v89, v89
    v_mfma_f32_16x16x32_bf16 a[148:151], v[64:67], v[148:151], a[148:151]
    v_exp_f32 v90, v90
    s_waitcnt lgkmcnt(2)
    v_mfma_f32_16x16x32_bf16 a[24:27], v[68:71], v[116:119], a[24:27]
    ds_read_b128 v[44:47], v4 offset:24576
    ds_read_b128 v[48:51], v5 offset:24576
    v_mfma_f32_16x16x32_bf16 a[56:59], v[68:71], v[124:127], a[56:59]
    v_exp_f32 v91, v91
    s_nop 1
    v_mfma_f32_16x16x32_bf16 a[88:91], v[68:71], v[132:135], a[88:91]
    v_mfma_f32_16x16x32_bf16 a[120:123], v[68:71], v[140:143], a[120:123]
    v_cvt_pk_bf16_f32 v86, v88, v89
    v_cvt_pk_bf16_f32 v87, v90, v91
    v_mfma_f32_16x16x32_bf16 a[152:155], v[68:71], v[148:151], a[152:155]
    v_exp_f32 v92, v92
    s_waitcnt lgkmcnt(2)
    v_mfma_f32_16x16x32_bf16 a[28:31], v[72:75], v[116:119], a[28:31]
    v_exp_f32 v93, v93
    v_mfma_f32_16x16x32_bf16 a[60:63], v[72:75], v[124:127], a[60:63]
    s_nop 0
    v_mfma_f32_16x16x32_bf16 a[92:95], v[72:75], v[132:135], a[92:95]
    v_exp_f32 v94, v94
    v_mfma_f32_16x16x32_bf16 a[124:127], v[72:75], v[140:143], a[124:127]
    v_exp_f32 v95, v95
    v_mfma_f32_16x16x32_bf16 a[156:159], v[72:75], v[148:151], a[156:159]
    v_exp_f32 v96, v96
    v_mfma_f32_16x16x32_bf16 a[240:243], v[248:251], v[116:119], a[240:243]
    v_mfma_f32_16x16x32_bf16 a[244:247], v[248:251], v[124:127], a[244:247]
    v_cvt_pk_bf16_f32 v92, v92, v93
    v_cvt_pk_bf16_f32 v93, v94, v95
    s_waitcnt vmcnt(8)
    s_barrier
    v_mfma_f32_16x16x32_bf16 a[248:251], v[248:251], v[132:135], a[248:251]
    s_add_u32 m0, s34, 57344
    s_nop 0
    buffer_load_dwordx4 v1, s[16:19], s33 offen lds
    v_mfma_f32_16x16x32_bf16 a[252:255], v[248:251], v[140:143], a[252:255]
    buffer_load_dwordx4 v2, s[16:19], s33 offen offset:1024 lds
    v_mfma_f32_16x16x32_bf16 v[20:23], v[248:251], v[148:151], v[20:23]
    s_add_u32 m0, s34, 122880
    s_nop 0
    buffer_load_dwordx4 v1, s[20:23], s33 offen lds
    s_waitcnt lgkmcnt(1)
    v_mfma_f32_16x16x32_bf16 v[116:119], v[44:47], a[160:163], v[24:27]
    ds_read_b128 v[52:55], v6 offset:24576
    ds_read_b128 v[56:59], v7 offset:24576
    v_mfma_f32_16x16x32_bf16 v[124:127], v[44:47], a[176:179], v[28:31]
    buffer_load_dwordx4 v2, s[20:23], s33 offen offset:1024 lds
    s_add_u32 s33, s33, 8192
    v_mfma_f32_16x16x32_bf16 v[132:135], v[44:47], a[192:195], v[32:35]
    s_cmp_eq_u32 s50, 1
    s_cbranch_scc1 L_c5_q1a
    s_cmp_eq_u32 s50, 2
    s_cbranch_scc0 L_c5_q1e
    s_add_u32 s38, s44, 8192
    buffer_load_dwordx4 v[192:195], v16, s[12:15], s38 offen offset:64
    s_branch L_c5_q1e
L_c5_q1a:
    s_add_u32 s38, s44, 0
    buffer_load_dwordx4 v[160:163], v16, s[12:15], s38 offen offset:64
L_c5_q1e:
    v_mfma_f32_16x16x32_bf16 v[140:143], v[44:47], a[208:211], v[36:39]
    v_exp_f32 v97, v97
    v_mfma_f32_16x16x32_bf16 v[148:151], v[44:47], a[224:227], v[40:43]
    v_exp_f32 v98, v98
    s_waitcnt lgkmcnt(2)
    v_mfma_f32_16x16x32_bf16 v[116:119], v[48:51], a[164:167], v[116:119]
    v_exp_f32 v99, v99
    v_mfma_f32_16x16x32_bf16 v[124:127], v[48:51], a[180:183], v[124:127]
    v_mfma_f32_16x16x32_bf16 v[132:135], v[48:51], a[196:199], v[132:135]
    v_cvt_pk_bf16_f32 v94, v96, v97
    v_cvt_pk_bf16_f32 v95, v98, v99
    v_mfma_f32_16x16x32_bf16 v[140:143], v[48:51], a[212:215], v[140:143]
    v_exp_f32 v100, v100
    v_mfma_f32_16x16x32_bf16 v[148:151], v[48:51], a[228:231], v[148:151]
    v_exp_f32 v101, v101
    s_waitcnt lgkmcnt(1)
    v_mfma_f32_16x16x32_bf16 v[116:119], v[52:55], a[168:171], v[116:119]
    ds_read_b128 v[60:63], v4 offset:28672
    ds_read_b128 v[64:67], v5 offset:28672
    v_mfma_f32_16x16x32_bf16 v[124:127], v[52:55], a[184:187], v[124:127]
    v_mfma_f32_16x16x32_bf16 v[132:135], v[52:55], a[200:203], v[132:135]
    v_exp_f32 v102, v102
    v_mfma_f32_16x16x32_bf16 v[140:143], v[52:55], a[216:219], v[140:143]
    v_exp_f32 v103, v103
    v_mfma_f32_16x16x32_bf16 v[148:151], v[52:55], a[232:235], v[148:151]
    v_exp_f32 v104, v104
    s_waitcnt lgkmcnt(2)
    v_mfma_f32_16x16x32_bf16 v[116:119], v[56:59], a[172:175], v[116:119]
    v_mfma_f32_16x16x32_bf16 v[124:127], v[56:59], a[188:191], v[124:127]
    v_cvt_pk_bf16_f32 v100, v100, v101
    v_cvt_pk_bf16_f32 v101, v102, v103
    v_mfma_f32_16x16x32_bf16 v[132:135], v[56:59], a[204:207], v[132:135]
    v_exp_f32 v105, v105
    v_mfma_f32_16x16x32_bf16 v[140:143], v[56:59], a[220:223], v[140:143]
    v_exp_f32 v106, v106
    v_mfma_f32_16x16x32_bf16 v[148:151], v[56:59], a[236:239], v[148:151]
    s_waitcnt lgkmcnt(1)
    v_mfma_f32_16x16x32_bf16 v[120:123], v[60:63], a[160:163], v[24:27]
    ds_read_b128 v[68:71], v6 offset:28672
    ds_read_b128 v[72:75], v7 offset:28672
    v_mfma_f32_16x16x32_bf16 v[128:131], v[60:63], a[176:179], v[28:31]
    v_exp_f32 v107, v107
    v_mfma_f32_16x16x32_bf16 v[136:139], v[60:63], a[192:195], v[32:35]
    v_cvt_pk_bf16_f32 v102, v104, v105
    v_cvt_pk_bf16_f32 v103, v106, v107
    v_mfma_f32_16x16x32_bf16 v[144:147], v[60:63], a[208:211], v[36:39]
    v_exp_f32 v108, v108
    v_mfma_f32_16x16x32_bf16 v[152:155], v[60:63], a[224:227], v[40:43]
    s_waitcnt lgkmcnt(2)
    v_mfma_f32_16x16x32_bf16 v[120:123], v[64:67], a[164:167], v[120:123]
    v_exp_f32 v109, v109
    v_mfma_f32_16x16x32_bf16 v[128:131], v[64:67], a[180:183], v[128:131]
    v_exp_f32 v110, v110
    v_mfma_f32_16x16x32_bf16 v[136:139], v[64:67], a[196:199], v[136:139]
    v_exp_f32 v111, v111
    v_mfma_f32_16x16x32_bf16 v[144:147], v[64:67], a[212:215], v[144:147]
    v_mfma_f32_16x16x32_bf16 v[152:155], v[64:67], a[228:231], v[152:155]
    v_exp_f32 v112, v112
    s_waitcnt lgkmcnt(1)
    v_mfma_f32_16x16x32_bf16 v[120:123], v[68:71], a[168:171], v[120:123]
    ds_read_b64_tr_b16 v[44:45], v8 offset:16384
    ds_read_b64_tr_b16 v[46:47], v8 offset:20480
    v_mfma_f32_16x16x32_bf16 v[128:131], v[68:71], a[184:187], v[128:131]
    v_cvt_pk_bf16_f32 v108, v108, v109
    v_cvt_pk_bf16_f32 v109, v110, v111
    v_mfma_f32_16x16x32_bf16 v[136:139], v[68:71], a[200:203], v[136:139]
    v_exp_f32 v113, v113
    v_mfma_f32_16x16x32_bf16 v[144:147], v[68:71], a[216:219], v[144:147]
    v_mfma_f32_16x16x32_bf16 v[152:155], v[68:71], a[232:235], v[152:155]
    v_exp_f32 v114, v114
    s_waitcnt lgkmcnt(2)
    v_mfma_f32_16x16x32_bf16 v[120:123], v[72:75], a[172:175], v[120:123]
    ds_read_b64_tr_b16 v[48:49], v9 offset:16384
    ds_read_b64_tr_b16 v[50:51], v9 offset:20480
    v_mfma_f32_16x16x32_bf16 v[128:131], v[72:75], a[188:191], v[128:131]
    v_exp_f32 v115, v115
    v_mfma_f32_16x16x32_bf16 v[136:139], v[72:75], a[204:207], v[136:139]
    v_cvt_pk_bf16_f32 v110, v112, v113
    v_cvt_pk_bf16_f32 v111, v114, v115
    v_mfma_f32_16x16x32_bf16 v[144:147], v[72:75], a[220:223], v[144:147]
    v_mfma_f32_16x16x32_bf16 v[152:155], v[72:75], a[236:239], v[152:155]
    s_waitcnt lgkmcnt(2)
    v_mfma_f32_16x16x32_bf16 a[0:3], v[44:47], v[76:79], a[0:3]
    ds_read_b64_tr_b16 v[52:53], v10 offset:16384
    ds_read_b64_tr_b16 v[54:55], v10 offset:20480
    v_mfma_f32_16x16x32_bf16 a[32:35], v[44:47], v[84:87], a[32:35]
    v_mfma_f32_16x16x32_bf16 a[64:67], v[44:47], v[92:95], a[64:67]
    v_exp_f32 v116, v116
    v_mfma_f32_16x16x32_bf16 a[96:99], v[44:47], v[100:103], a[96:99]
    v_exp_f32 v117, v117
    v_mfma_f32_16x16x32_bf16 a[128:131], v[44:47], v[108:111], a[128:131]
    v_exp_f32 v118, v118
    s_waitcnt lgkmcnt(2)
    v_mfma_f32_16x16x32_bf16 a[4:7], v[48:51], v[76:79], a[4:7]
    ds_read_b64_tr_b16 v[56:57], v11 offset:16384
    ds_read_b64_tr_b16 v[58:59], v11 offset:20480
    v_mfma_f32_16x16x32_bf16 a[36:39], v[48:51], v[84:87], a[36:39]
    v_exp_f32 v119, v119
    v_mfma_f32_16x16x32_bf16 a[68:71], v[48:51], v[92:95], a[68:71]
    v_mfma_f32_16x16x32_bf16 a[100:103], v[48:51], v[100:103], a[100:103]
    v_exp_f32 v120, v120
    v_mfma_f32_16x16x32_bf16 a[132:135], v[48:51], v[108:111], a[132:135]
    v_cvt_pk_bf16_f32 v116, v116, v117
    v_cvt_pk_bf16_f32 v117, v118, v119
    s_waitcnt lgkmcnt(2)
    v_mfma_f32_16x16x32_bf16 a[8:11], v[52:55], v[76:79], a[8:11]
    ds_read_b64_tr_b16 v[60:61], v12 offset:16384
    ds_read_b64_tr_b16 v[62:63], v12 offset:20480
    v_mfma_f32_16x16x32_bf16 a[40:43], v[52:55], v[84:87], a[40:43]
    v_exp_f32 v121, v121
    v_mfma_f32_16x16x32_bf16 a[72:75], v[52:55], v[92:95], a[72:75]
    v_mfma_f32_16x16x32_bf16 a[104:107], v[52:55], v[100:103], a[104:107]
    v_exp_f32 v122, v122
    v_mfma_f32_16x16x32_bf16 a[136:139], v[52:55], v[108:111], a[136:139]
    v_exp_f32 v123, v123
    s_waitcnt lgkmcnt(2)
    v_mfma_f32_16x16x32_bf16 a[12:15], v[56:59], v[76:79], a[12:15]
    ds_read_b64_tr_b16 v[64:65], v13 offset:16384
    ds_read_b64_tr_b16 v[66:67], v13 offset:20480
    v_mfma_f32_16x16x32_bf16 a[44:47], v[56:59], v[84:87], a[44:47]
    v_cvt_pk_bf16_f32 v118, v120, v121
    v_cvt_pk_bf16_f32 v119, v122, v123
    v_mfma_f32_16x16x32_bf16 a[76:79], v[56:59], v[92:95], a[76:79]
    v_mfma_f32_16x16x32_bf16 a[108:111], v[56:59], v[100:103], a[108:111]
    v_exp_f32 v124, v124
    v_mfma_f32_16x16x32_bf16 a[140:143], v[56:59], v[108:111], a[140:143]
    v_exp_f32 v125, v125
    s_waitcnt lgkmcnt(2)
    v_mfma_f32_16x16x32_bf16 a[16:19], v[60:63], v[76:79], a[16:19]
    ds_read_b64_tr_b16 v[68:69], v14 offset:16384
    ds_read_b64_tr_b16 v[70:71], v14 offset:20480
    v_mfma_f32_16x16x32_bf16 a[48:51], v[60:63], v[84:87], a[48:51]
    v_exp_f32 v126, v126
    v_mfma_f32_16x16x32_bf16 a[80:83], v[60:63], v[92:95], a[80:83]
    v_mfma_f32_16x16x32_bf16 a[112:115], v[60:63], v[100:103], a[112:115]
    v_exp_f32 v127, v127
    v_mfma_f32_16x16x32_bf16 a[144:147], v[60:63], v[108:111], a[144:147]
    v_exp_f32 v128, v128
    s_waitcnt lgkmcnt(2)
    v_mfma_f32_16x16x32_bf16 a[20:23], v[64:67], v[76:79], a[20:23]
    ds_read_b64_tr_b16 v[72:73], v15 offset:16384
    ds_read_b64_tr_b16 v[74:75], v15 offset:20480
    v_mfma_f32_16x16x32_bf16 a[52:55], v[64:67], v[84:87], a[52:55]
    v_cvt_pk_bf16_f32 v124, v124, v125
    v_cvt_pk_bf16_f32 v125, v126, v127
    v_mfma_f32_16x16x32_bf16 a[84:87], v[64:67], v[92:95], a[84:87]
    v_mfma_f32_16x16x32_bf16 a[116:119], v[64:67], v[100:103], a[116:119]
    v_exp_f32 v129, v129
    v_mfma_f32_16x16x32_bf16 a[148:151], v[64:67], v[108:111], a[148:151]
    v_exp_f32 v130, v130
    s_waitcnt lgkmcnt(2)
    v_mfma_f32_16x16x32_bf16 a[24:27], v[68:71], v[76:79], a[24:27]
    ds_read_b128 v[44:47], v4 offset:32768
    ds_read_b128 v[48:51], v5 offset:32768
    v_mfma_f32_16x16x32_bf16 a[56:59], v[68:71], v[84:87], a[56:59]
    v_exp_f32 v131, v131
    v_mfma_f32_16x16x32_bf16 a[88:91], v[68:71], v[92:95], a[88:91]
    v_mfma_f32_16x16x32_bf16 a[120:123], v[68:71], v[100:103], a[120:123]
    v_cvt_pk_bf16_f32 v126, v128, v129
    v_cvt_pk_bf16_f32 v127, v130, v131
    v_mfma_f32_16x16x32_bf16 a[152:155], v[68:71], v[108:111], a[152:155]
    v_exp_f32 v132, v132
    s_waitcnt lgkmcnt(2)
    v_mfma_f32_16x16x32_bf16 a[28:31], v[72:75], v[76:79], a[28:31]
    v_exp_f32 v133, v133
    v_mfma_f32_16x16x32_bf16 a[60:63], v[72:75], v[84:87], a[60:63]
    v_mfma_f32_16x16x32_bf16 a[92:95], v[72:75], v[92:95], a[92:95]
    v_exp_f32 v134, v134
    v_mfma_f32_16x16x32_bf16 a[124:127], v[72:75], v[100:103], a[124:127]
    v_exp_f32 v135, v135
    v_mfma_f32_16x16x32_bf16 a[156:159], v[72:75], v[108:111], a[156:159]
    v_exp_f32 v136, v136
    v_mfma_f32_16x16x32_bf16 a[240:243], v[248:251], v[76:79], a[240:243]
    v_mfma_f32_16x16x32_bf16 a[244:247], v[248:251], v[84:87], a[244:247]
    v_cvt_pk_bf16_f32 v132, v132, v133
    v_cvt_pk_bf16_f32 v133, v134, v135
    s_waitcnt vmcnt(8)
    s_barrier
    v_mfma_f32_16x16x32_bf16 a[248:251], v[248:251], v[92:95], a[248:251]
    s_add_u32 m0, s34, 0
    s_nop 0
    buffer_load_dwordx4 v1, s[16:19], s33 offen lds
    v_mfma_f32_16x16x32_bf16 a[252:255], v[248:251], v[100:103], a[252:255]
    buffer_load_dwordx4 v2, s[16:19], s33 offen offset:1024 lds
    v_mfma_f32_16x16x32_bf16 v[20:23], v[248:251], v[108:111], v[20:23]
    s_add_u32 m0, s34, 65536
    s_nop 0
    buffer_load_dwordx4 v1, s[20:23], s33 offen lds
    s_waitcnt lgkmcnt(1)
    v_mfma_f32_16x16x32_bf16 v[76:79], v[44:47], a[160:163], v[24:27]
    ds_read_b128 v[52:55], v6 offset:32768
    ds_read_b128 v[56:59], v7 offset:32768
    v_mfma_f32_16x16x32_bf16 v[84:87], v[44:47], a[176:179], v[28:31]
    buffer_load_dwordx4 v2, s[20:23], s33 offen offset:1024 lds
    s_add_u32 s33, s33, 8192
    v_mfma_f32_16x16x32_bf16 v[92:95], v[44:47], a[192:195], v[32:35]
    s_cmp_eq_u32 s50, 1
    s_cbranch_scc1 L_c5_q2a
    s_cmp_eq_u32 s50, 2
    s_cbranch_scc0 L_c5_q2e
    s_add_u32 s38, s44, 8192
    buffer_load_dwordx4 v[196:199], v16, s[12:15], s38 offen offset:128
    s_branch L_c5_q2e
L_c5_q2a:
    s_add_u32 s38, s44, 0
    buffer_load_dwordx4 v[164:167], v16, s[12:15], s38 offen offset:128
L_c5_q2e:
    v_mfma_f32_16x16x32_bf16 v[100:103], v[44:47], a[208:211], v[36:39]
    v_exp_f32 v137, v137
    v_mfma_f32_16x16x32_bf16 v[108:111], v[44:47], a[224:227], v[40:43]
    v_exp_f32 v138, v138
    s_waitcnt lgkmcnt(2)
    v_mfma_f32_16x16x32_bf16 v[76:79], v[48:51], a[164:167], v[76:79]
    v_exp_f32 v139, v139
    v_mfma_f32_16x16x32_bf16 v[84:87], v[48:51], a[180:183], v[84:87]
    v_mfma_f32_16x16x32_bf16 v[92:95], v[48:51], a[196:199], v[92:95]
    v_cvt_pk_bf16_f32 v134, v136, v137
    v_cvt_pk_bf16_f32 v135, v138, v139
    v_mfma_f32_16x16x32_bf16 v[100:103], v[48:51], a[212:215], v[100:103]
    v_exp_f32 v140, v140
    v_mfma_f32_16x16x32_bf16 v[108:111], v[48:51], a[228:231], v[108:111]
    v_exp_f32 v141, v141
    s_waitcnt lgkmcnt(1)
    v_mfma_f32_16x16x32_bf16 v[76:79], v[52:55], a[168:171], v[76:79]
    ds_read_b128 v[60:63], v4 offset:36864
    ds_read_b128 v[64:67], v5 offset:36864
    v_mfma_f32_16x16x32_bf16 v[84:87], v[52:55], a[184:187], v[84:87]
    v_mfma_f32_16x16x32_bf16 v[92:95], v[52:55], a[200:203], v[92:95]
    v_exp_f32 v142, v142
    v_mfma_f32_16x16x32_bf16 v[100:103], v[52:55], a[216:219], v[100:103]
    v_exp_f32 v143, v143
    v_mfma_f32_16x16x32_bf16 v[108:111], v[52:55], a[232:235], v[108:111]
    v_exp_f32 v144, v144
    s_waitcnt lgkmcnt(2)
    v_mfma_f32_16x16x32_bf16 v[76:79], v[56:59], a[172:175], v[76:79]
    v_mfma_f32_16x16x32_bf16 v[84:87], v[56:59], a[188:191], v[84:87]
    v_cvt_pk_bf16_f32 v140, v140, v141
    v_cvt_pk_bf16_f32 v141, v142, v143
    v_mfma_f32_16x16x32_bf16 v[92:95], v[56:59], a[204:207], v[92:95]
    v_exp_f32 v145, v145
    v_mfma_f32_16x16x32_bf16 v[100:103], v[56:59], a[220:223], v[100:103]
    v_exp_f32 v146, v146
    v_mfma_f32_16x16x32_bf16 v[108:111], v[56:59], a[236:239], v[108:111]
    s_waitcnt lgkmcnt(1)
    v_mfma_f32_16x16x32_bf16 v[80:83], v[60:63], a[160:163], v[24:27]
    ds_read_b128 v[68:71], v6 offset:36864
    ds_read_b128 v[72:75], v7 offset:36864
    v_mfma_f32_16x16x32_bf16 v[88:91], v[60:63], a[176:179], v[28:31]
    v_exp_f32 v147, v147
    v_mfma_f32_16x16x32_bf16 v[96:99], v[60:63], a[192:195], v[32:35]
    v_cvt_pk_bf16_f32 v142, v144, v145
    v_cvt_pk_bf16_f32 v143, v146, v147
    v_mfma_f32_16x16x32_bf16 v[104:107], v[60:63], a[208:211], v[36:39]
    v_exp_f32 v148, v148
    v_mfma_f32_16x16x32_bf16 v[112:115], v[60:63], a[224:227], v[40:43]
    s_waitcnt lgkmcnt(2)
    v_mfma_f32_16x16x32_bf16 v[80:83], v[64:67], a[164:167], v[80:83]
    v_exp_f32 v149, v149
    v_mfma_f32_16x16x32_bf16 v[88:91], v[64:67], a[180:183], v[88:91]
    v_exp_f32 v150, v150
    v_mfma_f32_16x16x32_bf16 v[96:99], v[64:67], a[196:199], v[96:99]
    v_exp_f32 v151, v151
    v_mfma_f32_16x16x32_bf16 v[104:107], v[64:67], a[212:215], v[104:107]
    v_mfma_f32_16x16x32_bf16 v[112:115], v[64:67], a[228:231], v[112:115]
    v_exp_f32 v152, v152
    s_waitcnt lgkmcnt(1)
    v_mfma_f32_16x16x32_bf16 v[80:83], v[68:71], a[168:171], v[80:83]
    ds_read_b64_tr_b16 v[44:45], v8 offset:24576
    ds_read_b64_tr_b16 v[46:47], v8 offset:28672
    v_mfma_f32_16x16x32_bf16 v[88:91], v[68:71], a[184:187], v[88:91]
    v_cvt_pk_bf16_f32 v148, v148, v149
    v_cvt_pk_bf16_f32 v149, v150, v151
    v_mfma_f32_16x16x32_bf16 v[96:99], v[68:71], a[200:203], v[96:99]
    v_exp_f32 v153, v153
    v_mfma_f32_16x16x32_bf16 v[104:107], v[68:71], a[216:219], v[104:107]
    v_mfma_f32_16x16x32_bf16 v[112:115], v[68:71], a[232:235], v[112:115]
    v_exp_f32 v154, v154
    s_waitcnt lgkmcnt(2)
    v_mfma_f32_16x16x32_bf16 v[80:83], v[72:75], a[172:175], v[80:83]
    ds_read_b64_tr_b16 v[48:49], v9 offset:24576
    ds_read_b64_tr_b16 v[50:51], v9 offset:28672
    v_mfma_f32_16x16x32_bf16 v[88:91], v[72:75], a[188:191], v[88:91]
    v_exp_f32 v155, v155
    v_mfma_f32_16x16x32_bf16 v[96:99], v[72:75], a[204:207], v[96:99]
    v_cvt_pk_bf16_f32 v150, v152, v153
    v_cvt_pk_bf16_f32 v151, v154, v155
    v_mfma_f32_16x16x32_bf16 v[104:107], v[72:75], a[220:223], v[104:107]
    v_mfma_f32_16x16x32_bf16 v[112:115], v[72:75], a[236:239], v[112:115]
    s_waitcnt lgkmcnt(2)
    v_mfma_f32_16x16x32_bf16 a[0:3], v[44:47], v[116:119], a[0:3]
    ds_read_b64_tr_b16 v[52:53], v10 offset:24576
    ds_read_b64_tr_b16 v[54:55], v10 offset:28672
    v_mfma_f32_16x16x32_bf16 a[32:35], v[44:47], v[124:127], a[32:35]
    v_mfma_f32_16x16x32_bf16 a[64:67], v[44:47], v[132:135], a[64:67]
    v_exp_f32 v76, v76
    v_mfma_f32_16x16x32_bf16 a[96:99], v[44:47], v[140:143], a[96:99]
    v_exp_f32 v77, v77
    v_mfma_f32_16x16x32_bf16 a[128:131], v[44:47], v[148:151], a[128:131]
    v_exp_f32 v78, v78
    s_waitcnt lgkmcnt(2)
    v_mfma_f32_16x16x32_bf16 a[4:7], v[48:51], v[116:119], a[4:7]
    ds_read_b64_tr_b16 v[56:57], v11 offset:24576
    ds_read_b64_tr_b16 v[58:59], v11 offset:28672
    v_mfma_f32_16x16x32_bf16 a[36:39], v[48:51], v[124:127], a[36:39]
    v_exp_f32 v79, v79
    v_mfma_f32_16x16x32_bf16 a[68:71], v[48:51], v[132:135], a[68:71]
    v_mfma_f32_16x16x32_bf16 a[100:103], v[48:51], v[140:143], a[100:103]
    v_exp_f32 v80, v80
    v_mfma_f32_16x16x32_bf16 a[132:135], v[48:51], v[148:151], a[132:135]
    v_cvt_pk_bf16_f32 v76, v76, v77
    v_cvt_pk_bf16_f32 v77, v78, v79
    s_waitcnt lgkmcnt(2)
    v_mfma_f32_16x16x32_bf16 a[8:11], v[52:55], v[116:119], a[8:11]
    ds_read_b64_tr_b16 v[60:61], v12 offset:24576
    ds_read_b64_tr_b16 v[62:63], v12 offset:28672
    v_mfma_f32_16x16x32_bf16 a[40:43], v[52:55], v[124:127], a[40:43]
    v_exp_f32 v81, v81
    v_mfma_f32_16x16x32_bf16 a[72:75], v[52:55], v[132:135], a[72:75]
    v_mfma_f32_16x16x32_bf16 a[104:107], v[52:55], v[140:143], a[104:107]
    v_exp_f32 v82, v82
    v_mfma_f32_16x16x32_bf16 a[136:139], v[52:55], v[148:151], a[136:139]
    v_exp_f32 v83, v83
    s_waitcnt lgkmcnt(2)
    v_mfma_f32_16x16x32_bf16 a[12:15], v[56:59], v[116:119], a[12:15]
    ds_read_b64_tr_b16 v[64:65], v13 offset:24576
    ds_read_b64_tr_b16 v[66:67], v13 offset:28672
    v_mfma_f32_16x16x32_bf16 a[44:47], v[56:59], v[124:127], a[44:47]
    v_cvt_pk_bf16_f32 v78, v80, v81
    v_cvt_pk_bf16_f32 v79, v82, v83
    s_nop 1
    v_mfma_f32_16x16x32_bf16 a[76:79], v[56:59], v[132:135], a[76:79]
    v_mfma_f32_16x16x32_bf16 a[108:111], v[56:59], v[140:143], a[108:111]
    v_exp_f32 v84, v84
    v_mfma_f32_16x16x32_bf16 a[140:143], v[56:59], v[148:151], a[140:143]
    v_exp_f32 v85, v85
    s_waitcnt lgkmcnt(2)
    v_mfma_f32_16x16x32_bf16 a[16:19], v[60:63], v[116:119], a[16:19]
    ds_read_b64_tr_b16 v[68:69], v14 offset:24576
    ds_read_b64_tr_b16 v[70:71], v14 offset:28672
    v_mfma_f32_16x16x32_bf16 a[48:51], v[60:63], v[124:127], a[48:51]
    v_exp_f32 v86, v86
    v_mfma_f32_16x16x32_bf16 a[80:83], v[60:63], v[132:135], a[80:83]
    v_mfma_f32_16x16x32_bf16 a[112:115], v[60:63], v[140:143], a[112:115]
    v_exp_f32 v87, v87
    v_mfma_f32_16x16x32_bf16 a[144:147], v[60:63], v[148:151], a[144:147]
    v_exp_f32 v88, v88
    s_waitcnt lgkmcnt(2)
    v_mfma_f32_16x16x32_bf16 a[20:23], v[64:67], v[116:119], a[20:23]
    ds_read_b64_tr_b16 v[72:73], v15 offset:24576
    ds_read_b64_tr_b16 v[74:75], v15 offset:28672
    v_mfma_f32_16x16x32_bf16 a[52:55], v[64:67], v[124:127], a[52:55]
    v_cvt_pk_bf16_f32 v84, v84, v85
    v_cvt_pk_bf16_f32 v85, v86, v87
    s_nop 1
    v_mfma_f32_16x16x32_bf16 a[84:87], v[64:67], v[132:135], a[84:87]
    v_mfma_f32_16x16x32_bf16 a[116:119], v[64:67], v[140:143], a[116:119]
    v_exp_f32 v89, v89
    v_mfma_f32_16x16x32_bf16 a[148:151], v[64:67], v[148:151], a[148:151]
    v_exp_f32 v90, v90
    s_waitcnt lgkmcnt(2)
    v_mfma_f32_16x16x32_bf16 a[24:27], v[68:71], v[116:119], a[24:27]
    ds_read_b128 v[44:47], v4 offset:40960
    ds_read_b128 v[48:51], v5 offset:40960
    v_mfma_f32_16x16x32_bf16 a[56:59], v[68:71], v[124:127], a[56:59]
    v_exp_f32 v91, v91
    s_nop 1
    v_mfma_f32_16x16x32_bf16 a[88:91], v[68:71], v[132:135], a[88:91]
    v_mfma_f32_16x16x32_bf16 a[120:123], v[68:71], v[140:143], a[120:123]
    v_cvt_pk_bf16_f32 v86, v88, v89
    v_cvt_pk_bf16_f32 v87, v90, v91
    v_mfma_f32_16x16x32_bf16 a[152:155], v[68:71], v[148:151], a[152:155]
    v_exp_f32 v92, v92
    s_waitcnt lgkmcnt(2)
    v_mfma_f32_16x16x32_bf16 a[28:31], v[72:75], v[116:119], a[28:31]
    v_exp_f32 v93, v93
    v_mfma_f32_16x16x32_bf16 a[60:63], v[72:75], v[124:127], a[60:63]
    s_nop 0
    v_mfma_f32_16x16x32_bf16 a[92:95], v[72:75], v[132:135], a[92:95]
    v_exp_f32 v94, v94
    v_mfma_f32_16x16x32_bf16 a[124:127], v[72:75], v[140:143], a[124:127]
    v_exp_f32 v95, v95
    v_mfma_f32_16x16x32_bf16 a[156:159], v[72:75], v[148:151], a[156:159]
    v_exp_f32 v96, v96
    v_mfma_f32_16x16x32_bf16 a[240:243], v[248:251], v[116:119], a[240:243]
    v_mfma_f32_16x16x32_bf16 a[244:247], v[248:251], v[124:127], a[244:247]
    v_cvt_pk_bf16_f32 v92, v92, v93
    v_cvt_pk_bf16_f32 v93, v94, v95
    s_waitcnt vmcnt(8)
    s_barrier
    v_mfma_f32_16x16x32_bf16 a[248:251], v[248:251], v[132:135], a[248:251]
    s_add_u32 m0, s34, 8192
    s_nop 0
    buffer_load_dwordx4 v1, s[16:19], s33 offen lds
    v_mfma_f32_16x16x32_bf16 a[252:255], v[248:251], v[140:143], a[252:255]
    buffer_load_dwordx4 v2, s[16:19], s33 offen offset:1024 lds
    v_mfma_f32_16x16x32_bf16 v[20:23], v[248:251], v[148:151], v[20:23]
    s_add_u32 m0, s34, 73728
    s_nop 0
    buffer_load_dwordx4 v1, s[20:23], s33 offen lds
    s_waitcnt lgkmcnt(1)
    v_mfma_f32_16x16x32_bf16 v[116:119], v[44:47], a[160:163], v[24:27]
    ds_read_b128 v[52:55], v6 offset:40960
    ds_read_b128 v[56:59], v7 offset:40960
    v_mfma_f32_16x16x32_bf16 v[124:127], v[44:47], a[176:179], v[28:31]
    buffer_load_dwordx4 v2, s[20:23], s33 offen offset:1024 lds
    s_add_u32 s33, s33, 8192
    v_mfma_f32_16x16x32_bf16 v[132:135], v[44:47], a[192:195], v[32:35]
    s_cmp_eq_u32 s50, 1
    s_cbranch_scc1 L_c5_q3a
    s_cmp_eq_u32 s50, 2
    s_cbranch_scc0 L_c5_q3e
    s_add_u32 s38, s44, 8192
    buffer_load_dwordx4 v[200:203], v16, s[12:15], s38 offen offset:192
    s_branch L_c5_q3e
L_c5_q3a:
    s_add_u32 s38, s44, 0
    buffer_load_dwordx4 v[168:171], v16, s[12:15], s38 offen offset:192
L_c5_q3e:
    v_mfma_f32_16x16x32_bf16 v[140:143], v[44:47], a[208:211], v[36:39]
    v_exp_f32 v97, v97
    v_mfma_f32_16x16x32_bf16 v[148:151], v[44:47], a[224:227], v[40:43]
    v_exp_f32 v98, v98
    s_waitcnt lgkmcnt(2)
    v_mfma_f32_16x16x32_bf16 v[116:119], v[48:51], a[164:167], v[116:119]
    v_exp_f32 v99, v99
    v_mfma_f32_16x16x32_bf16 v[124:127], v[48:51], a[180:183], v[124:127]
    v_mfma_f32_16x16x32_bf16 v[132:135], v[48:51], a[196:199], v[132:135]
    v_cvt_pk_bf16_f32 v94, v96, v97
    v_cvt_pk_bf16_f32 v95, v98, v99
    v_mfma_f32_16x16x32_bf16 v[140:143], v[48:51], a[212:215], v[140:143]
    v_exp_f32 v100, v100
    v_mfma_f32_16x16x32_bf16 v[148:151], v[48:51], a[228:231], v[148:151]
    v_exp_f32 v101, v101
    s_waitcnt lgkmcnt(1)
    v_mfma_f32_16x16x32_bf16 v[116:119], v[52:55], a[168:171], v[116:119]
    ds_read_b128 v[60:63], v4 offset:45056
    ds_read_b128 v[64:67], v5 offset:45056
    v_mfma_f32_16x16x32_bf16 v[124:127], v[52:55], a[184:187], v[124:127]
    v_mfma_f32_16x16x32_bf16 v[132:135], v[52:55], a[200:203], v[132:135]
    v_exp_f32 v102, v102
    v_mfma_f32_16x16x32_bf16 v[140:143], v[52:55], a[216:219], v[140:143]
    v_exp_f32 v103, v103
    v_mfma_f32_16x16x32_bf16 v[148:151], v[52:55], a[232:235], v[148:151]
    v_exp_f32 v104, v104
    s_waitcnt lgkmcnt(2)
    v_mfma_f32_16x16x32_bf16 v[116:119], v[56:59], a[172:175], v[116:119]
    v_mfma_f32_16x16x32_bf16 v[124:127], v[56:59], a[188:191], v[124:127]
    v_cvt_pk_bf16_f32 v100, v100, v101
    v_cvt_pk_bf16_f32 v101, v102, v103
    v_mfma_f32_16x16x32_bf16 v[132:135], v[56:59], a[204:207], v[132:135]
    v_exp_f32 v105, v105
    v_mfma_f32_16x16x32_bf16 v[140:143], v[56:59], a[220:223], v[140:143]
    v_exp_f32 v106, v106
    v_mfma_f32_16x16x32_bf16 v[148:151], v[56:59], a[236:239], v[148:151]
    s_waitcnt lgkmcnt(1)
    v_mfma_f32_16x16x32_bf16 v[120:123], v[60:63], a[160:163], v[24:27]
    ds_read_b128 v[68:71], v6 offset:45056
    ds_read_b128 v[72:75], v7 offset:45056
    v_mfma_f32_16x16x32_bf16 v[128:131], v[60:63], a[176:179], v[28:31]
    v_exp_f32 v107, v107
    v_mfma_f32_16x16x32_bf16 v[136:139], v[60:63], a[192:195], v[32:35]
    v_cvt_pk_bf16_f32 v102, v104, v105
    v_cvt_pk_bf16_f32 v103, v106, v107
    v_mfma_f32_16x16x32_bf16 v[144:147], v[60:63], a[208:211], v[36:39]
    v_exp_f32 v108, v108
    v_mfma_f32_16x16x32_bf16 v[152:155], v[60:63], a[224:227], v[40:43]
    s_waitcnt lgkmcnt(2)
    v_mfma_f32_16x16x32_bf16 v[120:123], v[64:67], a[164:167], v[120:123]
    v_exp_f32 v109, v109
    v_mfma_f32_16x16x32_bf16 v[128:131], v[64:67], a[180:183], v[128:131]
    v_exp_f32 v110, v110
    v_mfma_f32_16x16x32_bf16 v[136:139], v[64:67], a[196:199], v[136:139]
    v_exp_f32 v111, v111
    v_mfma_f32_16x16x32_bf16 v[144:147], v[64:67], a[212:215], v[144:147]
    v_mfma_f32_16x16x32_bf16 v[152:155], v[64:67], a[228:231], v[152:155]
    v_exp_f32 v112, v112
    s_waitcnt lgkmcnt(1)
    v_mfma_f32_16x16x32_bf16 v[120:123], v[68:71], a[168:171], v[120:123]
    ds_read_b64_tr_b16 v[44:45], v8 offset:32768
    ds_read_b64_tr_b16 v[46:47], v8 offset:36864
    v_mfma_f32_16x16x32_bf16 v[128:131], v[68:71], a[184:187], v[128:131]
    v_cvt_pk_bf16_f32 v108, v108, v109
    v_cvt_pk_bf16_f32 v109, v110, v111
    v_mfma_f32_16x16x32_bf16 v[136:139], v[68:71], a[200:203], v[136:139]
    v_exp_f32 v113, v113
    v_mfma_f32_16x16x32_bf16 v[144:147], v[68:71], a[216:219], v[144:147]
    v_mfma_f32_16x16x32_bf16 v[152:155], v[68:71], a[232:235], v[152:155]
    v_exp_f32 v114, v114
    s_waitcnt lgkmcnt(2)
    v_mfma_f32_16x16x32_bf16 v[120:123], v[72:75], a[172:175], v[120:123]
    ds_read_b64_tr_b16 v[48:49], v9 offset:32768
    ds_read_b64_tr_b16 v[50:51], v9 offset:36864
    v_mfma_f32_16x16x32_bf16 v[128:131], v[72:75], a[188:191], v[128:131]
    v_exp_f32 v115, v115
    v_mfma_f32_16x16x32_bf16 v[136:139], v[72:75], a[204:207], v[136:139]
    v_cvt_pk_bf16_f32 v110, v112, v113
    v_cvt_pk_bf16_f32 v111, v114, v115
    v_mfma_f32_16x16x32_bf16 v[144:147], v[72:75], a[220:223], v[144:147]
    v_mfma_f32_16x16x32_bf16 v[152:155], v[72:75], a[236:239], v[152:155]
    s_waitcnt lgkmcnt(2)
    v_mfma_f32_16x16x32_bf16 a[0:3], v[44:47], v[76:79], a[0:3]
    ds_read_b64_tr_b16 v[52:53], v10 offset:32768
    ds_read_b64_tr_b16 v[54:55], v10 offset:36864
    v_mfma_f32_16x16x32_bf16 a[32:35], v[44:47], v[84:87], a[32:35]
    v_mfma_f32_16x16x32_bf16 a[64:67], v[44:47], v[92:95], a[64:67]
    v_exp_f32 v116, v116
    v_mfma_f32_16x16x32_bf16 a[96:99], v[44:47], v[100:103], a[96:99]
    v_exp_f32 v117, v117
    v_mfma_f32_16x16x32_bf16 a[128:131], v[44:47], v[108:111], a[128:131]
    v_exp_f32 v118, v118
    s_waitcnt lgkmcnt(2)
    v_mfma_f32_16x16x32_bf16 a[4:7], v[48:51], v[76:79], a[4:7]
    ds_read_b64_tr_b16 v[56:57], v11 offset:32768
    ds_read_b64_tr_b16 v[58:59], v11 offset:36864
    v_mfma_f32_16x16x32_bf16 a[36:39], v[48:51], v[84:87], a[36:39]
    v_exp_f32 v119, v119
    v_mfma_f32_16x16x32_bf16 a[68:71], v[48:51], v[92:95], a[68:71]
    v_mfma_f32_16x16x32_bf16 a[100:103], v[48:51], v[100:103], a[100:103]
    v_exp_f32 v120, v120
    v_mfma_f32_16x16x32_bf16 a[132:135], v[48:51], v[108:111], a[132:135]
    v_cvt_pk_bf16_f32 v116, v116, v117
    v_cvt_pk_bf16_f32 v117, v118, v119
    s_waitcnt lgkmcnt(2)
    v_mfma_f32_16x16x32_bf16 a[8:11], v[52:55], v[76:79], a[8:11]
    ds_read_b64_tr_b16 v[60:61], v12 offset:32768
    ds_read_b64_tr_b16 v[62:63], v12 offset:36864
    v_mfma_f32_16x16x32_bf16 a[40:43], v[52:55], v[84:87], a[40:43]
    v_exp_f32 v121, v121
    v_mfma_f32_16x16x32_bf16 a[72:75], v[52:55], v[92:95], a[72:75]
    v_mfma_f32_16x16x32_bf16 a[104:107], v[52:55], v[100:103], a[104:107]
    v_exp_f32 v122, v122
    v_mfma_f32_16x16x32_bf16 a[136:139], v[52:55], v[108:111], a[136:139]
    v_exp_f32 v123, v123
    s_waitcnt lgkmcnt(2)
    v_mfma_f32_16x16x32_bf16 a[12:15], v[56:59], v[76:79], a[12:15]
    ds_read_b64_tr_b16 v[64:65], v13 offset:32768
    ds_read_b64_tr_b16 v[66:67], v13 offset:36864
    v_mfma_f32_16x16x32_bf16 a[44:47], v[56:59], v[84:87], a[44:47]
    v_cvt_pk_bf16_f32 v118, v120, v121
    v_cvt_pk_bf16_f32 v119, v122, v123
    v_mfma_f32_16x16x32_bf16 a[76:79], v[56:59], v[92:95], a[76:79]
    v_mfma_f32_16x16x32_bf16 a[108:111], v[56:59], v[100:103], a[108:111]
    v_exp_f32 v124, v124
    v_mfma_f32_16x16x32_bf16 a[140:143], v[56:59], v[108:111], a[140:143]
    v_exp_f32 v125, v125
    s_waitcnt lgkmcnt(2)
    v_mfma_f32_16x16x32_bf16 a[16:19], v[60:63], v[76:79], a[16:19]
    ds_read_b64_tr_b16 v[68:69], v14 offset:32768
    ds_read_b64_tr_b16 v[70:71], v14 offset:36864
    v_mfma_f32_16x16x32_bf16 a[48:51], v[60:63], v[84:87], a[48:51]
    v_exp_f32 v126, v126
    v_mfma_f32_16x16x32_bf16 a[80:83], v[60:63], v[92:95], a[80:83]
    v_mfma_f32_16x16x32_bf16 a[112:115], v[60:63], v[100:103], a[112:115]
    v_exp_f32 v127, v127
    v_mfma_f32_16x16x32_bf16 a[144:147], v[60:63], v[108:111], a[144:147]
    v_exp_f32 v128, v128
    s_waitcnt lgkmcnt(2)
    v_mfma_f32_16x16x32_bf16 a[20:23], v[64:67], v[76:79], a[20:23]
    ds_read_b64_tr_b16 v[72:73], v15 offset:32768
    ds_read_b64_tr_b16 v[74:75], v15 offset:36864
    v_mfma_f32_16x16x32_bf16 a[52:55], v[64:67], v[84:87], a[52:55]
    v_cvt_pk_bf16_f32 v124, v124, v125
    v_cvt_pk_bf16_f32 v125, v126, v127
    v_mfma_f32_16x16x32_bf16 a[84:87], v[64:67], v[92:95], a[84:87]
    v_mfma_f32_16x16x32_bf16 a[116:119], v[64:67], v[100:103], a[116:119]
    v_exp_f32 v129, v129
    v_mfma_f32_16x16x32_bf16 a[148:151], v[64:67], v[108:111], a[148:151]
    v_exp_f32 v130, v130
    s_waitcnt lgkmcnt(2)
    v_mfma_f32_16x16x32_bf16 a[24:27], v[68:71], v[76:79], a[24:27]
    ds_read_b128 v[44:47], v4 offset:49152
    ds_read_b128 v[48:51], v5 offset:49152
    v_mfma_f32_16x16x32_bf16 a[56:59], v[68:71], v[84:87], a[56:59]
    v_exp_f32 v131, v131
    v_mfma_f32_16x16x32_bf16 a[88:91], v[68:71], v[92:95], a[88:91]
    v_mfma_f32_16x16x32_bf16 a[120:123], v[68:71], v[100:103], a[120:123]
    v_cvt_pk_bf16_f32 v126, v128, v129
    v_cvt_pk_bf16_f32 v127, v130, v131
    v_mfma_f32_16x16x32_bf16 a[152:155], v[68:71], v[108:111], a[152:155]
    v_exp_f32 v132, v132
    s_waitcnt lgkmcnt(2)
    v_mfma_f32_16x16x32_bf16 a[28:31], v[72:75], v[76:79], a[28:31]
    v_exp_f32 v133, v133
    v_mfma_f32_16x16x32_bf16 a[60:63], v[72:75], v[84:87], a[60:63]
    v_mfma_f32_16x16x32_bf16 a[92:95], v[72:75], v[92:95], a[92:95]
    v_exp_f32 v134, v134
    v_mfma_f32_16x16x32_bf16 a[124:127], v[72:75], v[100:103], a[124:127]
    v_exp_f32 v135, v135
    v_mfma_f32_16x16x32_bf16 a[156:159], v[72:75], v[108:111], a[156:159]
    v_exp_f32 v136, v136
    v_mfma_f32_16x16x32_bf16 a[240:243], v[248:251], v[76:79], a[240:243]
    v_mfma_f32_16x16x32_bf16 a[244:247], v[248:251], v[84:87], a[244:247]
    v_cvt_pk_bf16_f32 v132, v132, v133
    v_cvt_pk_bf16_f32 v133, v134, v135
    s_waitcnt vmcnt(8)
    s_barrier
    v_mfma_f32_16x16x32_bf16 a[248:251], v[248:251], v[92:95], a[248:251]
    s_add_u32 m0, s34, 16384
    s_nop 0
    buffer_load_dwordx4 v1, s[16:19], s33 offen lds
    v_mfma_f32_16x16x32_bf16 a[252:255], v[248:251], v[100:103], a[252:255]
    buffer_load_dwordx4 v2, s[16:19], s33 offen offset:1024 lds
    v_mfma_f32_16x16x32_bf16 v[20:23], v[248:251], v[108:111], v[20:23]
    s_add_u32 m0, s34, 81920
    s_nop 0
    buffer_load_dwordx4 v1, s[20:23], s33 offen lds
    s_waitcnt lgkmcnt(1)
    v_mfma_f32_16x16x32_bf16 v[76:79], v[44:47], a[160:163], v[24:27]
    ds_read_b128 v[52:55], v6 offset:49152
    ds_read_b128 v[56:59], v7 offset:49152
    v_mfma_f32_16x16x32_bf16 v[84:87], v[44:47], a[176:179], v[28:31]
    buffer_load_dwordx4 v2, s[20:23], s33 offen offset:1024 lds
    s_add_u32 s33, s33, 8192
    v_mfma_f32_16x16x32_bf16 v[92:95], v[44:47], a[192:195], v[32:35]
    s_cmp_eq_u32 s50, 1
    s_cbranch_scc1 L_c5_q4a
    s_cmp_eq_u32 s50, 2
    s_cbranch_scc0 L_c5_q4e
    s_add_u32 s38, s44, 12288
    buffer_load_dwordx4 v[204:207], v16, s[12:15], s38 offen offset:0
    s_branch L_c5_q4e
L_c5_q4a:
    s_add_u32 s38, s44, 4096
    buffer_load_dwordx4 v[172:175], v16, s[12:15], s38 offen offset:0
L_c5_q4e:
    v_mfma_f32_16x16x32_bf16 v[100:103], v[44:47], a[208:211], v[36:39]
    v_exp_f32 v137, v137
    v_mfma_f32_16x16x32_bf16 v[108:111], v[44:47], a[224:227], v[40:43]
    v_exp_f32 v138, v138
    s_waitcnt lgkmcnt(2)
    v_mfma_f32_16x16x32_bf16 v[76:79], v[48:51], a[164:167], v[76:79]
    v_exp_f32 v139, v139
    v_mfma_f32_16x16x32_bf16 v[84:87], v[48:51], a[180:183], v[84:87]
    v_mfma_f32_16x16x32_bf16 v[92:95], v[48:51], a[196:199], v[92:95]
    v_cvt_pk_bf16_f32 v134, v136, v137
    v_cvt_pk_bf16_f32 v135, v138, v139
    v_mfma_f32_16x16x32_bf16 v[100:103], v[48:51], a[212:215], v[100:103]
    v_exp_f32 v140, v140
    v_mfma_f32_16x16x32_bf16 v[108:111], v[48:51], a[228:231], v[108:111]
    v_exp_f32 v141, v141
    s_waitcnt lgkmcnt(1)
    v_mfma_f32_16x16x32_bf16 v[76:79], v[52:55], a[168:171], v[76:79]
    ds_read_b128 v[60:63], v4 offset:53248
    ds_read_b128 v[64:67], v5 offset:53248
    v_mfma_f32_16x16x32_bf16 v[84:87], v[52:55], a[184:187], v[84:87]
    v_mfma_f32_16x16x32_bf16 v[92:95], v[52:55], a[200:203], v[92:95]
    v_exp_f32 v142, v142
    v_mfma_f32_16x16x32_bf16 v[100:103], v[52:55], a[216:219], v[100:103]
    v_exp_f32 v143, v143
    v_mfma_f32_16x16x32_bf16 v[108:111], v[52:55], a[232:235], v[108:111]
    v_exp_f32 v144, v144
    s_waitcnt lgkmcnt(2)
    v_mfma_f32_16x16x32_bf16 v[76:79], v[56:59], a[172:175], v[76:79]
    v_mfma_f32_16x16x32_bf16 v[84:87], v[56:59], a[188:191], v[84:87]
    v_cvt_pk_bf16_f32 v140, v140, v141
    v_cvt_pk_bf16_f32 v141, v142, v143
    v_mfma_f32_16x16x32_bf16 v[92:95], v[56:59], a[204:207], v[92:95]
    v_exp_f32 v145, v145
    v_mfma_f32_16x16x32_bf16 v[100:103], v[56:59], a[220:223], v[100:103]
    v_exp_f32 v146, v146
    v_mfma_f32_16x16x32_bf16 v[108:111], v[56:59], a[236:239], v[108:111]
    s_waitcnt lgkmcnt(1)
    v_mfma_f32_16x16x32_bf16 v[80:83], v[60:63], a[160:163], v[24:27]
    ds_read_b128 v[68:71], v6 offset:53248
    ds_read_b128 v[72:75], v7 offset:53248
    v_mfma_f32_16x16x32_bf16 v[88:91], v[60:63], a[176:179], v[28:31]
    v_exp_f32 v147, v147
    v_mfma_f32_16x16x32_bf16 v[96:99], v[60:63], a[192:195], v[32:35]
    v_cvt_pk_bf16_f32 v142, v144, v145
    v_cvt_pk_bf16_f32 v143, v146, v147
    v_mfma_f32_16x16x32_bf16 v[104:107], v[60:63], a[208:211], v[36:39]
    v_exp_f32 v148, v148
    v_mfma_f32_16x16x32_bf16 v[112:115], v[60:63], a[224:227], v[40:43]
    s_waitcnt lgkmcnt(2)
    v_mfma_f32_16x16x32_bf16 v[80:83], v[64:67], a[164:167], v[80:83]
    v_exp_f32 v149, v149
    v_mfma_f32_16x16x32_bf16 v[88:91], v[64:67], a[180:183], v[88:91]
    v_exp_f32 v150, v150
    v_mfma_f32_16x16x32_bf16 v[96:99], v[64:67], a[196:199], v[96:99]
    v_exp_f32 v151, v151
    v_mfma_f32_16x16x32_bf16 v[104:107], v[64:67], a[212:215], v[104:107]
    v_mfma_f32_16x16x32_bf16 v[112:115], v[64:67], a[228:231], v[112:115]
    v_exp_f32 v152, v152
    s_waitcnt lgkmcnt(1)
    v_mfma_f32_16x16x32_bf16 v[80:83], v[68:71], a[168:171], v[80:83]
    ds_read_b64_tr_b16 v[44:45], v8 offset:40960
    ds_read_b64_tr_b16 v[46:47], v8 offset:45056
    v_mfma_f32_16x16x32_bf16 v[88:91], v[68:71], a[184:187], v[88:91]
    v_cvt_pk_bf16_f32 v148, v148, v149
    v_cvt_pk_bf16_f32 v149, v150, v151
    v_mfma_f32_16x16x32_bf16 v[96:99], v[68:71], a[200:203], v[96:99]
    v_exp_f32 v153, v153
    v_mfma_f32_16x16x32_bf16 v[104:107], v[68:71], a[216:219], v[104:107]
    v_mfma_f32_16x16x32_bf16 v[112:115], v[68:71], a[232:235], v[112:115]
    v_exp_f32 v154, v154
    s_waitcnt lgkmcnt(2)
    v_mfma_f32_16x16x32_bf16 v[80:83], v[72:75], a[172:175], v[80:83]
    ds_read_b64_tr_b16 v[48:49], v9 offset:40960
    ds_read_b64_tr_b16 v[50:51], v9 offset:45056
    v_mfma_f32_16x16x32_bf16 v[88:91], v[72:75], a[188:191], v[88:91]
    v_exp_f32 v155, v155
    v_mfma_f32_16x16x32_bf16 v[96:99], v[72:75], a[204:207], v[96:99]
    v_cvt_pk_bf16_f32 v150, v152, v153
    v_cvt_pk_bf16_f32 v151, v154, v155
    v_mfma_f32_16x16x32_bf16 v[104:107], v[72:75], a[220:223], v[104:107]
    v_mfma_f32_16x16x32_bf16 v[112:115], v[72:75], a[236:239], v[112:115]
    s_waitcnt lgkmcnt(2)
    v_mfma_f32_16x16x32_bf16 a[0:3], v[44:47], v[116:119], a[0:3]
    ds_read_b64_tr_b16 v[52:53], v10 offset:40960
    ds_read_b64_tr_b16 v[54:55], v10 offset:45056
    v_mfma_f32_16x16x32_bf16 a[32:35], v[44:47], v[124:127], a[32:35]
    v_mfma_f32_16x16x32_bf16 a[64:67], v[44:47], v[132:135], a[64:67]
    v_exp_f32 v76, v76
    v_mfma_f32_16x16x32_bf16 a[96:99], v[44:47], v[140:143], a[96:99]
    v_exp_f32 v77, v77
    v_mfma_f32_16x16x32_bf16 a[128:131], v[44:47], v[148:151], a[128:131]
    v_exp_f32 v78, v78
    s_waitcnt lgkmcnt(2)
    v_mfma_f32_16x16x32_bf16 a[4:7], v[48:51], v[116:119], a[4:7]
    ds_read_b64_tr_b16 v[56:57], v11 offset:40960
    ds_read_b64_tr_b16 v[58:59], v11 offset:45056
    v_mfma_f32_16x16x32_bf16 a[36:39], v[48:51], v[124:127], a[36:39]
    v_exp_f32 v79, v79
    v_mfma_f32_16x16x32_bf16 a[68:71], v[48:51], v[132:135], a[68:71]
    v_mfma_f32_16x16x32_bf16 a[100:103], v[48:51], v[140:143], a[100:103]
    v_exp_f32 v80, v80
    v_mfma_f32_16x16x32_bf16 a[132:135], v[48:51], v[148:151], a[132:135]
    v_cvt_pk_bf16_f32 v76, v76, v77
    v_cvt_pk_bf16_f32 v77, v78, v79
    s_waitcnt lgkmcnt(2)
    v_mfma_f32_16x16x32_bf16 a[8:11], v[52:55], v[116:119], a[8:11]
    ds_read_b64_tr_b16 v[60:61], v12 offset:40960
    ds_read_b64_tr_b16 v[62:63], v12 offset:45056
    v_mfma_f32_16x16x32_bf16 a[40:43], v[52:55], v[124:127], a[40:43]
    v_exp_f32 v81, v81
    v_mfma_f32_16x16x32_bf16 a[72:75], v[52:55], v[132:135], a[72:75]
    v_mfma_f32_16x16x32_bf16 a[104:107], v[52:55], v[140:143], a[104:107]
    v_exp_f32 v82, v82
    v_mfma_f32_16x16x32_bf16 a[136:139], v[52:55], v[148:151], a[136:139]
    v_exp_f32 v83, v83
    s_waitcnt lgkmcnt(2)
    v_mfma_f32_16x16x32_bf16 a[12:15], v[56:59], v[116:119], a[12:15]
    ds_read_b64_tr_b16 v[64:65], v13 offset:40960
    ds_read_b64_tr_b16 v[66:67], v13 offset:45056
    v_mfma_f32_16x16x32_bf16 a[44:47], v[56:59], v[124:127], a[44:47]
    v_cvt_pk_bf16_f32 v78, v80, v81
    v_cvt_pk_bf16_f32 v79, v82, v83
    s_nop 1
    v_mfma_f32_16x16x32_bf16 a[76:79], v[56:59], v[132:135], a[76:79]
    v_mfma_f32_16x16x32_bf16 a[108:111], v[56:59], v[140:143], a[108:111]
    v_exp_f32 v84, v84
    v_mfma_f32_16x16x32_bf16 a[140:143], v[56:59], v[148:151], a[140:143]
    v_exp_f32 v85, v85
    s_waitcnt lgkmcnt(2)
    v_mfma_f32_16x16x32_bf16 a[16:19], v[60:63], v[116:119], a[16:19]
    ds_read_b64_tr_b16 v[68:69], v14 offset:40960
    ds_read_b64_tr_b16 v[70:71], v14 offset:45056
    v_mfma_f32_16x16x32_bf16 a[48:51], v[60:63], v[124:127], a[48:51]
    v_exp_f32 v86, v86
    v_mfma_f32_16x16x32_bf16 a[80:83], v[60:63], v[132:135], a[80:83]
    v_mfma_f32_16x16x32_bf16 a[112:115], v[60:63], v[140:143], a[112:115]
    v_exp_f32 v87, v87
    v_mfma_f32_16x16x32_bf16 a[144:147], v[60:63], v[148:151], a[144:147]
    v_exp_f32 v88, v88
    s_waitcnt lgkmcnt(2)
    v_mfma_f32_16x16x32_bf16 a[20:23], v[64:67], v[116:119], a[20:23]
    ds_read_b64_tr_b16 v[72:73], v15 offset:40960
    ds_read_b64_tr_b16 v[74:75], v15 offset:45056
    v_mfma_f32_16x16x32_bf16 a[52:55], v[64:67], v[124:127], a[52:55]
    v_cvt_pk_bf16_f32 v84, v84, v85
    v_cvt_pk_bf16_f32 v85, v86, v87
    s_nop 1
    v_mfma_f32_16x16x32_bf16 a[84:87], v[64:67], v[132:135], a[84:87]
    v_mfma_f32_16x16x32_bf16 a[116:119], v[64:67], v[140:143], a[116:119]
    v_exp_f32 v89, v89
    v_mfma_f32_16x16x32_bf16 a[148:151], v[64:67], v[148:151], a[148:151]
    v_exp_f32 v90, v90
    s_waitcnt lgkmcnt(2)
    v_mfma_f32_16x16x32_bf16 a[24:27], v[68:71], v[116:119], a[24:27]
    ds_read_b128 v[44:47], v4 offset:57344
    ds_read_b128 v[48:51], v5 offset:57344
    v_mfma_f32_16x16x32_bf16 a[56:59], v[68:71], v[124:127], a[56:59]
    v_exp_f32 v91, v91
    s_nop 1
    v_mfma_f32_16x16x32_bf16 a[88:91], v[68:71], v[132:135], a[88:91]
    v_mfma_f32_16x16x32_bf16 a[120:123], v[68:71], v[140:143], a[120:123]
    v_cvt_pk_bf16_f32 v86, v88, v89
    v_cvt_pk_bf16_f32 v87, v90, v91
    v_mfma_f32_16x16x32_bf16 a[152:155], v[68:71], v[148:151], a[152:155]
    v_exp_f32 v92, v92
    s_waitcnt lgkmcnt(2)
    v_mfma_f32_16x16x32_bf16 a[28:31], v[72:75], v[116:119], a[28:31]
    v_exp_f32 v93, v93
    v_mfma_f32_16x16x32_bf16 a[60:63], v[72:75], v[124:127], a[60:63]
    s_nop 0
    v_mfma_f32_16x16x32_bf16 a[92:95], v[72:75], v[132:135], a[92:95]
    v_exp_f32 v94, v94
    v_mfma_f32_16x16x32_bf16 a[124:127], v[72:75], v[140:143], a[124:127]
    v_exp_f32 v95, v95
    v_mfma_f32_16x16x32_bf16 a[156:159], v[72:75], v[148:151], a[156:159]
    v_exp_f32 v96, v96
    v_mfma_f32_16x16x32_bf16 a[240:243], v[248:251], v[116:119], a[240:243]
    v_mfma_f32_16x16x32_bf16 a[244:247], v[248:251], v[124:127], a[244:247]
    v_cvt_pk_bf16_f32 v92, v92, v93
    v_cvt_pk_bf16_f32 v93, v94, v95
    s_waitcnt vmcnt(8)
    s_barrier
    v_mfma_f32_16x16x32_bf16 a[248:251], v[248:251], v[132:135], a[248:251]
    s_add_u32 m0, s34, 24576
    s_nop 0
    buffer_load_dwordx4 v1, s[16:19], s33 offen lds
    v_mfma_f32_16x16x32_bf16 a[252:255], v[248:251], v[140:143], a[252:255]
    buffer_load_dwordx4 v2, s[16:19], s33 offen offset:1024 lds
    v_mfma_f32_16x16x32_bf16 v[20:23], v[248:251], v[148:151], v[20:23]
    s_add_u32 m0, s34, 90112
    s_nop 0
    buffer_load_dwordx4 v1, s[20:23], s33 offen lds
    s_waitcnt lgkmcnt(1)
    v_mfma_f32_16x16x32_bf16 v[116:119], v[44:47], a[160:163], v[24:27]
    ds_read_b128 v[52:55], v6 offset:57344
    ds_read_b128 v[56:59], v7 offset:57344
    v_mfma_f32_16x16x32_bf16 v[124:127], v[44:47], a[176:179], v[28:31]
    buffer_load_dwordx4 v2, s[20:23], s33 offen offset:1024 lds
    s_add_u32 s33, s33, 8192
    v_mfma_f32_16x16x32_bf16 v[132:135], v[44:47], a[192:195], v[32:35]
    s_cmp_eq_u32 s50, 1
    s_cbranch_scc1 L_c5_q5a
    s_cmp_eq_u32 s50, 2
    s_cbranch_scc0 L_c5_q5e
    s_add_u32 s38, s44, 12288
    buffer_load_dwordx4 v[208:211], v16, s[12:15], s38 offen offset:64
    s_branch L_c5_q5e
L_c5_q5a:
    s_add_u32 s38, s44, 4096
    buffer_load_dwordx4 v[176:179], v16, s[12:15], s38 offen offset:64
L_c5_q5e:
    v_mfma_f32_16x16x32_bf16 v[140:143], v[44:47], a[208:211], v[36:39]
    v_exp_f32 v97, v97
    v_mfma_f32_16x16x32_bf16 v[148:151], v[44:47], a[224:227], v[40:43]
    v_exp_f32 v98, v98
    s_waitcnt lgkmcnt(2)
    v_mfma_f32_16x16x32_bf16 v[116:119], v[48:51], a[164:167], v[116:119]
    v_exp_f32 v99, v99
    v_mfma_f32_16x16x32_bf16 v[124:127], v[48:51], a[180:183], v[124:127]
    v_mfma_f32_16x16x32_bf16 v[132:135], v[48:51], a[196:199], v[132:135]
    v_cvt_pk_bf16_f32 v94, v96, v97
    v_cvt_pk_bf16_f32 v95, v98, v99
    v_mfma_f32_16x16x32_bf16 v[140:143], v[48:51], a[212:215], v[140:143]
    v_exp_f32 v100, v100
    v_mfma_f32_16x16x32_bf16 v[148:151], v[48:51], a[228:231], v[148:151]
    v_exp_f32 v101, v101
    s_waitcnt lgkmcnt(1)
    v_mfma_f32_16x16x32_bf16 v[116:119], v[52:55], a[168:171], v[116:119]
    ds_read_b128 v[60:63], v4 offset:61440
    ds_read_b128 v[64:67], v5 offset:61440
    v_mfma_f32_16x16x32_bf16 v[124:127], v[52:55], a[184:187], v[124:127]
    v_mfma_f32_16x16x32_bf16 v[132:135], v[52:55], a[200:203], v[132:135]
    v_exp_f32 v102, v102
    v_mfma_f32_16x16x32_bf16 v[140:143], v[52:55], a[216:219], v[140:143]
    v_exp_f32 v103, v103
    v_mfma_f32_16x16x32_bf16 v[148:151], v[52:55], a[232:235], v[148:151]
    v_exp_f32 v104, v104
    s_waitcnt lgkmcnt(2)
    v_mfma_f32_16x16x32_bf16 v[116:119], v[56:59], a[172:175], v[116:119]
    v_mfma_f32_16x16x32_bf16 v[124:127], v[56:59], a[188:191], v[124:127]
    v_cvt_pk_bf16_f32 v100, v100, v101
    v_cvt_pk_bf16_f32 v101, v102, v103
    v_mfma_f32_16x16x32_bf16 v[132:135], v[56:59], a[204:207], v[132:135]
    v_exp_f32 v105, v105
    v_mfma_f32_16x16x32_bf16 v[140:143], v[56:59], a[220:223], v[140:143]
    v_exp_f32 v106, v106
    v_mfma_f32_16x16x32_bf16 v[148:151], v[56:59], a[236:239], v[148:151]
    s_waitcnt lgkmcnt(1)
    v_mfma_f32_16x16x32_bf16 v[120:123], v[60:63], a[160:163], v[24:27]
    ds_read_b128 v[68:71], v6 offset:61440
    ds_read_b128 v[72:75], v7 offset:61440
    v_mfma_f32_16x16x32_bf16 v[128:131], v[60:63], a[176:179], v[28:31]
    v_exp_f32 v107, v107
    v_mfma_f32_16x16x32_bf16 v[136:139], v[60:63], a[192:195], v[32:35]
    v_cvt_pk_bf16_f32 v102, v104, v105
    v_cvt_pk_bf16_f32 v103, v106, v107
    v_mfma_f32_16x16x32_bf16 v[144:147], v[60:63], a[208:211], v[36:39]
    v_exp_f32 v108, v108
    v_mfma_f32_16x16x32_bf16 v[152:155], v[60:63], a[224:227], v[40:43]
    s_waitcnt lgkmcnt(2)
    v_mfma_f32_16x16x32_bf16 v[120:123], v[64:67], a[164:167], v[120:123]
    v_exp_f32 v109, v109
    v_mfma_f32_16x16x32_bf16 v[128:131], v[64:67], a[180:183], v[128:131]
    v_exp_f32 v110, v110
    v_mfma_f32_16x16x32_bf16 v[136:139], v[64:67], a[196:199], v[136:139]
    v_exp_f32 v111, v111
    v_mfma_f32_16x16x32_bf16 v[144:147], v[64:67], a[212:215], v[144:147]
    v_mfma_f32_16x16x32_bf16 v[152:155], v[64:67], a[228:231], v[152:155]
    v_exp_f32 v112, v112
    s_waitcnt lgkmcnt(1)
    v_mfma_f32_16x16x32_bf16 v[120:123], v[68:71], a[168:171], v[120:123]
    ds_read_b64_tr_b16 v[44:45], v8 offset:49152
    ds_read_b64_tr_b16 v[46:47], v8 offset:53248
    v_mfma_f32_16x16x32_bf16 v[128:131], v[68:71], a[184:187], v[128:131]
    v_cvt_pk_bf16_f32 v108, v108, v109
    v_cvt_pk_bf16_f32 v109, v110, v111
    v_mfma_f32_16x16x32_bf16 v[136:139], v[68:71], a[200:203], v[136:139]
    v_exp_f32 v113, v113
    v_mfma_f32_16x16x32_bf16 v[144:147], v[68:71], a[216:219], v[144:147]
    v_mfma_f32_16x16x32_bf16 v[152:155], v[68:71], a[232:235], v[152:155]
    v_exp_f32 v114, v114
    s_waitcnt lgkmcnt(2)
    v_mfma_f32_16x16x32_bf16 v[120:123], v[72:75], a[172:175], v[120:123]
    ds_read_b64_tr_b16 v[48:49], v9 offset:49152
    ds_read_b64_tr_b16 v[50:51], v9 offset:53248
    v_mfma_f32_16x16x32_bf16 v[128:131], v[72:75], a[188:191], v[128:131]
    v_exp_f32 v115, v115
    v_mfma_f32_16x16x32_bf16 v[136:139], v[72:75], a[204:207], v[136:139]
    v_cvt_pk_bf16_f32 v110, v112, v113
    v_cvt_pk_bf16_f32 v111, v114, v115
    v_mfma_f32_16x16x32_bf16 v[144:147], v[72:75], a[220:223], v[144:147]
    v_mfma_f32_16x16x32_bf16 v[152:155], v[72:75], a[236:239], v[152:155]
    s_waitcnt lgkmcnt(2)
    v_mfma_f32_16x16x32_bf16 a[0:3], v[44:47], v[76:79], a[0:3]
    ds_read_b64_tr_b16 v[52:53], v10 offset:49152
    ds_read_b64_tr_b16 v[54:55], v10 offset:53248
    v_mfma_f32_16x16x32_bf16 a[32:35], v[44:47], v[84:87], a[32:35]
    v_mfma_f32_16x16x32_bf16 a[64:67], v[44:47], v[92:95], a[64:67]
    v_exp_f32 v116, v116
    v_mfma_f32_16x16x32_bf16 a[96:99], v[44:47], v[100:103], a[96:99]
    v_exp_f32 v117, v117
    v_mfma_f32_16x16x32_bf16 a[128:131], v[44:47], v[108:111], a[128:131]
    v_exp_f32 v118, v118
    s_waitcnt lgkmcnt(2)
    v_mfma_f32_16x16x32_bf16 a[4:7], v[48:51], v[76:79], a[4:7]
    ds_read_b64_tr_b16 v[56:57], v11 offset:49152
    ds_read_b64_tr_b16 v[58:59], v11 offset:53248
    v_mfma_f32_16x16x32_bf16 a[36:39], v[48:51], v[84:87], a[36:39]
    v_exp_f32 v119, v119
    v_mfma_f32_16x16x32_bf16 a[68:71], v[48:51], v[92:95], a[68:71]
    v_mfma_f32_16x16x32_bf16 a[100:103], v[48:51], v[100:103], a[100:103]
    v_exp_f32 v120, v120
    v_mfma_f32_16x16x32_bf16 a[132:135], v[48:51], v[108:111], a[132:135]
    v_cvt_pk_bf16_f32 v116, v116, v117
    v_cvt_pk_bf16_f32 v117, v118, v119
    s_waitcnt lgkmcnt(2)
    v_mfma_f32_16x16x32_bf16 a[8:11], v[52:55], v[76:79], a[8:11]
    ds_read_b64_tr_b16 v[60:61], v12 offset:49152
    ds_read_b64_tr_b16 v[62:63], v12 offset:53248
    v_mfma_f32_16x16x32_bf16 a[40:43], v[52:55], v[84:87], a[40:43]
    v_exp_f32 v121, v121
    v_mfma_f32_16x16x32_bf16 a[72:75], v[52:55], v[92:95], a[72:75]
    v_mfma_f32_16x16x32_bf16 a[104:107], v[52:55], v[100:103], a[104:107]
    v_exp_f32 v122, v122
    v_mfma_f32_16x16x32_bf16 a[136:139], v[52:55], v[108:111], a[136:139]
    v_exp_f32 v123, v123
    s_waitcnt lgkmcnt(2)
    v_mfma_f32_16x16x32_bf16 a[12:15], v[56:59], v[76:79], a[12:15]
    ds_read_b64_tr_b16 v[64:65], v13 offset:49152
    ds_read_b64_tr_b16 v[66:67], v13 offset:53248
    v_mfma_f32_16x16x32_bf16 a[44:47], v[56:59], v[84:87], a[44:47]
    v_cvt_pk_bf16_f32 v118, v120, v121
    v_cvt_pk_bf16_f32 v119, v122, v123
    v_mfma_f32_16x16x32_bf16 a[76:79], v[56:59], v[92:95], a[76:79]
    v_mfma_f32_16x16x32_bf16 a[108:111], v[56:59], v[100:103], a[108:111]
    v_exp_f32 v124, v124
    v_mfma_f32_16x16x32_bf16 a[140:143], v[56:59], v[108:111], a[140:143]
    v_exp_f32 v125, v125
    s_waitcnt lgkmcnt(2)
    v_mfma_f32_16x16x32_bf16 a[16:19], v[60:63], v[76:79], a[16:19]
    ds_read_b64_tr_b16 v[68:69], v14 offset:49152
    ds_read_b64_tr_b16 v[70:71], v14 offset:53248
    v_mfma_f32_16x16x32_bf16 a[48:51], v[60:63], v[84:87], a[48:51]
    v_exp_f32 v126, v126
    v_mfma_f32_16x16x32_bf16 a[80:83], v[60:63], v[92:95], a[80:83]
    v_mfma_f32_16x16x32_bf16 a[112:115], v[60:63], v[100:103], a[112:115]
    v_exp_f32 v127, v127
    v_mfma_f32_16x16x32_bf16 a[144:147], v[60:63], v[108:111], a[144:147]
    v_exp_f32 v128, v128
    s_waitcnt lgkmcnt(2)
    v_mfma_f32_16x16x32_bf16 a[20:23], v[64:67], v[76:79], a[20:23]
    ds_read_b64_tr_b16 v[72:73], v15 offset:49152
    ds_read_b64_tr_b16 v[74:75], v15 offset:53248
    v_mfma_f32_16x16x32_bf16 a[52:55], v[64:67], v[84:87], a[52:55]
    v_cvt_pk_bf16_f32 v124, v124, v125
    v_cvt_pk_bf16_f32 v125, v126, v127
    v_mfma_f32_16x16x32_bf16 a[84:87], v[64:67], v[92:95], a[84:87]
    v_mfma_f32_16x16x32_bf16 a[116:119], v[64:67], v[100:103], a[116:119]
    v_exp_f32 v129, v129
    v_mfma_f32_16x16x32_bf16 a[148:151], v[64:67], v[108:111], a[148:151]
    v_exp_f32 v130, v130
    s_waitcnt lgkmcnt(2)
    v_mfma_f32_16x16x32_bf16 a[24:27], v[68:71], v[76:79], a[24:27]
    ds_read_b128 v[44:47], v4 offset:0
    ds_read_b128 v[48:51], v5 offset:0
    v_mfma_f32_16x16x32_bf16 a[56:59], v[68:71], v[84:87], a[56:59]
    v_exp_f32 v131, v131
    v_mfma_f32_16x16x32_bf16 a[88:91], v[68:71], v[92:95], a[88:91]
    v_mfma_f32_16x16x32_bf16 a[120:123], v[68:71], v[100:103], a[120:123]
    v_cvt_pk_bf16_f32 v126, v128, v129
    v_cvt_pk_bf16_f32 v127, v130, v131
    v_mfma_f32_16x16x32_bf16 a[152:155], v[68:71], v[108:111], a[152:155]
    v_exp_f32 v132, v132
    s_waitcnt lgkmcnt(2)
    v_mfma_f32_16x16x32_bf16 a[28:31], v[72:75], v[76:79], a[28:31]
    v_exp_f32 v133, v133
    v_mfma_f32_16x16x32_bf16 a[60:63], v[72:75], v[84:87], a[60:63]
    v_mfma_f32_16x16x32_bf16 a[92:95], v[72:75], v[92:95], a[92:95]
    v_exp_f32 v134, v134
    v_mfma_f32_16x16x32_bf16 a[124:127], v[72:75], v[100:103], a[124:127]
    v_exp_f32 v135, v135
    v_mfma_f32_16x16x32_bf16 a[156:159], v[72:75], v[108:111], a[156:159]
    v_exp_f32 v136, v136
    v_mfma_f32_16x16x32_bf16 a[240:243], v[248:251], v[76:79], a[240:243]
    v_mfma_f32_16x16x32_bf16 a[244:247], v[248:251], v[84:87], a[244:247]
    v_cvt_pk_bf16_f32 v132, v132, v133
    v_cvt_pk_bf16_f32 v133, v134, v135
    s_waitcnt vmcnt(8)
    s_barrier
    v_mfma_f32_16x16x32_bf16 a[248:251], v[248:251], v[92:95], a[248:251]
    s_add_u32 m0, s34, 32768
    s_nop 0
    buffer_load_dwordx4 v1, s[16:19], s33 offen lds
    v_mfma_f32_16x16x32_bf16 a[252:255], v[248:251], v[100:103], a[252:255]
    buffer_load_dwordx4 v2, s[16:19], s33 offen offset:1024 lds
    v_mfma_f32_16x16x32_bf16 v[20:23], v[248:251], v[108:111], v[20:23]
    s_add_u32 m0, s34, 98304
    s_nop 0
    buffer_load_dwordx4 v1, s[20:23], s33 offen lds
    s_waitcnt lgkmcnt(1)
    v_mfma_f32_16x16x32_bf16 v[76:79], v[44:47], a[160:163], v[24:27]
    ds_read_b128 v[52:55], v6 offset:0
    ds_read_b128 v[56:59], v7 offset:0
    v_mfma_f32_16x16x32_bf16 v[84:87], v[44:47], a[176:179], v[28:31]
    buffer_load_dwordx4 v2, s[20:23], s33 offen offset:1024 lds
    s_add_u32 s33, s33, 8192
    v_mfma_f32_16x16x32_bf16 v[92:95], v[44:47], a[192:195], v[32:35]
    s_cmp_eq_u32 s50, 1
    s_cbranch_scc1 L_c5_q6a
    s_cmp_eq_u32 s50, 2
    s_cbranch_scc0 L_c5_q6e
    s_add_u32 s38, s44, 12288
    buffer_load_dwordx4 v[212:215], v16, s[12:15], s38 offen offset:128
    s_branch L_c5_q6e
L_c5_q6a:
    s_add_u32 s38, s44, 4096
    buffer_load_dwordx4 v[180:183], v16, s[12:15], s38 offen offset:128
L_c5_q6e:
    v_mfma_f32_16x16x32_bf16 v[100:103], v[44:47], a[208:211], v[36:39]
    v_exp_f32 v137, v137
    v_mfma_f32_16x16x32_bf16 v[108:111], v[44:47], a[224:227], v[40:43]
    v_exp_f32 v138, v138
    s_waitcnt lgkmcnt(2)
    v_mfma_f32_16x16x32_bf16 v[76:79], v[48:51], a[164:167], v[76:79]
    v_exp_f32 v139, v139
    v_mfma_f32_16x16x32_bf16 v[84:87], v[48:51], a[180:183], v[84:87]
    v_mfma_f32_16x16x32_bf16 v[92:95], v[48:51], a[196:199], v[92:95]
    v_cvt_pk_bf16_f32 v134, v136, v137
    v_cvt_pk_bf16_f32 v135, v138, v139
    v_mfma_f32_16x16x32_bf16 v[100:103], v[48:51], a[212:215], v[100:103]
    v_exp_f32 v140, v140
    v_mfma_f32_16x16x32_bf16 v[108:111], v[48:51], a[228:231], v[108:111]
    v_exp_f32 v141, v141
    s_waitcnt lgkmcnt(1)
    v_mfma_f32_16x16x32_bf16 v[76:79], v[52:55], a[168:171], v[76:79]
    ds_read_b128 v[60:63], v4 offset:4096
    ds_read_b128 v[64:67], v5 offset:4096
    v_mfma_f32_16x16x32_bf16 v[84:87], v[52:55], a[184:187], v[84:87]
    v_mfma_f32_16x16x32_bf16 v[92:95], v[52:55], a[200:203], v[92:95]
    v_exp_f32 v142, v142
    v_mfma_f32_16x16x32_bf16 v[100:103], v[52:55], a[216:219], v[100:103]
    v_exp_f32 v143, v143
    v_mfma_f32_16x16x32_bf16 v[108:111], v[52:55], a[232:235], v[108:111]
    v_exp_f32 v144, v144
    s_waitcnt lgkmcnt(2)
    v_mfma_f32_16x16x32_bf16 v[76:79], v[56:59], a[172:175], v[76:79]
    v_mfma_f32_16x16x32_bf16 v[84:87], v[56:59], a[188:191], v[84:87]
    v_cvt_pk_bf16_f32 v140, v140, v141
    v_cvt_pk_bf16_f32 v141, v142, v143
    v_mfma_f32_16x16x32_bf16 v[92:95], v[56:59], a[204:207], v[92:95]
    v_exp_f32 v145, v145
    v_mfma_f32_16x16x32_bf16 v[100:103], v[56:59], a[220:223], v[100:103]
    v_exp_f32 v146, v146
    v_mfma_f32_16x16x32_bf16 v[108:111], v[56:59], a[236:239], v[108:111]
    s_waitcnt lgkmcnt(1)
    v_mfma_f32_16x16x32_bf16 v[80:83], v[60:63], a[160:163], v[24:27]
    ds_read_b128 v[68:71], v6 offset:4096
    ds_read_b128 v[72:75], v7 offset:4096
    v_mfma_f32_16x16x32_bf16 v[88:91], v[60:63], a[176:179], v[28:31]
    v_exp_f32 v147, v147
    v_mfma_f32_16x16x32_bf16 v[96:99], v[60:63], a[192:195], v[32:35]
    v_cvt_pk_bf16_f32 v142, v144, v145
    v_cvt_pk_bf16_f32 v143, v146, v147
    v_mfma_f32_16x16x32_bf16 v[104:107], v[60:63], a[208:211], v[36:39]
    v_exp_f32 v148, v148
    v_mfma_f32_16x16x32_bf16 v[112:115], v[60:63], a[224:227], v[40:43]
    s_waitcnt lgkmcnt(2)
    v_mfma_f32_16x16x32_bf16 v[80:83], v[64:67], a[164:167], v[80:83]
    v_exp_f32 v149, v149
    v_mfma_f32_16x16x32_bf16 v[88:91], v[64:67], a[180:183], v[88:91]
    v_exp_f32 v150, v150
    v_mfma_f32_16x16x32_bf16 v[96:99], v[64:67], a[196:199], v[96:99]
    v_exp_f32 v151, v151
    v_mfma_f32_16x16x32_bf16 v[104:107], v[64:67], a[212:215], v[104:107]
    v_mfma_f32_16x16x32_bf16 v[112:115], v[64:67], a[228:231], v[112:115]
    v_exp_f32 v152, v152
    s_waitcnt lgkmcnt(1)
    v_mfma_f32_16x16x32_bf16 v[80:83], v[68:71], a[168:171], v[80:83]
    ds_read_b64_tr_b16 v[44:45], v8 offset:57344
    ds_read_b64_tr_b16 v[46:47], v8 offset:61440
    v_mfma_f32_16x16x32_bf16 v[88:91], v[68:71], a[184:187], v[88:91]
    v_cvt_pk_bf16_f32 v148, v148, v149
    v_cvt_pk_bf16_f32 v149, v150, v151
    v_mfma_f32_16x16x32_bf16 v[96:99], v[68:71], a[200:203], v[96:99]
    v_exp_f32 v153, v153
    v_mfma_f32_16x16x32_bf16 v[104:107], v[68:71], a[216:219], v[104:107]
    v_mfma_f32_16x16x32_bf16 v[112:115], v[68:71], a[232:235], v[112:115]
    v_exp_f32 v154, v154
    s_waitcnt lgkmcnt(2)
    v_mfma_f32_16x16x32_bf16 v[80:83], v[72:75], a[172:175], v[80:83]
    ds_read_b64_tr_b16 v[48:49], v9 offset:57344
    ds_read_b64_tr_b16 v[50:51], v9 offset:61440
    v_mfma_f32_16x16x32_bf16 v[88:91], v[72:75], a[188:191], v[88:91]
    v_exp_f32 v155, v155
    v_mfma_f32_16x16x32_bf16 v[96:99], v[72:75], a[204:207], v[96:99]
    v_cvt_pk_bf16_f32 v150, v152, v153
    v_cvt_pk_bf16_f32 v151, v154, v155
    v_mfma_f32_16x16x32_bf16 v[104:107], v[72:75], a[220:223], v[104:107]
    v_mfma_f32_16x16x32_bf16 v[112:115], v[72:75], a[236:239], v[112:115]
    s_waitcnt lgkmcnt(2)
    v_mfma_f32_16x16x32_bf16 a[0:3], v[44:47], v[116:119], a[0:3]
    ds_read_b64_tr_b16 v[52:53], v10 offset:57344
    ds_read_b64_tr_b16 v[54:55], v10 offset:61440
    v_mfma_f32_16x16x32_bf16 a[32:35], v[44:47], v[124:127], a[32:35]
    v_mfma_f32_16x16x32_bf16 a[64:67], v[44:47], v[132:135], a[64:67]
    v_exp_f32 v76, v76
    v_mfma_f32_16x16x32_bf16 a[96:99], v[44:47], v[140:143], a[96:99]
    v_exp_f32 v77, v77
    v_mfma_f32_16x16x32_bf16 a[128:131], v[44:47], v[148:151], a[128:131]
    v_exp_f32 v78, v78
    s_waitcnt lgkmcnt(2)
    v_mfma_f32_16x16x32_bf16 a[4:7], v[48:51], v[116:119], a[4:7]
    ds_read_b64_tr_b16 v[56:57], v11 offset:57344
    ds_read_b64_tr_b16 v[58:59], v11 offset:61440
    v_mfma_f32_16x16x32_bf16 a[36:39], v[48:51], v[124:127], a[36:39]
    v_exp_f32 v79, v79
    v_mfma_f32_16x16x32_bf16 a[68:71], v[48:51], v[132:135], a[68:71]
    v_mfma_f32_16x16x32_bf16 a[100:103], v[48:51], v[140:143], a[100:103]
    v_exp_f32 v80, v80
    v_mfma_f32_16x16x32_bf16 a[132:135], v[48:51], v[148:151], a[132:135]
    v_cvt_pk_bf16_f32 v76, v76, v77
    v_cvt_pk_bf16_f32 v77, v78, v79
    s_waitcnt lgkmcnt(2)
    v_mfma_f32_16x16x32_bf16 a[8:11], v[52:55], v[116:119], a[8:11]
    ds_read_b64_tr_b16 v[60:61], v12 offset:57344
    ds_read_b64_tr_b16 v[62:63], v12 offset:61440
    v_mfma_f32_16x16x32_bf16 a[40:43], v[52:55], v[124:127], a[40:43]
    v_exp_f32 v81, v81
    v_mfma_f32_16x16x32_bf16 a[72:75], v[52:55], v[132:135], a[72:75]
    v_mfma_f32_16x16x32_bf16 a[104:107], v[52:55], v[140:143], a[104:107]
    v_exp_f32 v82, v82
    v_mfma_f32_16x16x32_bf16 a[136:139], v[52:55], v[148:151], a[136:139]
    v_exp_f32 v83, v83
    s_waitcnt lgkmcnt(2)
    v_mfma_f32_16x16x32_bf16 a[12:15], v[56:59], v[116:119], a[12:15]
    ds_read_b64_tr_b16 v[64:65], v13 offset:57344
    ds_read_b64_tr_b16 v[66:67], v13 offset:61440
    v_mfma_f32_16x16x32_bf16 a[44:47], v[56:59], v[124:127], a[44:47]
    v_cvt_pk_bf16_f32 v78, v80, v81
    v_cvt_pk_bf16_f32 v79, v82, v83
    s_nop 1
    v_mfma_f32_16x16x32_bf16 a[76:79], v[56:59], v[132:135], a[76:79]
    v_mfma_f32_16x16x32_bf16 a[108:111], v[56:59], v[140:143], a[108:111]
    v_exp_f32 v84, v84
    v_mfma_f32_16x16x32_bf16 a[140:143], v[56:59], v[148:151], a[140:143]
    v_exp_f32 v85, v85
    s_waitcnt lgkmcnt(2)
    v_mfma_f32_16x16x32_bf16 a[16:19], v[60:63], v[116:119], a[16:19]
    ds_read_b64_tr_b16 v[68:69], v14 offset:57344
    ds_read_b64_tr_b16 v[70:71], v14 offset:61440
    v_mfma_f32_16x16x32_bf16 a[48:51], v[60:63], v[124:127], a[48:51]
    v_exp_f32 v86, v86
    v_mfma_f32_16x16x32_bf16 a[80:83], v[60:63], v[132:135], a[80:83]
    v_mfma_f32_16x16x32_bf16 a[112:115], v[60:63], v[140:143], a[112:115]
    v_exp_f32 v87, v87
    v_mfma_f32_16x16x32_bf16 a[144:147], v[60:63], v[148:151], a[144:147]
    v_exp_f32 v88, v88
    s_waitcnt lgkmcnt(2)
    v_mfma_f32_16x16x32_bf16 a[20:23], v[64:67], v[116:119], a[20:23]
    ds_read_b64_tr_b16 v[72:73], v15 offset:57344
    ds_read_b64_tr_b16 v[74:75], v15 offset:61440
    v_mfma_f32_16x16x32_bf16 a[52:55], v[64:67], v[124:127], a[52:55]
    v_cvt_pk_bf16_f32 v84, v84, v85
    v_cvt_pk_bf16_f32 v85, v86, v87
    s_nop 1
    v_mfma_f32_16x16x32_bf16 a[84:87], v[64:67], v[132:135], a[84:87]
    v_mfma_f32_16x16x32_bf16 a[116:119], v[64:67], v[140:143], a[116:119]
    v_exp_f32 v89, v89
    v_mfma_f32_16x16x32_bf16 a[148:151], v[64:67], v[148:151], a[148:151]
    v_exp_f32 v90, v90
    s_waitcnt lgkmcnt(2)
    v_mfma_f32_16x16x32_bf16 a[24:27], v[68:71], v[116:119], a[24:27]
    ds_read_b128 v[44:47], v4 offset:8192
    ds_read_b128 v[48:51], v5 offset:8192
    v_mfma_f32_16x16x32_bf16 a[56:59], v[68:71], v[124:127], a[56:59]
    v_exp_f32 v91, v91
    s_nop 1
    v_mfma_f32_16x16x32_bf16 a[88:91], v[68:71], v[132:135], a[88:91]
    v_mfma_f32_16x16x32_bf16 a[120:123], v[68:71], v[140:143], a[120:123]
    v_cvt_pk_bf16_f32 v86, v88, v89
    v_cvt_pk_bf16_f32 v87, v90, v91
    v_mfma_f32_16x16x32_bf16 a[152:155], v[68:71], v[148:151], a[152:155]
    v_exp_f32 v92, v92
    s_waitcnt lgkmcnt(2)
    v_mfma_f32_16x16x32_bf16 a[28:31], v[72:75], v[116:119], a[28:31]
    v_exp_f32 v93, v93
    v_mfma_f32_16x16x32_bf16 a[60:63], v[72:75], v[124:127], a[60:63]
    s_nop 0
    v_mfma_f32_16x16x32_bf16 a[92:95], v[72:75], v[132:135], a[92:95]
    v_exp_f32 v94, v94
    v_mfma_f32_16x16x32_bf16 a[124:127], v[72:75], v[140:143], a[124:127]
    v_exp_f32 v95, v95
    v_mfma_f32_16x16x32_bf16 a[156:159], v[72:75], v[148:151], a[156:159]
    v_exp_f32 v96, v96
    v_mfma_f32_16x16x32_bf16 a[240:243], v[248:251], v[116:119], a[240:243]
    v_mfma_f32_16x16x32_bf16 a[244:247], v[248:251], v[124:127], a[244:247]
    v_cvt_pk_bf16_f32 v92, v92, v93
    v_cvt_pk_bf16_f32 v93, v94, v95
    s_waitcnt vmcnt(8)
    s_barrier
    v_mfma_f32_16x16x32_bf16 a[248:251], v[248:251], v[132:135], a[248:251]
    s_add_u32 m0, s34, 40960
    s_nop 0
    buffer_load_dwordx4 v1, s[16:19], s33 offen lds
    v_mfma_f32_16x16x32_bf16 a[252:255], v[248:251], v[140:143], a[252:255]
    buffer_load_dwordx4 v2, s[16:19], s33 offen offset:1024 lds
    v_mfma_f32_16x16x32_bf16 v[20:23], v[248:251], v[148:151], v[20:23]
    s_add_u32 m0, s34, 106496
    s_nop 0
    buffer_load_dwordx4 v1, s[20:23], s33 offen lds
    s_waitcnt lgkmcnt(1)
    v_mfma_f32_16x16x32_bf16 v[116:119], v[44:47], a[160:163], v[24:27]
    ds_read_b128 v[52:55], v6 offset:8192
    ds_read_b128 v[56:59], v7 offset:8192
    v_mfma_f32_16x16x32_bf16 v[124:127], v[44:47], a[176:179], v[28:31]
    buffer_load_dwordx4 v2, s[20:23], s33 offen offset:1024 lds
    s_add_u32 s33, s33, 8192
    v_mfma_f32_16x16x32_bf16 v[132:135], v[44:47], a[192:195], v[32:35]
    s_cmp_eq_u32 s50, 1
    s_cbranch_scc1 L_c5_q7a
    s_cmp_eq_u32 s50, 2
    s_cbranch_scc0 L_c5_q7e
    s_add_u32 s38, s44, 12288
    buffer_load_dwordx4 v[216:219], v16, s[12:15], s38 offen offset:192
    s_branch L_c5_q7e
L_c5_q7a:
    s_add_u32 s38, s44, 4096
    buffer_load_dwordx4 v[184:187], v16, s[12:15], s38 offen offset:192
L_c5_q7e:
    v_mfma_f32_16x16x32_bf16 v[140:143], v[44:47], a[208:211], v[36:39]
    v_exp_f32 v97, v97
    v_mfma_f32_16x16x32_bf16 v[148:151], v[44:47], a[224:227], v[40:43]
    v_exp_f32 v98, v98
    s_waitcnt lgkmcnt(2)
    v_mfma_f32_16x16x32_bf16 v[116:119], v[48:51], a[164:167], v[116:119]
    v_exp_f32 v99, v99
    v_mfma_f32_16x16x32_bf16 v[124:127], v[48:51], a[180:183], v[124:127]
    v_mfma_f32_16x16x32_bf16 v[132:135], v[48:51], a[196:199], v[132:135]
    v_cvt_pk_bf16_f32 v94, v96, v97
    v_cvt_pk_bf16_f32 v95, v98, v99
    v_mfma_f32_16x16x32_bf16 v[140:143], v[48:51], a[212:215], v[140:143]
    v_exp_f32 v100, v100
    v_mfma_f32_16x16x32_bf16 v[148:151], v[48:51], a[228:231], v[148:151]
    v_exp_f32 v101, v101
    s_waitcnt lgkmcnt(1)
    v_mfma_f32_16x16x32_bf16 v[116:119], v[52:55], a[168:171], v[116:119]
    ds_read_b128 v[60:63], v4 offset:12288
    ds_read_b128 v[64:67], v5 offset:12288
    v_mfma_f32_16x16x32_bf16 v[124:127], v[52:55], a[184:187], v[124:127]
    v_mfma_f32_16x16x32_bf16 v[132:135], v[52:55], a[200:203], v[132:135]
    v_exp_f32 v102, v102
    v_mfma_f32_16x16x32_bf16 v[140:143], v[52:55], a[216:219], v[140:143]
    v_exp_f32 v103, v103
    v_mfma_f32_16x16x32_bf16 v[148:151], v[52:55], a[232:235], v[148:151]
    v_exp_f32 v104, v104
    s_waitcnt lgkmcnt(2)
    v_mfma_f32_16x16x32_bf16 v[116:119], v[56:59], a[172:175], v[116:119]
    v_mfma_f32_16x16x32_bf16 v[124:127], v[56:59], a[188:191], v[124:127]
    v_cvt_pk_bf16_f32 v100, v100, v101
    v_cvt_pk_bf16_f32 v101, v102, v103
    v_mfma_f32_16x16x32_bf16 v[132:135], v[56:59], a[204:207], v[132:135]
    v_exp_f32 v105, v105
    v_mfma_f32_16x16x32_bf16 v[140:143], v[56:59], a[220:223], v[140:143]
    v_exp_f32 v106, v106
    v_mfma_f32_16x16x32_bf16 v[148:151], v[56:59], a[236:239], v[148:151]
    s_waitcnt lgkmcnt(1)
    v_mfma_f32_16x16x32_bf16 v[120:123], v[60:63], a[160:163], v[24:27]
    ds_read_b128 v[68:71], v6 offset:12288
    ds_read_b128 v[72:75], v7 offset:12288
    v_mfma_f32_16x16x32_bf16 v[128:131], v[60:63], a[176:179], v[28:31]
    v_exp_f32 v107, v107
    v_mfma_f32_16x16x32_bf16 v[136:139], v[60:63], a[192:195], v[32:35]
    v_cvt_pk_bf16_f32 v102, v104, v105
    v_cvt_pk_bf16_f32 v103, v106, v107
    v_mfma_f32_16x16x32_bf16 v[144:147], v[60:63], a[208:211], v[36:39]
    v_exp_f32 v108, v108
    v_mfma_f32_16x16x32_bf16 v[152:155], v[60:63], a[224:227], v[40:43]
    s_waitcnt lgkmcnt(2)
    v_mfma_f32_16x16x32_bf16 v[120:123], v[64:67], a[164:167], v[120:123]
    v_exp_f32 v109, v109
    v_mfma_f32_16x16x32_bf16 v[128:131], v[64:67], a[180:183], v[128:131]
    v_exp_f32 v110, v110
    v_mfma_f32_16x16x32_bf16 v[136:139], v[64:67], a[196:199], v[136:139]
    v_exp_f32 v111, v111
    v_mfma_f32_16x16x32_bf16 v[144:147], v[64:67], a[212:215], v[144:147]
    v_mfma_f32_16x16x32_bf16 v[152:155], v[64:67], a[228:231], v[152:155]
    v_exp_f32 v112, v112
    s_waitcnt lgkmcnt(1)
    v_mfma_f32_16x16x32_bf16 v[120:123], v[68:71], a[168:171], v[120:123]
    ds_read_b64_tr_b16 v[44:45], v8 offset:0
    ds_read_b64_tr_b16 v[46:47], v8 offset:4096
    v_mfma_f32_16x16x32_bf16 v[128:131], v[68:71], a[184:187], v[128:131]
    v_cvt_pk_bf16_f32 v108, v108, v109
    v_cvt_pk_bf16_f32 v109, v110, v111
    v_mfma_f32_16x16x32_bf16 v[136:139], v[68:71], a[200:203], v[136:139]
    v_exp_f32 v113, v113
    v_mfma_f32_16x16x32_bf16 v[144:147], v[68:71], a[216:219], v[144:147]
    v_mfma_f32_16x16x32_bf16 v[152:155], v[68:71], a[232:235], v[152:155]
    v_exp_f32 v114, v114
    s_waitcnt lgkmcnt(2)
    v_mfma_f32_16x16x32_bf16 v[120:123], v[72:75], a[172:175], v[120:123]
    ds_read_b64_tr_b16 v[48:49], v9 offset:0
    ds_read_b64_tr_b16 v[50:51], v9 offset:4096
    v_mfma_f32_16x16x32_bf16 v[128:131], v[72:75], a[188:191], v[128:131]
    v_exp_f32 v115, v115
    v_mfma_f32_16x16x32_bf16 v[136:139], v[72:75], a[204:207], v[136:139]
    v_cvt_pk_bf16_f32 v110, v112, v113
    v_cvt_pk_bf16_f32 v111, v114, v115
    v_mfma_f32_16x16x32_bf16 v[144:147], v[72:75], a[220:223], v[144:147]
    v_mfma_f32_16x16x32_bf16 v[152:155], v[72:75], a[236:239], v[152:155]
    s_add_u32 s50, s50, 1
    s_add_u32 s35, s35, 1
    s_cmp_lt_u32 s35, 3
    s_cbranch_scc1 L_c5_loop
    s_cmp_lg_u32 s46, 0
    s_cbranch_scc1 L_c5_tail2
    s_waitcnt lgkmcnt(2)
    v_mfma_f32_16x16x32_bf16 a[0:3], v[44:47], v[76:79], a[0:3]
    ds_read_b64_tr_b16 v[52:53], v10 offset:0
    ds_read_b64_tr_b16 v[54:55], v10 offset:4096
    v_mfma_f32_16x16x32_bf16 a[32:35], v[44:47], v[84:87], a[32:35]
    v_mfma_f32_16x16x32_bf16 a[64:67], v[44:47], v[92:95], a[64:67]
    v_exp_f32 v116, v116
    v_mfma_f32_16x16x32_bf16 a[96:99], v[44:47], v[100:103], a[96:99]
    v_exp_f32 v117, v117
    v_mfma_f32_16x16x32_bf16 a[128:131], v[44:47], v[108:111], a[128:131]
    v_exp_f32 v118, v118
    s_waitcnt lgkmcnt(2)
    v_mfma_f32_16x16x32_bf16 a[4:7], v[48:51], v[76:79], a[4:7]
    ds_read_b64_tr_b16 v[56:57], v11 offset:0
    ds_read_b64_tr_b16 v[58:59], v11 offset:4096
    v_mfma_f32_16x16x32_bf16 a[36:39], v[48:51], v[84:87], a[36:39]
    v_exp_f32 v119, v119
    v_mfma_f32_16x16x32_bf16 a[68:71], v[48:51], v[92:95], a[68:71]
    v_mfma_f32_16x16x32_bf16 a[100:103], v[48:51], v[100:103], a[100:103]
    v_exp_f32 v120, v120
    v_mfma_f32_16x16x32_bf16 a[132:135], v[48:51], v[108:111], a[132:135]
    v_cvt_pk_bf16_f32 v116, v116, v117
    v_cvt_pk_bf16_f32 v117, v118, v119
    s_waitcnt lgkmcnt(2)
    v_mfma_f32_16x16x32_bf16 a[8:11], v[52:55], v[76:79], a[8:11]
    ds_read_b64_tr_b16 v[60:61], v12 offset:0
    ds_read_b64_tr_b16 v[62:63], v12 offset:4096
    v_mfma_f32_16x16x32_bf16 a[40:43], v[52:55], v[84:87], a[40:43]
    v_exp_f32 v121, v121
    v_mfma_f32_16x16x32_bf16 a[72:75], v[52:55], v[92:95], a[72:75]
    v_mfma_f32_16x16x32_bf16 a[104:107], v[52:55], v[100:103], a[104:107]
    v_exp_f32 v122, v122
    v_mfma_f32_16x16x32_bf16 a[136:139], v[52:55], v[108:111], a[136:139]
    v_exp_f32 v123, v123
    s_waitcnt lgkmcnt(2)
    v_mfma_f32_16x16x32_bf16 a[12:15], v[56:59], v[76:79], a[12:15]
    ds_read_b64_tr_b16 v[64:65], v13 offset:0
    ds_read_b64_tr_b16 v[66:67], v13 offset:4096
    v_mfma_f32_16x16x32_bf16 a[44:47], v[56:59], v[84:87], a[44:47]
    v_cvt_pk_bf16_f32 v118, v120, v121
    v_cvt_pk_bf16_f32 v119, v122, v123
    v_mfma_f32_16x16x32_bf16 a[76:79], v[56:59], v[92:95], a[76:79]
    v_mfma_f32_16x16x32_bf16 a[108:111], v[56:59], v[100:103], a[108:111]
    v_exp_f32 v124, v124
    v_mfma_f32_16x16x32_bf16 a[140:143], v[56:59], v[108:111], a[140:143]
    v_exp_f32 v125, v125
    s_waitcnt lgkmcnt(2)
    v_mfma_f32_16x16x32_bf16 a[16:19], v[60:63], v[76:79], a[16:19]
    ds_read_b64_tr_b16 v[68:69], v14 offset:0
    ds_read_b64_tr_b16 v[70:71], v14 offset:4096
    v_mfma_f32_16x16x32_bf16 a[48:51], v[60:63], v[84:87], a[48:51]
    v_exp_f32 v126, v126
    v_mfma_f32_16x16x32_bf16 a[80:83], v[60:63], v[92:95], a[80:83]
    v_mfma_f32_16x16x32_bf16 a[112:115], v[60:63], v[100:103], a[112:115]
    v_exp_f32 v127, v127
    v_mfma_f32_16x16x32_bf16 a[144:147], v[60:63], v[108:111], a[144:147]
    v_exp_f32 v128, v128
    s_waitcnt lgkmcnt(2)
    v_mfma_f32_16x16x32_bf16 a[20:23], v[64:67], v[76:79], a[20:23]
    ds_read_b64_tr_b16 v[72:73], v15 offset:0
    ds_read_b64_tr_b16 v[74:75], v15 offset:4096
    v_mfma_f32_16x16x32_bf16 a[52:55], v[64:67], v[84:87], a[52:55]
    v_cvt_pk_bf16_f32 v124, v124, v125
    v_cvt_pk_bf16_f32 v125, v126, v127
    v_mfma_f32_16x16x32_bf16 a[84:87], v[64:67], v[92:95], a[84:87]
    v_mfma_f32_16x16x32_bf16 a[116:119], v[64:67], v[100:103], a[116:119]
    v_exp_f32 v129, v129
    v_mfma_f32_16x16x32_bf16 a[148:151], v[64:67], v[108:111], a[148:151]
    v_exp_f32 v130, v130
    s_waitcnt lgkmcnt(2)
    v_mfma_f32_16x16x32_bf16 a[24:27], v[68:71], v[76:79], a[24:27]
    ds_read_b128 v[44:47], v4 offset:16384
    ds_read_b128 v[48:51], v5 offset:16384
    v_mfma_f32_16x16x32_bf16 a[56:59], v[68:71], v[84:87], a[56:59]
    v_exp_f32 v131, v131
    v_mfma_f32_16x16x32_bf16 a[88:91], v[68:71], v[92:95], a[88:91]
    v_mfma_f32_16x16x32_bf16 a[120:123], v[68:71], v[100:103], a[120:123]
    v_cvt_pk_bf16_f32 v126, v128, v129
    v_cvt_pk_bf16_f32 v127, v130, v131
    v_mfma_f32_16x16x32_bf16 a[152:155], v[68:71], v[108:111], a[152:155]
    v_exp_f32 v132, v132
    s_waitcnt lgkmcnt(2)
    v_mfma_f32_16x16x32_bf16 a[28:31], v[72:75], v[76:79], a[28:31]
    v_exp_f32 v133, v133
    v_mfma_f32_16x16x32_bf16 a[60:63], v[72:75], v[84:87], a[60:63]
    v_mfma_f32_16x16x32_bf16 a[92:95], v[72:75], v[92:95], a[92:95]
    v_exp_f32 v134, v134
    v_mfma_f32_16x16x32_bf16 a[124:127], v[72:75], v[100:103], a[124:127]
    v_exp_f32 v135, v135
    v_mfma_f32_16x16x32_bf16 a[156:159], v[72:75], v[108:111], a[156:159]
    v_exp_f32 v136, v136
    v_mfma_f32_16x16x32_bf16 a[240:243], v[248:251], v[76:79], a[240:243]
    v_mfma_f32_16x16x32_bf16 a[244:247], v[248:251], v[84:87], a[244:247]
    v_cvt_pk_bf16_f32 v132, v132, v133
    v_cvt_pk_bf16_f32 v133, v134, v135
    s_waitcnt vmcnt(11)
    s_barrier
    v_mfma_f32_16x16x32_bf16 a[248:251], v[248:251], v[92:95], a[248:251]
    s_add_u32 m0, s34, 49152
    s_nop 0
    buffer_load_dwordx4 v1, s[16:19], s33 offen lds
    v_mfma_f32_16x16x32_bf16 a[252:255], v[248:251], v[100:103], a[252:255]
    buffer_load_dwordx4 v2, s[16:19], s33 offen offset:1024 lds
    v_mfma_f32_16x16x32_bf16 v[20:23], v[248:251], v[108:111], v[20:23]
    s_add_u32 m0, s34, 114688
    s_nop 0
    buffer_load_dwordx4 v1, s[20:23], s33 offen lds
    s_waitcnt lgkmcnt(1)
    v_mfma_f32_16x16x32_bf16 v[76:79], v[44:47], a[160:163], v[24:27]
    ds_read_b128 v[52:55], v6 offset:16384
    ds_read_b128 v[56:59], v7 offset:16384
    v_mfma_f32_16x16x32_bf16 v[84:87], v[44:47], a[176:179], v[28:31]
    buffer_load_dwordx4 v2, s[20:23], s33 offen offset:1024 lds
    s_add_u32 s33, s33, 8192
    v_mfma_f32_16x16x32_bf16 v[92:95], v[44:47], a[192:195], v[32:35]
    s_add_u32 s38, s44, 16384
    buffer_load_dwordx4 v[220:223], v16, s[12:15], s38 offen offset:0
    v_mfma_f32_16x16x32_bf16 v[100:103], v[44:47], a[208:211], v[36:39]
    v_exp_f32 v137, v137
    v_mfma_f32_16x16x32_bf16 v[108:111], v[44:47], a[224:227], v[40:43]
    v_exp_f32 v138, v138
    s_waitcnt lgkmcnt(2)
    v_mfma_f32_16x16x32_bf16 v[76:79], v[48:51], a[164:167], v[76:79]
    v_exp_f32 v139, v139
    v_mfma_f32_16x16x32_bf16 v[84:87], v[48:51], a[180:183], v[84:87]
    v_mfma_f32_16x16x32_bf16 v[92:95], v[48:51], a[196:199], v[92:95]
    v_cvt_pk_bf16_f32 v134, v136, v137
    v_cvt_pk_bf16_f32 v135, v138, v139
    v_mfma_f32_16x16x32_bf16 v[100:103], v[48:51], a[212:215], v[100:103]
    v_exp_f32 v140, v140
    v_mfma_f32_16x16x32_bf16 v[108:111], v[48:51], a[228:231], v[108:111]
    v_exp_f32 v141, v141
    s_waitcnt lgkmcnt(1)
    v_mfma_f32_16x16x32_bf16 v[76:79], v[52:55], a[168:171], v[76:79]
    ds_read_b128 v[60:63], v4 offset:20480
    ds_read_b128 v[64:67], v5 offset:20480
    v_mfma_f32_16x16x32_bf16 v[84:87], v[52:55], a[184:187], v[84:87]
    v_mfma_f32_16x16x32_bf16 v[92:95], v[52:55], a[200:203], v[92:95]
    v_exp_f32 v142, v142
    v_mfma_f32_16x16x32_bf16 v[100:103], v[52:55], a[216:219], v[100:103]
    v_exp_f32 v143, v143
    v_mfma_f32_16x16x32_bf16 v[108:111], v[52:55], a[232:235], v[108:111]
    v_exp_f32 v144, v144
    s_waitcnt lgkmcnt(2)
    v_mfma_f32_16x16x32_bf16 v[76:79], v[56:59], a[172:175], v[76:79]
    v_mfma_f32_16x16x32_bf16 v[84:87], v[56:59], a[188:191], v[84:87]
    v_cvt_pk_bf16_f32 v140, v140, v141
    v_cvt_pk_bf16_f32 v141, v142, v143
    v_mfma_f32_16x16x32_bf16 v[92:95], v[56:59], a[204:207], v[92:95]
    v_exp_f32 v145, v145
    v_mfma_f32_16x16x32_bf16 v[100:103], v[56:59], a[220:223], v[100:103]
    v_exp_f32 v146, v146
    v_mfma_f32_16x16x32_bf16 v[108:111], v[56:59], a[236:239], v[108:111]
    s_waitcnt lgkmcnt(1)
    v_mfma_f32_16x16x32_bf16 v[80:83], v[60:63], a[160:163], v[24:27]
    ds_read_b128 v[68:71], v6 offset:20480
    ds_read_b128 v[72:75], v7 offset:20480
    v_mfma_f32_16x16x32_bf16 v[88:91], v[60:63], a[176:179], v[28:31]
    v_exp_f32 v147, v147
    v_mfma_f32_16x16x32_bf16 v[96:99], v[60:63], a[192:195], v[32:35]
    v_cvt_pk_bf16_f32 v142, v144, v145
    v_cvt_pk_bf16_f32 v143, v146, v147
    v_mfma_f32_16x16x32_bf16 v[104:107], v[60:63], a[208:211], v[36:39]
    v_exp_f32 v148, v148
    v_mfma_f32_16x16x32_bf16 v[112:115], v[60:63], a[224:227], v[40:43]
    s_waitcnt lgkmcnt(2)
    v_mfma_f32_16x16x32_bf16 v[80:83], v[64:67], a[164:167], v[80:83]
    v_exp_f32 v149, v149
    v_mfma_f32_16x16x32_bf16 v[88:91], v[64:67], a[180:183], v[88:91]
    v_exp_f32 v150, v150
    v_mfma_f32_16x16x32_bf16 v[96:99], v[64:67], a[196:199], v[96:99]
    v_exp_f32 v151, v151
    v_mfma_f32_16x16x32_bf16 v[104:107], v[64:67], a[212:215], v[104:107]
    v_mfma_f32_16x16x32_bf16 v[112:115], v[64:67], a[228:231], v[112:115]
    v_exp_f32 v152, v152
    s_waitcnt lgkmcnt(1)
    v_mfma_f32_16x16x32_bf16 v[80:83], v[68:71], a[168:171], v[80:83]
    ds_read_b64_tr_b16 v[44:45], v8 offset:8192
    ds_read_b64_tr_b16 v[46:47], v8 offset:12288
    v_mfma_f32_16x16x32_bf16 v[88:91], v[68:71], a[184:187], v[88:91]
    v_cvt_pk_bf16_f32 v148, v148, v149
    v_cvt_pk_bf16_f32 v149, v150, v151
    v_mfma_f32_16x16x32_bf16 v[96:99], v[68:71], a[200:203], v[96:99]
    v_exp_f32 v153, v153
    v_mfma_f32_16x16x32_bf16 v[104:107], v[68:71], a[216:219], v[104:107]
    v_mfma_f32_16x16x32_bf16 v[112:115], v[68:71], a[232:235], v[112:115]
    v_exp_f32 v154, v154
    s_waitcnt lgkmcnt(2)
    v_mfma_f32_16x16x32_bf16 v[80:83], v[72:75], a[172:175], v[80:83]
    ds_read_b64_tr_b16 v[48:49], v9 offset:8192
    ds_read_b64_tr_b16 v[50:51], v9 offset:12288
    v_mfma_f32_16x16x32_bf16 v[88:91], v[72:75], a[188:191], v[88:91]
    v_exp_f32 v155, v155
    v_mfma_f32_16x16x32_bf16 v[96:99], v[72:75], a[204:207], v[96:99]
    v_cvt_pk_bf16_f32 v150, v152, v153
    v_cvt_pk_bf16_f32 v151, v154, v155
    v_mfma_f32_16x16x32_bf16 v[104:107], v[72:75], a[220:223], v[104:107]
    v_mfma_f32_16x16x32_bf16 v[112:115], v[72:75], a[236:239], v[112:115]
    s_waitcnt lgkmcnt(2)
    v_mfma_f32_16x16x32_bf16 a[0:3], v[44:47], v[116:119], a[0:3]
    ds_read_b64_tr_b16 v[52:53], v10 offset:8192
    ds_read_b64_tr_b16 v[54:55], v10 offset:12288
    v_mfma_f32_16x16x32_bf16 a[32:35], v[44:47], v[124:127], a[32:35]
    v_mfma_f32_16x16x32_bf16 a[64:67], v[44:47], v[132:135], a[64:67]
    v_exp_f32 v76, v76
    v_mfma_f32_16x16x32_bf16 a[96:99], v[44:47], v[140:143], a[96:99]
    v_lshlrev_b32 v236, 16, v156
    v_and_b32 v237, 0xffff0000, v156
    v_mfma_f32_16x16x32_bf16 a[128:131], v[44:47], v[148:151], a[128:131]
    v_exp_f32 v77, v77
    s_waitcnt lgkmcnt(2)
    v_mfma_f32_16x16x32_bf16 a[4:7], v[48:51], v[116:119], a[4:7]
    ds_read_b64_tr_b16 v[56:57], v11 offset:8192
    ds_read_b64_tr_b16 v[58:59], v11 offset:12288
    v_mfma_f32_16x16x32_bf16 a[36:39], v[48:51], v[124:127], a[36:39]
    v_exp_f32 v78, v78
    v_mfma_f32_16x16x32_bf16 a[68:71], v[48:51], v[132:135], a[68:71]
    v_exp_f32 v79, v79
    v_mfma_f32_16x16x32_bf16 a[100:103], v[48:51], v[140:143], a[100:103]
    v_lshlrev_b32 v238, 16, v157
    v_and_b32 v239, 0xffff0000, v157
    v_mfma_f32_16x16x32_bf16 a[132:135], v[48:51], v[148:151], a[132:135]
    v_exp_f32 v80, v80
    s_waitcnt lgkmcnt(2)
    v_mfma_f32_16x16x32_bf16 a[8:11], v[52:55], v[116:119], a[8:11]
    ds_read_b64_tr_b16 v[60:61], v12 offset:8192
    ds_read_b64_tr_b16 v[62:63], v12 offset:12288
    v_mfma_f32_16x16x32_bf16 a[40:43], v[52:55], v[124:127], a[40:43]
    v_cvt_pk_bf16_f32 v76, v76, v77
    v_cvt_pk_bf16_f32 v77, v78, v79
    v_mfma_f32_16x16x32_bf16 a[72:75], v[52:55], v[132:135], a[72:75]
    v_exp_f32 v81, v81
    v_mfma_f32_16x16x32_bf16 a[104:107], v[52:55], v[140:143], a[104:107]
    v_pk_mul_f32 v[236:237], v[236:237], s[36:37]
    v_pk_mul_f32 v[238:239], v[238:239], s[36:37]
    v_cvt_pk_bf16_f32 v156, v236, v237
    v_cvt_pk_bf16_f32 v157, v238, v239
    v_mfma_f32_16x16x32_bf16 a[136:139], v[52:55], v[148:151], a[136:139]
    v_exp_f32 v82, v82
    s_waitcnt lgkmcnt(2)
    v_mfma_f32_16x16x32_bf16 a[12:15], v[56:59], v[116:119], a[12:15]
    ds_read_b64_tr_b16 v[64:65], v13 offset:8192
    ds_read_b64_tr_b16 v[66:67], v13 offset:12288
    v_mfma_f32_16x16x32_bf16 a[44:47], v[56:59], v[124:127], a[44:47]
    v_exp_f32 v83, v83
    v_mfma_f32_16x16x32_bf16 a[76:79], v[56:59], v[132:135], a[76:79]
    v_cvt_pk_bf16_f32 v78, v80, v81
    v_cvt_pk_bf16_f32 v79, v82, v83
    v_mfma_f32_16x16x32_bf16 a[108:111], v[56:59], v[140:143], a[108:111]
    v_lshlrev_b32 v240, 16, v158
    v_and_b32 v241, 0xffff0000, v158
    v_mfma_f32_16x16x32_bf16 a[140:143], v[56:59], v[148:151], a[140:143]
    v_exp_f32 v84, v84
    s_waitcnt lgkmcnt(2)
    v_mfma_f32_16x16x32_bf16 a[16:19], v[60:63], v[116:119], a[16:19]
    ds_read_b64_tr_b16 v[68:69], v14 offset:8192
    ds_read_b64_tr_b16 v[70:71], v14 offset:12288
    v_mfma_f32_16x16x32_bf16 a[48:51], v[60:63], v[124:127], a[48:51]
    v_exp_f32 v85, v85
    v_mfma_f32_16x16x32_bf16 a[80:83], v[60:63], v[132:135], a[80:83]
    v_exp_f32 v86, v86
    v_mfma_f32_16x16x32_bf16 a[112:115], v[60:63], v[140:143], a[112:115]
    v_lshlrev_b32 v242, 16, v159
    v_and_b32 v243, 0xffff0000, v159
    v_mfma_f32_16x16x32_bf16 a[144:147], v[60:63], v[148:151], a[144:147]
    v_exp_f32 v87, v87
    s_waitcnt lgkmcnt(2)
    v_mfma_f32_16x16x32_bf16 a[20:23], v[64:67], v[116:119], a[20:23]
    ds_read_b64_tr_b16 v[72:73], v15 offset:8192
    ds_read_b64_tr_b16 v[74:75], v15 offset:12288
    v_mfma_f32_16x16x32_bf16 a[52:55], v[64:67], v[124:127], a[52:55]
    v_exp_f32 v88, v88
    v_mfma_f32_16x16x32_bf16 a[84:87], v[64:67], v[132:135], a[84:87]
    v_cvt_pk_bf16_f32 v84, v84, v85
    v_cvt_pk_bf16_f32 v85, v86, v87
    v_mfma_f32_16x16x32_bf16 a[116:119], v[64:67], v[140:143], a[116:119]
    v_pk_mul_f32 v[240:241], v[240:241], s[36:37]
    v_pk_mul_f32 v[242:243], v[242:243], s[36:37]
    v_cvt_pk_bf16_f32 v158, v240, v241
    v_cvt_pk_bf16_f32 v159, v242, v243
    v_mfma_f32_16x16x32_bf16 a[148:151], v[64:67], v[148:151], a[148:151]
    v_exp_f32 v89, v89
    s_waitcnt lgkmcnt(2)
    v_mfma_f32_16x16x32_bf16 a[24:27], v[68:71], v[116:119], a[24:27]
    ds_read_b128 v[44:47], v4 offset:24576
    ds_read_b128 v[48:51], v5 offset:24576
    v_mfma_f32_16x16x32_bf16 a[56:59], v[68:71], v[124:127], a[56:59]
    v_exp_f32 v90, v90
    s_nop 1
    v_mfma_f32_16x16x32_bf16 a[88:91], v[68:71], v[132:135], a[88:91]
    v_exp_f32 v91, v91
    v_mfma_f32_16x16x32_bf16 a[120:123], v[68:71], v[140:143], a[120:123]
    v_lshlrev_b32 v236, 16, v160
    v_and_b32 v237, 0xffff0000, v160
    v_mfma_f32_16x16x32_bf16 a[152:155], v[68:71], v[148:151], a[152:155]
    v_cvt_pk_bf16_f32 v86, v88, v89
    v_cvt_pk_bf16_f32 v87, v90, v91
    s_waitcnt lgkmcnt(2)
    v_mfma_f32_16x16x32_bf16 a[28:31], v[72:75], v[116:119], a[28:31]
    v_exp_f32 v92, v92
    v_mfma_f32_16x16x32_bf16 a[60:63], v[72:75], v[124:127], a[60:63]
    v_exp_f32 v93, v93
    s_nop 1
    v_mfma_f32_16x16x32_bf16 a[92:95], v[72:75], v[132:135], a[92:95]
    v_lshlrev_b32 v238, 16, v161
    v_and_b32 v239, 0xffff0000, v161
    v_mfma_f32_16x16x32_bf16 a[124:127], v[72:75], v[140:143], a[124:127]
    v_exp_f32 v94, v94
    v_mfma_f32_16x16x32_bf16 a[156:159], v[72:75], v[148:151], a[156:159]
    v_exp_f32 v95, v95
    v_mfma_f32_16x16x32_bf16 a[240:243], v[248:251], v[116:119], a[240:243]
    v_exp_f32 v96, v96
    v_mfma_f32_16x16x32_bf16 a[244:247], v[248:251], v[124:127], a[244:247]
    v_cvt_pk_bf16_f32 v92, v92, v93
    v_cvt_pk_bf16_f32 v93, v94, v95
    s_waitcnt vmcnt(11)
    s_barrier
    v_mfma_f32_16x16x32_bf16 a[248:251], v[248:251], v[132:135], a[248:251]
    s_add_u32 m0, s34, 57344
    s_nop 0
    buffer_load_dwordx4 v1, s[16:19], s33 offen lds
    v_mfma_f32_16x16x32_bf16 a[252:255], v[248:251], v[140:143], a[252:255]
    buffer_load_dwordx4 v2, s[16:19], s33 offen offset:1024 lds
    v_mfma_f32_16x16x32_bf16 v[20:23], v[248:251], v[148:151], v[20:23]
    s_add_u32 m0, s34, 122880
    s_nop 0
    buffer_load_dwordx4 v1, s[20:23], s33 offen lds
    s_waitcnt lgkmcnt(1)
    v_mfma_f32_16x16x32_bf16 v[116:119], v[44:47], a[160:163], v[24:27]
    ds_read_b128 v[52:55], v6 offset:24576
    ds_read_b128 v[56:59], v7 offset:24576
    v_mfma_f32_16x16x32_bf16 v[124:127], v[44:47], a[176:179], v[28:31]
    buffer_load_dwordx4 v2, s[20:23], s33 offen offset:1024 lds
    s_add_u32 s33, s33, 8192
    v_mfma_f32_16x16x32_bf16 v[132:135], v[44:47], a[192:195], v[32:35]
    s_add_u32 s38, s44, 16384
    buffer_load_dwordx4 v[224:227], v16, s[12:15], s38 offen offset:64
    v_mfma_f32_16x16x32_bf16 v[140:143], v[44:47], a[208:211], v[36:39]
    v_pk_mul_f32 v[236:237], v[236:237], s[36:37]
    v_pk_mul_f32 v[238:239], v[238:239], s[36:37]
    v_cvt_pk_bf16_f32 v160, v236, v237
    v_cvt_pk_bf16_f32 v161, v238, v239
    v_mfma_f32_16x16x32_bf16 v[148:151], v[44:47], a[224:227], v[40:43]
    v_exp_f32 v97, v97
    s_waitcnt lgkmcnt(2)
    v_mfma_f32_16x16x32_bf16 v[116:119], v[48:51], a[164:167], v[116:119]
    v_exp_f32 v98, v98
    v_mfma_f32_16x16x32_bf16 v[124:127], v[48:51], a[180:183], v[124:127]
    v_exp_f32 v99, v99
    v_mfma_f32_16x16x32_bf16 v[132:135], v[48:51], a[196:199], v[132:135]
    v_lshlrev_b32 v240, 16, v162
    v_and_b32 v241, 0xffff0000, v162
    v_mfma_f32_16x16x32_bf16 v[140:143], v[48:51], a[212:215], v[140:143]
    v_cvt_pk_bf16_f32 v94, v96, v97
    v_cvt_pk_bf16_f32 v95, v98, v99
    v_mfma_f32_16x16x32_bf16 v[148:151], v[48:51], a[228:231], v[148:151]
    v_exp_f32 v100, v100
    s_waitcnt lgkmcnt(1)
    v_mfma_f32_16x16x32_bf16 v[116:119], v[52:55], a[168:171], v[116:119]
    ds_read_b128 v[60:63], v4 offset:28672
    ds_read_b128 v[64:67], v5 offset:28672
    v_mfma_f32_16x16x32_bf16 v[124:127], v[52:55], a[184:187], v[124:127]
    v_exp_f32 v101, v101
    v_mfma_f32_16x16x32_bf16 v[132:135], v[52:55], a[200:203], v[132:135]
    v_lshlrev_b32 v242, 16, v163
    v_and_b32 v243, 0xffff0000, v163
    v_mfma_f32_16x16x32_bf16 v[140:143], v[52:55], a[216:219], v[140:143]
    v_exp_f32 v102, v102
    v_mfma_f32_16x16x32_bf16 v[148:151], v[52:55], a[232:235], v[148:151]
    v_exp_f32 v103, v103
    s_waitcnt lgkmcnt(2)
    v_mfma_f32_16x16x32_bf16 v[116:119], v[56:59], a[172:175], v[116:119]
    v_exp_f32 v104, v104
    v_mfma_f32_16x16x32_bf16 v[124:127], v[56:59], a[188:191], v[124:127]
    v_pk_mul_f32 v[240:241], v[240:241], s[36:37]
    v_pk_mul_f32 v[242:243], v[242:243], s[36:37]
    v_cvt_pk_bf16_f32 v162, v240, v241
    v_cvt_pk_bf16_f32 v163, v242, v243
    v_mfma_f32_16x16x32_bf16 v[132:135], v[56:59], a[204:207], v[132:135]
    v_cvt_pk_bf16_f32 v100, v100, v101
    v_cvt_pk_bf16_f32 v101, v102, v103
    v_mfma_f32_16x16x32_bf16 v[140:143], v[56:59], a[220:223], v[140:143]
    v_exp_f32 v105, v105
    v_mfma_f32_16x16x32_bf16 v[148:151], v[56:59], a[236:239], v[148:151]
    v_exp_f32 v106, v106
    s_waitcnt lgkmcnt(1)
    v_mfma_f32_16x16x32_bf16 v[120:123], v[60:63], a[160:163], v[24:27]
    ds_read_b128 v[68:71], v6 offset:28672
    ds_read_b128 v[72:75], v7 offset:28672
    v_mfma_f32_16x16x32_bf16 v[128:131], v[60:63], a[176:179], v[28:31]
    v_lshlrev_b32 v236, 16, v164
    v_and_b32 v237, 0xffff0000, v164
    v_mfma_f32_16x16x32_bf16 v[136:139], v[60:63], a[192:195], v[32:35]
    v_exp_f32 v107, v107
    v_mfma_f32_16x16x32_bf16 v[144:147], v[60:63], a[208:211], v[36:39]
    v_cvt_pk_bf16_f32 v102, v104, v105
    v_cvt_pk_bf16_f32 v103, v106, v107
    v_mfma_f32_16x16x32_bf16 v[152:155], v[60:63], a[224:227], v[40:43]
    v_exp_f32 v108, v108
    s_waitcnt lgkmcnt(2)
    v_mfma_f32_16x16x32_bf16 v[120:123], v[64:67], a[164:167], v[120:123]
    v_lshlrev_b32 v238, 16, v165
    v_and_b32 v239, 0xffff0000, v165
    v_mfma_f32_16x16x32_bf16 v[128:131], v[64:67], a[180:183], v[128:131]
    v_exp_f32 v109, v109
    v_mfma_f32_16x16x32_bf16 v[136:139], v[64:67], a[196:199], v[136:139]
    v_exp_f32 v110, v110
    v_mfma_f32_16x16x32_bf16 v[144:147], v[64:67], a[212:215], v[144:147]
    v_exp_f32 v111, v111
    v_mfma_f32_16x16x32_bf16 v[152:155], v[64:67], a[228:231], v[152:155]
    v_pk_mul_f32 v[236:237], v[236:237], s[36:37]
    v_pk_mul_f32 v[238:239], v[238:239], s[36:37]
    v_cvt_pk_bf16_f32 v164, v236, v237
    v_cvt_pk_bf16_f32 v165, v238, v239
    s_waitcnt lgkmcnt(1)
    v_mfma_f32_16x16x32_bf16 v[120:123], v[68:71], a[168:171], v[120:123]
    ds_read_b64_tr_b16 v[44:45], v8 offset:16384
    ds_read_b64_tr_b16 v[46:47], v8 offset:20480
    v_mfma_f32_16x16x32_bf16 v[128:131], v[68:71], a[184:187], v[128:131]
    v_exp_f32 v112, v112
    v_mfma_f32_16x16x32_bf16 v[136:139], v[68:71], a[200:203], v[136:139]
    v_cvt_pk_bf16_f32 v108, v108, v109
    v_cvt_pk_bf16_f32 v109, v110, v111
    v_mfma_f32_16x16x32_bf16 v[144:147], v[68:71], a[216:219], v[144:147]
    v_exp_f32 v113, v113
    v_mfma_f32_16x16x32_bf16 v[152:155], v[68:71], a[232:235], v[152:155]
    v_lshlrev_b32 v240, 16, v166
    v_and_b32 v241, 0xffff0000, v166
    s_waitcnt lgkmcnt(2)
    v_mfma_f32_16x16x32_bf16 v[120:123], v[72:75], a[172:175], v[120:123]
    ds_read_b64_tr_b16 v[48:49], v9 offset:16384
    ds_read_b64_tr_b16 v[50:51], v9 offset:20480
    v_mfma_f32_16x16x32_bf16 v[128:131], v[72:75], a[188:191], v[128:131]
    v_exp_f32 v114, v114
    v_mfma_f32_16x16x32_bf16 v[136:139], v[72:75], a[204:207], v[136:139]
    v_exp_f32 v115, v115
    v_mfma_f32_16x16x32_bf16 v[144:147], v[72:75], a[220:223], v[144:147]
    v_cvt_pk_bf16_f32 v110, v112, v113
    v_cvt_pk_bf16_f32 v111, v114, v115
    v_mfma_f32_16x16x32_bf16 v[152:155], v[72:75], a[236:239], v[152:155]
    s_mov_b32 s33, s45
    s_waitcnt lgkmcnt(2)
    v_mfma_f32_16x16x32_bf16 a[0:3], v[44:47], v[76:79], a[0:3]
    ds_read_b64_tr_b16 v[52:53], v10 offset:16384
    ds_read_b64_tr_b16 v[54:55], v10 offset:20480
    v_mfma_f32_16x16x32_bf16 a[32:35], v[44:47], v[84:87], a[32:35]
    v_mfma_f32_16x16x32_bf16 a[64:67], v[44:47], v[92:95], a[64:67]
    v_exp_f32 v116, v116
    v_mfma_f32_16x16x32_bf16 a[96:99], v[44:47], v[100:103], a[96:99]
    v_lshlrev_b32 v242, 16, v167
    v_and_b32 v243, 0xffff0000, v167
    v_mfma_f32_16x16x32_bf16 a[128:131], v[44:47], v[108:111], a[128:131]
    v_exp_f32 v117, v117
    s_waitcnt lgkmcnt(2)
    v_mfma_f32_16x16x32_bf16 a[4:7], v[48:51], v[76:79], a[4:7]
    ds_read_b64_tr_b16 v[56:57], v11 offset:16384
    ds_read_b64_tr_b16 v[58:59], v11 offset:20480
    v_mfma_f32_16x16x32_bf16 a[36:39], v[48:51], v[84:87], a[36:39]
    v_exp_f32 v118, v118
    v_mfma_f32_16x16x32_bf16 a[68:71], v[48:51], v[92:95], a[68:71]
    v_exp_f32 v119, v119
    v_mfma_f32_16x16x32_bf16 a[100:103], v[48:51], v[100:103], a[100:103]
    v_pk_mul_f32 v[240:241], v[240:241], s[36:37]
    v_pk_mul_f32 v[242:243], v[242:243], s[36:37]
    v_cvt_pk_bf16_f32 v166, v240, v241
    v_cvt_pk_bf16_f32 v167, v242, v243
    v_mfma_f32_16x16x32_bf16 a[132:135], v[48:51], v[108:111], a[132:135]
    v_exp_f32 v120, v120
    s_waitcnt lgkmcnt(2)
    v_mfma_f32_16x16x32_bf16 a[8:11], v[52:55], v[76:79], a[8:11]
    ds_read_b64_tr_b16 v[60:61], v12 offset:16384
    ds_read_b64_tr_b16 v[62:63], v12 offset:20480
    v_mfma_f32_16x16x32_bf16 a[40:43], v[52:55], v[84:87], a[40:43]
    v_cvt_pk_bf16_f32 v116, v116, v117
    v_cvt_pk_bf16_f32 v117, v118, v119
    v_mfma_f32_16x16x32_bf16 a[72:75], v[52:55], v[92:95], a[72:75]
    v_exp_f32 v121, v121
    v_mfma_f32_16x16x32_bf16 a[104:107], v[52:55], v[100:103], a[104:107]
    v_lshlrev_b32 v236, 16, v168
    v_and_b32 v237, 0xffff0000, v168
    v_mfma_f32_16x16x32_bf16 a[136:139], v[52:55], v[108:111], a[136:139]
    v_exp_f32 v122, v122
    s_waitcnt lgkmcnt(2)
    v_mfma_f32_16x16x32_bf16 a[12:15], v[56:59], v[76:79], a[12:15]
    ds_read_b64_tr_b16 v[64:65], v13 offset:16384
    ds_read_b64_tr_b16 v[66:67], v13 offset:20480
    v_mfma_f32_16x16x32_bf16 a[44:47], v[56:59], v[84:87], a[44:47]
    v_exp_f32 v123, v123
    v_mfma_f32_16x16x32_bf16 a[76:79], v[56:59], v[92:95], a[76:79]
    v_cvt_pk_bf16_f32 v118, v120, v121
    v_cvt_pk_bf16_f32 v119, v122, v123
    v_mfma_f32_16x16x32_bf16 a[108:111], v[56:59], v[100:103], a[108:111]
    v_lshlrev_b32 v238, 16, v169
    v_and_b32 v239, 0xffff0000, v169
    v_mfma_f32_16x16x32_bf16 a[140:143], v[56:59], v[108:111], a[140:143]
    v_exp_f32 v124, v124
    s_waitcnt lgkmcnt(2)
    v_mfma_f32_16x16x32_bf16 a[16:19], v[60:63], v[76:79], a[16:19]
    ds_read_b64_tr_b16 v[68:69], v14 offset:16384
    ds_read_b64_tr_b16 v[70:71], v14 offset:20480
    v_mfma_f32_16x16x32_bf16 a[48:51], v[60:63], v[84:87], a[48:51]
    v_exp_f32 v125, v125
    v_mfma_f32_16x16x32_bf16 a[80:83], v[60:63], v[92:95], a[80:83]
    v_exp_f32 v126, v126
    v_mfma_f32_16x16x32_bf16 a[112:115], v[60:63], v[100:103], a[112:115]
    v_pk_mul_f32 v[236:237], v[236:237], s[36:37]
    v_pk_mul_f32 v[238:239], v[238:239], s[36:37]
    v_cvt_pk_bf16_f32 v168, v236, v237
    v_cvt_pk_bf16_f32 v169, v238, v239
    v_mfma_f32_16x16x32_bf16 a[144:147], v[60:63], v[108:111], a[144:147]
    v_exp_f32 v127, v127
    s_waitcnt lgkmcnt(2)
    v_mfma_f32_16x16x32_bf16 a[20:23], v[64:67], v[76:79], a[20:23]
    ds_read_b64_tr_b16 v[72:73], v15 offset:16384
    ds_read_b64_tr_b16 v[74:75], v15 offset:20480
    v_mfma_f32_16x16x32_bf16 a[52:55], v[64:67], v[84:87], a[52:55]
    v_exp_f32 v128, v128
    v_mfma_f32_16x16x32_bf16 a[84:87], v[64:67], v[92:95], a[84:87]
    v_cvt_pk_bf16_f32 v124, v124, v125
    v_cvt_pk_bf16_f32 v125, v126, v127
    v_mfma_f32_16x16x32_bf16 a[116:119], v[64:67], v[100:103], a[116:119]
    v_lshlrev_b32 v240, 16, v170
    v_and_b32 v241, 0xffff0000, v170
    v_mfma_f32_16x16x32_bf16 a[148:151], v[64:67], v[108:111], a[148:151]
    v_exp_f32 v129, v129
    s_waitcnt lgkmcnt(2)
    v_mfma_f32_16x16x32_bf16 a[24:27], v[68:71], v[76:79], a[24:27]
    ds_read_b128 v[44:47], v4 offset:32768
    ds_read_b128 v[48:51], v5 offset:32768
    v_mfma_f32_16x16x32_bf16 a[56:59], v[68:71], v[84:87], a[56:59]
    v_exp_f32 v130, v130
    v_mfma_f32_16x16x32_bf16 a[88:91], v[68:71], v[92:95], a[88:91]
    v_exp_f32 v131, v131
    v_mfma_f32_16x16x32_bf16 a[120:123], v[68:71], v[100:103], a[120:123]
    v_lshlrev_b32 v242, 16, v171
    v_and_b32 v243, 0xffff0000, v171
    v_mfma_f32_16x16x32_bf16 a[152:155], v[68:71], v[108:111], a[152:155]
    v_cvt_pk_bf16_f32 v126, v128, v129
    v_cvt_pk_bf16_f32 v127, v130, v131
    s_waitcnt lgkmcnt(2)
    v_mfma_f32_16x16x32_bf16 a[28:31], v[72:75], v[76:79], a[28:31]
    v_exp_f32 v132, v132
    v_mfma_f32_16x16x32_bf16 a[60:63], v[72:75], v[84:87], a[60:63]
    v_exp_f32 v133, v133
    v_mfma_f32_16x16x32_bf16 a[92:95], v[72:75], v[92:95], a[92:95]
    v_pk_mul_f32 v[240:241], v[240:241], s[36:37]
    v_pk_mul_f32 v[242:243], v[242:243], s[36:37]
    v_cvt_pk_bf16_f32 v170, v240, v241
    v_cvt_pk_bf16_f32 v171, v242, v243
    v_mfma_f32_16x16x32_bf16 a[124:127], v[72:75], v[100:103], a[124:127]
    v_exp_f32 v134, v134
    v_mfma_f32_16x16x32_bf16 a[156:159], v[72:75], v[108:111], a[156:159]
    v_exp_f32 v135, v135
    v_mfma_f32_16x16x32_bf16 a[240:243], v[248:251], v[76:79], a[240:243]
    v_exp_f32 v136, v136
    v_mfma_f32_16x16x32_bf16 a[244:247], v[248:251], v[84:87], a[244:247]
    v_cvt_pk_bf16_f32 v132, v132, v133
    v_cvt_pk_bf16_f32 v133, v134, v135
    s_waitcnt vmcnt(11)
    s_barrier
    v_mfma_f32_16x16x32_bf16 a[248:251], v[248:251], v[92:95], a[248:251]
    s_add_u32 m0, s34, 0
    s_nop 0
    buffer_load_dwordx4 v1, s[16:19], s33 offen lds
    v_mfma_f32_16x16x32_bf16 a[252:255], v[248:251], v[100:103], a[252:255]
    buffer_load_dwordx4 v2, s[16:19], s33 offen offset:1024 lds
    v_mfma_f32_16x16x32_bf16 v[20:23], v[248:251], v[108:111], v[20:23]
    s_add_u32 m0, s34, 65536
    s_nop 0
    buffer_load_dwordx4 v1, s[20:23], s33 offen lds
    s_waitcnt lgkmcnt(1)
    v_mfma_f32_16x16x32_bf16 v[76:79], v[44:47], a[160:163], v[24:27]
    ds_read_b128 v[52:55], v6 offset:32768
    ds_read_b128 v[56:59], v7 offset:32768
    v_mfma_f32_16x16x32_bf16 v[84:87], v[44:47], a[176:179], v[28:31]
    buffer_load_dwordx4 v2, s[20:23], s33 offen offset:1024 lds
    s_add_u32 s33, s33, 8192
    v_mfma_f32_16x16x32_bf16 v[92:95], v[44:47], a[192:195], v[32:35]
    s_add_u32 s38, s44, 16384
    buffer_load_dwordx4 v[228:231], v16, s[12:15], s38 offen offset:128
    v_mfma_f32_16x16x32_bf16 v[100:103], v[44:47], a[208:211], v[36:39]
    v_lshlrev_b32 v236, 16, v172
    v_and_b32 v237, 0xffff0000, v172
    v_mfma_f32_16x16x32_bf16 v[108:111], v[44:47], a[224:227], v[40:43]
    v_exp_f32 v137, v137
    s_waitcnt lgkmcnt(2)
    v_mfma_f32_16x16x32_bf16 v[76:79], v[48:51], a[164:167], v[76:79]
    v_exp_f32 v138, v138
    v_mfma_f32_16x16x32_bf16 v[84:87], v[48:51], a[180:183], v[84:87]
    v_exp_f32 v139, v139
    v_mfma_f32_16x16x32_bf16 v[92:95], v[48:51], a[196:199], v[92:95]
    v_lshlrev_b32 v238, 16, v173
    v_and_b32 v239, 0xffff0000, v173
    v_mfma_f32_16x16x32_bf16 v[100:103], v[48:51], a[212:215], v[100:103]
    v_cvt_pk_bf16_f32 v134, v136, v137
    v_cvt_pk_bf16_f32 v135, v138, v139
    v_mfma_f32_16x16x32_bf16 v[108:111], v[48:51], a[228:231], v[108:111]
    v_exp_f32 v140, v140
    s_waitcnt lgkmcnt(1)
    v_mfma_f32_16x16x32_bf16 v[76:79], v[52:55], a[168:171], v[76:79]
    ds_read_b128 v[60:63], v4 offset:36864
    ds_read_b128 v[64:67], v5 offset:36864
    v_mfma_f32_16x16x32_bf16 v[84:87], v[52:55], a[184:187], v[84:87]
    v_exp_f32 v141, v141
    v_mfma_f32_16x16x32_bf16 v[92:95], v[52:55], a[200:203], v[92:95]
    v_pk_mul_f32 v[236:237], v[236:237], s[36:37]
    v_pk_mul_f32 v[238:239], v[238:239], s[36:37]
    v_cvt_pk_bf16_f32 v172, v236, v237
    v_cvt_pk_bf16_f32 v173, v238, v239
    v_mfma_f32_16x16x32_bf16 v[100:103], v[52:55], a[216:219], v[100:103]
    v_exp_f32 v142, v142
    v_mfma_f32_16x16x32_bf16 v[108:111], v[52:55], a[232:235], v[108:111]
    v_exp_f32 v143, v143
    s_waitcnt lgkmcnt(2)
    v_mfma_f32_16x16x32_bf16 v[76:79], v[56:59], a[172:175], v[76:79]
    v_exp_f32 v144, v144
    v_mfma_f32_16x16x32_bf16 v[84:87], v[56:59], a[188:191], v[84:87]
    v_lshlrev_b32 v240, 16, v174
    v_and_b32 v241, 0xffff0000, v174
    v_mfma_f32_16x16x32_bf16 v[92:95], v[56:59], a[204:207], v[92:95]
    v_cvt_pk_bf16_f32 v140, v140, v141
    v_cvt_pk_bf16_f32 v141, v142, v143
    v_mfma_f32_16x16x32_bf16 v[100:103], v[56:59], a[220:223], v[100:103]
    v_exp_f32 v145, v145
    v_mfma_f32_16x16x32_bf16 v[108:111], v[56:59], a[236:239], v[108:111]
    v_exp_f32 v146, v146
    s_waitcnt lgkmcnt(1)
    v_mfma_f32_16x16x32_bf16 v[80:83], v[60:63], a[160:163], v[24:27]
    ds_read_b128 v[68:71], v6 offset:36864
    ds_read_b128 v[72:75], v7 offset:36864
    v_mfma_f32_16x16x32_bf16 v[88:91], v[60:63], a[176:179], v[28:31]
    v_lshlrev_b32 v242, 16, v175
    v_and_b32 v243, 0xffff0000, v175
    v_mfma_f32_16x16x32_bf16 v[96:99], v[60:63], a[192:195], v[32:35]
    v_exp_f32 v147, v147
    v_mfma_f32_16x16x32_bf16 v[104:107], v[60:63], a[208:211], v[36:39]
    v_cvt_pk_bf16_f32 v142, v144, v145
    v_cvt_pk_bf16_f32 v143, v146, v147
    v_mfma_f32_16x16x32_bf16 v[112:115], v[60:63], a[224:227], v[40:43]
    v_exp_f32 v148, v148
    s_waitcnt lgkmcnt(2)
    v_mfma_f32_16x16x32_bf16 v[80:83], v[64:67], a[164:167], v[80:83]
    v_pk_mul_f32 v[240:241], v[240:241], s[36:37]
    v_pk_mul_f32 v[242:243], v[242:243], s[36:37]
    v_cvt_pk_bf16_f32 v174, v240, v241
    v_cvt_pk_bf16_f32 v175, v242, v243
    v_mfma_f32_16x16x32_bf16 v[88:91], v[64:67], a[180:183], v[88:91]
    v_exp_f32 v149, v149
    v_mfma_f32_16x16x32_bf16 v[96:99], v[64:67], a[196:199], v[96:99]
    v_exp_f32 v150, v150
    v_mfma_f32_16x16x32_bf16 v[104:107], v[64:67], a[212:215], v[104:107]
    v_exp_f32 v151, v151
    v_mfma_f32_16x16x32_bf16 v[112:115], v[64:67], a[228:231], v[112:115]
    v_lshlrev_b32 v236, 16, v176
    v_and_b32 v237, 0xffff0000, v176
    s_waitcnt lgkmcnt(1)
    v_mfma_f32_16x16x32_bf16 v[80:83], v[68:71], a[168:171], v[80:83]
    ds_read_b64_tr_b16 v[44:45], v8 offset:24576
    ds_read_b64_tr_b16 v[46:47], v8 offset:28672
    v_mfma_f32_16x16x32_bf16 v[88:91], v[68:71], a[184:187], v[88:91]
    v_exp_f32 v152, v152
    v_mfma_f32_16x16x32_bf16 v[96:99], v[68:71], a[200:203], v[96:99]
    v_cvt_pk_bf16_f32 v148, v148, v149
    v_cvt_pk_bf16_f32 v149, v150, v151
    v_mfma_f32_16x16x32_bf16 v[104:107], v[68:71], a[216:219], v[104:107]
    v_exp_f32 v153, v153
    v_mfma_f32_16x16x32_bf16 v[112:115], v[68:71], a[232:235], v[112:115]
    v_lshlrev_b32 v238, 16, v177
    v_and_b32 v239, 0xffff0000, v177
    s_waitcnt lgkmcnt(2)
    v_mfma_f32_16x16x32_bf16 v[80:83], v[72:75], a[172:175], v[80:83]
    ds_read_b64_tr_b16 v[48:49], v9 offset:24576
    ds_read_b64_tr_b16 v[50:51], v9 offset:28672
    v_mfma_f32_16x16x32_bf16 v[88:91], v[72:75], a[188:191], v[88:91]
    v_exp_f32 v154, v154
    v_mfma_f32_16x16x32_bf16 v[96:99], v[72:75], a[204:207], v[96:99]
    v_exp_f32 v155, v155
    v_mfma_f32_16x16x32_bf16 v[104:107], v[72:75], a[220:223], v[104:107]
    v_cvt_pk_bf16_f32 v150, v152, v153
    v_cvt_pk_bf16_f32 v151, v154, v155
    v_mfma_f32_16x16x32_bf16 v[112:115], v[72:75], a[236:239], v[112:115]
    s_waitcnt lgkmcnt(2)
    v_mfma_f32_16x16x32_bf16 a[0:3], v[44:47], v[116:119], a[0:3]
    ds_read_b64_tr_b16 v[52:53], v10 offset:24576
    ds_read_b64_tr_b16 v[54:55], v10 offset:28672
    v_mfma_f32_16x16x32_bf16 a[32:35], v[44:47], v[124:127], a[32:35]
    v_mfma_f32_16x16x32_bf16 a[64:67], v[44:47], v[132:135], a[64:67]
    v_exp_f32 v76, v76
    v_mfma_f32_16x16x32_bf16 a[96:99], v[44:47], v[140:143], a[96:99]
    v_pk_mul_f32 v[236:237], v[236:237], s[36:37]
    v_pk_mul_f32 v[238:239], v[238:239], s[36:37]
    v_cvt_pk_bf16_f32 v176, v236, v237
    v_cvt_pk_bf16_f32 v177, v238, v239
    v_mfma_f32_16x16x32_bf16 a[128:131], v[44:47], v[148:151], a[128:131]
    v_exp_f32 v77, v77
    s_waitcnt lgkmcnt(2)
    v_mfma_f32_16x16x32_bf16 a[4:7], v[48:51], v[116:119], a[4:7]
    ds_read_b64_tr_b16 v[56:57], v11 offset:24576
    ds_read_b64_tr_b16 v[58:59], v11 offset:28672
    v_mfma_f32_16x16x32_bf16 a[36:39], v[48:51], v[124:127], a[36:39]
    v_exp_f32 v78, v78
    v_mfma_f32_16x16x32_bf16 a[68:71], v[48:51], v[132:135], a[68:71]
    v_exp_f32 v79, v79
    v_mfma_f32_16x16x32_bf16 a[100:103], v[48:51], v[140:143], a[100:103]
    v_lshlrev_b32 v240, 16, v178
    v_and_b32 v241, 0xffff0000, v178
    v_mfma_f32_16x16x32_bf16 a[132:135], v[48:51], v[148:151], a[132:135]
    v_exp_f32 v80, v80
    s_waitcnt lgkmcnt(2)
    v_mfma_f32_16x16x32_bf16 a[8:11], v[52:55], v[116:119], a[8:11]
    ds_read_b64_tr_b16 v[60:61], v12 offset:24576
    ds_read_b64_tr_b16 v[62:63], v12 offset:28672
    v_mfma_f32_16x16x32_bf16 a[40:43], v[52:55], v[124:127], a[40:43]
    v_cvt_pk_bf16_f32 v76, v76, v77
    v_cvt_pk_bf16_f32 v77, v78, v79
    v_mfma_f32_16x16x32_bf16 a[72:75], v[52:55], v[132:135], a[72:75]
    v_exp_f32 v81, v81
    v_mfma_f32_16x16x32_bf16 a[104:107], v[52:55], v[140:143], a[104:107]
    v_lshlrev_b32 v242, 16, v179
    v_and_b32 v243, 0xffff0000, v179
    v_mfma_f32_16x16x32_bf16 a[136:139], v[52:55], v[148:151], a[136:139]
    v_exp_f32 v82, v82
    s_waitcnt lgkmcnt(2)
    v_mfma_f32_16x16x32_bf16 a[12:15], v[56:59], v[116:119], a[12:15]
    ds_read_b64_tr_b16 v[64:65], v13 offset:24576
    ds_read_b64_tr_b16 v[66:67], v13 offset:28672
    v_mfma_f32_16x16x32_bf16 a[44:47], v[56:59], v[124:127], a[44:47]
    v_exp_f32 v83, v83
    v_mfma_f32_16x16x32_bf16 a[76:79], v[56:59], v[132:135], a[76:79]
    v_cvt_pk_bf16_f32 v78, v80, v81
    v_cvt_pk_bf16_f32 v79, v82, v83
    v_mfma_f32_16x16x32_bf16 a[108:111], v[56:59], v[140:143], a[108:111]
    v_pk_mul_f32 v[240:241], v[240:241], s[36:37]
    v_pk_mul_f32 v[242:243], v[242:243], s[36:37]
    v_cvt_pk_bf16_f32 v178, v240, v241
    v_cvt_pk_bf16_f32 v179, v242, v243
    v_mfma_f32_16x16x32_bf16 a[140:143], v[56:59], v[148:151], a[140:143]
    v_exp_f32 v84, v84
    s_waitcnt lgkmcnt(2)
    v_mfma_f32_16x16x32_bf16 a[16:19], v[60:63], v[116:119], a[16:19]
    ds_read_b64_tr_b16 v[68:69], v14 offset:24576
    ds_read_b64_tr_b16 v[70:71], v14 offset:28672
    v_mfma_f32_16x16x32_bf16 a[48:51], v[60:63], v[124:127], a[48:51]
    v_exp_f32 v85, v85
    v_mfma_f32_16x16x32_bf16 a[80:83], v[60:63], v[132:135], a[80:83]
    v_exp_f32 v86, v86
    v_mfma_f32_16x16x32_bf16 a[112:115], v[60:63], v[140:143], a[112:115]
    v_lshlrev_b32 v236, 16, v180
    v_and_b32 v237, 0xffff0000, v180
    v_mfma_f32_16x16x32_bf16 a[144:147], v[60:63], v[148:151], a[144:147]
    v_exp_f32 v87, v87
    s_waitcnt lgkmcnt(2)
    v_mfma_f32_16x16x32_bf16 a[20:23], v[64:67], v[116:119], a[20:23]
    ds_read_b64_tr_b16 v[72:73], v15 offset:24576
    ds_read_b64_tr_b16 v[74:75], v15 offset:28672
    v_mfma_f32_16x16x32_bf16 a[52:55], v[64:67], v[124:127], a[52:55]
    v_exp_f32 v88, v88
    v_mfma_f32_16x16x32_bf16 a[84:87], v[64:67], v[132:135], a[84:87]
    v_cvt_pk_bf16_f32 v84, v84, v85
    v_cvt_pk_bf16_f32 v85, v86, v87
    v_mfma_f32_16x16x32_bf16 a[116:119], v[64:67], v[140:143], a[116:119]
    v_lshlrev_b32 v238, 16, v181
    v_and_b32 v239, 0xffff0000, v181
    v_mfma_f32_16x16x32_bf16 a[148:151], v[64:67], v[148:151], a[148:151]
    v_exp_f32 v89, v89
    s_waitcnt lgkmcnt(2)
    v_mfma_f32_16x16x32_bf16 a[24:27], v[68:71], v[116:119], a[24:27]
    ds_read_b128 v[44:47], v4 offset:40960
    ds_read_b128 v[48:51], v5 offset:40960
    v_mfma_f32_16x16x32_bf16 a[56:59], v[68:71], v[124:127], a[56:59]
    v_exp_f32 v90, v90
    s_nop 1
    v_mfma_f32_16x16x32_bf16 a[88:91], v[68:71], v[132:135], a[88:91]
    v_exp_f32 v91, v91
    v_mfma_f32_16x16x32_bf16 a[120:123], v[68:71], v[140:143], a[120:123]
    v_pk_mul_f32 v[236:237], v[236:237], s[36:37]
    v_pk_mul_f32 v[238:239], v[238:239], s[36:37]
    v_cvt_pk_bf16_f32 v180, v236, v237
    v_cvt_pk_bf16_f32 v181, v238, v239
    v_mfma_f32_16x16x32_bf16 a[152:155], v[68:71], v[148:151], a[152:155]
    v_cvt_pk_bf16_f32 v86, v88, v89
    v_cvt_pk_bf16_f32 v87, v90, v91
    s_waitcnt lgkmcnt(2)
    v_mfma_f32_16x16x32_bf16 a[28:31], v[72:75], v[116:119], a[28:31]
    v_exp_f32 v92, v92
    v_mfma_f32_16x16x32_bf16 a[60:63], v[72:75], v[124:127], a[60:63]
    v_exp_f32 v93, v93
    s_nop 1
    v_mfma_f32_16x16x32_bf16 a[92:95], v[72:75], v[132:135], a[92:95]
    v_lshlrev_b32 v240, 16, v182
    v_and_b32 v241, 0xffff0000, v182
    v_mfma_f32_16x16x32_bf16 a[124:127], v[72:75], v[140:143], a[124:127]
    v_exp_f32 v94, v94
    v_mfma_f32_16x16x32_bf16 a[156:159], v[72:75], v[148:151], a[156:159]
    v_exp_f32 v95, v95
    v_mfma_f32_16x16x32_bf16 a[240:243], v[248:251], v[116:119], a[240:243]
    v_exp_f32 v96, v96
    v_mfma_f32_16x16x32_bf16 a[244:247], v[248:251], v[124:127], a[244:247]
    v_cvt_pk_bf16_f32 v92, v92, v93
    v_cvt_pk_bf16_f32 v93, v94, v95
    s_waitcnt vmcnt(11)
    s_barrier
    v_mfma_f32_16x16x32_bf16 a[248:251], v[248:251], v[132:135], a[248:251]
    s_add_u32 m0, s34, 8192
    s_nop 0
    buffer_load_dwordx4 v1, s[16:19], s33 offen lds
    v_mfma_f32_16x16x32_bf16 a[252:255], v[248:251], v[140:143], a[252:255]
    buffer_load_dwordx4 v2, s[16:19], s33 offen offset:1024 lds
    v_mfma_f32_16x16x32_bf16 v[20:23], v[248:251], v[148:151], v[20:23]
    s_add_u32 m0, s34, 73728
    s_nop 0
    buffer_load_dwordx4 v1, s[20:23], s33 offen lds
    s_waitcnt lgkmcnt(1)
    v_mfma_f32_16x16x32_bf16 v[116:119], v[44:47], a[160:163], v[24:27]
    ds_read_b128 v[52:55], v6 offset:40960
    ds_read_b128 v[56:59], v7 offset:40960
    v_mfma_f32_16x16x32_bf16 v[124:127], v[44:47], a[176:179], v[28:31]
    buffer_load_dwordx4 v2, s[20:23], s33 offen offset:1024 lds
    s_add_u32 s33, s33, 8192
    v_mfma_f32_16x16x32_bf16 v[132:135], v[44:47], a[192:195], v[32:35]
    s_add_u32 s38, s44, 16384
    buffer_load_dwordx4 v[232:235], v16, s[12:15], s38 offen offset:192
    v_mfma_f32_16x16x32_bf16 v[140:143], v[44:47], a[208:211], v[36:39]
    v_lshlrev_b32 v242, 16, v183
    v_and_b32 v243, 0xffff0000, v183
    v_mfma_f32_16x16x32_bf16 v[148:151], v[44:47], a[224:227], v[40:43]
    v_exp_f32 v97, v97
    s_waitcnt lgkmcnt(2)
    v_mfma_f32_16x16x32_bf16 v[116:119], v[48:51], a[164:167], v[116:119]
    v_exp_f32 v98, v98
    v_mfma_f32_16x16x32_bf16 v[124:127], v[48:51], a[180:183], v[124:127]
    v_exp_f32 v99, v99
    v_mfma_f32_16x16x32_bf16 v[132:135], v[48:51], a[196:199], v[132:135]
    v_pk_mul_f32 v[240:241], v[240:241], s[36:37]
    v_pk_mul_f32 v[242:243], v[242:243], s[36:37]
    v_cvt_pk_bf16_f32 v182, v240, v241
    v_cvt_pk_bf16_f32 v183, v242, v243
    v_mfma_f32_16x16x32_bf16 v[140:143], v[48:51], a[212:215], v[140:143]
    v_cvt_pk_bf16_f32 v94, v96, v97
    v_cvt_pk_bf16_f32 v95, v98, v99
    v_mfma_f32_16x16x32_bf16 v[148:151], v[48:51], a[228:231], v[148:151]
    v_exp_f32 v100, v100
    s_waitcnt lgkmcnt(1)
    v_mfma_f32_16x16x32_bf16 v[116:119], v[52:55], a[168:171], v[116:119]
    ds_read_b128 v[60:63], v4 offset:45056
    ds_read_b128 v[64:67], v5 offset:45056
    v_mfma_f32_16x16x32_bf16 v[124:127], v[52:55], a[184:187], v[124:127]
    v_exp_f32 v101, v101
    v_mfma_f32_16x16x32_bf16 v[132:135], v[52:55], a[200:203], v[132:135]
    v_lshlrev_b32 v236, 16, v184
    v_and_b32 v237, 0xffff0000, v184
    v_mfma_f32_16x16x32_bf16 v[140:143], v[52:55], a[216:219], v[140:143]
    v_exp_f32 v102, v102
    v_mfma_f32_16x16x32_bf16 v[148:151], v[52:55], a[232:235], v[148:151]
    v_exp_f32 v103, v103
    s_waitcnt lgkmcnt(2)
    v_mfma_f32_16x16x32_bf16 v[116:119], v[56:59], a[172:175], v[116:119]
    v_exp_f32 v104, v104
    v_mfma_f32_16x16x32_bf16 v[124:127], v[56:59], a[188:191], v[124:127]
    v_lshlrev_b32 v238, 16, v185
    v_and_b32 v239, 0xffff0000, v185
    v_mfma_f32_16x16x32_bf16 v[132:135], v[56:59], a[204:207], v[132:135]
    v_cvt_pk_bf16_f32 v100, v100, v101
    v_cvt_pk_bf16_f32 v101, v102, v103
    v_mfma_f32_16x16x32_bf16 v[140:143], v[56:59], a[220:223], v[140:143]
    v_exp_f32 v105, v105
    v_mfma_f32_16x16x32_bf16 v[148:151], v[56:59], a[236:239], v[148:151]
    v_exp_f32 v106, v106
    s_waitcnt lgkmcnt(1)
    v_mfma_f32_16x16x32_bf16 v[120:123], v[60:63], a[160:163], v[24:27]
    ds_read_b128 v[68:71], v6 offset:45056
    ds_read_b128 v[72:75], v7 offset:45056
    v_mfma_f32_16x16x32_bf16 v[128:131], v[60:63], a[176:179], v[28:31]
    v_pk_mul_f32 v[236:237], v[236:237], s[36:37]
    v_pk_mul_f32 v[238:239], v[238:239], s[36:37]
    v_cvt_pk_bf16_f32 v184, v236, v237
    v_cvt_pk_bf16_f32 v185, v238, v239
    v_mfma_f32_16x16x32_bf16 v[136:139], v[60:63], a[192:195], v[32:35]
    v_exp_f32 v107, v107
    v_mfma_f32_16x16x32_bf16 v[144:147], v[60:63], a[208:211], v[36:39]
    v_cvt_pk_bf16_f32 v102, v104, v105
    v_cvt_pk_bf16_f32 v103, v106, v107
    v_mfma_f32_16x16x32_bf16 v[152:155], v[60:63], a[224:227], v[40:43]
    v_exp_f32 v108, v108
    s_waitcnt lgkmcnt(2)
    v_mfma_f32_16x16x32_bf16 v[120:123], v[64:67], a[164:167], v[120:123]
    v_lshlrev_b32 v240, 16, v186
    v_and_b32 v241, 0xffff0000, v186
    v_mfma_f32_16x16x32_bf16 v[128:131], v[64:67], a[180:183], v[128:131]
    v_exp_f32 v109, v109
    v_mfma_f32_16x16x32_bf16 v[136:139], v[64:67], a[196:199], v[136:139]
    v_exp_f32 v110, v110
    v_mfma_f32_16x16x32_bf16 v[144:147], v[64:67], a[212:215], v[144:147]
    v_exp_f32 v111, v111
    v_mfma_f32_16x16x32_bf16 v[152:155], v[64:67], a[228:231], v[152:155]
    v_lshlrev_b32 v242, 16, v187
    v_and_b32 v243, 0xffff0000, v187
    s_waitcnt lgkmcnt(1)
    v_mfma_f32_16x16x32_bf16 v[120:123], v[68:71], a[168:171], v[120:123]
    ds_read_b64_tr_b16 v[44:45], v8 offset:32768
    ds_read_b64_tr_b16 v[46:47], v8 offset:36864
    v_mfma_f32_16x16x32_bf16 v[128:131], v[68:71], a[184:187], v[128:131]
    v_exp_f32 v112, v112
    v_mfma_f32_16x16x32_bf16 v[136:139], v[68:71], a[200:203], v[136:139]
    v_cvt_pk_bf16_f32 v108, v108, v109
    v_cvt_pk_bf16_f32 v109, v110, v111
    v_mfma_f32_16x16x32_bf16 v[144:147], v[68:71], a[216:219], v[144:147]
    v_exp_f32 v113, v113
    v_mfma_f32_16x16x32_bf16 v[152:155], v[68:71], a[232:235], v[152:155]
    v_pk_mul_f32 v[240:241], v[240:241], s[36:37]
    v_pk_mul_f32 v[242:243], v[242:243], s[36:37]
    v_cvt_pk_bf16_f32 v186, v240, v241
    v_cvt_pk_bf16_f32 v187, v242, v243
    s_waitcnt lgkmcnt(2)
    v_mfma_f32_16x16x32_bf16 v[120:123], v[72:75], a[172:175], v[120:123]
    ds_read_b64_tr_b16 v[48:49], v9 offset:32768
    ds_read_b64_tr_b16 v[50:51], v9 offset:36864
    v_mfma_f32_16x16x32_bf16 v[128:131], v[72:75], a[188:191], v[128:131]
    v_exp_f32 v114, v114
    v_mfma_f32_16x16x32_bf16 v[136:139], v[72:75], a[204:207], v[136:139]
    v_exp_f32 v115, v115
    v_mfma_f32_16x16x32_bf16 v[144:147], v[72:75], a[220:223], v[144:147]
    v_cvt_pk_bf16_f32 v110, v112, v113
    v_cvt_pk_bf16_f32 v111, v114, v115
    v_mfma_f32_16x16x32_bf16 v[152:155], v[72:75], a[236:239], v[152:155]
    s_waitcnt vmcnt(40)
    s_waitcnt lgkmcnt(2)
    v_mfma_f32_16x16x32_bf16 a[0:3], v[44:47], v[76:79], a[0:3]
    ds_read_b64_tr_b16 v[52:53], v10 offset:32768
    ds_read_b64_tr_b16 v[54:55], v10 offset:36864
    v_mfma_f32_16x16x32_bf16 a[32:35], v[44:47], v[84:87], a[32:35]
    v_mfma_f32_16x16x32_bf16 a[64:67], v[44:47], v[92:95], a[64:67]
    v_exp_f32 v116, v116
    v_mfma_f32_16x16x32_bf16 a[96:99], v[44:47], v[100:103], a[96:99]
    v_lshlrev_b32 v236, 16, v188
    v_and_b32 v237, 0xffff0000, v188
    v_mfma_f32_16x16x32_bf16 a[128:131], v[44:47], v[108:111], a[128:131]
    v_exp_f32 v117, v117
    s_waitcnt lgkmcnt(2)
    v_mfma_f32_16x16x32_bf16 a[4:7], v[48:51], v[76:79], a[4:7]
    ds_read_b64_tr_b16 v[56:57], v11 offset:32768
    ds_read_b64_tr_b16 v[58:59], v11 offset:36864
    v_mfma_f32_16x16x32_bf16 a[36:39], v[48:51], v[84:87], a[36:39]
    v_exp_f32 v118, v118
    v_mfma_f32_16x16x32_bf16 a[68:71], v[48:51], v[92:95], a[68:71]
    v_exp_f32 v119, v119
    v_mfma_f32_16x16x32_bf16 a[100:103], v[48:51], v[100:103], a[100:103]
    v_lshlrev_b32 v238, 16, v189
    v_and_b32 v239, 0xffff0000, v189
    v_mfma_f32_16x16x32_bf16 a[132:135], v[48:51], v[108:111], a[132:135]
    v_exp_f32 v120, v120
    s_waitcnt lgkmcnt(2)
    v_mfma_f32_16x16x32_bf16 a[8:11], v[52:55], v[76:79], a[8:11]
    ds_read_b64_tr_b16 v[60:61], v12 offset:32768
    ds_read_b64_tr_b16 v[62:63], v12 offset:36864
    v_mfma_f32_16x16x32_bf16 a[40:43], v[52:55], v[84:87], a[40:43]
    v_cvt_pk_bf16_f32 v116, v116, v117
    v_cvt_pk_bf16_f32 v117, v118, v119
    v_mfma_f32_16x16x32_bf16 a[72:75], v[52:55], v[92:95], a[72:75]
    v_exp_f32 v121, v121
    v_mfma_f32_16x16x32_bf16 a[104:107], v[52:55], v[100:103], a[104:107]
    v_pk_mul_f32 v[236:237], v[236:237], s[36:37]
    v_pk_mul_f32 v[238:239], v[238:239], s[36:37]
    v_cvt_pk_bf16_f32 v188, v236, v237
    v_cvt_pk_bf16_f32 v189, v238, v239
    v_mfma_f32_16x16x32_bf16 a[136:139], v[52:55], v[108:111], a[136:139]
    v_exp_f32 v122, v122
    s_waitcnt lgkmcnt(2)
    v_mfma_f32_16x16x32_bf16 a[12:15], v[56:59], v[76:79], a[12:15]
    ds_read_b64_tr_b16 v[64:65], v13 offset:32768
    ds_read_b64_tr_b16 v[66:67], v13 offset:36864
    v_mfma_f32_16x16x32_bf16 a[44:47], v[56:59], v[84:87], a[44:47]
    v_exp_f32 v123, v123
    v_mfma_f32_16x16x32_bf16 a[76:79], v[56:59], v[92:95], a[76:79]
    v_cvt_pk_bf16_f32 v118, v120, v121
    v_cvt_pk_bf16_f32 v119, v122, v123
    v_mfma_f32_16x16x32_bf16 a[108:111], v[56:59], v[100:103], a[108:111]
    v_lshlrev_b32 v240, 16, v190
    v_and_b32 v241, 0xffff0000, v190
    v_mfma_f32_16x16x32_bf16 a[140:143], v[56:59], v[108:111], a[140:143]
    v_exp_f32 v124, v124
    s_waitcnt lgkmcnt(2)
    v_mfma_f32_16x16x32_bf16 a[16:19], v[60:63], v[76:79], a[16:19]
    ds_read_b64_tr_b16 v[68:69], v14 offset:32768
    ds_read_b64_tr_b16 v[70:71], v14 offset:36864
    v_mfma_f32_16x16x32_bf16 a[48:51], v[60:63], v[84:87], a[48:51]
    v_exp_f32 v125, v125
    v_mfma_f32_16x16x32_bf16 a[80:83], v[60:63], v[92:95], a[80:83]
    v_exp_f32 v126, v126
    v_mfma_f32_16x16x32_bf16 a[112:115], v[60:63], v[100:103], a[112:115]
    v_lshlrev_b32 v242, 16, v191
    v_and_b32 v243, 0xffff0000, v191
    v_mfma_f32_16x16x32_bf16 a[144:147], v[60:63], v[108:111], a[144:147]
    v_exp_f32 v127, v127
    s_waitcnt lgkmcnt(2)
    v_mfma_f32_16x16x32_bf16 a[20:23], v[64:67], v[76:79], a[20:23]
    ds_read_b64_tr_b16 v[72:73], v15 offset:32768
    ds_read_b64_tr_b16 v[74:75], v15 offset:36864
    v_mfma_f32_16x16x32_bf16 a[52:55], v[64:67], v[84:87], a[52:55]
    v_exp_f32 v128, v128
    v_mfma_f32_16x16x32_bf16 a[84:87], v[64:67], v[92:95], a[84:87]
    v_cvt_pk_bf16_f32 v124, v124, v125
    v_cvt_pk_bf16_f32 v125, v126, v127
    v_mfma_f32_16x16x32_bf16 a[116:119], v[64:67], v[100:103], a[116:119]
    v_pk_mul_f32 v[240:241], v[240:241], s[36:37]
    v_pk_mul_f32 v[242:243], v[242:243], s[36:37]
    v_cvt_pk_bf16_f32 v190, v240, v241
    v_cvt_pk_bf16_f32 v191, v242, v243
    v_mfma_f32_16x16x32_bf16 a[148:151], v[64:67], v[108:111], a[148:151]
    v_exp_f32 v129, v129
    s_waitcnt lgkmcnt(2)
    v_mfma_f32_16x16x32_bf16 a[24:27], v[68:71], v[76:79], a[24:27]
    ds_read_b128 v[44:47], v4 offset:49152
    ds_read_b128 v[48:51], v5 offset:49152
    v_mfma_f32_16x16x32_bf16 a[56:59], v[68:71], v[84:87], a[56:59]
    v_exp_f32 v130, v130
    v_mfma_f32_16x16x32_bf16 a[88:91], v[68:71], v[92:95], a[88:91]
    v_exp_f32 v131, v131
    v_mfma_f32_16x16x32_bf16 a[120:123], v[68:71], v[100:103], a[120:123]
    v_lshlrev_b32 v236, 16, v192
    v_and_b32 v237, 0xffff0000, v192
    v_mfma_f32_16x16x32_bf16 a[152:155], v[68:71], v[108:111], a[152:155]
    v_cvt_pk_bf16_f32 v126, v128, v129
    v_cvt_pk_bf16_f32 v127, v130, v131
    s_waitcnt lgkmcnt(2)
    v_mfma_f32_16x16x32_bf16 a[28:31], v[72:75], v[76:79], a[28:31]
    v_exp_f32 v132, v132
    v_mfma_f32_16x16x32_bf16 a[60:63], v[72:75], v[84:87], a[60:63]
    v_exp_f32 v133, v133
    v_mfma_f32_16x16x32_bf16 a[92:95], v[72:75], v[92:95], a[92:95]
    v_lshlrev_b32 v238, 16, v193
    v_and_b32 v239, 0xffff0000, v193
    v_mfma_f32_16x16x32_bf16 a[124:127], v[72:75], v[100:103], a[124:127]
    v_exp_f32 v134, v134
    v_mfma_f32_16x16x32_bf16 a[156:159], v[72:75], v[108:111], a[156:159]
    v_exp_f32 v135, v135
    v_mfma_f32_16x16x32_bf16 a[240:243], v[248:251], v[76:79], a[240:243]
    v_exp_f32 v136, v136
    v_mfma_f32_16x16x32_bf16 a[244:247], v[248:251], v[84:87], a[244:247]
    v_cvt_pk_bf16_f32 v132, v132, v133
    v_cvt_pk_bf16_f32 v133, v134, v135
    s_waitcnt vmcnt(11)
    s_barrier
    v_mfma_f32_16x16x32_bf16 a[248:251], v[248:251], v[92:95], a[248:251]
    s_add_u32 m0, s34, 16384
    s_nop 0
    buffer_load_dwordx4 v1, s[16:19], s33 offen lds
    v_mfma_f32_16x16x32_bf16 a[252:255], v[248:251], v[100:103], a[252:255]
    buffer_load_dwordx4 v2, s[16:19], s33 offen offset:1024 lds
    v_mfma_f32_16x16x32_bf16 v[20:23], v[248:251], v[108:111], v[20:23]
    s_add_u32 m0, s34, 81920
    s_nop 0
    buffer_load_dwordx4 v1, s[20:23], s33 offen lds
    s_waitcnt lgkmcnt(1)
    v_mfma_f32_16x16x32_bf16 v[76:79], v[44:47], a[160:163], v[24:27]
    ds_read_b128 v[52:55], v6 offset:49152
    ds_read_b128 v[56:59], v7 offset:49152
    v_mfma_f32_16x16x32_bf16 v[84:87], v[44:47], a[176:179], v[28:31]
    buffer_load_dwordx4 v2, s[20:23], s33 offen offset:1024 lds
    s_add_u32 s33, s33, 8192
    v_mfma_f32_16x16x32_bf16 v[92:95], v[44:47], a[192:195], v[32:35]
    v_pk_mul_f32 v[236:237], v[236:237], s[36:37]
    v_pk_mul_f32 v[238:239], v[238:239], s[36:37]
    v_cvt_pk_bf16_f32 v192, v236, v237
    v_cvt_pk_bf16_f32 v193, v238, v239
    v_mfma_f32_16x16x32_bf16 v[100:103], v[44:47], a[208:211], v[36:39]
    v_exp_f32 v137, v137
    v_mfma_f32_16x16x32_bf16 v[108:111], v[44:47], a[224:227], v[40:43]
    v_exp_f32 v138, v138
    s_waitcnt lgkmcnt(2)
    v_mfma_f32_16x16x32_bf16 v[76:79], v[48:51], a[164:167], v[76:79]
    v_exp_f32 v139, v139
    v_mfma_f32_16x16x32_bf16 v[84:87], v[48:51], a[180:183], v[84:87]
    v_lshlrev_b32 v240, 16, v194
    v_and_b32 v241, 0xffff0000, v194
    v_mfma_f32_16x16x32_bf16 v[92:95], v[48:51], a[196:199], v[92:95]
    v_cvt_pk_bf16_f32 v134, v136, v137
    v_cvt_pk_bf16_f32 v135, v138, v139
    v_mfma_f32_16x16x32_bf16 v[100:103], v[48:51], a[212:215], v[100:103]
    v_exp_f32 v140, v140
    v_mfma_f32_16x16x32_bf16 v[108:111], v[48:51], a[228:231], v[108:111]
    v_exp_f32 v141, v141
    s_waitcnt lgkmcnt(1)
    v_mfma_f32_16x16x32_bf16 v[76:79], v[52:55], a[168:171], v[76:79]
    ds_read_b128 v[60:63], v4 offset:53248
    ds_read_b128 v[64:67], v5 offset:53248
    v_mfma_f32_16x16x32_bf16 v[84:87], v[52:55], a[184:187], v[84:87]
    v_lshlrev_b32 v242, 16, v195
    v_and_b32 v243, 0xffff0000, v195
    v_mfma_f32_16x16x32_bf16 v[92:95], v[52:55], a[200:203], v[92:95]
    v_exp_f32 v142, v142
    v_mfma_f32_16x16x32_bf16 v[100:103], v[52:55], a[216:219], v[100:103]
    v_exp_f32 v143, v143
    v_mfma_f32_16x16x32_bf16 v[108:111], v[52:55], a[232:235], v[108:111]
    v_exp_f32 v144, v144
    s_waitcnt lgkmcnt(2)
    v_mfma_f32_16x16x32_bf16 v[76:79], v[56:59], a[172:175], v[76:79]
    v_pk_mul_f32 v[240:241], v[240:241], s[36:37]
    v_pk_mul_f32 v[242:243], v[242:243], s[36:37]
    v_cvt_pk_bf16_f32 v194, v240, v241
    v_cvt_pk_bf16_f32 v195, v242, v243
    v_mfma_f32_16x16x32_bf16 v[84:87], v[56:59], a[188:191], v[84:87]
    v_cvt_pk_bf16_f32 v140, v140, v141
    v_cvt_pk_bf16_f32 v141, v142, v143
    v_mfma_f32_16x16x32_bf16 v[92:95], v[56:59], a[204:207], v[92:95]
    v_exp_f32 v145, v145
    v_mfma_f32_16x16x32_bf16 v[100:103], v[56:59], a[220:223], v[100:103]
    v_exp_f32 v146, v146
    v_mfma_f32_16x16x32_bf16 v[108:111], v[56:59], a[236:239], v[108:111]
    v_lshlrev_b32 v236, 16, v196
    v_and_b32 v237, 0xffff0000, v196
    s_waitcnt lgkmcnt(1)
    v_mfma_f32_16x16x32_bf16 v[80:83], v[60:63], a[160:163], v[24:27]
    ds_read_b128 v[68:71], v6 offset:53248
    ds_read_b128 v[72:75], v7 offset:53248
    v_mfma_f32_16x16x32_bf16 v[88:91], v[60:63], a[176:179], v[28:31]
    v_exp_f32 v147, v147
    v_mfma_f32_16x16x32_bf16 v[96:99], v[60:63], a[192:195], v[32:35]
    v_cvt_pk_bf16_f32 v142, v144, v145
    v_cvt_pk_bf16_f32 v143, v146, v147
    v_mfma_f32_16x16x32_bf16 v[104:107], v[60:63], a[208:211], v[36:39]
    v_exp_f32 v148, v148
    v_mfma_f32_16x16x32_bf16 v[112:115], v[60:63], a[224:227], v[40:43]
    v_lshlrev_b32 v238, 16, v197
    v_and_b32 v239, 0xffff0000, v197
    s_waitcnt lgkmcnt(2)
    v_mfma_f32_16x16x32_bf16 v[80:83], v[64:67], a[164:167], v[80:83]
    v_exp_f32 v149, v149
    v_mfma_f32_16x16x32_bf16 v[88:91], v[64:67], a[180:183], v[88:91]
    v_exp_f32 v150, v150
    v_mfma_f32_16x16x32_bf16 v[96:99], v[64:67], a[196:199], v[96:99]
    v_exp_f32 v151, v151
    v_mfma_f32_16x16x32_bf16 v[104:107], v[64:67], a[212:215], v[104:107]
    v_pk_mul_f32 v[236:237], v[236:237], s[36:37]
    v_pk_mul_f32 v[238:239], v[238:239], s[36:37]
    v_cvt_pk_bf16_f32 v196, v236, v237
    v_cvt_pk_bf16_f32 v197, v238, v239
    v_mfma_f32_16x16x32_bf16 v[112:115], v[64:67], a[228:231], v[112:115]
    v_exp_f32 v152, v152
    s_waitcnt lgkmcnt(1)
    v_mfma_f32_16x16x32_bf16 v[80:83], v[68:71], a[168:171], v[80:83]
    ds_read_b64_tr_b16 v[44:45], v8 offset:40960
    ds_read_b64_tr_b16 v[46:47], v8 offset:45056
    v_mfma_f32_16x16x32_bf16 v[88:91], v[68:71], a[184:187], v[88:91]
    v_cvt_pk_bf16_f32 v148, v148, v149
    v_cvt_pk_bf16_f32 v149, v150, v151
    v_mfma_f32_16x16x32_bf16 v[96:99], v[68:71], a[200:203], v[96:99]
    v_exp_f32 v153, v153
    v_mfma_f32_16x16x32_bf16 v[104:107], v[68:71], a[216:219], v[104:107]
    v_lshlrev_b32 v240, 16, v198
    v_and_b32 v241, 0xffff0000, v198
    v_mfma_f32_16x16x32_bf16 v[112:115], v[68:71], a[232:235], v[112:115]
    v_exp_f32 v154, v154
    s_waitcnt lgkmcnt(2)
    v_mfma_f32_16x16x32_bf16 v[80:83], v[72:75], a[172:175], v[80:83]
    ds_read_b64_tr_b16 v[48:49], v9 offset:40960
    ds_read_b64_tr_b16 v[50:51], v9 offset:45056
    v_mfma_f32_16x16x32_bf16 v[88:91], v[72:75], a[188:191], v[88:91]
    v_exp_f32 v155, v155
    v_mfma_f32_16x16x32_bf16 v[96:99], v[72:75], a[204:207], v[96:99]
    v_cvt_pk_bf16_f32 v150, v152, v153
    v_cvt_pk_bf16_f32 v151, v154, v155
    v_mfma_f32_16x16x32_bf16 v[104:107], v[72:75], a[220:223], v[104:107]
    v_mfma_f32_16x16x32_bf16 v[112:115], v[72:75], a[236:239], v[112:115]
    s_waitcnt vmcnt(24)
    s_waitcnt lgkmcnt(2)
    v_mfma_f32_16x16x32_bf16 a[0:3], v[44:47], v[116:119], a[0:3]
    ds_read_b64_tr_b16 v[52:53], v10 offset:40960
    ds_read_b64_tr_b16 v[54:55], v10 offset:45056
    v_mfma_f32_16x16x32_bf16 a[32:35], v[44:47], v[124:127], a[32:35]
    v_mfma_f32_16x16x32_bf16 a[64:67], v[44:47], v[132:135], a[64:67]
    v_exp_f32 v76, v76
    v_mfma_f32_16x16x32_bf16 a[96:99], v[44:47], v[140:143], a[96:99]
    v_lshlrev_b32 v242, 16, v199
    v_and_b32 v243, 0xffff0000, v199
    v_mfma_f32_16x16x32_bf16 a[128:131], v[44:47], v[148:151], a[128:131]
    v_exp_f32 v77, v77
    s_waitcnt lgkmcnt(2)
    v_mfma_f32_16x16x32_bf16 a[4:7], v[48:51], v[116:119], a[4:7]
    ds_read_b64_tr_b16 v[56:57], v11 offset:40960
    ds_read_b64_tr_b16 v[58:59], v11 offset:45056
    v_mfma_f32_16x16x32_bf16 a[36:39], v[48:51], v[124:127], a[36:39]
    v_exp_f32 v78, v78
    v_mfma_f32_16x16x32_bf16 a[68:71], v[48:51], v[132:135], a[68:71]
    v_exp_f32 v79, v79
    v_mfma_f32_16x16x32_bf16 a[100:103], v[48:51], v[140:143], a[100:103]
    v_pk_mul_f32 v[240:241], v[240:241], s[36:37]
    v_pk_mul_f32 v[242:243], v[242:243], s[36:37]
    v_cvt_pk_bf16_f32 v198, v240, v241
    v_cvt_pk_bf16_f32 v199, v242, v243
    v_mfma_f32_16x16x32_bf16 a[132:135], v[48:51], v[148:151], a[132:135]
    v_exp_f32 v80, v80
    s_waitcnt lgkmcnt(2)
    v_mfma_f32_16x16x32_bf16 a[8:11], v[52:55], v[116:119], a[8:11]
    ds_read_b64_tr_b16 v[60:61], v12 offset:40960
    ds_read_b64_tr_b16 v[62:63], v12 offset:45056
    v_mfma_f32_16x16x32_bf16 a[40:43], v[52:55], v[124:127], a[40:43]
    v_cvt_pk_bf16_f32 v76, v76, v77
    v_cvt_pk_bf16_f32 v77, v78, v79
    v_mfma_f32_16x16x32_bf16 a[72:75], v[52:55], v[132:135], a[72:75]
    v_exp_f32 v81, v81
    v_mfma_f32_16x16x32_bf16 a[104:107], v[52:55], v[140:143], a[104:107]
    v_lshlrev_b32 v236, 16, v200
    v_and_b32 v237, 0xffff0000, v200
    v_mfma_f32_16x16x32_bf16 a[136:139], v[52:55], v[148:151], a[136:139]
    v_exp_f32 v82, v82
    s_waitcnt lgkmcnt(2)
    v_mfma_f32_16x16x32_bf16 a[12:15], v[56:59], v[116:119], a[12:15]
    ds_read_b64_tr_b16 v[64:65], v13 offset:40960
    ds_read_b64_tr_b16 v[66:67], v13 offset:45056
    v_mfma_f32_16x16x32_bf16 a[44:47], v[56:59], v[124:127], a[44:47]
    v_exp_f32 v83, v83
    v_mfma_f32_16x16x32_bf16 a[76:79], v[56:59], v[132:135], a[76:79]
    v_cvt_pk_bf16_f32 v78, v80, v81
    v_cvt_pk_bf16_f32 v79, v82, v83
    v_mfma_f32_16x16x32_bf16 a[108:111], v[56:59], v[140:143], a[108:111]
    v_lshlrev_b32 v238, 16, v201
    v_and_b32 v239, 0xffff0000, v201
    v_mfma_f32_16x16x32_bf16 a[140:143], v[56:59], v[148:151], a[140:143]
    v_exp_f32 v84, v84
    s_waitcnt lgkmcnt(2)
    v_mfma_f32_16x16x32_bf16 a[16:19], v[60:63], v[116:119], a[16:19]
    ds_read_b64_tr_b16 v[68:69], v14 offset:40960
    ds_read_b64_tr_b16 v[70:71], v14 offset:45056
    v_mfma_f32_16x16x32_bf16 a[48:51], v[60:63], v[124:127], a[48:51]
    v_exp_f32 v85, v85
    v_mfma_f32_16x16x32_bf16 a[80:83], v[60:63], v[132:135], a[80:83]
    v_exp_f32 v86, v86
    v_mfma_f32_16x16x32_bf16 a[112:115], v[60:63], v[140:143], a[112:115]
    v_pk_mul_f32 v[236:237], v[236:237], s[36:37]
    v_pk_mul_f32 v[238:239], v[238:239], s[36:37]
    v_cvt_pk_bf16_f32 v200, v236, v237
    v_cvt_pk_bf16_f32 v201, v238, v239
    v_mfma_f32_16x16x32_bf16 a[144:147], v[60:63], v[148:151], a[144:147]
    v_exp_f32 v87, v87
    s_waitcnt lgkmcnt(2)
    v_mfma_f32_16x16x32_bf16 a[20:23], v[64:67], v[116:119], a[20:23]
    ds_read_b64_tr_b16 v[72:73], v15 offset:40960
    ds_read_b64_tr_b16 v[74:75], v15 offset:45056
    v_mfma_f32_16x16x32_bf16 a[52:55], v[64:67], v[124:127], a[52:55]
    v_exp_f32 v88, v88
    v_mfma_f32_16x16x32_bf16 a[84:87], v[64:67], v[132:135], a[84:87]
    v_cvt_pk_bf16_f32 v84, v84, v85
    v_cvt_pk_bf16_f32 v85, v86, v87
    v_mfma_f32_16x16x32_bf16 a[116:119], v[64:67], v[140:143], a[116:119]
    v_lshlrev_b32 v240, 16, v202
    v_and_b32 v241, 0xffff0000, v202
    v_mfma_f32_16x16x32_bf16 a[148:151], v[64:67], v[148:151], a[148:151]
    v_exp_f32 v89, v89
    s_waitcnt lgkmcnt(2)
    v_mfma_f32_16x16x32_bf16 a[24:27], v[68:71], v[116:119], a[24:27]
    ds_read_b128 v[44:47], v4 offset:57344
    ds_read_b128 v[48:51], v5 offset:57344
    v_mfma_f32_16x16x32_bf16 a[56:59], v[68:71], v[124:127], a[56:59]
    v_exp_f32 v90, v90
    s_nop 1
    v_mfma_f32_16x16x32_bf16 a[88:91], v[68:71], v[132:135], a[88:91]
    v_exp_f32 v91, v91
    v_mfma_f32_16x16x32_bf16 a[120:123], v[68:71], v[140:143], a[120:123]
    v_lshlrev_b32 v242, 16, v203
    v_and_b32 v243, 0xffff0000, v203
    v_mfma_f32_16x16x32_bf16 a[152:155], v[68:71], v[148:151], a[152:155]
    v_cvt_pk_bf16_f32 v86, v88, v89
    v_cvt_pk_bf16_f32 v87, v90, v91
    s_waitcnt lgkmcnt(2)
    v_mfma_f32_16x16x32_bf16 a[28:31], v[72:75], v[116:119], a[28:31]
    v_exp_f32 v92, v92
    v_mfma_f32_16x16x32_bf16 a[60:63], v[72:75], v[124:127], a[60:63]
    v_exp_f32 v93, v93
    s_nop 1
    v_mfma_f32_16x16x32_bf16 a[92:95], v[72:75], v[132:135], a[92:95]
    v_pk_mul_f32 v[240:241], v[240:241], s[36:37]
    v_pk_mul_f32 v[242:243], v[242:243], s[36:37]
    v_cvt_pk_bf16_f32 v202, v240, v241
    v_cvt_pk_bf16_f32 v203, v242, v243
    v_mfma_f32_16x16x32_bf16 a[124:127], v[72:75], v[140:143], a[124:127]
    v_exp_f32 v94, v94
    v_mfma_f32_16x16x32_bf16 a[156:159], v[72:75], v[148:151], a[156:159]
    v_exp_f32 v95, v95
    v_mfma_f32_16x16x32_bf16 a[240:243], v[248:251], v[116:119], a[240:243]
    v_exp_f32 v96, v96
    v_mfma_f32_16x16x32_bf16 a[244:247], v[248:251], v[124:127], a[244:247]
    v_cvt_pk_bf16_f32 v92, v92, v93
    v_cvt_pk_bf16_f32 v93, v94, v95
    s_barrier
    v_mfma_f32_16x16x32_bf16 a[248:251], v[248:251], v[132:135], a[248:251]
    s_add_u32 m0, s34, 24576
    s_nop 0
    buffer_load_dwordx4 v1, s[16:19], s33 offen lds
    v_mfma_f32_16x16x32_bf16 a[252:255], v[248:251], v[140:143], a[252:255]
    buffer_load_dwordx4 v2, s[16:19], s33 offen offset:1024 lds
    v_mfma_f32_16x16x32_bf16 v[20:23], v[248:251], v[148:151], v[20:23]
    s_add_u32 m0, s34, 90112
    s_nop 0
    buffer_load_dwordx4 v1, s[20:23], s33 offen lds
    s_waitcnt lgkmcnt(1)
    v_mfma_f32_16x16x32_bf16 v[116:119], v[44:47], a[160:163], v[24:27]
    ds_read_b128 v[52:55], v6 offset:57344
    ds_read_b128 v[56:59], v7 offset:57344
    v_mfma_f32_16x16x32_bf16 v[124:127], v[44:47], a[176:179], v[28:31]
    buffer_load_dwordx4 v2, s[20:23], s33 offen offset:1024 lds
    s_add_u32 s33, s33, 8192
    v_mfma_f32_16x16x32_bf16 v[132:135], v[44:47], a[192:195], v[32:35]
    v_lshlrev_b32 v236, 16, v204
    v_and_b32 v237, 0xffff0000, v204
    v_mfma_f32_16x16x32_bf16 v[140:143], v[44:47], a[208:211], v[36:39]
    v_exp_f32 v97, v97
    v_mfma_f32_16x16x32_bf16 v[148:151], v[44:47], a[224:227], v[40:43]
    v_exp_f32 v98, v98
    s_waitcnt lgkmcnt(2)
    v_mfma_f32_16x16x32_bf16 v[116:119], v[48:51], a[164:167], v[116:119]
    v_exp_f32 v99, v99
    v_mfma_f32_16x16x32_bf16 v[124:127], v[48:51], a[180:183], v[124:127]
    v_lshlrev_b32 v238, 16, v205
    v_and_b32 v239, 0xffff0000, v205
    v_mfma_f32_16x16x32_bf16 v[132:135], v[48:51], a[196:199], v[132:135]
    v_cvt_pk_bf16_f32 v94, v96, v97
    v_cvt_pk_bf16_f32 v95, v98, v99
    v_mfma_f32_16x16x32_bf16 v[140:143], v[48:51], a[212:215], v[140:143]
    v_exp_f32 v100, v100
    v_mfma_f32_16x16x32_bf16 v[148:151], v[48:51], a[228:231], v[148:151]
    v_exp_f32 v101, v101
    s_waitcnt lgkmcnt(1)
    v_mfma_f32_16x16x32_bf16 v[116:119], v[52:55], a[168:171], v[116:119]
    ds_read_b128 v[60:63], v4 offset:61440
    ds_read_b128 v[64:67], v5 offset:61440
    v_mfma_f32_16x16x32_bf16 v[124:127], v[52:55], a[184:187], v[124:127]
    v_pk_mul_f32 v[236:237], v[236:237], s[36:37]
    v_pk_mul_f32 v[238:239], v[238:239], s[36:37]
    v_cvt_pk_bf16_f32 v204, v236, v237
    v_cvt_pk_bf16_f32 v205, v238, v239
    v_mfma_f32_16x16x32_bf16 v[132:135], v[52:55], a[200:203], v[132:135]
    v_exp_f32 v102, v102
    v_mfma_f32_16x16x32_bf16 v[140:143], v[52:55], a[216:219], v[140:143]
    v_exp_f32 v103, v103
    v_mfma_f32_16x16x32_bf16 v[148:151], v[52:55], a[232:235], v[148:151]
    v_exp_f32 v104, v104
    s_waitcnt lgkmcnt(2)
    v_mfma_f32_16x16x32_bf16 v[116:119], v[56:59], a[172:175], v[116:119]
    v_lshlrev_b32 v240, 16, v206
    v_and_b32 v241, 0xffff0000, v206
    v_mfma_f32_16x16x32_bf16 v[124:127], v[56:59], a[188:191], v[124:127]
    v_cvt_pk_bf16_f32 v100, v100, v101
    v_cvt_pk_bf16_f32 v101, v102, v103
    v_mfma_f32_16x16x32_bf16 v[132:135], v[56:59], a[204:207], v[132:135]
    v_exp_f32 v105, v105
    v_mfma_f32_16x16x32_bf16 v[140:143], v[56:59], a[220:223], v[140:143]
    v_exp_f32 v106, v106
    v_mfma_f32_16x16x32_bf16 v[148:151], v[56:59], a[236:239], v[148:151]
    v_lshlrev_b32 v242, 16, v207
    v_and_b32 v243, 0xffff0000, v207
    s_waitcnt lgkmcnt(1)
    v_mfma_f32_16x16x32_bf16 v[120:123], v[60:63], a[160:163], v[24:27]
    ds_read_b128 v[68:71], v6 offset:61440
    ds_read_b128 v[72:75], v7 offset:61440
    v_mfma_f32_16x16x32_bf16 v[128:131], v[60:63], a[176:179], v[28:31]
    v_exp_f32 v107, v107
    v_mfma_f32_16x16x32_bf16 v[136:139], v[60:63], a[192:195], v[32:35]
    v_cvt_pk_bf16_f32 v102, v104, v105
    v_cvt_pk_bf16_f32 v103, v106, v107
    v_mfma_f32_16x16x32_bf16 v[144:147], v[60:63], a[208:211], v[36:39]
    v_exp_f32 v108, v108
    v_mfma_f32_16x16x32_bf16 v[152:155], v[60:63], a[224:227], v[40:43]
    v_pk_mul_f32 v[240:241], v[240:241], s[36:37]
    v_pk_mul_f32 v[242:243], v[242:243], s[36:37]
    v_cvt_pk_bf16_f32 v206, v240, v241
    v_cvt_pk_bf16_f32 v207, v242, v243
    s_waitcnt lgkmcnt(2)
    v_mfma_f32_16x16x32_bf16 v[120:123], v[64:67], a[164:167], v[120:123]
    v_exp_f32 v109, v109
    v_mfma_f32_16x16x32_bf16 v[128:131], v[64:67], a[180:183], v[128:131]
    v_exp_f32 v110, v110
    v_mfma_f32_16x16x32_bf16 v[136:139], v[64:67], a[196:199], v[136:139]
    v_exp_f32 v111, v111
    v_mfma_f32_16x16x32_bf16 v[144:147], v[64:67], a[212:215], v[144:147]
    v_lshlrev_b32 v236, 16, v208
    v_and_b32 v237, 0xffff0000, v208
    v_mfma_f32_16x16x32_bf16 v[152:155], v[64:67], a[228:231], v[152:155]
    v_exp_f32 v112, v112
    s_waitcnt lgkmcnt(1)
    v_mfma_f32_16x16x32_bf16 v[120:123], v[68:71], a[168:171], v[120:123]
    ds_read_b64_tr_b16 v[44:45], v8 offset:49152
    ds_read_b64_tr_b16 v[46:47], v8 offset:53248
    v_mfma_f32_16x16x32_bf16 v[128:131], v[68:71], a[184:187], v[128:131]
    v_cvt_pk_bf16_f32 v108, v108, v109
    v_cvt_pk_bf16_f32 v109, v110, v111
    v_mfma_f32_16x16x32_bf16 v[136:139], v[68:71], a[200:203], v[136:139]
    v_exp_f32 v113, v113
    v_mfma_f32_16x16x32_bf16 v[144:147], v[68:71], a[216:219], v[144:147]
    v_lshlrev_b32 v238, 16, v209
    v_and_b32 v239, 0xffff0000, v209
    v_mfma_f32_16x16x32_bf16 v[152:155], v[68:71], a[232:235], v[152:155]
    v_exp_f32 v114, v114
    s_waitcnt lgkmcnt(2)
    v_mfma_f32_16x16x32_bf16 v[120:123], v[72:75], a[172:175], v[120:123]
    ds_read_b64_tr_b16 v[48:49], v9 offset:49152
    ds_read_b64_tr_b16 v[50:51], v9 offset:53248
    v_mfma_f32_16x16x32_bf16 v[128:131], v[72:75], a[188:191], v[128:131]
    v_exp_f32 v115, v115
    v_mfma_f32_16x16x32_bf16 v[136:139], v[72:75], a[204:207], v[136:139]
    v_cvt_pk_bf16_f32 v110, v112, v113
    v_cvt_pk_bf16_f32 v111, v114, v115
    v_mfma_f32_16x16x32_bf16 v[144:147], v[72:75], a[220:223], v[144:147]
    v_mfma_f32_16x16x32_bf16 v[152:155], v[72:75], a[236:239], v[152:155]
    s_waitcnt vmcnt(28)
    s_waitcnt lgkmcnt(2)
    v_mfma_f32_16x16x32_bf16 a[0:3], v[44:47], v[76:79], a[0:3]
    ds_read_b64_tr_b16 v[52:53], v10 offset:49152
    ds_read_b64_tr_b16 v[54:55], v10 offset:53248
    v_mfma_f32_16x16x32_bf16 a[32:35], v[44:47], v[84:87], a[32:35]
    v_mfma_f32_16x16x32_bf16 a[64:67], v[44:47], v[92:95], a[64:67]
    v_exp_f32 v116, v116
    v_pk_mul_f32 v[236:237], v[236:237], s[36:37]
    v_pk_mul_f32 v[238:239], v[238:239], s[36:37]
    v_cvt_pk_bf16_f32 v208, v236, v237
    v_cvt_pk_bf16_f32 v209, v238, v239
    v_mfma_f32_16x16x32_bf16 a[96:99], v[44:47], v[100:103], a[96:99]
    v_exp_f32 v117, v117
    v_exp_f32 v118, v118
    v_mfma_f32_16x16x32_bf16 a[128:131], v[44:47], v[108:111], a[128:131]
    v_exp_f32 v119, v119
    v_lshlrev_b32 v240, 16, v210
    v_and_b32 v241, 0xffff0000, v210
    s_waitcnt lgkmcnt(2)
    v_mfma_f32_16x16x32_bf16 a[4:7], v[48:51], v[76:79], a[4:7]
    ds_read_b64_tr_b16 v[56:57], v11 offset:49152
    ds_read_b64_tr_b16 v[58:59], v11 offset:53248
    v_mfma_f32_16x16x32_bf16 a[36:39], v[48:51], v[84:87], a[36:39]
    v_exp_f32 v120, v120
    v_cvt_pk_bf16_f32 v116, v116, v117
    v_cvt_pk_bf16_f32 v117, v118, v119
    v_mfma_f32_16x16x32_bf16 a[68:71], v[48:51], v[92:95], a[68:71]
    v_exp_f32 v121, v121
    v_lshlrev_b32 v242, 16, v211
    v_and_b32 v243, 0xffff0000, v211
    v_mfma_f32_16x16x32_bf16 a[100:103], v[48:51], v[100:103], a[100:103]
    v_exp_f32 v122, v122
    v_exp_f32 v123, v123
    v_mfma_f32_16x16x32_bf16 a[132:135], v[48:51], v[108:111], a[132:135]
    v_cvt_pk_bf16_f32 v118, v120, v121
    v_cvt_pk_bf16_f32 v119, v122, v123
    v_pk_mul_f32 v[240:241], v[240:241], s[36:37]
    v_pk_mul_f32 v[242:243], v[242:243], s[36:37]
    v_cvt_pk_bf16_f32 v210, v240, v241
    v_cvt_pk_bf16_f32 v211, v242, v243
    s_waitcnt lgkmcnt(2)
    v_mfma_f32_16x16x32_bf16 a[8:11], v[52:55], v[76:79], a[8:11]
    ds_read_b64_tr_b16 v[60:61], v12 offset:49152
    ds_read_b64_tr_b16 v[62:63], v12 offset:53248
    v_mfma_f32_16x16x32_bf16 a[40:43], v[52:55], v[84:87], a[40:43]
    v_exp_f32 v124, v124
    v_exp_f32 v125, v125
    v_mfma_f32_16x16x32_bf16 a[72:75], v[52:55], v[92:95], a[72:75]
    v_exp_f32 v126, v126
    v_mfma_f32_16x16x32_bf16 a[104:107], v[52:55], v[100:103], a[104:107]
    v_lshlrev_b32 v236, 16, v212
    v_and_b32 v237, 0xffff0000, v212
    v_exp_f32 v127, v127
    v_mfma_f32_16x16x32_bf16 a[136:139], v[52:55], v[108:111], a[136:139]
    v_exp_f32 v128, v128
    v_cvt_pk_bf16_f32 v124, v124, v125
    v_cvt_pk_bf16_f32 v125, v126, v127
    s_waitcnt lgkmcnt(2)
    v_mfma_f32_16x16x32_bf16 a[12:15], v[56:59], v[76:79], a[12:15]
    ds_read_b64_tr_b16 v[64:65], v13 offset:49152
    ds_read_b64_tr_b16 v[66:67], v13 offset:53248
    v_mfma_f32_16x16x32_bf16 a[44:47], v[56:59], v[84:87], a[44:47]
    v_lshlrev_b32 v238, 16, v213
    v_and_b32 v239, 0xffff0000, v213
    v_exp_f32 v129, v129
    v_mfma_f32_16x16x32_bf16 a[76:79], v[56:59], v[92:95], a[76:79]
    v_exp_f32 v130, v130
    v_exp_f32 v131, v131
    v_mfma_f32_16x16x32_bf16 a[108:111], v[56:59], v[100:103], a[108:111]
    v_pk_mul_f32 v[236:237], v[236:237], s[36:37]
    v_pk_mul_f32 v[238:239], v[238:239], s[36:37]
    v_cvt_pk_bf16_f32 v212, v236, v237
    v_cvt_pk_bf16_f32 v213, v238, v239
    v_cvt_pk_bf16_f32 v126, v128, v129
    v_cvt_pk_bf16_f32 v127, v130, v131
    v_mfma_f32_16x16x32_bf16 a[140:143], v[56:59], v[108:111], a[140:143]
    v_exp_f32 v132, v132
    v_exp_f32 v133, v133
    s_waitcnt lgkmcnt(2)
    v_mfma_f32_16x16x32_bf16 a[16:19], v[60:63], v[76:79], a[16:19]
    ds_read_b64_tr_b16 v[68:69], v14 offset:49152
    ds_read_b64_tr_b16 v[70:71], v14 offset:53248
    v_mfma_f32_16x16x32_bf16 a[48:51], v[60:63], v[84:87], a[48:51]
    v_lshlrev_b32 v240, 16, v214
    v_and_b32 v241, 0xffff0000, v214
    v_exp_f32 v134, v134
    v_mfma_f32_16x16x32_bf16 a[80:83], v[60:63], v[92:95], a[80:83]
    v_exp_f32 v135, v135
    v_exp_f32 v136, v136
    v_mfma_f32_16x16x32_bf16 a[112:115], v[60:63], v[100:103], a[112:115]
    v_cvt_pk_bf16_f32 v132, v132, v133
    v_cvt_pk_bf16_f32 v133, v134, v135
    v_mfma_f32_16x16x32_bf16 a[144:147], v[60:63], v[108:111], a[144:147]
    v_lshlrev_b32 v242, 16, v215
    v_and_b32 v243, 0xffff0000, v215
    v_exp_f32 v137, v137
    s_waitcnt lgkmcnt(2)
    v_mfma_f32_16x16x32_bf16 a[20:23], v[64:67], v[76:79], a[20:23]
    ds_read_b64_tr_b16 v[72:73], v15 offset:49152
    ds_read_b64_tr_b16 v[74:75], v15 offset:53248
    v_mfma_f32_16x16x32_bf16 a[52:55], v[64:67], v[84:87], a[52:55]
    v_exp_f32 v138, v138
    v_exp_f32 v139, v139
    v_mfma_f32_16x16x32_bf16 a[84:87], v[64:67], v[92:95], a[84:87]
    v_pk_mul_f32 v[240:241], v[240:241], s[36:37]
    v_pk_mul_f32 v[242:243], v[242:243], s[36:37]
    v_cvt_pk_bf16_f32 v214, v240, v241
    v_cvt_pk_bf16_f32 v215, v242, v243
    v_cvt_pk_bf16_f32 v134, v136, v137
    v_cvt_pk_bf16_f32 v135, v138, v139
    v_mfma_f32_16x16x32_bf16 a[116:119], v[64:67], v[100:103], a[116:119]
    v_exp_f32 v140, v140
    v_exp_f32 v141, v141
    v_mfma_f32_16x16x32_bf16 a[148:151], v[64:67], v[108:111], a[148:151]
    v_lshlrev_b32 v236, 16, v216
    v_and_b32 v237, 0xffff0000, v216
    v_exp_f32 v142, v142
    s_waitcnt lgkmcnt(2)
    v_mfma_f32_16x16x32_bf16 a[24:27], v[68:71], v[76:79], a[24:27]
    ds_read_b64_tr_b16 v[44:45], v8 offset:57344
    ds_read_b64_tr_b16 v[46:47], v8 offset:61440
    v_mfma_f32_16x16x32_bf16 a[56:59], v[68:71], v[84:87], a[56:59]
    v_exp_f32 v143, v143
    v_exp_f32 v144, v144
    v_mfma_f32_16x16x32_bf16 a[88:91], v[68:71], v[92:95], a[88:91]
    v_lshlrev_b32 v238, 16, v217
    v_and_b32 v239, 0xffff0000, v217
    v_cvt_pk_bf16_f32 v140, v140, v141
    v_cvt_pk_bf16_f32 v141, v142, v143
    v_mfma_f32_16x16x32_bf16 a[120:123], v[68:71], v[100:103], a[120:123]
    v_exp_f32 v145, v145
    v_exp_f32 v146, v146
    v_mfma_f32_16x16x32_bf16 a[152:155], v[68:71], v[108:111], a[152:155]
    v_pk_mul_f32 v[236:237], v[236:237], s[36:37]
    v_pk_mul_f32 v[238:239], v[238:239], s[36:37]
    v_cvt_pk_bf16_f32 v216, v236, v237
    v_cvt_pk_bf16_f32 v217, v238, v239
    s_waitcnt lgkmcnt(2)
    v_mfma_f32_16x16x32_bf16 a[28:31], v[72:75], v[76:79], a[28:31]
    ds_read_b64_tr_b16 v[48:49], v9 offset:57344
    ds_read_b64_tr_b16 v[50:51], v9 offset:61440
    v_mfma_f32_16x16x32_bf16 a[60:63], v[72:75], v[84:87], a[60:63]
    v_exp_f32 v147, v147
    v_cvt_pk_bf16_f32 v142, v144, v145
    v_cvt_pk_bf16_f32 v143, v146, v147
    v_mfma_f32_16x16x32_bf16 a[92:95], v[72:75], v[92:95], a[92:95]
    v_exp_f32 v148, v148
    v_lshlrev_b32 v240, 16, v218
    v_and_b32 v241, 0xffff0000, v218
    v_mfma_f32_16x16x32_bf16 a[124:127], v[72:75], v[100:103], a[124:127]
    v_exp_f32 v149, v149
    v_exp_f32 v150, v150
    v_mfma_f32_16x16x32_bf16 a[156:159], v[72:75], v[108:111], a[156:159]
    v_exp_f32 v151, v151
    v_lshlrev_b32 v242, 16, v219
    v_and_b32 v243, 0xffff0000, v219
    s_nop 1
    v_mfma_f32_16x16x32_bf16 a[240:243], v[248:251], v[76:79], a[240:243]
    v_exp_f32 v152, v152
    v_cvt_pk_bf16_f32 v148, v148, v149
    v_cvt_pk_bf16_f32 v149, v150, v151
    v_mfma_f32_16x16x32_bf16 a[244:247], v[248:251], v[84:87], a[244:247]
    v_exp_f32 v153, v153
    v_pk_mul_f32 v[240:241], v[240:241], s[36:37]
    v_pk_mul_f32 v[242:243], v[242:243], s[36:37]
    v_cvt_pk_bf16_f32 v218, v240, v241
    v_cvt_pk_bf16_f32 v219, v242, v243
    v_mfma_f32_16x16x32_bf16 a[248:251], v[248:251], v[92:95], a[248:251]
    v_exp_f32 v154, v154
    v_exp_f32 v155, v155
    v_mfma_f32_16x16x32_bf16 a[252:255], v[248:251], v[100:103], a[252:255]
    v_cvt_pk_bf16_f32 v150, v152, v153
    v_cvt_pk_bf16_f32 v151, v154, v155
    v_mfma_f32_16x16x32_bf16 v[20:23], v[248:251], v[108:111], v[20:23]
    s_nop 1
    v_mfma_f32_16x16x32_bf16 a[240:243], v[248:251], v[116:119], a[240:243]
    v_mfma_f32_16x16x32_bf16 a[244:247], v[248:251], v[124:127], a[244:247]
    v_mfma_f32_16x16x32_bf16 a[248:251], v[248:251], v[132:135], a[248:251]
    v_mfma_f32_16x16x32_bf16 a[252:255], v[248:251], v[140:143], a[252:255]
    v_mfma_f32_16x16x32_bf16 v[20:23], v[248:251], v[148:151], v[20:23]
    s_nop 7
    v_accvgpr_read_b32 v236, a240
    v_accvgpr_read_b32 v237, a244
    v_accvgpr_read_b32 v238, a248
    v_accvgpr_read_b32 v239, a252
    v_mov_b32 v240, v20
    v_cmp_nge_f32 s[42:43], s40, v236
    v_cmp_nge_f32 s[48:49], s40, v237
    s_nop 1
    s_or_b64 s[42:43], s[42:43], s[48:49]
    v_cmp_nge_f32 s[48:49], s40, v238
    s_nop 1
    s_or_b64 s[42:43], s[42:43], s[48:49]
    v_cmp_nge_f32 s[48:49], s40, v239
    s_nop 1
    s_or_b64 s[42:43], s[42:43], s[48:49]
    v_cmp_nge_f32 s[48:49], s40, v240
    s_nop 1
    s_or_b64 s[42:43], s[42:43], s[48:49]
    s_nop 1
    s_cmp_lg_u64 s[42:43], 0
    s_cselect_b32 s38, 1, 0
    v_mov_b32 v246, s38
    ds_write_b32 v18, v246
    s_waitcnt lgkmcnt(0)
    s_barrier
    ds_read_b128 v[240:243], v19
    s_waitcnt lgkmcnt(0)
    v_or3_b32 v240, v240, v241, v242
    v_or_b32 v240, v240, v243
    s_nop 0
    v_readfirstlane_b32 s38, v240
    s_nop 1
    s_cmp_lg_u32 s38, 0
    s_cbranch_scc1 L_c5_fallback
    s_add_u32 m0, s34, 32768
    s_nop 0
    buffer_load_dwordx4 v1, s[16:19], s33 offen lds
    buffer_load_dwordx4 v2, s[16:19], s33 offen offset:1024 lds
    s_add_u32 m0, s34, 98304
    s_nop 0
    buffer_load_dwordx4 v1, s[20:23], s33 offen lds
    buffer_load_dwordx4 v2, s[20:23], s33 offen offset:1024 lds
    s_add_u32 s33, s33, 8192
    s_waitcnt vmcnt(12)
    s_waitcnt lgkmcnt(2)
    v_mfma_f32_16x16x32_bf16 a[0:3], v[44:47], v[116:119], a[0:3]
    ds_read_b64_tr_b16 v[52:53], v10 offset:57344
    ds_read_b64_tr_b16 v[54:55], v10 offset:61440
    v_mfma_f32_16x16x32_bf16 a[32:35], v[44:47], v[124:127], a[32:35]
    v_mfma_f32_16x16x32_bf16 a[64:67], v[44:47], v[132:135], a[64:67]
    v_lshlrev_b32 v236, 16, v220
    v_and_b32 v237, 0xffff0000, v220
    v_lshlrev_b32 v238, 16, v221
    v_and_b32 v239, 0xffff0000, v221
    v_mfma_f32_16x16x32_bf16 a[96:99], v[44:47], v[140:143], a[96:99]
    v_pk_mul_f32 v[236:237], v[236:237], s[36:37]
    v_pk_mul_f32 v[238:239], v[238:239], s[36:37]
    v_cvt_pk_bf16_f32 v220, v236, v237
    v_cvt_pk_bf16_f32 v221, v238, v239
    v_lshlrev_b32 v240, 16, v222
    v_and_b32 v241, 0xffff0000, v222
    v_mfma_f32_16x16x32_bf16 a[128:131], v[44:47], v[148:151], a[128:131]
    v_lshlrev_b32 v242, 16, v223
    v_and_b32 v243, 0xffff0000, v223
    v_pk_mul_f32 v[240:241], v[240:241], s[36:37]
    v_pk_mul_f32 v[242:243], v[242:243], s[36:37]
    v_cvt_pk_bf16_f32 v222, v240, v241
    v_cvt_pk_bf16_f32 v223, v242, v243
    s_waitcnt lgkmcnt(2)
    v_mfma_f32_16x16x32_bf16 a[4:7], v[48:51], v[116:119], a[4:7]
    ds_read_b64_tr_b16 v[56:57], v11 offset:57344
    ds_read_b64_tr_b16 v[58:59], v11 offset:61440
    v_mfma_f32_16x16x32_bf16 a[36:39], v[48:51], v[124:127], a[36:39]
    v_lshlrev_b32 v236, 16, v224
    v_and_b32 v237, 0xffff0000, v224
    v_lshlrev_b32 v238, 16, v225
    v_and_b32 v239, 0xffff0000, v225
    v_mfma_f32_16x16x32_bf16 a[68:71], v[48:51], v[132:135], a[68:71]
    v_pk_mul_f32 v[236:237], v[236:237], s[36:37]
    v_pk_mul_f32 v[238:239], v[238:239], s[36:37]
    v_cvt_pk_bf16_f32 v224, v236, v237
    v_cvt_pk_bf16_f32 v225, v238, v239
    v_lshlrev_b32 v240, 16, v226
    v_and_b32 v241, 0xffff0000, v226
    v_mfma_f32_16x16x32_bf16 a[100:103], v[48:51], v[140:143], a[100:103]
    v_lshlrev_b32 v242, 16, v227
    v_and_b32 v243, 0xffff0000, v227
    v_pk_mul_f32 v[240:241], v[240:241], s[36:37]
    v_pk_mul_f32 v[242:243], v[242:243], s[36:37]
    v_cvt_pk_bf16_f32 v226, v240, v241
    v_cvt_pk_bf16_f32 v227, v242, v243
    v_mfma_f32_16x16x32_bf16 a[132:135], v[48:51], v[148:151], a[132:135]
    v_lshlrev_b32 v236, 16, v228
    v_and_b32 v237, 0xffff0000, v228
    v_lshlrev_b32 v238, 16, v229
    v_and_b32 v239, 0xffff0000, v229
    s_waitcnt lgkmcnt(2)
    v_mfma_f32_16x16x32_bf16 a[8:11], v[52:55], v[116:119], a[8:11]
    ds_read_b64_tr_b16 v[60:61], v12 offset:57344
    ds_read_b64_tr_b16 v[62:63], v12 offset:61440
    v_mfma_f32_16x16x32_bf16 a[40:43], v[52:55], v[124:127], a[40:43]
    v_pk_mul_f32 v[236:237], v[236:237], s[36:37]
    v_pk_mul_f32 v[238:239], v[238:239], s[36:37]
    v_cvt_pk_bf16_f32 v228, v236, v237
    v_cvt_pk_bf16_f32 v229, v238, v239
    v_lshlrev_b32 v240, 16, v230
    v_and_b32 v241, 0xffff0000, v230
    v_mfma_f32_16x16x32_bf16 a[72:75], v[52:55], v[132:135], a[72:75]
    v_lshlrev_b32 v242, 16, v231
    v_and_b32 v243, 0xffff0000, v231
    v_pk_mul_f32 v[240:241], v[240:241], s[36:37]
    v_pk_mul_f32 v[242:243], v[242:243], s[36:37]
    v_cvt_pk_bf16_f32 v230, v240, v241
    v_cvt_pk_bf16_f32 v231, v242, v243
    v_mfma_f32_16x16x32_bf16 a[104:107], v[52:55], v[140:143], a[104:107]
    v_lshlrev_b32 v236, 16, v232
    v_and_b32 v237, 0xffff0000, v232
    v_lshlrev_b32 v238, 16, v233
    v_and_b32 v239, 0xffff0000, v233
    v_mfma_f32_16x16x32_bf16 a[136:139], v[52:55], v[148:151], a[136:139]
    v_pk_mul_f32 v[236:237], v[236:237], s[36:37]
    v_pk_mul_f32 v[238:239], v[238:239], s[36:37]
    v_cvt_pk_bf16_f32 v232, v236, v237
    v_cvt_pk_bf16_f32 v233, v238, v239
    v_lshlrev_b32 v240, 16, v234
    v_and_b32 v241, 0xffff0000, v234
    s_waitcnt lgkmcnt(2)
    v_mfma_f32_16x16x32_bf16 a[12:15], v[56:59], v[116:119], a[12:15]
    ds_read_b64_tr_b16 v[64:65], v13 offset:57344
    ds_read_b64_tr_b16 v[66:67], v13 offset:61440
    v_mfma_f32_16x16x32_bf16 a[44:47], v[56:59], v[124:127], a[44:47]
    v_lshlrev_b32 v242, 16, v235
    v_and_b32 v243, 0xffff0000, v235
    v_pk_mul_f32 v[240:241], v[240:241], s[36:37]
    v_pk_mul_f32 v[242:243], v[242:243], s[36:37]
    v_cvt_pk_bf16_f32 v234, v240, v241
    v_cvt_pk_bf16_f32 v235, v242, v243
    v_mfma_f32_16x16x32_bf16 a[76:79], v[56:59], v[132:135], a[76:79]
    v_accvgpr_write_b32 a160, v156
    v_accvgpr_write_b32 a161, v157
    v_accvgpr_write_b32 a162, v158
    v_accvgpr_write_b32 a163, v159
    v_mfma_f32_16x16x32_bf16 a[108:111], v[56:59], v[140:143], a[108:111]
    v_accvgpr_write_b32 a164, v160
    v_accvgpr_write_b32 a165, v161
    v_accvgpr_write_b32 a166, v162
    v_accvgpr_write_b32 a167, v163
    v_mfma_f32_16x16x32_bf16 a[140:143], v[56:59], v[148:151], a[140:143]
    v_accvgpr_write_b32 a168, v164
    v_accvgpr_write_b32 a169, v165
    v_accvgpr_write_b32 a170, v166
    v_accvgpr_write_b32 a171, v167
    s_waitcnt lgkmcnt(2)
    v_mfma_f32_16x16x32_bf16 a[16:19], v[60:63], v[116:119], a[16:19]
    ds_read_b64_tr_b16 v[68:69], v14 offset:57344
    ds_read_b64_tr_b16 v[70:71], v14 offset:61440
    v_mfma_f32_16x16x32_bf16 a[48:51], v[60:63], v[124:127], a[48:51]
    v_accvgpr_write_b32 a172, v168
    v_accvgpr_write_b32 a173, v169
    v_accvgpr_write_b32 a174, v170
    v_accvgpr_write_b32 a175, v171
    v_mfma_f32_16x16x32_bf16 a[80:83], v[60:63], v[132:135], a[80:83]
    v_accvgpr_write_b32 a176, v172
    v_accvgpr_write_b32 a177, v173
    v_accvgpr_write_b32 a178, v174
    v_accvgpr_write_b32 a179, v175
    v_mfma_f32_16x16x32_bf16 a[112:115], v[60:63], v[140:143], a[112:115]
    v_accvgpr_write_b32 a180, v176
    v_accvgpr_write_b32 a181, v177
    v_accvgpr_write_b32 a182, v178
    v_accvgpr_write_b32 a183, v179
    v_mfma_f32_16x16x32_bf16 a[144:147], v[60:63], v[148:151], a[144:147]
    v_accvgpr_write_b32 a184, v180
    v_accvgpr_write_b32 a185, v181
    v_accvgpr_write_b32 a186, v182
    v_accvgpr_write_b32 a187, v183
    s_waitcnt lgkmcnt(2)
    v_mfma_f32_16x16x32_bf16 a[20:23], v[64:67], v[116:119], a[20:23]
    ds_read_b64_tr_b16 v[72:73], v15 offset:57344
    ds_read_b64_tr_b16 v[74:75], v15 offset:61440
    v_mfma_f32_16x16x32_bf16 a[52:55], v[64:67], v[124:127], a[52:55]
    v_accvgpr_write_b32 a188, v184
    v_accvgpr_write_b32 a189, v185
    v_accvgpr_write_b32 a190, v186
    v_accvgpr_write_b32 a191, v187
    v_mfma_f32_16x16x32_bf16 a[84:87], v[64:67], v[132:135], a[84:87]
    v_accvgpr_write_b32 a192, v188
    v_accvgpr_write_b32 a193, v189
    v_accvgpr_write_b32 a194, v190
    v_accvgpr_write_b32 a195, v191
    v_mfma_f32_16x16x32_bf16 a[116:119], v[64:67], v[140:143], a[116:119]
    v_accvgpr_write_b32 a196, v192
    v_accvgpr_write_b32 a197, v193
    v_accvgpr_write_b32 a198, v194
    v_accvgpr_write_b32 a199, v195
    v_mfma_f32_16x16x32_bf16 a[148:151], v[64:67], v[148:151], a[148:151]
    v_accvgpr_write_b32 a200, v196
    v_accvgpr_write_b32 a201, v197
    v_accvgpr_write_b32 a202, v198
    v_accvgpr_write_b32 a203, v199
    s_waitcnt lgkmcnt(2)
    v_mfma_f32_16x16x32_bf16 a[24:27], v[68:71], v[116:119], a[24:27]
    v_accvgpr_write_b32 a204, v200
    v_accvgpr_write_b32 a205, v201
    v_accvgpr_write_b32 a206, v202
    v_accvgpr_write_b32 a207, v203
    v_mfma_f32_16x16x32_bf16 a[56:59], v[68:71], v[124:127], a[56:59]
    v_accvgpr_write_b32 a208, v204
    v_accvgpr_write_b32 a209, v205
    v_accvgpr_write_b32 a210, v206
    v_accvgpr_write_b32 a211, v207
    v_mfma_f32_16x16x32_bf16 a[88:91], v[68:71], v[132:135], a[88:91]
    v_accvgpr_write_b32 a212, v208
    v_accvgpr_write_b32 a213, v209
    v_accvgpr_write_b32 a214, v210
    v_accvgpr_write_b32 a215, v211
    v_mfma_f32_16x16x32_bf16 a[120:123], v[68:71], v[140:143], a[120:123]
    v_accvgpr_write_b32 a216, v212
    v_accvgpr_write_b32 a217, v213
    v_accvgpr_write_b32 a218, v214
    v_accvgpr_write_b32 a219, v215
    v_mfma_f32_16x16x32_bf16 a[152:155], v[68:71], v[148:151], a[152:155]
    v_accvgpr_write_b32 a220, v216
    v_accvgpr_write_b32 a221, v217
    v_accvgpr_write_b32 a222, v218
    v_accvgpr_write_b32 a223, v219
    s_waitcnt lgkmcnt(0)
    v_mfma_f32_16x16x32_bf16 a[28:31], v[72:75], v[116:119], a[28:31]
    v_accvgpr_write_b32 a224, v220
    v_accvgpr_write_b32 a225, v221
    v_accvgpr_write_b32 a226, v222
    v_accvgpr_write_b32 a227, v223
    v_mfma_f32_16x16x32_bf16 a[60:63], v[72:75], v[124:127], a[60:63]
    v_accvgpr_write_b32 a228, v224
    v_accvgpr_write_b32 a229, v225
    v_accvgpr_write_b32 a230, v226
    v_accvgpr_write_b32 a231, v227
    v_mfma_f32_16x16x32_bf16 a[92:95], v[72:75], v[132:135], a[92:95]
    v_accvgpr_write_b32 a232, v228
    v_accvgpr_write_b32 a233, v229
    v_accvgpr_write_b32 a234, v230
    v_accvgpr_write_b32 a235, v231
    v_mfma_f32_16x16x32_bf16 a[124:127], v[72:75], v[140:143], a[124:127]
    v_accvgpr_write_b32 a236, v232
    v_accvgpr_write_b32 a237, v233
    v_accvgpr_write_b32 a238, v234
    v_accvgpr_write_b32 a239, v235
    v_mfma_f32_16x16x32_bf16 a[156:159], v[72:75], v[148:151], a[156:159]
    s_waitcnt vmcnt(8)
    s_barrier
    s_add_u32 m0, s34, 40960
    s_nop 0
    buffer_load_dwordx4 v1, s[16:19], s33 offen lds
    buffer_load_dwordx4 v2, s[16:19], s33 offen offset:1024 lds
    s_add_u32 m0, s34, 106496
    s_nop 0
    buffer_load_dwordx4 v1, s[20:23], s33 offen lds
    buffer_load_dwordx4 v2, s[20:23], s33 offen offset:1024 lds
    s_add_u32 s33, s33, 8192
L_c5_bnd:
    s_nop 7
    v_accvgpr_read_b32 v221, a240
    v_accvgpr_read_b32 v223, a244
    v_accvgpr_read_b32 v225, a248
    v_accvgpr_read_b32 v227, a252
    v_mov_b32 v229, v20
    v_rcp_f32 v220, v221
    v_rcp_f32 v222, v223
    v_rcp_f32 v224, v225
    v_rcp_f32 v226, v227
    v_rcp_f32 v228, v229
    s_nop 0
    v_mov_b32 v221, v220
    v_mov_b32 v223, v222
    v_mov_b32 v225, v224
    v_mov_b32 v227, v226
    v_mov_b32 v229, v228
    ds_read_b128 v[44:47], v4 offset:0
    ds_read_b128 v[48:51], v5 offset:0
    ds_read_b128 v[52:55], v6 offset:0
    s_waitcnt lgkmcnt(2)
    v_mfma_f32_16x16x32_bf16 v[76:79], v[44:47], a[160:163], 0
    ds_read_b128 v[56:59], v7 offset:0
    s_nop 0
    s_add_u32 s38, s32, 0
    v_accvgpr_read_b32 v156, a0
    v_accvgpr_read_b32 v157, a1
    v_accvgpr_read_b32 v158, a2
    v_accvgpr_read_b32 v159, a3
    v_mfma_f32_16x16x32_bf16 v[84:87], v[44:47], a[176:179], 0
    v_accvgpr_read_b32 v160, a4
    v_accvgpr_read_b32 v161, a5
    v_accvgpr_read_b32 v162, a6
    v_accvgpr_read_b32 v163, a7
    v_pk_mul_f32 v[156:157], v[156:157], v[220:221]
    v_pk_mul_f32 v[158:159], v[158:159], v[220:221]
    s_nop 1
    v_mfma_f32_16x16x32_bf16 v[92:95], v[44:47], a[192:195], 0
    v_pk_mul_f32 v[160:161], v[160:161], v[220:221]
    v_pk_mul_f32 v[162:163], v[162:163], v[220:221]
    v_cvt_pk_bf16_f32 v156, v156, v157
    v_cvt_pk_bf16_f32 v157, v158, v159
    v_cvt_pk_bf16_f32 v158, v160, v161
    v_cvt_pk_bf16_f32 v159, v162, v163
    v_mfma_f32_16x16x32_bf16 v[100:103], v[44:47], a[208:211], 0
    s_nop 1
    v_permlane16_swap_b32 v156, v158
    v_permlane16_swap_b32 v157, v159
    buffer_store_dwordx4 v[156:159], v17, s[24:27], s38 offen offset:0
    v_accvgpr_read_b32 v164, a8
    v_accvgpr_read_b32 v165, a9
    v_mfma_f32_16x16x32_bf16 v[108:111], v[44:47], a[224:227], 0
    v_accvgpr_read_b32 v166, a10
    v_accvgpr_read_b32 v167, a11
    v_accvgpr_read_b32 v168, a12
    v_accvgpr_read_b32 v169, a13
    v_accvgpr_read_b32 v170, a14
    v_accvgpr_read_b32 v171, a15
    s_waitcnt lgkmcnt(2)
    v_mfma_f32_16x16x32_bf16 v[76:79], v[48:51], a[164:167], v[76:79]
    ds_read_b128 v[60:63], v4 offset:4096
    v_pk_mul_f32 v[164:165], v[164:165], v[220:221]
    v_pk_mul_f32 v[166:167], v[166:167], v[220:221]
    v_pk_mul_f32 v[168:169], v[168:169], v[220:221]
    v_pk_mul_f32 v[170:171], v[170:171], v[220:221]
    v_cvt_pk_bf16_f32 v164, v164, v165
    v_cvt_pk_bf16_f32 v165, v166, v167
    v_mfma_f32_16x16x32_bf16 v[84:87], v[48:51], a[180:183], v[84:87]
    v_cvt_pk_bf16_f32 v166, v168, v169
    v_cvt_pk_bf16_f32 v167, v170, v171
    s_nop 1
    v_permlane16_swap_b32 v164, v166
    v_permlane16_swap_b32 v165, v167
    buffer_store_dwordx4 v[164:167], v17, s[24:27], s38 offen offset:64
    v_mfma_f32_16x16x32_bf16 v[92:95], v[48:51], a[196:199], v[92:95]
    v_accvgpr_read_b32 v172, a16
    v_accvgpr_read_b32 v173, a17
    v_accvgpr_read_b32 v174, a18
    v_accvgpr_read_b32 v175, a19
    v_accvgpr_read_b32 v176, a20
    v_accvgpr_read_b32 v177, a21
    v_mfma_f32_16x16x32_bf16 v[100:103], v[48:51], a[212:215], v[100:103]
    v_accvgpr_read_b32 v178, a22
    v_accvgpr_read_b32 v179, a23
    v_pk_mul_f32 v[172:173], v[172:173], v[220:221]
    v_pk_mul_f32 v[174:175], v[174:175], v[220:221]
    v_pk_mul_f32 v[176:177], v[176:177], v[220:221]
    v_pk_mul_f32 v[178:179], v[178:179], v[220:221]
    s_nop 1
    v_mfma_f32_16x16x32_bf16 v[108:111], v[48:51], a[228:231], v[108:111]
    v_cvt_pk_bf16_f32 v172, v172, v173
    v_cvt_pk_bf16_f32 v173, v174, v175
    v_cvt_pk_bf16_f32 v174, v176, v177
    v_cvt_pk_bf16_f32 v175, v178, v179
    s_nop 1
    v_permlane16_swap_b32 v172, v174
    s_waitcnt lgkmcnt(2)
    v_mfma_f32_16x16x32_bf16 v[76:79], v[52:55], a[168:171], v[76:79]
    ds_read_b128 v[64:67], v5 offset:4096
    v_permlane16_swap_b32 v173, v175
    buffer_store_dwordx4 v[172:175], v17, s[24:27], s38 offen offset:128
    v_accvgpr_read_b32 v180, a24
    v_accvgpr_read_b32 v181, a25
    v_accvgpr_read_b32 v182, a26
    v_accvgpr_read_b32 v183, a27
    v_mfma_f32_16x16x32_bf16 v[84:87], v[52:55], a[184:187], v[84:87]
    v_accvgpr_read_b32 v184, a28
    v_accvgpr_read_b32 v185, a29
    v_accvgpr_read_b32 v186, a30
    v_accvgpr_read_b32 v187, a31
    v_pk_mul_f32 v[180:181], v[180:181], v[220:221]
    v_pk_mul_f32 v[182:183], v[182:183], v[220:221]
    s_nop 1
    v_mfma_f32_16x16x32_bf16 v[92:95], v[52:55], a[200:203], v[92:95]
    v_pk_mul_f32 v[184:185], v[184:185], v[220:221]
    v_pk_mul_f32 v[186:187], v[186:187], v[220:221]
    v_cvt_pk_bf16_f32 v180, v180, v181
    v_cvt_pk_bf16_f32 v181, v182, v183
    v_cvt_pk_bf16_f32 v182, v184, v185
    v_cvt_pk_bf16_f32 v183, v186, v187
    v_mfma_f32_16x16x32_bf16 v[100:103], v[52:55], a[216:219], v[100:103]
    s_nop 1
    v_permlane16_swap_b32 v180, v182
    v_permlane16_swap_b32 v181, v183
    buffer_store_dwordx4 v[180:183], v17, s[24:27], s38 offen offset:192
    s_add_u32 s38, s32, 4096
    v_accvgpr_read_b32 v188, a32
    v_accvgpr_read_b32 v189, a33
    v_mfma_f32_16x16x32_bf16 v[108:111], v[52:55], a[232:235], v[108:111]
    v_accvgpr_read_b32 v190, a34
    v_accvgpr_read_b32 v191, a35
    v_accvgpr_read_b32 v192, a36
    v_accvgpr_read_b32 v193, a37
    v_accvgpr_read_b32 v194, a38
    v_accvgpr_read_b32 v195, a39
    s_waitcnt lgkmcnt(2)
    v_mfma_f32_16x16x32_bf16 v[76:79], v[56:59], a[172:175], v[76:79]
    ds_read_b128 v[68:71], v6 offset:4096
    v_pk_mul_f32 v[188:189], v[188:189], v[222:223]
    v_pk_mul_f32 v[190:191], v[190:191], v[222:223]
    v_pk_mul_f32 v[192:193], v[192:193], v[222:223]
    v_pk_mul_f32 v[194:195], v[194:195], v[222:223]
    v_cvt_pk_bf16_f32 v188, v188, v189
    v_cvt_pk_bf16_f32 v189, v190, v191
    s_nop 1
    v_mfma_f32_16x16x32_bf16 v[84:87], v[56:59], a[188:191], v[84:87]
    v_cvt_pk_bf16_f32 v190, v192, v193
    v_cvt_pk_bf16_f32 v191, v194, v195
    s_nop 1
    v_permlane16_swap_b32 v188, v190
    v_permlane16_swap_b32 v189, v191
    buffer_store_dwordx4 v[188:191], v17, s[24:27], s38 offen offset:0
    v_mfma_f32_16x16x32_bf16 v[92:95], v[56:59], a[204:207], v[92:95]
    v_accvgpr_read_b32 v196, a40
    v_accvgpr_read_b32 v197, a41
    v_accvgpr_read_b32 v198, a42
    v_accvgpr_read_b32 v199, a43
    v_accvgpr_read_b32 v200, a44
    v_accvgpr_read_b32 v201, a45
    v_mfma_f32_16x16x32_bf16 v[100:103], v[56:59], a[220:223], v[100:103]
    v_accvgpr_read_b32 v202, a46
    v_accvgpr_read_b32 v203, a47
    v_pk_mul_f32 v[196:197], v[196:197], v[222:223]
    v_pk_mul_f32 v[198:199], v[198:199], v[222:223]
    v_pk_mul_f32 v[200:201], v[200:201], v[222:223]
    v_pk_mul_f32 v[202:203], v[202:203], v[222:223]
    s_nop 1
    v_mfma_f32_16x16x32_bf16 v[108:111], v[56:59], a[236:239], v[108:111]
    v_cvt_pk_bf16_f32 v196, v196, v197
    v_cvt_pk_bf16_f32 v197, v198, v199
    v_cvt_pk_bf16_f32 v198, v200, v201
    v_cvt_pk_bf16_f32 v199, v202, v203
    s_nop 1
    v_permlane16_swap_b32 v196, v198
    s_waitcnt lgkmcnt(2)
    v_mfma_f32_16x16x32_bf16 v[80:83], v[60:63], a[160:163], 0
    ds_read_b128 v[72:75], v7 offset:4096
    v_permlane16_swap_b32 v197, v199
    buffer_store_dwordx4 v[196:199], v17, s[24:27], s38 offen offset:64
    v_accvgpr_read_b32 v204, a48
    v_accvgpr_read_b32 v205, a49
    v_accvgpr_read_b32 v206, a50
    v_accvgpr_read_b32 v207, a51
    v_mfma_f32_16x16x32_bf16 v[88:91], v[60:63], a[176:179], 0
    v_accvgpr_read_b32 v208, a52
    v_accvgpr_read_b32 v209, a53
    v_accvgpr_read_b32 v210, a54
    v_accvgpr_read_b32 v211, a55
    v_pk_mul_f32 v[204:205], v[204:205], v[222:223]
    v_pk_mul_f32 v[206:207], v[206:207], v[222:223]
    s_nop 1
    v_mfma_f32_16x16x32_bf16 v[96:99], v[60:63], a[192:195], 0
    v_pk_mul_f32 v[208:209], v[208:209], v[222:223]
    v_pk_mul_f32 v[210:211], v[210:211], v[222:223]
    v_cvt_pk_bf16_f32 v204, v204, v205
    v_cvt_pk_bf16_f32 v205, v206, v207
    v_cvt_pk_bf16_f32 v206, v208, v209
    v_cvt_pk_bf16_f32 v207, v210, v211
    v_mfma_f32_16x16x32_bf16 v[104:107], v[60:63], a[208:211], 0
    s_nop 1
    v_permlane16_swap_b32 v204, v206
    v_permlane16_swap_b32 v205, v207
    buffer_store_dwordx4 v[204:207], v17, s[24:27], s38 offen offset:128
    v_accvgpr_read_b32 v212, a56
    v_accvgpr_read_b32 v213, a57
    v_mfma_f32_16x16x32_bf16 v[112:115], v[60:63], a[224:227], 0
    v_accvgpr_read_b32 v214, a58
    v_accvgpr_read_b32 v215, a59
    v_accvgpr_read_b32 v216, a60
    v_accvgpr_read_b32 v217, a61
    v_accvgpr_read_b32 v218, a62
    v_accvgpr_read_b32 v219, a63
    s_waitcnt lgkmcnt(2)
    v_mfma_f32_16x16x32_bf16 v[80:83], v[64:67], a[164:167], v[80:83]
    v_pk_mul_f32 v[212:213], v[212:213], v[222:223]
    v_pk_mul_f32 v[214:215], v[214:215], v[222:223]
    v_pk_mul_f32 v[216:217], v[216:217], v[222:223]
    v_pk_mul_f32 v[218:219], v[218:219], v[222:223]
    v_cvt_pk_bf16_f32 v212, v212, v213
    v_cvt_pk_bf16_f32 v213, v214, v215
    v_mfma_f32_16x16x32_bf16 v[88:91], v[64:67], a[180:183], v[88:91]
    v_cvt_pk_bf16_f32 v214, v216, v217
    v_cvt_pk_bf16_f32 v215, v218, v219
    s_nop 1
    v_permlane16_swap_b32 v212, v214
    v_permlane16_swap_b32 v213, v215
    buffer_store_dwordx4 v[212:215], v17, s[24:27], s38 offen offset:192
    s_add_u32 s38, s32, 8192
    v_mfma_f32_16x16x32_bf16 v[96:99], v[64:67], a[196:199], v[96:99]
    v_accvgpr_read_b32 v156, a64
    v_accvgpr_read_b32 v157, a65
    v_accvgpr_read_b32 v158, a66
    v_accvgpr_read_b32 v159, a67
    v_accvgpr_read_b32 v160, a68
    v_accvgpr_read_b32 v161, a69
    v_mfma_f32_16x16x32_bf16 v[104:107], v[64:67], a[212:215], v[104:107]
    v_accvgpr_read_b32 v162, a70
    v_accvgpr_read_b32 v163, a71
    v_pk_mul_f32 v[156:157], v[156:157], v[224:225]
    v_pk_mul_f32 v[158:159], v[158:159], v[224:225]
    v_pk_mul_f32 v[160:161], v[160:161], v[224:225]
    v_pk_mul_f32 v[162:163], v[162:163], v[224:225]
    s_nop 1
    v_mfma_f32_16x16x32_bf16 v[112:115], v[64:67], a[228:231], v[112:115]
    v_cvt_pk_bf16_f32 v156, v156, v157
    v_cvt_pk_bf16_f32 v157, v158, v159
    v_cvt_pk_bf16_f32 v158, v160, v161
    v_cvt_pk_bf16_f32 v159, v162, v163
    s_nop 1
    v_permlane16_swap_b32 v156, v158
    s_waitcnt lgkmcnt(1)
    v_mfma_f32_16x16x32_bf16 v[80:83], v[68:71], a[168:171], v[80:83]
    v_permlane16_swap_b32 v157, v159
    buffer_store_dwordx4 v[156:159], v17, s[24:27], s38 offen offset:0
    v_accvgpr_read_b32 v164, a72
    v_accvgpr_read_b32 v165, a73
    v_accvgpr_read_b32 v166, a74
    v_accvgpr_read_b32 v167, a75
    v_mfma_f32_16x16x32_bf16 v[88:91], v[68:71], a[184:187], v[88:91]
    v_accvgpr_read_b32 v168, a76
    v_accvgpr_read_b32 v169, a77
    v_accvgpr_read_b32 v170, a78
    v_accvgpr_read_b32 v171, a79
    v_pk_mul_f32 v[164:165], v[164:165], v[224:225]
    v_pk_mul_f32 v[166:167], v[166:167], v[224:225]
    s_nop 1
    v_mfma_f32_16x16x32_bf16 v[96:99], v[68:71], a[200:203], v[96:99]
    v_pk_mul_f32 v[168:169], v[168:169], v[224:225]
    v_pk_mul_f32 v[170:171], v[170:171], v[224:225]
    v_cvt_pk_bf16_f32 v164, v164, v165
    v_cvt_pk_bf16_f32 v165, v166, v167
    v_cvt_pk_bf16_f32 v166, v168, v169
    v_cvt_pk_bf16_f32 v167, v170, v171
    v_mfma_f32_16x16x32_bf16 v[104:107], v[68:71], a[216:219], v[104:107]
    s_nop 1
    v_permlane16_swap_b32 v164, v166
    v_permlane16_swap_b32 v165, v167
    buffer_store_dwordx4 v[164:167], v17, s[24:27], s38 offen offset:64
    v_accvgpr_read_b32 v172, a80
    v_accvgpr_read_b32 v173, a81
    v_mfma_f32_16x16x32_bf16 v[112:115], v[68:71], a[232:235], v[112:115]
    v_accvgpr_read_b32 v174, a82
    v_accvgpr_read_b32 v175, a83
    v_accvgpr_read_b32 v176, a84
    v_accvgpr_read_b32 v177, a85
    v_accvgpr_read_b32 v178, a86
    v_accvgpr_read_b32 v179, a87
    s_waitcnt lgkmcnt(0)
    v_mfma_f32_16x16x32_bf16 v[80:83], v[72:75], a[172:175], v[80:83]
    v_pk_mul_f32 v[172:173], v[172:173], v[224:225]
    v_pk_mul_f32 v[174:175], v[174:175], v[224:225]
    v_pk_mul_f32 v[176:177], v[176:177], v[224:225]
    v_pk_mul_f32 v[178:179], v[178:179], v[224:225]
    v_cvt_pk_bf16_f32 v172, v172, v173
    v_cvt_pk_bf16_f32 v173, v174, v175
    v_mfma_f32_16x16x32_bf16 v[88:91], v[72:75], a[188:191], v[88:91]
    v_cvt_pk_bf16_f32 v174, v176, v177
    v_cvt_pk_bf16_f32 v175, v178, v179
    s_nop 1
    v_permlane16_swap_b32 v172, v174
    v_permlane16_swap_b32 v173, v175
    buffer_store_dwordx4 v[172:175], v17, s[24:27], s38 offen offset:128
    v_mfma_f32_16x16x32_bf16 v[96:99], v[72:75], a[204:207], v[96:99]
    v_accvgpr_read_b32 v180, a88
    v_accvgpr_read_b32 v181, a89
    v_accvgpr_read_b32 v182, a90
    v_accvgpr_read_b32 v183, a91
    v_accvgpr_read_b32 v184, a92
    v_accvgpr_read_b32 v185, a93
    v_mfma_f32_16x16x32_bf16 v[104:107], v[72:75], a[220:223], v[104:107]
    v_accvgpr_read_b32 v186, a94
    v_accvgpr_read_b32 v187, a95
    v_pk_mul_f32 v[180:181], v[180:181], v[224:225]
    v_pk_mul_f32 v[182:183], v[182:183], v[224:225]
    v_pk_mul_f32 v[184:185], v[184:185], v[224:225]
    v_pk_mul_f32 v[186:187], v[186:187], v[224:225]
    s_nop 1
    v_mfma_f32_16x16x32_bf16 v[112:115], v[72:75], a[236:239], v[112:115]
    v_cvt_pk_bf16_f32 v180, v180, v181
    v_cvt_pk_bf16_f32 v181, v182, v183
    v_cvt_pk_bf16_f32 v182, v184, v185
    v_cvt_pk_bf16_f32 v183, v186, v187
    s_nop 1
    v_permlane16_swap_b32 v180, v182
    v_permlane16_swap_b32 v181, v183
    s_nop 7
    v_max3_f32 v236, v76, v77, v78
    v_max3_f32 v237, v79, v80, v81
    v_max3_f32 v236, v236, v82, v83
    v_max_f32 v236, v236, v237
    v_max3_f32 v238, v84, v85, v86
    v_max3_f32 v239, v87, v88, v89
    v_max3_f32 v238, v238, v90, v91
    v_max_f32 v238, v238, v239
    v_max3_f32 v240, v92, v93, v94
    v_max3_f32 v241, v95, v96, v97
    v_max3_f32 v240, v240, v98, v99
    v_max_f32 v240, v240, v241
    v_max3_f32 v242, v100, v101, v102
    v_max3_f32 v243, v103, v104, v105
    v_max3_f32 v242, v242, v106, v107
    v_max_f32 v242, v242, v243
    v_max3_f32 v244, v108, v109, v110
    v_max3_f32 v245, v111, v112, v113
    v_max3_f32 v244, v244, v114, v115
    v_max_f32 v244, v244, v245
    v_mov_b32 v237, v236
    v_mov_b32 v239, v238
    v_mov_b32 v241, v240
    v_mov_b32 v243, v242
    v_mov_b32 v245, v244
    s_nop 1
    v_permlane16_swap_b32 v236, v237
    v_permlane16_swap_b32 v238, v239
    v_permlane16_swap_b32 v240, v241
    v_permlane16_swap_b32 v242, v243
    v_permlane16_swap_b32 v244, v245
    v_max_f32 v236, v236, v237
    v_mov_b32 v237, v236
    v_max_f32 v238, v238, v239
    v_mov_b32 v239, v238
    v_max_f32 v240, v240, v241
    v_mov_b32 v241, v240
    v_max_f32 v242, v242, v243
    v_mov_b32 v243, v242
    v_max_f32 v244, v244, v245
    v_mov_b32 v245, v244
    s_nop 1
    v_permlane32_swap_b32 v236, v237
    v_permlane32_swap_b32 v238, v239
    v_permlane32_swap_b32 v240, v241
    v_permlane32_swap_b32 v242, v243
    v_permlane32_swap_b32 v244, v245
    v_max_f32 v236, v236, v237
    v_max_f32 v238, v238, v239
    v_max_f32 v240, v240, v241
    v_max_f32 v242, v242, v243
    v_max_f32 v244, v244, v245
    v_sub_f32 v24, 0, v236
    v_sub_f32 v25, 0, v236
    v_sub_f32 v26, 0, v236
    v_sub_f32 v27, 0, v236
    v_sub_f32 v28, 0, v238
    v_sub_f32 v29, 0, v238
    v_sub_f32 v30, 0, v238
    v_sub_f32 v31, 0, v238
    v_sub_f32 v32, 0, v240
    v_sub_f32 v33, 0, v240
    v_sub_f32 v34, 0, v240
    v_sub_f32 v35, 0, v240
    v_sub_f32 v36, 0, v242
    v_sub_f32 v37, 0, v242
    v_sub_f32 v38, 0, v242
    v_sub_f32 v39, 0, v242
    v_sub_f32 v40, 0, v244
    v_sub_f32 v41, 0, v244
    v_sub_f32 v42, 0, v244
    v_sub_f32 v43, 0, v244
    s_nop 1
    ds_read_b128 v[44:47], v4 offset:8192
    ds_read_b128 v[48:51], v5 offset:8192
    ds_read_b128 v[52:55], v6 offset:8192
    s_waitcnt lgkmcnt(2)
    v_mfma_f32_16x16x32_bf16 v[116:119], v[44:47], a[160:163], v[24:27]
    ds_read_b128 v[56:59], v7 offset:8192
    buffer_store_dwordx4 v[180:183], v17, s[24:27], s38 offen offset:192
    s_add_u32 s38, s32, 12288
    v_accvgpr_read_b32 v188, a96
    v_accvgpr_read_b32 v189, a97
    v_accvgpr_read_b32 v190, a98
    v_accvgpr_read_b32 v191, a99
    v_mfma_f32_16x16x32_bf16 v[124:127], v[44:47], a[176:179], v[28:31]
    v_accvgpr_read_b32 v192, a100
    v_accvgpr_read_b32 v193, a101
    v_accvgpr_read_b32 v194, a102
    v_accvgpr_read_b32 v195, a103
    v_pk_mul_f32 v[188:189], v[188:189], v[226:227]
    v_pk_mul_f32 v[190:191], v[190:191], v[226:227]
    v_pk_mul_f32 v[192:193], v[192:193], v[226:227]
    s_nop 1
    v_mfma_f32_16x16x32_bf16 v[132:135], v[44:47], a[192:195], v[32:35]
    v_pk_mul_f32 v[194:195], v[194:195], v[226:227]
    v_cvt_pk_bf16_f32 v188, v188, v189
    v_cvt_pk_bf16_f32 v189, v190, v191
    v_cvt_pk_bf16_f32 v190, v192, v193
    v_cvt_pk_bf16_f32 v191, v194, v195
    s_nop 1
    v_permlane16_swap_b32 v188, v190
    v_mfma_f32_16x16x32_bf16 v[140:143], v[44:47], a[208:211], v[36:39]
    v_permlane16_swap_b32 v189, v191
    buffer_store_dwordx4 v[188:191], v17, s[24:27], s38 offen offset:0
    v_accvgpr_read_b32 v196, a104
    v_accvgpr_read_b32 v197, a105
    v_accvgpr_read_b32 v198, a106
    v_accvgpr_read_b32 v199, a107
    v_accvgpr_read_b32 v200, a108
    v_mfma_f32_16x16x32_bf16 v[148:151], v[44:47], a[224:227], v[40:43]
    v_accvgpr_read_b32 v201, a109
    v_accvgpr_read_b32 v202, a110
    v_accvgpr_read_b32 v203, a111
    v_pk_mul_f32 v[196:197], v[196:197], v[226:227]
    v_pk_mul_f32 v[198:199], v[198:199], v[226:227]
    v_pk_mul_f32 v[200:201], v[200:201], v[226:227]
    v_pk_mul_f32 v[202:203], v[202:203], v[226:227]
    s_waitcnt lgkmcnt(2)
    s_nop 0
    v_mfma_f32_16x16x32_bf16 v[116:119], v[48:51], a[164:167], v[116:119]
    ds_read_b128 v[60:63], v4 offset:12288
    v_cvt_pk_bf16_f32 v196, v196, v197
    v_cvt_pk_bf16_f32 v197, v198, v199
    v_cvt_pk_bf16_f32 v198, v200, v201
    v_cvt_pk_bf16_f32 v199, v202, v203
    s_nop 1
    v_permlane16_swap_b32 v196, v198
    v_permlane16_swap_b32 v197, v199
    v_mfma_f32_16x16x32_bf16 v[124:127], v[48:51], a[180:183], v[124:127]
    buffer_store_dwordx4 v[196:199], v17, s[24:27], s38 offen offset:64
    v_accvgpr_read_b32 v204, a112
    v_accvgpr_read_b32 v205, a113
    v_accvgpr_read_b32 v206, a114
    v_accvgpr_read_b32 v207, a115
    v_accvgpr_read_b32 v208, a116
    v_accvgpr_read_b32 v209, a117
    v_mfma_f32_16x16x32_bf16 v[132:135], v[48:51], a[196:199], v[132:135]
    v_accvgpr_read_b32 v210, a118
    v_accvgpr_read_b32 v211, a119
    v_pk_mul_f32 v[204:205], v[204:205], v[226:227]
    v_pk_mul_f32 v[206:207], v[206:207], v[226:227]
    v_pk_mul_f32 v[208:209], v[208:209], v[226:227]
    v_pk_mul_f32 v[210:211], v[210:211], v[226:227]
    v_cvt_pk_bf16_f32 v204, v204, v205
    s_nop 0
    v_mfma_f32_16x16x32_bf16 v[140:143], v[48:51], a[212:215], v[140:143]
    v_cvt_pk_bf16_f32 v205, v206, v207
    v_cvt_pk_bf16_f32 v206, v208, v209
    v_cvt_pk_bf16_f32 v207, v210, v211
    s_nop 1
    v_permlane16_swap_b32 v204, v206
    v_permlane16_swap_b32 v205, v207
    buffer_store_dwordx4 v[204:207], v17, s[24:27], s38 offen offset:128
    v_mfma_f32_16x16x32_bf16 v[148:151], v[48:51], a[228:231], v[148:151]
    v_accvgpr_read_b32 v212, a120
    v_accvgpr_read_b32 v213, a121
    v_accvgpr_read_b32 v214, a122
    v_accvgpr_read_b32 v215, a123
    v_accvgpr_read_b32 v216, a124
    v_accvgpr_read_b32 v217, a125
    v_accvgpr_read_b32 v218, a126
    s_waitcnt lgkmcnt(2)
    v_mfma_f32_16x16x32_bf16 v[116:119], v[52:55], a[168:171], v[116:119]
    ds_read_b128 v[64:67], v5 offset:12288
    v_accvgpr_read_b32 v219, a127
    v_pk_mul_f32 v[212:213], v[212:213], v[226:227]
    v_pk_mul_f32 v[214:215], v[214:215], v[226:227]
    v_pk_mul_f32 v[216:217], v[216:217], v[226:227]
    v_pk_mul_f32 v[218:219], v[218:219], v[226:227]
    v_cvt_pk_bf16_f32 v212, v212, v213
    v_cvt_pk_bf16_f32 v213, v214, v215
    v_mfma_f32_16x16x32_bf16 v[124:127], v[52:55], a[184:187], v[124:127]
    v_cvt_pk_bf16_f32 v214, v216, v217
    v_cvt_pk_bf16_f32 v215, v218, v219
    s_nop 1
    v_permlane16_swap_b32 v212, v214
    v_permlane16_swap_b32 v213, v215
    buffer_store_dwordx4 v[212:215], v17, s[24:27], s38 offen offset:192
    s_add_u32 s38, s32, 16384
    v_mfma_f32_16x16x32_bf16 v[132:135], v[52:55], a[200:203], v[132:135]
    v_accvgpr_read_b32 v156, a128
    v_accvgpr_read_b32 v157, a129
    v_accvgpr_read_b32 v158, a130
    v_accvgpr_read_b32 v159, a131
    v_accvgpr_read_b32 v160, a132
    v_accvgpr_read_b32 v161, a133
    v_accvgpr_read_b32 v162, a134
    v_mfma_f32_16x16x32_bf16 v[140:143], v[52:55], a[216:219], v[140:143]
    v_accvgpr_read_b32 v163, a135
    v_pk_mul_f32 v[156:157], v[156:157], v[228:229]
    v_pk_mul_f32 v[158:159], v[158:159], v[228:229]
    v_pk_mul_f32 v[160:161], v[160:161], v[228:229]
    v_pk_mul_f32 v[162:163], v[162:163], v[228:229]
    v_cvt_pk_bf16_f32 v156, v156, v157
    v_cvt_pk_bf16_f32 v157, v158, v159
    v_mfma_f32_16x16x32_bf16 v[148:151], v[52:55], a[232:235], v[148:151]
    v_cvt_pk_bf16_f32 v158, v160, v161
    v_cvt_pk_bf16_f32 v159, v162, v163
    s_nop 1
    v_permlane16_swap_b32 v156, v158
    v_permlane16_swap_b32 v157, v159
    buffer_store_dwordx4 v[156:159], v17, s[24:27], s38 offen offset:0
    v_accvgpr_read_b32 v164, a136
    s_waitcnt lgkmcnt(2)
    v_mfma_f32_16x16x32_bf16 v[116:119], v[56:59], a[172:175], v[116:119]
    ds_read_b128 v[68:71], v6 offset:12288
    v_accvgpr_read_b32 v165, a137
    v_accvgpr_read_b32 v166, a138
    v_accvgpr_read_b32 v167, a139
    v_accvgpr_read_b32 v168, a140
    v_accvgpr_read_b32 v169, a141
    v_accvgpr_read_b32 v170, a142
    v_accvgpr_read_b32 v171, a143
    v_mfma_f32_16x16x32_bf16 v[124:127], v[56:59], a[188:191], v[124:127]
    v_pk_mul_f32 v[164:165], v[164:165], v[228:229]
    v_pk_mul_f32 v[166:167], v[166:167], v[228:229]
    v_pk_mul_f32 v[168:169], v[168:169], v[228:229]
    v_pk_mul_f32 v[170:171], v[170:171], v[228:229]
    v_cvt_pk_bf16_f32 v164, v164, v165
    v_cvt_pk_bf16_f32 v165, v166, v167
    v_cvt_pk_bf16_f32 v166, v168, v169
    v_mfma_f32_16x16x32_bf16 v[132:135], v[56:59], a[204:207], v[132:135]
    v_cvt_pk_bf16_f32 v167, v170, v171
    s_nop 1
    v_permlane16_swap_b32 v164, v166
    v_permlane16_swap_b32 v165, v167
    buffer_store_dwordx4 v[164:167], v17, s[24:27], s38 offen offset:64
    v_accvgpr_read_b32 v172, a144
    v_accvgpr_read_b32 v173, a145
    v_mfma_f32_16x16x32_bf16 v[140:143], v[56:59], a[220:223], v[140:143]
    v_accvgpr_read_b32 v174, a146
    v_accvgpr_read_b32 v175, a147
    v_accvgpr_read_b32 v176, a148
    v_accvgpr_read_b32 v177, a149
    v_accvgpr_read_b32 v178, a150
    v_accvgpr_read_b32 v179, a151
    v_pk_mul_f32 v[172:173], v[172:173], v[228:229]
    s_nop 1
    v_mfma_f32_16x16x32_bf16 v[148:151], v[56:59], a[236:239], v[148:151]
    v_pk_mul_f32 v[174:175], v[174:175], v[228:229]
    v_pk_mul_f32 v[176:177], v[176:177], v[228:229]
    v_pk_mul_f32 v[178:179], v[178:179], v[228:229]
    v_cvt_pk_bf16_f32 v172, v172, v173
    v_cvt_pk_bf16_f32 v173, v174, v175
    v_cvt_pk_bf16_f32 v174, v176, v177
    v_cvt_pk_bf16_f32 v175, v178, v179
    s_waitcnt lgkmcnt(2)
    v_mfma_f32_16x16x32_bf16 v[120:123], v[60:63], a[160:163], v[24:27]
    ds_read_b128 v[72:75], v7 offset:12288
    s_nop 1
    v_permlane16_swap_b32 v172, v174
    v_permlane16_swap_b32 v173, v175
    buffer_store_dwordx4 v[172:175], v17, s[24:27], s38 offen offset:128
    v_accvgpr_read_b32 v180, a152
    v_accvgpr_read_b32 v181, a153
    v_mfma_f32_16x16x32_bf16 v[128:131], v[60:63], a[176:179], v[28:31]
    v_accvgpr_read_b32 v182, a154
    v_accvgpr_read_b32 v183, a155
    v_accvgpr_read_b32 v184, a156
    v_accvgpr_read_b32 v185, a157
    v_accvgpr_read_b32 v186, a158
    v_accvgpr_read_b32 v187, a159
    v_pk_mul_f32 v[180:181], v[180:181], v[228:229]
    s_nop 1
    v_mfma_f32_16x16x32_bf16 v[136:139], v[60:63], a[192:195], v[32:35]
    v_pk_mul_f32 v[182:183], v[182:183], v[228:229]
    v_pk_mul_f32 v[184:185], v[184:185], v[228:229]
    v_pk_mul_f32 v[186:187], v[186:187], v[228:229]
    v_cvt_pk_bf16_f32 v180, v180, v181
    v_cvt_pk_bf16_f32 v181, v182, v183
    v_cvt_pk_bf16_f32 v182, v184, v185
    v_cvt_pk_bf16_f32 v183, v186, v187
    v_mfma_f32_16x16x32_bf16 v[144:147], v[60:63], a[208:211], v[36:39]
    s_nop 1
    v_permlane16_swap_b32 v180, v182
    v_permlane16_swap_b32 v181, v183
    buffer_store_dwordx4 v[180:183], v17, s[24:27], s38 offen offset:192
    v_mfma_f32_32x32x16_bf16 a[0:15], v[252:255], v[252:255], 0
    v_mfma_f32_32x32x16_bf16 a[16:31], v[252:255], v[252:255], 0
    v_mfma_f32_32x32x16_bf16 a[32:47], v[252:255], v[252:255], 0
    v_mfma_f32_16x16x32_bf16 v[152:155], v[60:63], a[224:227], v[40:43]
    v_mfma_f32_32x32x16_bf16 a[48:63], v[252:255], v[252:255], 0
    v_mfma_f32_32x32x16_bf16 a[64:79], v[252:255], v[252:255], 0
    v_mfma_f32_32x32x16_bf16 a[80:95], v[252:255], v[252:255], 0
    v_mfma_f32_32x32x16_bf16 a[96:111], v[252:255], v[252:255], 0
    v_mfma_f32_32x32x16_bf16 a[112:127], v[252:255], v[252:255], 0
    v_mfma_f32_32x32x16_bf16 a[128:143], v[252:255], v[252:255], 0
    v_mfma_f32_32x32x16_bf16 a[144:159], v[252:255], v[252:255], 0
    s_waitcnt lgkmcnt(2)
    v_mfma_f32_16x16x32_bf16 v[120:123], v[64:67], a[164:167], v[120:123]
    v_mfma_f32_32x32x16_bf16 a[240:255], v[252:255], v[252:255], 0
    v_mov_b32 v20, 0
    v_mov_b32 v21, 0
    v_mov_b32 v22, 0
    v_mov_b32 v23, 0
    v_sub_f32 v76, v76, v236
    v_sub_f32 v77, v77, v236
    v_mfma_f32_16x16x32_bf16 v[128:131], v[64:67], a[180:183], v[128:131]
    v_sub_f32 v78, v78, v236
    v_sub_f32 v79, v79, v236
    v_sub_f32 v80, v80, v236
    v_sub_f32 v81, v81, v236
    v_sub_f32 v82, v82, v236
    v_sub_f32 v83, v83, v236
    v_sub_f32 v84, v84, v238
    v_mfma_f32_16x16x32_bf16 v[136:139], v[64:67], a[196:199], v[136:139]
    v_sub_f32 v85, v85, v238
    v_sub_f32 v86, v86, v238
    v_sub_f32 v87, v87, v238
    v_sub_f32 v88, v88, v238
    v_sub_f32 v89, v89, v238
    v_sub_f32 v90, v90, v238
    v_sub_f32 v91, v91, v238
    v_mfma_f32_16x16x32_bf16 v[144:147], v[64:67], a[212:215], v[144:147]
    v_sub_f32 v92, v92, v240
    v_sub_f32 v93, v93, v240
    v_sub_f32 v94, v94, v240
    v_sub_f32 v95, v95, v240
    v_sub_f32 v96, v96, v240
    v_sub_f32 v97, v97, v240
    v_sub_f32 v98, v98, v240
    v_mfma_f32_16x16x32_bf16 v[152:155], v[64:67], a[228:231], v[152:155]
    v_sub_f32 v99, v99, v240
    v_sub_f32 v100, v100, v242
    v_sub_f32 v101, v101, v242
    v_sub_f32 v102, v102, v242
    v_sub_f32 v103, v103, v242
    v_sub_f32 v104, v104, v242
    v_sub_f32 v105, v105, v242
    s_waitcnt lgkmcnt(1)
    v_mfma_f32_16x16x32_bf16 v[120:123], v[68:71], a[168:171], v[120:123]
    v_sub_f32 v106, v106, v242
    v_sub_f32 v107, v107, v242
    v_sub_f32 v108, v108, v244
    v_sub_f32 v109, v109, v244
    v_sub_f32 v110, v110, v244
    v_sub_f32 v111, v111, v244
    v_sub_f32 v112, v112, v244
    v_mfma_f32_16x16x32_bf16 v[128:131], v[68:71], a[184:187], v[128:131]
    v_sub_f32 v113, v113, v244
    v_sub_f32 v114, v114, v244
    v_sub_f32 v115, v115, v244
    v_exp_f32 v76, v76
    v_exp_f32 v77, v77
    v_exp_f32 v78, v78
    v_exp_f32 v79, v79
    v_mfma_f32_16x16x32_bf16 v[136:139], v[68:71], a[200:203], v[136:139]
    v_exp_f32 v80, v80
    v_cvt_pk_bf16_f32 v76, v76, v77
    v_cvt_pk_bf16_f32 v77, v78, v79
    v_exp_f32 v81, v81
    v_exp_f32 v82, v82
    v_exp_f32 v83, v83
    v_cvt_pk_bf16_f32 v78, v80, v81
    v_mfma_f32_16x16x32_bf16 v[144:147], v[68:71], a[216:219], v[144:147]
    v_cvt_pk_bf16_f32 v79, v82, v83
    v_exp_f32 v84, v84
    v_exp_f32 v85, v85
    v_exp_f32 v86, v86
    v_exp_f32 v87, v87
    v_exp_f32 v88, v88
    v_cvt_pk_bf16_f32 v84, v84, v85
    v_mfma_f32_16x16x32_bf16 v[152:155], v[68:71], a[232:235], v[152:155]
    v_cvt_pk_bf16_f32 v85, v86, v87
    v_exp_f32 v89, v89
    v_exp_f32 v90, v90
    v_exp_f32 v91, v91
    v_cvt_pk_bf16_f32 v86, v88, v89
    v_cvt_pk_bf16_f32 v87, v90, v91
    v_exp_f32 v92, v92
    s_waitcnt lgkmcnt(0)
    v_mfma_f32_16x16x32_bf16 v[120:123], v[72:75], a[172:175], v[120:123]
    v_exp_f32 v93, v93
    v_exp_f32 v94, v94
    v_exp_f32 v95, v95
    v_exp_f32 v96, v96
    v_cvt_pk_bf16_f32 v92, v92, v93
    v_cvt_pk_bf16_f32 v93, v94, v95
    v_exp_f32 v97, v97
    v_mfma_f32_16x16x32_bf16 v[128:131], v[72:75], a[188:191], v[128:131]
    v_exp_f32 v98, v98
    v_exp_f32 v99, v99
    v_cvt_pk_bf16_f32 v94, v96, v97
    v_cvt_pk_bf16_f32 v95, v98, v99
    v_exp_f32 v100, v100
    v_exp_f32 v101, v101
    v_exp_f32 v102, v102
    v_mfma_f32_16x16x32_bf16 v[136:139], v[72:75], a[204:207], v[136:139]
    v_exp_f32 v103, v103
    v_exp_f32 v104, v104
    v_cvt_pk_bf16_f32 v100, v100, v101
    v_cvt_pk_bf16_f32 v101, v102, v103
    v_exp_f32 v105, v105
    v_exp_f32 v106, v106
    v_exp_f32 v107, v107
    v_mfma_f32_16x16x32_bf16 v[144:147], v[72:75], a[220:223], v[144:147]
    v_cvt_pk_bf16_f32 v102, v104, v105
    v_cvt_pk_bf16_f32 v103, v106, v107
    v_exp_f32 v108, v108
    v_exp_f32 v109, v109
    v_exp_f32 v110, v110
    v_exp_f32 v111, v111
    v_exp_f32 v112, v112
    v_mfma_f32_16x16x32_bf16 v[152:155], v[72:75], a[236:239], v[152:155]
    v_cvt_pk_bf16_f32 v108, v108, v109
    v_cvt_pk_bf16_f32 v109, v110, v111
    v_exp_f32 v113, v113
    v_exp_f32 v114, v114
    v_exp_f32 v115, v115
    v_cvt_pk_bf16_f32 v110, v112, v113
    v_cvt_pk_bf16_f32 v111, v114, v115
    ds_read_b64_tr_b16 v[44:45], v8 offset:0
    ds_read_b64_tr_b16 v[46:47], v8 offset:4096
    ds_read_b64_tr_b16 v[48:49], v9 offset:0
    ds_read_b64_tr_b16 v[50:51], v9 offset:4096
    s_mov_b32 s32, s44
    s_mov_b32 s30, s45
    s_mov_b32 s45, 0x40000000
    s_mov_b32 s46, 1
    s_branch L_c5_go
L_c5_tail2:
    s_waitcnt lgkmcnt(2)
    v_mfma_f32_16x16x32_bf16 a[0:3], v[44:47], v[76:79], a[0:3]
    ds_read_b64_tr_b16 v[52:53], v10 offset:0
    ds_read_b64_tr_b16 v[54:55], v10 offset:4096
    v_mfma_f32_16x16x32_bf16 a[32:35], v[44:47], v[84:87], a[32:35]
    v_mfma_f32_16x16x32_bf16 a[64:67], v[44:47], v[92:95], a[64:67]
    v_exp_f32 v116, v116
    v_mfma_f32_16x16x32_bf16 a[96:99], v[44:47], v[100:103], a[96:99]
    v_exp_f32 v117, v117
    v_mfma_f32_16x16x32_bf16 a[128:131], v[44:47], v[108:111], a[128:131]
    v_exp_f32 v118, v118
    s_waitcnt lgkmcnt(2)
    v_mfma_f32_16x16x32_bf16 a[4:7], v[48:51], v[76:79], a[4:7]
    ds_read_b64_tr_b16 v[56:57], v11 offset:0
    ds_read_b64_tr_b16 v[58:59], v11 offset:4096
    v_mfma_f32_16x16x32_bf16 a[36:39], v[48:51], v[84:87], a[36:39]
    v_mfma_f32_16x16x32_bf16 a[68:71], v[48:51], v[92:95], a[68:71]
    v_exp_f32 v119, v119
    v_mfma_f32_16x16x32_bf16 a[100:103], v[48:51], v[100:103], a[100:103]
    v_exp_f32 v120, v120
    v_mfma_f32_16x16x32_bf16 a[132:135], v[48:51], v[108:111], a[132:135]
    v_cvt_pk_bf16_f32 v116, v116, v117
    v_cvt_pk_bf16_f32 v117, v118, v119
    s_waitcnt lgkmcnt(2)
    v_mfma_f32_16x16x32_bf16 a[8:11], v[52:55], v[76:79], a[8:11]
    ds_read_b64_tr_b16 v[60:61], v12 offset:0
    ds_read_b64_tr_b16 v[62:63], v12 offset:4096
    v_mfma_f32_16x16x32_bf16 a[40:43], v[52:55], v[84:87], a[40:43]
    v_mfma_f32_16x16x32_bf16 a[72:75], v[52:55], v[92:95], a[72:75]
    v_exp_f32 v121, v121
    v_mfma_f32_16x16x32_bf16 a[104:107], v[52:55], v[100:103], a[104:107]
    v_exp_f32 v122, v122
    v_mfma_f32_16x16x32_bf16 a[136:139], v[52:55], v[108:111], a[136:139]
    v_exp_f32 v123, v123
    s_waitcnt lgkmcnt(2)
    v_mfma_f32_16x16x32_bf16 a[12:15], v[56:59], v[76:79], a[12:15]
    ds_read_b64_tr_b16 v[64:65], v13 offset:0
    ds_read_b64_tr_b16 v[66:67], v13 offset:4096
    v_mfma_f32_16x16x32_bf16 a[44:47], v[56:59], v[84:87], a[44:47]
    v_mfma_f32_16x16x32_bf16 a[76:79], v[56:59], v[92:95], a[76:79]
    v_cvt_pk_bf16_f32 v118, v120, v121
    v_cvt_pk_bf16_f32 v119, v122, v123
    v_mfma_f32_16x16x32_bf16 a[108:111], v[56:59], v[100:103], a[108:111]
    v_exp_f32 v124, v124
    v_mfma_f32_16x16x32_bf16 a[140:143], v[56:59], v[108:111], a[140:143]
    v_exp_f32 v125, v125
    s_waitcnt lgkmcnt(2)
    v_mfma_f32_16x16x32_bf16 a[16:19], v[60:63], v[76:79], a[16:19]
    ds_read_b64_tr_b16 v[68:69], v14 offset:0
    ds_read_b64_tr_b16 v[70:71], v14 offset:4096
    v_mfma_f32_16x16x32_bf16 a[48:51], v[60:63], v[84:87], a[48:51]
    v_mfma_f32_16x16x32_bf16 a[80:83], v[60:63], v[92:95], a[80:83]
    v_exp_f32 v126, v126
    v_mfma_f32_16x16x32_bf16 a[112:115], v[60:63], v[100:103], a[112:115]
    v_exp_f32 v127, v127
    v_mfma_f32_16x16x32_bf16 a[144:147], v[60:63], v[108:111], a[144:147]
    v_exp_f32 v128, v128
    s_waitcnt lgkmcnt(2)
    v_mfma_f32_16x16x32_bf16 a[20:23], v[64:67], v[76:79], a[20:23]
    ds_read_b64_tr_b16 v[72:73], v15 offset:0
    ds_read_b64_tr_b16 v[74:75], v15 offset:4096
    v_mfma_f32_16x16x32_bf16 a[52:55], v[64:67], v[84:87], a[52:55]
    v_mfma_f32_16x16x32_bf16 a[84:87], v[64:67], v[92:95], a[84:87]
    v_cvt_pk_bf16_f32 v124, v124, v125
    v_cvt_pk_bf16_f32 v125, v126, v127
    v_mfma_f32_16x16x32_bf16 a[116:119], v[64:67], v[100:103], a[116:119]
    v_exp_f32 v129, v129
    v_mfma_f32_16x16x32_bf16 a[148:151], v[64:67], v[108:111], a[148:151]
    v_exp_f32 v130, v130
    s_waitcnt lgkmcnt(2)
    v_mfma_f32_16x16x32_bf16 a[24:27], v[68:71], v[76:79], a[24:27]
    ds_read_b128 v[44:47], v4 offset:16384
    ds_read_b128 v[48:51], v5 offset:16384
    v_mfma_f32_16x16x32_bf16 a[56:59], v[68:71], v[84:87], a[56:59]
    v_mfma_f32_16x16x32_bf16 a[88:91], v[68:71], v[92:95], a[88:91]
    v_exp_f32 v131, v131
    v_mfma_f32_16x16x32_bf16 a[120:123], v[68:71], v[100:103], a[120:123]
    v_cvt_pk_bf16_f32 v126, v128, v129
    v_cvt_pk_bf16_f32 v127, v130, v131
    v_mfma_f32_16x16x32_bf16 a[152:155], v[68:71], v[108:111], a[152:155]
    v_exp_f32 v132, v132
    s_waitcnt lgkmcnt(2)
    v_mfma_f32_16x16x32_bf16 a[28:31], v[72:75], v[76:79], a[28:31]
    v_mfma_f32_16x16x32_bf16 a[60:63], v[72:75], v[84:87], a[60:63]
    v_exp_f32 v133, v133
    v_mfma_f32_16x16x32_bf16 a[92:95], v[72:75], v[92:95], a[92:95]
    v_exp_f32 v134, v134
    v_mfma_f32_16x16x32_bf16 a[124:127], v[72:75], v[100:103], a[124:127]
    v_exp_f32 v135, v135
    v_mfma_f32_16x16x32_bf16 a[156:159], v[72:75], v[108:111], a[156:159]
    v_mfma_f32_16x16x32_bf16 a[240:243], v[248:251], v[76:79], a[240:243]
    v_exp_f32 v136, v136
    v_mfma_f32_16x16x32_bf16 a[244:247], v[248:251], v[84:87], a[244:247]
    v_cvt_pk_bf16_f32 v132, v132, v133
    v_cvt_pk_bf16_f32 v133, v134, v135
    s_waitcnt vmcnt(8)
    s_barrier
    v_mfma_f32_16x16x32_bf16 a[248:251], v[248:251], v[92:95], a[248:251]
    s_add_u32 m0, s34, 49152
    s_nop 0
    buffer_load_dwordx4 v1, s[16:19], s33 offen lds
    v_mfma_f32_16x16x32_bf16 a[252:255], v[248:251], v[100:103], a[252:255]
    buffer_load_dwordx4 v2, s[16:19], s33 offen offset:1024 lds
    v_mfma_f32_16x16x32_bf16 v[20:23], v[248:251], v[108:111], v[20:23]
    s_add_u32 m0, s34, 114688
    s_nop 0
    buffer_load_dwordx4 v1, s[20:23], s33 offen lds
    s_waitcnt lgkmcnt(1)
    v_mfma_f32_16x16x32_bf16 v[76:79], v[44:47], a[160:163], v[24:27]
    ds_read_b128 v[52:55], v6 offset:16384
    ds_read_b128 v[56:59], v7 offset:16384
    v_mfma_f32_16x16x32_bf16 v[84:87], v[44:47], a[176:179], v[28:31]
    buffer_load_dwordx4 v2, s[20:23], s33 offen offset:1024 lds
    s_add_u32 s33, s33, 8192
    v_mfma_f32_16x16x32_bf16 v[92:95], v[44:47], a[192:195], v[32:35]
    v_exp_f32 v137, v137
    v_mfma_f32_16x16x32_bf16 v[100:103], v[44:47], a[208:211], v[36:39]
    v_mfma_f32_16x16x32_bf16 v[108:111], v[44:47], a[224:227], v[40:43]
    v_exp_f32 v138, v138
    s_waitcnt lgkmcnt(2)
    v_mfma_f32_16x16x32_bf16 v[76:79], v[48:51], a[164:167], v[76:79]
    v_exp_f32 v139, v139
    v_mfma_f32_16x16x32_bf16 v[84:87], v[48:51], a[180:183], v[84:87]
    v_cvt_pk_bf16_f32 v134, v136, v137
    v_cvt_pk_bf16_f32 v135, v138, v139
    v_mfma_f32_16x16x32_bf16 v[92:95], v[48:51], a[196:199], v[92:95]
    v_mfma_f32_16x16x32_bf16 v[100:103], v[48:51], a[212:215], v[100:103]
    v_exp_f32 v140, v140
    v_mfma_f32_16x16x32_bf16 v[108:111], v[48:51], a[228:231], v[108:111]
    v_exp_f32 v141, v141
    s_waitcnt lgkmcnt(1)
    v_mfma_f32_16x16x32_bf16 v[76:79], v[52:55], a[168:171], v[76:79]
    ds_read_b128 v[60:63], v4 offset:20480
    ds_read_b128 v[64:67], v5 offset:20480
    v_mfma_f32_16x16x32_bf16 v[84:87], v[52:55], a[184:187], v[84:87]
    v_exp_f32 v142, v142
    v_mfma_f32_16x16x32_bf16 v[92:95], v[52:55], a[200:203], v[92:95]
    v_mfma_f32_16x16x32_bf16 v[100:103], v[52:55], a[216:219], v[100:103]
    v_exp_f32 v143, v143
    v_mfma_f32_16x16x32_bf16 v[108:111], v[52:55], a[232:235], v[108:111]
    v_exp_f32 v144, v144
    s_waitcnt lgkmcnt(2)
    v_mfma_f32_16x16x32_bf16 v[76:79], v[56:59], a[172:175], v[76:79]
    v_cvt_pk_bf16_f32 v140, v140, v141
    v_cvt_pk_bf16_f32 v141, v142, v143
    v_mfma_f32_16x16x32_bf16 v[84:87], v[56:59], a[188:191], v[84:87]
    v_mfma_f32_16x16x32_bf16 v[92:95], v[56:59], a[204:207], v[92:95]
    v_exp_f32 v145, v145
    v_mfma_f32_16x16x32_bf16 v[100:103], v[56:59], a[220:223], v[100:103]
    v_exp_f32 v146, v146
    v_mfma_f32_16x16x32_bf16 v[108:111], v[56:59], a[236:239], v[108:111]
    v_exp_f32 v147, v147
    s_waitcnt lgkmcnt(1)
    v_mfma_f32_16x16x32_bf16 v[80:83], v[60:63], a[160:163], v[24:27]
    ds_read_b128 v[68:71], v6 offset:20480
    ds_read_b128 v[72:75], v7 offset:20480
    v_mfma_f32_16x16x32_bf16 v[88:91], v[60:63], a[176:179], v[28:31]
    v_mfma_f32_16x16x32_bf16 v[96:99], v[60:63], a[192:195], v[32:35]
    v_cvt_pk_bf16_f32 v142, v144, v145
    v_cvt_pk_bf16_f32 v143, v146, v147
    v_mfma_f32_16x16x32_bf16 v[104:107], v[60:63], a[208:211], v[36:39]
    v_exp_f32 v148, v148
    v_mfma_f32_16x16x32_bf16 v[112:115], v[60:63], a[224:227], v[40:43]
    v_exp_f32 v149, v149
    s_waitcnt lgkmcnt(2)
    v_mfma_f32_16x16x32_bf16 v[80:83], v[64:67], a[164:167], v[80:83]
    v_mfma_f32_16x16x32_bf16 v[88:91], v[64:67], a[180:183], v[88:91]
    v_exp_f32 v150, v150
    v_mfma_f32_16x16x32_bf16 v[96:99], v[64:67], a[196:199], v[96:99]
    v_exp_f32 v151, v151
    v_mfma_f32_16x16x32_bf16 v[104:107], v[64:67], a[212:215], v[104:107]
    v_exp_f32 v152, v152
    v_mfma_f32_16x16x32_bf16 v[112:115], v[64:67], a[228:231], v[112:115]
    s_waitcnt lgkmcnt(1)
    v_mfma_f32_16x16x32_bf16 v[80:83], v[68:71], a[168:171], v[80:83]
    ds_read_b64_tr_b16 v[44:45], v8 offset:8192
    ds_read_b64_tr_b16 v[46:47], v8 offset:12288
    v_mfma_f32_16x16x32_bf16 v[88:91], v[68:71], a[184:187], v[88:91]
    v_cvt_pk_bf16_f32 v148, v148, v149
    v_cvt_pk_bf16_f32 v149, v150, v151
    v_mfma_f32_16x16x32_bf16 v[96:99], v[68:71], a[200:203], v[96:99]
    v_exp_f32 v153, v153
    v_mfma_f32_16x16x32_bf16 v[104:107], v[68:71], a[216:219], v[104:107]
    v_exp_f32 v154, v154
    v_mfma_f32_16x16x32_bf16 v[112:115], v[68:71], a[232:235], v[112:115]
    s_waitcnt lgkmcnt(2)
    v_mfma_f32_16x16x32_bf16 v[80:83], v[72:75], a[172:175], v[80:83]
    ds_read_b64_tr_b16 v[48:49], v9 offset:8192
    ds_read_b64_tr_b16 v[50:51], v9 offset:12288
    v_mfma_f32_16x16x32_bf16 v[88:91], v[72:75], a[188:191], v[88:91]
    v_exp_f32 v155, v155
    v_mfma_f32_16x16x32_bf16 v[96:99], v[72:75], a[204:207], v[96:99]
    v_cvt_pk_bf16_f32 v150, v152, v153
    v_cvt_pk_bf16_f32 v151, v154, v155
    v_mfma_f32_16x16x32_bf16 v[104:107], v[72:75], a[220:223], v[104:107]
    v_mfma_f32_16x16x32_bf16 v[112:115], v[72:75], a[236:239], v[112:115]
    s_waitcnt lgkmcnt(2)
    v_mfma_f32_16x16x32_bf16 a[0:3], v[44:47], v[116:119], a[0:3]
    ds_read_b64_tr_b16 v[52:53], v10 offset:8192
    ds_read_b64_tr_b16 v[54:55], v10 offset:12288
    v_mfma_f32_16x16x32_bf16 a[32:35], v[44:47], v[124:127], a[32:35]
    v_mfma_f32_16x16x32_bf16 a[64:67], v[44:47], v[132:135], a[64:67]
    v_exp_f32 v76, v76
    v_mfma_f32_16x16x32_bf16 a[96:99], v[44:47], v[140:143], a[96:99]
    v_exp_f32 v77, v77
    v_mfma_f32_16x16x32_bf16 a[128:131], v[44:47], v[148:151], a[128:131]
    v_exp_f32 v78, v78
    s_waitcnt lgkmcnt(2)
    v_mfma_f32_16x16x32_bf16 a[4:7], v[48:51], v[116:119], a[4:7]
    ds_read_b64_tr_b16 v[56:57], v11 offset:8192
    ds_read_b64_tr_b16 v[58:59], v11 offset:12288
    v_mfma_f32_16x16x32_bf16 a[36:39], v[48:51], v[124:127], a[36:39]
    v_mfma_f32_16x16x32_bf16 a[68:71], v[48:51], v[132:135], a[68:71]
    v_exp_f32 v79, v79
    v_mfma_f32_16x16x32_bf16 a[100:103], v[48:51], v[140:143], a[100:103]
    v_exp_f32 v80, v80
    v_mfma_f32_16x16x32_bf16 a[132:135], v[48:51], v[148:151], a[132:135]
    v_cvt_pk_bf16_f32 v76, v76, v77
    v_cvt_pk_bf16_f32 v77, v78, v79
    s_waitcnt lgkmcnt(2)
    v_mfma_f32_16x16x32_bf16 a[8:11], v[52:55], v[116:119], a[8:11]
    ds_read_b64_tr_b16 v[60:61], v12 offset:8192
    ds_read_b64_tr_b16 v[62:63], v12 offset:12288
    v_mfma_f32_16x16x32_bf16 a[40:43], v[52:55], v[124:127], a[40:43]
    v_mfma_f32_16x16x32_bf16 a[72:75], v[52:55], v[132:135], a[72:75]
    v_exp_f32 v81, v81
    v_mfma_f32_16x16x32_bf16 a[104:107], v[52:55], v[140:143], a[104:107]
    v_exp_f32 v82, v82
    v_mfma_f32_16x16x32_bf16 a[136:139], v[52:55], v[148:151], a[136:139]
    v_exp_f32 v83, v83
    s_waitcnt lgkmcnt(2)
    v_mfma_f32_16x16x32_bf16 a[12:15], v[56:59], v[116:119], a[12:15]
    ds_read_b64_tr_b16 v[64:65], v13 offset:8192
    ds_read_b64_tr_b16 v[66:67], v13 offset:12288
    v_mfma_f32_16x16x32_bf16 a[44:47], v[56:59], v[124:127], a[44:47]
    v_mfma_f32_16x16x32_bf16 a[76:79], v[56:59], v[132:135], a[76:79]
    v_cvt_pk_bf16_f32 v78, v80, v81
    v_cvt_pk_bf16_f32 v79, v82, v83
    v_mfma_f32_16x16x32_bf16 a[108:111], v[56:59], v[140:143], a[108:111]
    v_exp_f32 v84, v84
    v_mfma_f32_16x16x32_bf16 a[140:143], v[56:59], v[148:151], a[140:143]
    v_exp_f32 v85, v85
    s_waitcnt lgkmcnt(2)
    v_mfma_f32_16x16x32_bf16 a[16:19], v[60:63], v[116:119], a[16:19]
    ds_read_b64_tr_b16 v[68:69], v14 offset:8192
    ds_read_b64_tr_b16 v[70:71], v14 offset:12288
    v_mfma_f32_16x16x32_bf16 a[48:51], v[60:63], v[124:127], a[48:51]
    v_mfma_f32_16x16x32_bf16 a[80:83], v[60:63], v[132:135], a[80:83]
    v_exp_f32 v86, v86
    v_mfma_f32_16x16x32_bf16 a[112:115], v[60:63], v[140:143], a[112:115]
    v_exp_f32 v87, v87
    v_mfma_f32_16x16x32_bf16 a[144:147], v[60:63], v[148:151], a[144:147]
    v_exp_f32 v88, v88
    s_waitcnt lgkmcnt(2)
    v_mfma_f32_16x16x32_bf16 a[20:23], v[64:67], v[116:119], a[20:23]
    ds_read_b64_tr_b16 v[72:73], v15 offset:8192
    ds_read_b64_tr_b16 v[74:75], v15 offset:12288
    v_mfma_f32_16x16x32_bf16 a[52:55], v[64:67], v[124:127], a[52:55]
    v_mfma_f32_16x16x32_bf16 a[84:87], v[64:67], v[132:135], a[84:87]
    v_cvt_pk_bf16_f32 v84, v84, v85
    v_cvt_pk_bf16_f32 v85, v86, v87
    v_mfma_f32_16x16x32_bf16 a[116:119], v[64:67], v[140:143], a[116:119]
    v_exp_f32 v89, v89
    v_mfma_f32_16x16x32_bf16 a[148:151], v[64:67], v[148:151], a[148:151]
    v_exp_f32 v90, v90
    s_waitcnt lgkmcnt(2)
    v_mfma_f32_16x16x32_bf16 a[24:27], v[68:71], v[116:119], a[24:27]
    ds_read_b128 v[44:47], v4 offset:24576
    ds_read_b128 v[48:51], v5 offset:24576
    v_mfma_f32_16x16x32_bf16 a[56:59], v[68:71], v[124:127], a[56:59]
    v_mfma_f32_16x16x32_bf16 a[88:91], v[68:71], v[132:135], a[88:91]
    v_exp_f32 v91, v91
    v_mfma_f32_16x16x32_bf16 a[120:123], v[68:71], v[140:143], a[120:123]
    v_cvt_pk_bf16_f32 v86, v88, v89
    v_cvt_pk_bf16_f32 v87, v90, v91
    v_mfma_f32_16x16x32_bf16 a[152:155], v[68:71], v[148:151], a[152:155]
    v_exp_f32 v92, v92
    s_waitcnt lgkmcnt(2)
    v_mfma_f32_16x16x32_bf16 a[28:31], v[72:75], v[116:119], a[28:31]
    v_mfma_f32_16x16x32_bf16 a[60:63], v[72:75], v[124:127], a[60:63]
    v_exp_f32 v93, v93
    s_nop 1
    v_mfma_f32_16x16x32_bf16 a[92:95], v[72:75], v[132:135], a[92:95]
    v_exp_f32 v94, v94
    v_mfma_f32_16x16x32_bf16 a[124:127], v[72:75], v[140:143], a[124:127]
    v_exp_f32 v95, v95
    v_mfma_f32_16x16x32_bf16 a[156:159], v[72:75], v[148:151], a[156:159]
    v_mfma_f32_16x16x32_bf16 a[240:243], v[248:251], v[116:119], a[240:243]
    v_exp_f32 v96, v96
    v_mfma_f32_16x16x32_bf16 a[244:247], v[248:251], v[124:127], a[244:247]
    v_cvt_pk_bf16_f32 v92, v92, v93
    v_cvt_pk_bf16_f32 v93, v94, v95
    s_waitcnt vmcnt(8)
    s_barrier
    v_mfma_f32_16x16x32_bf16 a[248:251], v[248:251], v[132:135], a[248:251]
    s_add_u32 m0, s34, 57344
    s_nop 0
    buffer_load_dwordx4 v1, s[16:19], s33 offen lds
    v_mfma_f32_16x16x32_bf16 a[252:255], v[248:251], v[140:143], a[252:255]
    buffer_load_dwordx4 v2, s[16:19], s33 offen offset:1024 lds
    v_mfma_f32_16x16x32_bf16 v[20:23], v[248:251], v[148:151], v[20:23]
    s_add_u32 m0, s34, 122880
    s_nop 0
    buffer_load_dwordx4 v1, s[20:23], s33 offen lds
    s_waitcnt lgkmcnt(1)
    v_mfma_f32_16x16x32_bf16 v[116:119], v[44:47], a[160:163], v[24:27]
    ds_read_b128 v[52:55], v6 offset:24576
    ds_read_b128 v[56:59], v7 offset:24576
    v_mfma_f32_16x16x32_bf16 v[124:127], v[44:47], a[176:179], v[28:31]
    buffer_load_dwordx4 v2, s[20:23], s33 offen offset:1024 lds
    s_add_u32 s33, s33, 8192
    v_mfma_f32_16x16x32_bf16 v[132:135], v[44:47], a[192:195], v[32:35]
    v_exp_f32 v97, v97
    v_mfma_f32_16x16x32_bf16 v[140:143], v[44:47], a[208:211], v[36:39]
    v_mfma_f32_16x16x32_bf16 v[148:151], v[44:47], a[224:227], v[40:43]
    v_exp_f32 v98, v98
    s_waitcnt lgkmcnt(2)
    v_mfma_f32_16x16x32_bf16 v[116:119], v[48:51], a[164:167], v[116:119]
    v_exp_f32 v99, v99
    v_mfma_f32_16x16x32_bf16 v[124:127], v[48:51], a[180:183], v[124:127]
    v_cvt_pk_bf16_f32 v94, v96, v97
    v_cvt_pk_bf16_f32 v95, v98, v99
    v_mfma_f32_16x16x32_bf16 v[132:135], v[48:51], a[196:199], v[132:135]
    v_mfma_f32_16x16x32_bf16 v[140:143], v[48:51], a[212:215], v[140:143]
    v_exp_f32 v100, v100
    v_mfma_f32_16x16x32_bf16 v[148:151], v[48:51], a[228:231], v[148:151]
    v_exp_f32 v101, v101
    s_waitcnt lgkmcnt(1)
    v_mfma_f32_16x16x32_bf16 v[116:119], v[52:55], a[168:171], v[116:119]
    ds_read_b128 v[60:63], v4 offset:28672
    ds_read_b128 v[64:67], v5 offset:28672
    v_mfma_f32_16x16x32_bf16 v[124:127], v[52:55], a[184:187], v[124:127]
    v_exp_f32 v102, v102
    v_mfma_f32_16x16x32_bf16 v[132:135], v[52:55], a[200:203], v[132:135]
    v_mfma_f32_16x16x32_bf16 v[140:143], v[52:55], a[216:219], v[140:143]
    v_exp_f32 v103, v103
    v_mfma_f32_16x16x32_bf16 v[148:151], v[52:55], a[232:235], v[148:151]
    v_exp_f32 v104, v104
    s_waitcnt lgkmcnt(2)
    v_mfma_f32_16x16x32_bf16 v[116:119], v[56:59], a[172:175], v[116:119]
    v_cvt_pk_bf16_f32 v100, v100, v101
    v_cvt_pk_bf16_f32 v101, v102, v103
    v_mfma_f32_16x16x32_bf16 v[124:127], v[56:59], a[188:191], v[124:127]
    v_mfma_f32_16x16x32_bf16 v[132:135], v[56:59], a[204:207], v[132:135]
    v_exp_f32 v105, v105
    v_mfma_f32_16x16x32_bf16 v[140:143], v[56:59], a[220:223], v[140:143]
    v_exp_f32 v106, v106
    v_mfma_f32_16x16x32_bf16 v[148:151], v[56:59], a[236:239], v[148:151]
    v_exp_f32 v107, v107
    s_waitcnt lgkmcnt(1)
    v_mfma_f32_16x16x32_bf16 v[120:123], v[60:63], a[160:163], v[24:27]
    ds_read_b128 v[68:71], v6 offset:28672
    ds_read_b128 v[72:75], v7 offset:28672
    v_mfma_f32_16x16x32_bf16 v[128:131], v[60:63], a[176:179], v[28:31]
    v_mfma_f32_16x16x32_bf16 v[136:139], v[60:63], a[192:195], v[32:35]
    v_cvt_pk_bf16_f32 v102, v104, v105
    v_cvt_pk_bf16_f32 v103, v106, v107
    v_mfma_f32_16x16x32_bf16 v[144:147], v[60:63], a[208:211], v[36:39]
    v_exp_f32 v108, v108
    v_mfma_f32_16x16x32_bf16 v[152:155], v[60:63], a[224:227], v[40:43]
    v_exp_f32 v109, v109
    s_waitcnt lgkmcnt(2)
    v_mfma_f32_16x16x32_bf16 v[120:123], v[64:67], a[164:167], v[120:123]
    v_mfma_f32_16x16x32_bf16 v[128:131], v[64:67], a[180:183], v[128:131]
    v_exp_f32 v110, v110
    v_mfma_f32_16x16x32_bf16 v[136:139], v[64:67], a[196:199], v[136:139]
    v_exp_f32 v111, v111
    v_mfma_f32_16x16x32_bf16 v[144:147], v[64:67], a[212:215], v[144:147]
    v_exp_f32 v112, v112
    v_mfma_f32_16x16x32_bf16 v[152:155], v[64:67], a[228:231], v[152:155]
    s_waitcnt lgkmcnt(1)
    v_mfma_f32_16x16x32_bf16 v[120:123], v[68:71], a[168:171], v[120:123]
    ds_read_b64_tr_b16 v[44:45], v8 offset:16384
    ds_read_b64_tr_b16 v[46:47], v8 offset:20480
    v_mfma_f32_16x16x32_bf16 v[128:131], v[68:71], a[184:187], v[128:131]
    v_cvt_pk_bf16_f32 v108, v108, v109
    v_cvt_pk_bf16_f32 v109, v110, v111
    v_mfma_f32_16x16x32_bf16 v[136:139], v[68:71], a[200:203], v[136:139]
    v_exp_f32 v113, v113
    v_mfma_f32_16x16x32_bf16 v[144:147], v[68:71], a[216:219], v[144:147]
    v_exp_f32 v114, v114
    v_mfma_f32_16x16x32_bf16 v[152:155], v[68:71], a[232:235], v[152:155]
    s_waitcnt lgkmcnt(2)
    v_mfma_f32_16x16x32_bf16 v[120:123], v[72:75], a[172:175], v[120:123]
    ds_read_b64_tr_b16 v[48:49], v9 offset:16384
    ds_read_b64_tr_b16 v[50:51], v9 offset:20480
    v_mfma_f32_16x16x32_bf16 v[128:131], v[72:75], a[188:191], v[128:131]
    v_exp_f32 v115, v115
    v_mfma_f32_16x16x32_bf16 v[136:139], v[72:75], a[204:207], v[136:139]
    v_cvt_pk_bf16_f32 v110, v112, v113
    v_cvt_pk_bf16_f32 v111, v114, v115
    v_mfma_f32_16x16x32_bf16 v[144:147], v[72:75], a[220:223], v[144:147]
    v_mfma_f32_16x16x32_bf16 v[152:155], v[72:75], a[236:239], v[152:155]
    s_waitcnt lgkmcnt(2)
    v_mfma_f32_16x16x32_bf16 a[0:3], v[44:47], v[76:79], a[0:3]
    ds_read_b64_tr_b16 v[52:53], v10 offset:16384
    ds_read_b64_tr_b16 v[54:55], v10 offset:20480
    v_mfma_f32_16x16x32_bf16 a[32:35], v[44:47], v[84:87], a[32:35]
    v_mfma_f32_16x16x32_bf16 a[64:67], v[44:47], v[92:95], a[64:67]
    v_exp_f32 v116, v116
    v_mfma_f32_16x16x32_bf16 a[96:99], v[44:47], v[100:103], a[96:99]
    v_exp_f32 v117, v117
    v_mfma_f32_16x16x32_bf16 a[128:131], v[44:47], v[108:111], a[128:131]
    v_exp_f32 v118, v118
    s_waitcnt lgkmcnt(2)
    v_mfma_f32_16x16x32_bf16 a[4:7], v[48:51], v[76:79], a[4:7]
    ds_read_b64_tr_b16 v[56:57], v11 offset:16384
    ds_read_b64_tr_b16 v[58:59], v11 offset:20480
    v_mfma_f32_16x16x32_bf16 a[36:39], v[48:51], v[84:87], a[36:39]
    v_mfma_f32_16x16x32_bf16 a[68:71], v[48:51], v[92:95], a[68:71]
    v_exp_f32 v119, v119
    v_mfma_f32_16x16x32_bf16 a[100:103], v[48:51], v[100:103], a[100:103]
    v_exp_f32 v120, v120
    v_mfma_f32_16x16x32_bf16 a[132:135], v[48:51], v[108:111], a[132:135]
    s_waitcnt lgkmcnt(2)
    v_mfma_f32_16x16x32_bf16 a[8:11], v[52:55], v[76:79], a[8:11]
    ds_read_b64_tr_b16 v[60:61], v12 offset:16384
    ds_read_b64_tr_b16 v[62:63], v12 offset:20480
    v_mfma_f32_16x16x32_bf16 a[40:43], v[52:55], v[84:87], a[40:43]
    v_cvt_pk_bf16_f32 v116, v116, v117
    v_cvt_pk_bf16_f32 v117, v118, v119
    v_mfma_f32_16x16x32_bf16 a[72:75], v[52:55], v[92:95], a[72:75]
    v_exp_f32 v121, v121
    v_mfma_f32_16x16x32_bf16 a[104:107], v[52:55], v[100:103], a[104:107]
    v_exp_f32 v122, v122
    v_mfma_f32_16x16x32_bf16 a[136:139], v[52:55], v[108:111], a[136:139]
    s_waitcnt lgkmcnt(2)
    v_mfma_f32_16x16x32_bf16 a[12:15], v[56:59], v[76:79], a[12:15]
    ds_read_b64_tr_b16 v[64:65], v13 offset:16384
    ds_read_b64_tr_b16 v[66:67], v13 offset:20480
    v_mfma_f32_16x16x32_bf16 a[44:47], v[56:59], v[84:87], a[44:47]
    v_exp_f32 v123, v123
    v_mfma_f32_16x16x32_bf16 a[76:79], v[56:59], v[92:95], a[76:79]
    v_cvt_pk_bf16_f32 v118, v120, v121
    v_cvt_pk_bf16_f32 v119, v122, v123
    v_mfma_f32_16x16x32_bf16 a[108:111], v[56:59], v[100:103], a[108:111]
    v_mfma_f32_16x16x32_bf16 a[140:143], v[56:59], v[108:111], a[140:143]
    v_exp_f32 v124, v124
    s_waitcnt lgkmcnt(2)
    v_mfma_f32_16x16x32_bf16 a[16:19], v[60:63], v[76:79], a[16:19]
    ds_read_b64_tr_b16 v[68:69], v14 offset:16384
    ds_read_b64_tr_b16 v[70:71], v14 offset:20480
    v_mfma_f32_16x16x32_bf16 a[48:51], v[60:63], v[84:87], a[48:51]
    v_exp_f32 v125, v125
    v_mfma_f32_16x16x32_bf16 a[80:83], v[60:63], v[92:95], a[80:83]
    v_mfma_f32_16x16x32_bf16 a[112:115], v[60:63], v[100:103], a[112:115]
    v_exp_f32 v126, v126
    v_mfma_f32_16x16x32_bf16 a[144:147], v[60:63], v[108:111], a[144:147]
    v_exp_f32 v127, v127
    s_waitcnt lgkmcnt(2)
    v_mfma_f32_16x16x32_bf16 a[20:23], v[64:67], v[76:79], a[20:23]
    ds_read_b64_tr_b16 v[72:73], v15 offset:16384
    ds_read_b64_tr_b16 v[74:75], v15 offset:20480
    v_mfma_f32_16x16x32_bf16 a[52:55], v[64:67], v[84:87], a[52:55]
    v_exp_f32 v128, v128
    v_mfma_f32_16x16x32_bf16 a[84:87], v[64:67], v[92:95], a[84:87]
    v_mfma_f32_16x16x32_bf16 a[116:119], v[64:67], v[100:103], a[116:119]
    v_cvt_pk_bf16_f32 v124, v124, v125
    v_cvt_pk_bf16_f32 v125, v126, v127
    v_mfma_f32_16x16x32_bf16 a[148:151], v[64:67], v[108:111], a[148:151]
    v_exp_f32 v129, v129
    s_waitcnt lgkmcnt(2)
    v_mfma_f32_16x16x32_bf16 a[24:27], v[68:71], v[76:79], a[24:27]
    ds_read_b128 v[44:47], v4 offset:32768
    ds_read_b128 v[48:51], v5 offset:32768
    v_mfma_f32_16x16x32_bf16 a[56:59], v[68:71], v[84:87], a[56:59]
    v_mfma_f32_16x16x32_bf16 a[88:91], v[68:71], v[92:95], a[88:91]
    v_exp_f32 v130, v130
    v_mfma_f32_16x16x32_bf16 a[120:123], v[68:71], v[100:103], a[120:123]
    v_exp_f32 v131, v131
    v_mfma_f32_16x16x32_bf16 a[152:155], v[68:71], v[108:111], a[152:155]
    v_cvt_pk_bf16_f32 v126, v128, v129
    v_cvt_pk_bf16_f32 v127, v130, v131
    s_waitcnt lgkmcnt(2)
    v_mfma_f32_16x16x32_bf16 a[28:31], v[72:75], v[76:79], a[28:31]
    v_mfma_f32_16x16x32_bf16 a[60:63], v[72:75], v[84:87], a[60:63]
    v_exp_f32 v132, v132
    v_mfma_f32_16x16x32_bf16 a[92:95], v[72:75], v[92:95], a[92:95]
    v_exp_f32 v133, v133
    v_mfma_f32_16x16x32_bf16 a[124:127], v[72:75], v[100:103], a[124:127]
    v_mfma_f32_16x16x32_bf16 a[156:159], v[72:75], v[108:111], a[156:159]
    v_exp_f32 v134, v134
    v_mfma_f32_16x16x32_bf16 a[240:243], v[248:251], v[76:79], a[240:243]
    v_exp_f32 v135, v135
    v_mfma_f32_16x16x32_bf16 a[244:247], v[248:251], v[84:87], a[244:247]
    s_waitcnt vmcnt(8)
    s_barrier
    v_mfma_f32_16x16x32_bf16 a[248:251], v[248:251], v[92:95], a[248:251]
    v_exp_f32 v136, v136
    v_mfma_f32_16x16x32_bf16 a[252:255], v[248:251], v[100:103], a[252:255]
    v_cvt_pk_bf16_f32 v132, v132, v133
    v_cvt_pk_bf16_f32 v133, v134, v135
    v_mfma_f32_16x16x32_bf16 v[20:23], v[248:251], v[108:111], v[20:23]
    v_exp_f32 v137, v137
    s_waitcnt lgkmcnt(1)
    v_mfma_f32_16x16x32_bf16 v[76:79], v[44:47], a[160:163], v[24:27]
    ds_read_b128 v[52:55], v6 offset:32768
    ds_read_b128 v[56:59], v7 offset:32768
    v_mfma_f32_16x16x32_bf16 v[84:87], v[44:47], a[176:179], v[28:31]
    v_mfma_f32_16x16x32_bf16 v[92:95], v[44:47], a[192:195], v[32:35]
    v_exp_f32 v138, v138
    v_mfma_f32_16x16x32_bf16 v[100:103], v[44:47], a[208:211], v[36:39]
    v_exp_f32 v139, v139
    v_mfma_f32_16x16x32_bf16 v[108:111], v[44:47], a[224:227], v[40:43]
    s_waitcnt lgkmcnt(2)
    v_mfma_f32_16x16x32_bf16 v[76:79], v[48:51], a[164:167], v[76:79]
    v_cvt_pk_bf16_f32 v134, v136, v137
    v_cvt_pk_bf16_f32 v135, v138, v139
    v_mfma_f32_16x16x32_bf16 v[84:87], v[48:51], a[180:183], v[84:87]
    v_exp_f32 v140, v140
    v_mfma_f32_16x16x32_bf16 v[92:95], v[48:51], a[196:199], v[92:95]
    v_mfma_f32_16x16x32_bf16 v[100:103], v[48:51], a[212:215], v[100:103]
    v_exp_f32 v141, v141
    v_mfma_f32_16x16x32_bf16 v[108:111], v[48:51], a[228:231], v[108:111]
    v_exp_f32 v142, v142
    s_waitcnt lgkmcnt(1)
    v_mfma_f32_16x16x32_bf16 v[76:79], v[52:55], a[168:171], v[76:79]
    ds_read_b128 v[60:63], v4 offset:36864
    ds_read_b128 v[64:67], v5 offset:36864
    v_mfma_f32_16x16x32_bf16 v[84:87], v[52:55], a[184:187], v[84:87]
    v_exp_f32 v143, v143
    v_mfma_f32_16x16x32_bf16 v[92:95], v[52:55], a[200:203], v[92:95]
    v_mfma_f32_16x16x32_bf16 v[100:103], v[52:55], a[216:219], v[100:103]
    v_exp_f32 v144, v144
    v_mfma_f32_16x16x32_bf16 v[108:111], v[52:55], a[232:235], v[108:111]
    v_cvt_pk_bf16_f32 v140, v140, v141
    v_cvt_pk_bf16_f32 v141, v142, v143
    s_waitcnt lgkmcnt(2)
    v_mfma_f32_16x16x32_bf16 v[76:79], v[56:59], a[172:175], v[76:79]
    v_mfma_f32_16x16x32_bf16 v[84:87], v[56:59], a[188:191], v[84:87]
    v_exp_f32 v145, v145
    v_mfma_f32_16x16x32_bf16 v[92:95], v[56:59], a[204:207], v[92:95]
    v_exp_f32 v146, v146
    v_mfma_f32_16x16x32_bf16 v[100:103], v[56:59], a[220:223], v[100:103]
    v_exp_f32 v147, v147
    v_mfma_f32_16x16x32_bf16 v[108:111], v[56:59], a[236:239], v[108:111]
    s_waitcnt lgkmcnt(1)
    v_mfma_f32_16x16x32_bf16 v[80:83], v[60:63], a[160:163], v[24:27]
    ds_read_b128 v[68:71], v6 offset:36864
    ds_read_b128 v[72:75], v7 offset:36864
    v_mfma_f32_16x16x32_bf16 v[88:91], v[60:63], a[176:179], v[28:31]
    v_cvt_pk_bf16_f32 v142, v144, v145
    v_cvt_pk_bf16_f32 v143, v146, v147
    v_mfma_f32_16x16x32_bf16 v[96:99], v[60:63], a[192:195], v[32:35]
    v_exp_f32 v148, v148
    v_mfma_f32_16x16x32_bf16 v[104:107], v[60:63], a[208:211], v[36:39]
    v_mfma_f32_16x16x32_bf16 v[112:115], v[60:63], a[224:227], v[40:43]
    v_exp_f32 v149, v149
    s_waitcnt lgkmcnt(2)
    v_mfma_f32_16x16x32_bf16 v[80:83], v[64:67], a[164:167], v[80:83]
    v_exp_f32 v150, v150
    v_mfma_f32_16x16x32_bf16 v[88:91], v[64:67], a[180:183], v[88:91]
    v_mfma_f32_16x16x32_bf16 v[96:99], v[64:67], a[196:199], v[96:99]
    v_exp_f32 v151, v151
    v_mfma_f32_16x16x32_bf16 v[104:107], v[64:67], a[212:215], v[104:107]
    v_exp_f32 v152, v152
    v_mfma_f32_16x16x32_bf16 v[112:115], v[64:67], a[228:231], v[112:115]
    v_cvt_pk_bf16_f32 v148, v148, v149
    v_cvt_pk_bf16_f32 v149, v150, v151
    s_waitcnt lgkmcnt(1)
    v_mfma_f32_16x16x32_bf16 v[80:83], v[68:71], a[168:171], v[80:83]
    ds_read_b64_tr_b16 v[44:45], v8 offset:24576
    ds_read_b64_tr_b16 v[46:47], v8 offset:28672
    v_mfma_f32_16x16x32_bf16 v[88:91], v[68:71], a[184:187], v[88:91]
    v_mfma_f32_16x16x32_bf16 v[96:99], v[68:71], a[200:203], v[96:99]
    v_exp_f32 v153, v153
    v_mfma_f32_16x16x32_bf16 v[104:107], v[68:71], a[216:219], v[104:107]
    v_exp_f32 v154, v154
    v_mfma_f32_16x16x32_bf16 v[112:115], v[68:71], a[232:235], v[112:115]
    s_waitcnt lgkmcnt(2)
    v_mfma_f32_16x16x32_bf16 v[80:83], v[72:75], a[172:175], v[80:83]
    ds_read_b64_tr_b16 v[48:49], v9 offset:24576
    ds_read_b64_tr_b16 v[50:51], v9 offset:28672
    v_mfma_f32_16x16x32_bf16 v[88:91], v[72:75], a[188:191], v[88:91]
    v_exp_f32 v155, v155
    v_mfma_f32_16x16x32_bf16 v[96:99], v[72:75], a[204:207], v[96:99]
    v_cvt_pk_bf16_f32 v150, v152, v153
    v_cvt_pk_bf16_f32 v151, v154, v155
    v_mfma_f32_16x16x32_bf16 v[104:107], v[72:75], a[220:223], v[104:107]
    v_mfma_f32_16x16x32_bf16 v[112:115], v[72:75], a[236:239], v[112:115]
    s_waitcnt lgkmcnt(2)
    v_mfma_f32_16x16x32_bf16 a[0:3], v[44:47], v[116:119], a[0:3]
    ds_read_b64_tr_b16 v[52:53], v10 offset:24576
    ds_read_b64_tr_b16 v[54:55], v10 offset:28672
    v_mfma_f32_16x16x32_bf16 a[32:35], v[44:47], v[124:127], a[32:35]
    v_mfma_f32_16x16x32_bf16 a[64:67], v[44:47], v[132:135], a[64:67]
    v_exp_f32 v76, v76
    v_mfma_f32_16x16x32_bf16 a[96:99], v[44:47], v[140:143], a[96:99]
    v_exp_f32 v77, v77
    v_mfma_f32_16x16x32_bf16 a[128:131], v[44:47], v[148:151], a[128:131]
    v_exp_f32 v78, v78
    s_waitcnt lgkmcnt(2)
    v_mfma_f32_16x16x32_bf16 a[4:7], v[48:51], v[116:119], a[4:7]
    ds_read_b64_tr_b16 v[56:57], v11 offset:24576
    ds_read_b64_tr_b16 v[58:59], v11 offset:28672
    v_mfma_f32_16x16x32_bf16 a[36:39], v[48:51], v[124:127], a[36:39]
    v_mfma_f32_16x16x32_bf16 a[68:71], v[48:51], v[132:135], a[68:71]
    v_exp_f32 v79, v79
    v_mfma_f32_16x16x32_bf16 a[100:103], v[48:51], v[140:143], a[100:103]
    v_exp_f32 v80, v80
    v_mfma_f32_16x16x32_bf16 a[132:135], v[48:51], v[148:151], a[132:135]
    s_waitcnt lgkmcnt(2)
    v_mfma_f32_16x16x32_bf16 a[8:11], v[52:55], v[116:119], a[8:11]
    ds_read_b64_tr_b16 v[60:61], v12 offset:24576
    ds_read_b64_tr_b16 v[62:63], v12 offset:28672
    v_mfma_f32_16x16x32_bf16 a[40:43], v[52:55], v[124:127], a[40:43]
    v_cvt_pk_bf16_f32 v76, v76, v77
    v_cvt_pk_bf16_f32 v77, v78, v79
    v_mfma_f32_16x16x32_bf16 a[72:75], v[52:55], v[132:135], a[72:75]
    v_exp_f32 v81, v81
    v_mfma_f32_16x16x32_bf16 a[104:107], v[52:55], v[140:143], a[104:107]
    v_exp_f32 v82, v82
    v_mfma_f32_16x16x32_bf16 a[136:139], v[52:55], v[148:151], a[136:139]
    s_waitcnt lgkmcnt(2)
    v_mfma_f32_16x16x32_bf16 a[12:15], v[56:59], v[116:119], a[12:15]
    ds_read_b64_tr_b16 v[64:65], v13 offset:24576
    ds_read_b64_tr_b16 v[66:67], v13 offset:28672
    v_mfma_f32_16x16x32_bf16 a[44:47], v[56:59], v[124:127], a[44:47]
    v_exp_f32 v83, v83
    v_mfma_f32_16x16x32_bf16 a[76:79], v[56:59], v[132:135], a[76:79]
    v_cvt_pk_bf16_f32 v78, v80, v81
    v_cvt_pk_bf16_f32 v79, v82, v83
    v_mfma_f32_16x16x32_bf16 a[108:111], v[56:59], v[140:143], a[108:111]
    v_mfma_f32_16x16x32_bf16 a[140:143], v[56:59], v[148:151], a[140:143]
    v_exp_f32 v84, v84
    s_waitcnt lgkmcnt(2)
    v_mfma_f32_16x16x32_bf16 a[16:19], v[60:63], v[116:119], a[16:19]
    ds_read_b64_tr_b16 v[68:69], v14 offset:24576
    ds_read_b64_tr_b16 v[70:71], v14 offset:28672
    v_mfma_f32_16x16x32_bf16 a[48:51], v[60:63], v[124:127], a[48:51]
    v_exp_f32 v85, v85
    v_mfma_f32_16x16x32_bf16 a[80:83], v[60:63], v[132:135], a[80:83]
    v_mfma_f32_16x16x32_bf16 a[112:115], v[60:63], v[140:143], a[112:115]
    v_exp_f32 v86, v86
    v_mfma_f32_16x16x32_bf16 a[144:147], v[60:63], v[148:151], a[144:147]
    v_exp_f32 v87, v87
    s_waitcnt lgkmcnt(2)
    v_mfma_f32_16x16x32_bf16 a[20:23], v[64:67], v[116:119], a[20:23]
    ds_read_b64_tr_b16 v[72:73], v15 offset:24576
    ds_read_b64_tr_b16 v[74:75], v15 offset:28672
    v_mfma_f32_16x16x32_bf16 a[52:55], v[64:67], v[124:127], a[52:55]
    v_exp_f32 v88, v88
    v_mfma_f32_16x16x32_bf16 a[84:87], v[64:67], v[132:135], a[84:87]
    v_mfma_f32_16x16x32_bf16 a[116:119], v[64:67], v[140:143], a[116:119]
    v_cvt_pk_bf16_f32 v84, v84, v85
    v_cvt_pk_bf16_f32 v85, v86, v87
    v_mfma_f32_16x16x32_bf16 a[148:151], v[64:67], v[148:151], a[148:151]
    v_exp_f32 v89, v89
    s_waitcnt lgkmcnt(2)
    v_mfma_f32_16x16x32_bf16 a[24:27], v[68:71], v[116:119], a[24:27]
    ds_read_b128 v[44:47], v4 offset:40960
    ds_read_b128 v[48:51], v5 offset:40960
    v_mfma_f32_16x16x32_bf16 a[56:59], v[68:71], v[124:127], a[56:59]
    v_mfma_f32_16x16x32_bf16 a[88:91], v[68:71], v[132:135], a[88:91]
    v_exp_f32 v90, v90
    v_mfma_f32_16x16x32_bf16 a[120:123], v[68:71], v[140:143], a[120:123]
    v_exp_f32 v91, v91
    v_mfma_f32_16x16x32_bf16 a[152:155], v[68:71], v[148:151], a[152:155]
    v_cvt_pk_bf16_f32 v86, v88, v89
    v_cvt_pk_bf16_f32 v87, v90, v91
    s_waitcnt lgkmcnt(2)
    v_mfma_f32_16x16x32_bf16 a[28:31], v[72:75], v[116:119], a[28:31]
    v_mfma_f32_16x16x32_bf16 a[60:63], v[72:75], v[124:127], a[60:63]
    v_exp_f32 v92, v92
    s_nop 1
    v_mfma_f32_16x16x32_bf16 a[92:95], v[72:75], v[132:135], a[92:95]
    v_exp_f32 v93, v93
    v_mfma_f32_16x16x32_bf16 a[124:127], v[72:75], v[140:143], a[124:127]
    v_mfma_f32_16x16x32_bf16 a[156:159], v[72:75], v[148:151], a[156:159]
    v_exp_f32 v94, v94
    v_mfma_f32_16x16x32_bf16 a[240:243], v[248:251], v[116:119], a[240:243]
    v_exp_f32 v95, v95
    v_mfma_f32_16x16x32_bf16 a[244:247], v[248:251], v[124:127], a[244:247]
    s_waitcnt vmcnt(4)
    s_barrier
    v_mfma_f32_16x16x32_bf16 a[248:251], v[248:251], v[132:135], a[248:251]
    v_exp_f32 v96, v96
    v_mfma_f32_16x16x32_bf16 a[252:255], v[248:251], v[140:143], a[252:255]
    v_cvt_pk_bf16_f32 v92, v92, v93
    v_cvt_pk_bf16_f32 v93, v94, v95
    v_mfma_f32_16x16x32_bf16 v[20:23], v[248:251], v[148:151], v[20:23]
    v_exp_f32 v97, v97
    s_waitcnt lgkmcnt(1)
    v_mfma_f32_16x16x32_bf16 v[116:119], v[44:47], a[160:163], v[24:27]
    ds_read_b128 v[52:55], v6 offset:40960
    ds_read_b128 v[56:59], v7 offset:40960
    v_mfma_f32_16x16x32_bf16 v[124:127], v[44:47], a[176:179], v[28:31]
    v_mfma_f32_16x16x32_bf16 v[132:135], v[44:47], a[192:195], v[32:35]
    v_exp_f32 v98, v98
    v_mfma_f32_16x16x32_bf16 v[140:143], v[44:47], a[208:211], v[36:39]
    v_exp_f32 v99, v99
    v_mfma_f32_16x16x32_bf16 v[148:151], v[44:47], a[224:227], v[40:43]
    s_waitcnt lgkmcnt(2)
    v_mfma_f32_16x16x32_bf16 v[116:119], v[48:51], a[164:167], v[116:119]
    v_cvt_pk_bf16_f32 v94, v96, v97
    v_cvt_pk_bf16_f32 v95, v98, v99
    v_mfma_f32_16x16x32_bf16 v[124:127], v[48:51], a[180:183], v[124:127]
    v_exp_f32 v100, v100
    v_mfma_f32_16x16x32_bf16 v[132:135], v[48:51], a[196:199], v[132:135]
    v_mfma_f32_16x16x32_bf16 v[140:143], v[48:51], a[212:215], v[140:143]
    v_exp_f32 v101, v101
    v_mfma_f32_16x16x32_bf16 v[148:151], v[48:51], a[228:231], v[148:151]
    v_exp_f32 v102, v102
    s_waitcnt lgkmcnt(1)
    v_mfma_f32_16x16x32_bf16 v[116:119], v[52:55], a[168:171], v[116:119]
    ds_read_b128 v[60:63], v4 offset:45056
    ds_read_b128 v[64:67], v5 offset:45056
    v_mfma_f32_16x16x32_bf16 v[124:127], v[52:55], a[184:187], v[124:127]
    v_exp_f32 v103, v103
    v_mfma_f32_16x16x32_bf16 v[132:135], v[52:55], a[200:203], v[132:135]
    v_mfma_f32_16x16x32_bf16 v[140:143], v[52:55], a[216:219], v[140:143]
    v_exp_f32 v104, v104
    v_mfma_f32_16x16x32_bf16 v[148:151], v[52:55], a[232:235], v[148:151]
    v_cvt_pk_bf16_f32 v100, v100, v101
    v_cvt_pk_bf16_f32 v101, v102, v103
    s_waitcnt lgkmcnt(2)
    v_mfma_f32_16x16x32_bf16 v[116:119], v[56:59], a[172:175], v[116:119]
    v_mfma_f32_16x16x32_bf16 v[124:127], v[56:59], a[188:191], v[124:127]
    v_exp_f32 v105, v105
    v_mfma_f32_16x16x32_bf16 v[132:135], v[56:59], a[204:207], v[132:135]
    v_exp_f32 v106, v106
    v_mfma_f32_16x16x32_bf16 v[140:143], v[56:59], a[220:223], v[140:143]
    v_exp_f32 v107, v107
    v_mfma_f32_16x16x32_bf16 v[148:151], v[56:59], a[236:239], v[148:151]
    s_waitcnt lgkmcnt(1)
    v_mfma_f32_16x16x32_bf16 v[120:123], v[60:63], a[160:163], v[24:27]
    ds_read_b128 v[68:71], v6 offset:45056
    ds_read_b128 v[72:75], v7 offset:45056
    v_mfma_f32_16x16x32_bf16 v[128:131], v[60:63], a[176:179], v[28:31]
    v_cvt_pk_bf16_f32 v102, v104, v105
    v_cvt_pk_bf16_f32 v103, v106, v107
    v_mfma_f32_16x16x32_bf16 v[136:139], v[60:63], a[192:195], v[32:35]
    v_exp_f32 v108, v108
    v_mfma_f32_16x16x32_bf16 v[144:147], v[60:63], a[208:211], v[36:39]
    v_mfma_f32_16x16x32_bf16 v[152:155], v[60:63], a[224:227], v[40:43]
    v_exp_f32 v109, v109
    s_waitcnt lgkmcnt(2)
    v_mfma_f32_16x16x32_bf16 v[120:123], v[64:67], a[164:167], v[120:123]
    v_exp_f32 v110, v110
    v_mfma_f32_16x16x32_bf16 v[128:131], v[64:67], a[180:183], v[128:131]
    v_mfma_f32_16x16x32_bf16 v[136:139], v[64:67], a[196:199], v[136:139]
    v_exp_f32 v111, v111
    v_mfma_f32_16x16x32_bf16 v[144:147], v[64:67], a[212:215], v[144:147]
    v_exp_f32 v112, v112
    v_mfma_f32_16x16x32_bf16 v[152:155], v[64:67], a[228:231], v[152:155]
    v_cvt_pk_bf16_f32 v108, v108, v109
    v_cvt_pk_bf16_f32 v109, v110, v111
    s_waitcnt lgkmcnt(1)
    v_mfma_f32_16x16x32_bf16 v[120:123], v[68:71], a[168:171], v[120:123]
    ds_read_b64_tr_b16 v[44:45], v8 offset:32768
    ds_read_b64_tr_b16 v[46:47], v8 offset:36864
    v_mfma_f32_16x16x32_bf16 v[128:131], v[68:71], a[184:187], v[128:131]
    v_mfma_f32_16x16x32_bf16 v[136:139], v[68:71], a[200:203], v[136:139]
    v_exp_f32 v113, v113
    v_mfma_f32_16x16x32_bf16 v[144:147], v[68:71], a[216:219], v[144:147]
    v_exp_f32 v114, v114
    v_mfma_f32_16x16x32_bf16 v[152:155], v[68:71], a[232:235], v[152:155]
    s_waitcnt lgkmcnt(2)
    v_mfma_f32_16x16x32_bf16 v[120:123], v[72:75], a[172:175], v[120:123]
    ds_read_b64_tr_b16 v[48:49], v9 offset:32768
    ds_read_b64_tr_b16 v[50:51], v9 offset:36864
    v_mfma_f32_16x16x32_bf16 v[128:131], v[72:75], a[188:191], v[128:131]
    v_exp_f32 v115, v115
    v_mfma_f32_16x16x32_bf16 v[136:139], v[72:75], a[204:207], v[136:139]
    v_cvt_pk_bf16_f32 v110, v112, v113
    v_cvt_pk_bf16_f32 v111, v114, v115
    v_mfma_f32_16x16x32_bf16 v[144:147], v[72:75], a[220:223], v[144:147]
    v_mfma_f32_16x16x32_bf16 v[152:155], v[72:75], a[236:239], v[152:155]
    s_waitcnt lgkmcnt(2)
    v_mfma_f32_16x16x32_bf16 a[0:3], v[44:47], v[76:79], a[0:3]
    ds_read_b64_tr_b16 v[52:53], v10 offset:32768
    ds_read_b64_tr_b16 v[54:55], v10 offset:36864
    v_mfma_f32_16x16x32_bf16 a[32:35], v[44:47], v[84:87], a[32:35]
    v_mfma_f32_16x16x32_bf16 a[64:67], v[44:47], v[92:95], a[64:67]
    v_exp_f32 v116, v116
    v_mfma_f32_16x16x32_bf16 a[96:99], v[44:47], v[100:103], a[96:99]
    v_exp_f32 v117, v117
    v_mfma_f32_16x16x32_bf16 a[128:131], v[44:47], v[108:111], a[128:131]
    v_exp_f32 v118, v118
    s_waitcnt lgkmcnt(2)
    v_mfma_f32_16x16x32_bf16 a[4:7], v[48:51], v[76:79], a[4:7]
    ds_read_b64_tr_b16 v[56:57], v11 offset:32768
    ds_read_b64_tr_b16 v[58:59], v11 offset:36864
    v_mfma_f32_16x16x32_bf16 a[36:39], v[48:51], v[84:87], a[36:39]
    v_mfma_f32_16x16x32_bf16 a[68:71], v[48:51], v[92:95], a[68:71]
    v_exp_f32 v119, v119
    v_mfma_f32_16x16x32_bf16 a[100:103], v[48:51], v[100:103], a[100:103]
    v_exp_f32 v120, v120
    v_mfma_f32_16x16x32_bf16 a[132:135], v[48:51], v[108:111], a[132:135]
    s_waitcnt lgkmcnt(2)
    v_mfma_f32_16x16x32_bf16 a[8:11], v[52:55], v[76:79], a[8:11]
    ds_read_b64_tr_b16 v[60:61], v12 offset:32768
    ds_read_b64_tr_b16 v[62:63], v12 offset:36864
    v_mfma_f32_16x16x32_bf16 a[40:43], v[52:55], v[84:87], a[40:43]
    v_cvt_pk_bf16_f32 v116, v116, v117
    v_cvt_pk_bf16_f32 v117, v118, v119
    v_mfma_f32_16x16x32_bf16 a[72:75], v[52:55], v[92:95], a[72:75]
    v_exp_f32 v121, v121
    v_mfma_f32_16x16x32_bf16 a[104:107], v[52:55], v[100:103], a[104:107]
    v_exp_f32 v122, v122
    v_mfma_f32_16x16x32_bf16 a[136:139], v[52:55], v[108:111], a[136:139]
    s_waitcnt lgkmcnt(2)
    v_mfma_f32_16x16x32_bf16 a[12:15], v[56:59], v[76:79], a[12:15]
    ds_read_b64_tr_b16 v[64:65], v13 offset:32768
    ds_read_b64_tr_b16 v[66:67], v13 offset:36864
    v_mfma_f32_16x16x32_bf16 a[44:47], v[56:59], v[84:87], a[44:47]
    v_exp_f32 v123, v123
    v_mfma_f32_16x16x32_bf16 a[76:79], v[56:59], v[92:95], a[76:79]
    v_cvt_pk_bf16_f32 v118, v120, v121
    v_cvt_pk_bf16_f32 v119, v122, v123
    v_mfma_f32_16x16x32_bf16 a[108:111], v[56:59], v[100:103], a[108:111]
    v_mfma_f32_16x16x32_bf16 a[140:143], v[56:59], v[108:111], a[140:143]
    v_exp_f32 v124, v124
    s_waitcnt lgkmcnt(2)
    v_mfma_f32_16x16x32_bf16 a[16:19], v[60:63], v[76:79], a[16:19]
    ds_read_b64_tr_b16 v[68:69], v14 offset:32768
    ds_read_b64_tr_b16 v[70:71], v14 offset:36864
    v_mfma_f32_16x16x32_bf16 a[48:51], v[60:63], v[84:87], a[48:51]
    v_exp_f32 v125, v125
    v_mfma_f32_16x16x32_bf16 a[80:83], v[60:63], v[92:95], a[80:83]
    v_mfma_f32_16x16x32_bf16 a[112:115], v[60:63], v[100:103], a[112:115]
    v_exp_f32 v126, v126
    v_mfma_f32_16x16x32_bf16 a[144:147], v[60:63], v[108:111], a[144:147]
    v_exp_f32 v127, v127
    s_waitcnt lgkmcnt(2)
    v_mfma_f32_16x16x32_bf16 a[20:23], v[64:67], v[76:79], a[20:23]
    ds_read_b64_tr_b16 v[72:73], v15 offset:32768
    ds_read_b64_tr_b16 v[74:75], v15 offset:36864
    v_mfma_f32_16x16x32_bf16 a[52:55], v[64:67], v[84:87], a[52:55]
    v_exp_f32 v128, v128
    v_mfma_f32_16x16x32_bf16 a[84:87], v[64:67], v[92:95], a[84:87]
    v_mfma_f32_16x16x32_bf16 a[116:119], v[64:67], v[100:103], a[116:119]
    v_cvt_pk_bf16_f32 v124, v124, v125
    v_cvt_pk_bf16_f32 v125, v126, v127
    v_mfma_f32_16x16x32_bf16 a[148:151], v[64:67], v[108:111], a[148:151]
    v_exp_f32 v129, v129
    s_waitcnt lgkmcnt(2)
    v_mfma_f32_16x16x32_bf16 a[24:27], v[68:71], v[76:79], a[24:27]
    ds_read_b128 v[44:47], v4 offset:49152
    ds_read_b128 v[48:51], v5 offset:49152
    v_mfma_f32_16x16x32_bf16 a[56:59], v[68:71], v[84:87], a[56:59]
    v_mfma_f32_16x16x32_bf16 a[88:91], v[68:71], v[92:95], a[88:91]
    v_exp_f32 v130, v130
    v_mfma_f32_16x16x32_bf16 a[120:123], v[68:71], v[100:103], a[120:123]
    v_exp_f32 v131, v131
    v_mfma_f32_16x16x32_bf16 a[152:155], v[68:71], v[108:111], a[152:155]
    v_cvt_pk_bf16_f32 v126, v128, v129
    v_cvt_pk_bf16_f32 v127, v130, v131
    s_waitcnt lgkmcnt(2)
    v_mfma_f32_16x16x32_bf16 a[28:31], v[72:75], v[76:79], a[28:31]
    v_mfma_f32_16x16x32_bf16 a[60:63], v[72:75], v[84:87], a[60:63]
    v_exp_f32 v132, v132
    v_mfma_f32_16x16x32_bf16 a[92:95], v[72:75], v[92:95], a[92:95]
    v_exp_f32 v133, v133
    v_mfma_f32_16x16x32_bf16 a[124:127], v[72:75], v[100:103], a[124:127]
    v_mfma_f32_16x16x32_bf16 a[156:159], v[72:75], v[108:111], a[156:159]
    v_exp_f32 v134, v134
    v_mfma_f32_16x16x32_bf16 a[240:243], v[248:251], v[76:79], a[240:243]
    v_exp_f32 v135, v135
    v_mfma_f32_16x16x32_bf16 a[244:247], v[248:251], v[84:87], a[244:247]
    s_waitcnt vmcnt(0)
    s_barrier
    v_mfma_f32_16x16x32_bf16 a[248:251], v[248:251], v[92:95], a[248:251]
    v_exp_f32 v136, v136
    v_mfma_f32_16x16x32_bf16 a[252:255], v[248:251], v[100:103], a[252:255]
    v_cvt_pk_bf16_f32 v132, v132, v133
    v_cvt_pk_bf16_f32 v133, v134, v135
    v_mfma_f32_16x16x32_bf16 v[20:23], v[248:251], v[108:111], v[20:23]
    v_exp_f32 v137, v137
    s_waitcnt lgkmcnt(1)
    v_mfma_f32_16x16x32_bf16 v[76:79], v[44:47], a[160:163], v[24:27]
    ds_read_b128 v[52:55], v6 offset:49152
    ds_read_b128 v[56:59], v7 offset:49152
    v_mfma_f32_16x16x32_bf16 v[84:87], v[44:47], a[176:179], v[28:31]
    v_mfma_f32_16x16x32_bf16 v[92:95], v[44:47], a[192:195], v[32:35]
    v_exp_f32 v138, v138
    v_mfma_f32_16x16x32_bf16 v[100:103], v[44:47], a[208:211], v[36:39]
    v_exp_f32 v139, v139
    v_mfma_f32_16x16x32_bf16 v[108:111], v[44:47], a[224:227], v[40:43]
    s_waitcnt lgkmcnt(2)
    v_mfma_f32_16x16x32_bf16 v[76:79], v[48:51], a[164:167], v[76:79]
    v_cvt_pk_bf16_f32 v134, v136, v137
    v_cvt_pk_bf16_f32 v135, v138, v139
    v_mfma_f32_16x16x32_bf16 v[84:87], v[48:51], a[180:183], v[84:87]
    v_exp_f32 v140, v140
    v_mfma_f32_16x16x32_bf16 v[92:95], v[48:51], a[196:199], v[92:95]
    v_mfma_f32_16x16x32_bf16 v[100:103], v[48:51], a[212:215], v[100:103]
    v_exp_f32 v141, v141
    v_mfma_f32_16x16x32_bf16 v[108:111], v[48:51], a[228:231], v[108:111]
    v_exp_f32 v142, v142
    s_waitcnt lgkmcnt(1)
    v_mfma_f32_16x16x32_bf16 v[76:79], v[52:55], a[168:171], v[76:79]
    ds_read_b128 v[60:63], v4 offset:53248
    ds_read_b128 v[64:67], v5 offset:53248
    v_mfma_f32_16x16x32_bf16 v[84:87], v[52:55], a[184:187], v[84:87]
    v_exp_f32 v143, v143
    v_mfma_f32_16x16x32_bf16 v[92:95], v[52:55], a[200:203], v[92:95]
    v_mfma_f32_16x16x32_bf16 v[100:103], v[52:55], a[216:219], v[100:103]
    v_exp_f32 v144, v144
    v_mfma_f32_16x16x32_bf16 v[108:111], v[52:55], a[232:235], v[108:111]
    v_cvt_pk_bf16_f32 v140, v140, v141
    v_cvt_pk_bf16_f32 v141, v142, v143
    s_waitcnt lgkmcnt(2)
    v_mfma_f32_16x16x32_bf16 v[76:79], v[56:59], a[172:175], v[76:79]
    v_mfma_f32_16x16x32_bf16 v[84:87], v[56:59], a[188:191], v[84:87]
    v_exp_f32 v145, v145
    v_mfma_f32_16x16x32_bf16 v[92:95], v[56:59], a[204:207], v[92:95]
    v_exp_f32 v146, v146
    v_mfma_f32_16x16x32_bf16 v[100:103], v[56:59], a[220:223], v[100:103]
    v_exp_f32 v147, v147
    v_mfma_f32_16x16x32_bf16 v[108:111], v[56:59], a[236:239], v[108:111]
    s_waitcnt lgkmcnt(1)
    v_mfma_f32_16x16x32_bf16 v[80:83], v[60:63], a[160:163], v[24:27]
    ds_read_b128 v[68:71], v6 offset:53248
    ds_read_b128 v[72:75], v7 offset:53248
    v_mfma_f32_16x16x32_bf16 v[88:91], v[60:63], a[176:179], v[28:31]
    v_cvt_pk_bf16_f32 v142, v144, v145
    v_cvt_pk_bf16_f32 v143, v146, v147
    v_mfma_f32_16x16x32_bf16 v[96:99], v[60:63], a[192:195], v[32:35]
    v_exp_f32 v148, v148
    v_mfma_f32_16x16x32_bf16 v[104:107], v[60:63], a[208:211], v[36:39]
    v_mfma_f32_16x16x32_bf16 v[112:115], v[60:63], a[224:227], v[40:43]
    v_exp_f32 v149, v149
    s_waitcnt lgkmcnt(2)
    v_mfma_f32_16x16x32_bf16 v[80:83], v[64:67], a[164:167], v[80:83]
    v_exp_f32 v150, v150
    v_mfma_f32_16x16x32_bf16 v[88:91], v[64:67], a[180:183], v[88:91]
    v_mfma_f32_16x16x32_bf16 v[96:99], v[64:67], a[196:199], v[96:99]
    v_exp_f32 v151, v151
    v_mfma_f32_16x16x32_bf16 v[104:107], v[64:67], a[212:215], v[104:107]
    v_exp_f32 v152, v152
    v_mfma_f32_16x16x32_bf16 v[112:115], v[64:67], a[228:231], v[112:115]
    v_cvt_pk_bf16_f32 v148, v148, v149
    v_cvt_pk_bf16_f32 v149, v150, v151
    s_waitcnt lgkmcnt(1)
    v_mfma_f32_16x16x32_bf16 v[80:83], v[68:71], a[168:171], v[80:83]
    ds_read_b64_tr_b16 v[44:45], v8 offset:40960
    ds_read_b64_tr_b16 v[46:47], v8 offset:45056
    v_mfma_f32_16x16x32_bf16 v[88:91], v[68:71], a[184:187], v[88:91]
    v_mfma_f32_16x16x32_bf16 v[96:99], v[68:71], a[200:203], v[96:99]
    v_exp_f32 v153, v153
    v_mfma_f32_16x16x32_bf16 v[104:107], v[68:71], a[216:219], v[104:107]
    v_exp_f32 v154, v154
    v_mfma_f32_16x16x32_bf16 v[112:115], v[68:71], a[232:235], v[112:115]
    s_waitcnt lgkmcnt(2)
    v_mfma_f32_16x16x32_bf16 v[80:83], v[72:75], a[172:175], v[80:83]
    ds_read_b64_tr_b16 v[48:49], v9 offset:40960
    ds_read_b64_tr_b16 v[50:51], v9 offset:45056
    v_mfma_f32_16x16x32_bf16 v[88:91], v[72:75], a[188:191], v[88:91]
    v_exp_f32 v155, v155
    v_mfma_f32_16x16x32_bf16 v[96:99], v[72:75], a[204:207], v[96:99]
    v_cvt_pk_bf16_f32 v150, v152, v153
    v_cvt_pk_bf16_f32 v151, v154, v155
    v_mfma_f32_16x16x32_bf16 v[104:107], v[72:75], a[220:223], v[104:107]
    v_mfma_f32_16x16x32_bf16 v[112:115], v[72:75], a[236:239], v[112:115]
    s_waitcnt lgkmcnt(2)
    v_mfma_f32_16x16x32_bf16 a[0:3], v[44:47], v[116:119], a[0:3]
    ds_read_b64_tr_b16 v[52:53], v10 offset:40960
    ds_read_b64_tr_b16 v[54:55], v10 offset:45056
    v_mfma_f32_16x16x32_bf16 a[32:35], v[44:47], v[124:127], a[32:35]
    v_mfma_f32_16x16x32_bf16 a[64:67], v[44:47], v[132:135], a[64:67]
    v_exp_f32 v76, v76
    v_mfma_f32_16x16x32_bf16 a[96:99], v[44:47], v[140:143], a[96:99]
    v_exp_f32 v77, v77
    v_mfma_f32_16x16x32_bf16 a[128:131], v[44:47], v[148:151], a[128:131]
    v_exp_f32 v78, v78
    s_waitcnt lgkmcnt(2)
    v_mfma_f32_16x16x32_bf16 a[4:7], v[48:51], v[116:119], a[4:7]
    ds_read_b64_tr_b16 v[56:57], v11 offset:40960
    ds_read_b64_tr_b16 v[58:59], v11 offset:45056
    v_mfma_f32_16x16x32_bf16 a[36:39], v[48:51], v[124:127], a[36:39]
    v_mfma_f32_16x16x32_bf16 a[68:71], v[48:51], v[132:135], a[68:71]
    v_exp_f32 v79, v79
    v_mfma_f32_16x16x32_bf16 a[100:103], v[48:51], v[140:143], a[100:103]
    v_exp_f32 v80, v80
    v_mfma_f32_16x16x32_bf16 a[132:135], v[48:51], v[148:151], a[132:135]
    s_waitcnt lgkmcnt(2)
    v_mfma_f32_16x16x32_bf16 a[8:11], v[52:55], v[116:119], a[8:11]
    ds_read_b64_tr_b16 v[60:61], v12 offset:40960
    ds_read_b64_tr_b16 v[62:63], v12 offset:45056
    v_mfma_f32_16x16x32_bf16 a[40:43], v[52:55], v[124:127], a[40:43]
    v_cvt_pk_bf16_f32 v76, v76, v77
    v_cvt_pk_bf16_f32 v77, v78, v79
    v_mfma_f32_16x16x32_bf16 a[72:75], v[52:55], v[132:135], a[72:75]
    v_exp_f32 v81, v81
    v_mfma_f32_16x16x32_bf16 a[104:107], v[52:55], v[140:143], a[104:107]
    v_exp_f32 v82, v82
    v_mfma_f32_16x16x32_bf16 a[136:139], v[52:55], v[148:151], a[136:139]
    s_waitcnt lgkmcnt(2)
    v_mfma_f32_16x16x32_bf16 a[12:15], v[56:59], v[116:119], a[12:15]
    ds_read_b64_tr_b16 v[64:65], v13 offset:40960
    ds_read_b64_tr_b16 v[66:67], v13 offset:45056
    v_mfma_f32_16x16x32_bf16 a[44:47], v[56:59], v[124:127], a[44:47]
    v_exp_f32 v83, v83
    v_mfma_f32_16x16x32_bf16 a[76:79], v[56:59], v[132:135], a[76:79]
    v_cvt_pk_bf16_f32 v78, v80, v81
    v_cvt_pk_bf16_f32 v79, v82, v83
    v_mfma_f32_16x16x32_bf16 a[108:111], v[56:59], v[140:143], a[108:111]
    v_mfma_f32_16x16x32_bf16 a[140:143], v[56:59], v[148:151], a[140:143]
    v_exp_f32 v84, v84
    s_waitcnt lgkmcnt(2)
    v_mfma_f32_16x16x32_bf16 a[16:19], v[60:63], v[116:119], a[16:19]
    ds_read_b64_tr_b16 v[68:69], v14 offset:40960
    ds_read_b64_tr_b16 v[70:71], v14 offset:45056
    v_mfma_f32_16x16x32_bf16 a[48:51], v[60:63], v[124:127], a[48:51]
    v_exp_f32 v85, v85
    v_mfma_f32_16x16x32_bf16 a[80:83], v[60:63], v[132:135], a[80:83]
    v_mfma_f32_16x16x32_bf16 a[112:115], v[60:63], v[140:143], a[112:115]
    v_exp_f32 v86, v86
    v_mfma_f32_16x16x32_bf16 a[144:147], v[60:63], v[148:151], a[144:147]
    v_exp_f32 v87, v87
    s_waitcnt lgkmcnt(2)
    v_mfma_f32_16x16x32_bf16 a[20:23], v[64:67], v[116:119], a[20:23]
    ds_read_b64_tr_b16 v[72:73], v15 offset:40960
    ds_read_b64_tr_b16 v[74:75], v15 offset:45056
    v_mfma_f32_16x16x32_bf16 a[52:55], v[64:67], v[124:127], a[52:55]
    v_exp_f32 v88, v88
    v_mfma_f32_16x16x32_bf16 a[84:87], v[64:67], v[132:135], a[84:87]
    v_mfma_f32_16x16x32_bf16 a[116:119], v[64:67], v[140:143], a[116:119]
    v_cvt_pk_bf16_f32 v84, v84, v85
    v_cvt_pk_bf16_f32 v85, v86, v87
    v_mfma_f32_16x16x32_bf16 a[148:151], v[64:67], v[148:151], a[148:151]
    v_exp_f32 v89, v89
    s_waitcnt lgkmcnt(2)
    v_mfma_f32_16x16x32_bf16 a[24:27], v[68:71], v[116:119], a[24:27]
    ds_read_b128 v[44:47], v4 offset:57344
    ds_read_b128 v[48:51], v5 offset:57344
    v_mfma_f32_16x16x32_bf16 a[56:59], v[68:71], v[124:127], a[56:59]
    v_mfma_f32_16x16x32_bf16 a[88:91], v[68:71], v[132:135], a[88:91]
    v_exp_f32 v90, v90
    v_mfma_f32_16x16x32_bf16 a[120:123], v[68:71], v[140:143], a[120:123]
    v_exp_f32 v91, v91
    v_mfma_f32_16x16x32_bf16 a[152:155], v[68:71], v[148:151], a[152:155]
    v_cvt_pk_bf16_f32 v86, v88, v89
    v_cvt_pk_bf16_f32 v87, v90, v91
    s_waitcnt lgkmcnt(2)
    v_mfma_f32_16x16x32_bf16 a[28:31], v[72:75], v[116:119], a[28:31]
    v_mfma_f32_16x16x32_bf16 a[60:63], v[72:75], v[124:127], a[60:63]
    v_exp_f32 v92, v92
    s_nop 1
    v_mfma_f32_16x16x32_bf16 a[92:95], v[72:75], v[132:135], a[92:95]
    v_exp_f32 v93, v93
    v_mfma_f32_16x16x32_bf16 a[124:127], v[72:75], v[140:143], a[124:127]
    v_mfma_f32_16x16x32_bf16 a[156:159], v[72:75], v[148:151], a[156:159]
    v_exp_f32 v94, v94
    v_mfma_f32_16x16x32_bf16 a[240:243], v[248:251], v[116:119], a[240:243]
    v_exp_f32 v95, v95
    v_mfma_f32_16x16x32_bf16 a[244:247], v[248:251], v[124:127], a[244:247]
    s_barrier
    v_mfma_f32_16x16x32_bf16 a[248:251], v[248:251], v[132:135], a[248:251]
    v_exp_f32 v96, v96
    v_mfma_f32_16x16x32_bf16 a[252:255], v[248:251], v[140:143], a[252:255]
    v_cvt_pk_bf16_f32 v92, v92, v93
    v_cvt_pk_bf16_f32 v93, v94, v95
    v_mfma_f32_16x16x32_bf16 v[20:23], v[248:251], v[148:151], v[20:23]
    v_exp_f32 v97, v97
    s_waitcnt lgkmcnt(1)
    v_mfma_f32_16x16x32_bf16 v[116:119], v[44:47], a[160:163], v[24:27]
    ds_read_b128 v[52:55], v6 offset:57344
    ds_read_b128 v[56:59], v7 offset:57344
    v_mfma_f32_16x16x32_bf16 v[124:127], v[44:47], a[176:179], v[28:31]
    v_mfma_f32_16x16x32_bf16 v[132:135], v[44:47], a[192:195], v[32:35]
    v_exp_f32 v98, v98
    v_mfma_f32_16x16x32_bf16 v[140:143], v[44:47], a[208:211], v[36:39]
    v_exp_f32 v99, v99
    v_mfma_f32_16x16x32_bf16 v[148:151], v[44:47], a[224:227], v[40:43]
    s_waitcnt lgkmcnt(2)
    v_mfma_f32_16x16x32_bf16 v[116:119], v[48:51], a[164:167], v[116:119]
    v_cvt_pk_bf16_f32 v94, v96, v97
    v_cvt_pk_bf16_f32 v95, v98, v99
    v_mfma_f32_16x16x32_bf16 v[124:127], v[48:51], a[180:183], v[124:127]
    v_exp_f32 v100, v100
    v_mfma_f32_16x16x32_bf16 v[132:135], v[48:51], a[196:199], v[132:135]
    v_mfma_f32_16x16x32_bf16 v[140:143], v[48:51], a[212:215], v[140:143]
    v_exp_f32 v101, v101
    v_mfma_f32_16x16x32_bf16 v[148:151], v[48:51], a[228:231], v[148:151]
    v_exp_f32 v102, v102
    s_waitcnt lgkmcnt(1)
    v_mfma_f32_16x16x32_bf16 v[116:119], v[52:55], a[168:171], v[116:119]
    ds_read_b128 v[60:63], v4 offset:61440
    ds_read_b128 v[64:67], v5 offset:61440
    v_mfma_f32_16x16x32_bf16 v[124:127], v[52:55], a[184:187], v[124:127]
    v_exp_f32 v103, v103
    v_mfma_f32_16x16x32_bf16 v[132:135], v[52:55], a[200:203], v[132:135]
    v_mfma_f32_16x16x32_bf16 v[140:143], v[52:55], a[216:219], v[140:143]
    v_exp_f32 v104, v104
    v_mfma_f32_16x16x32_bf16 v[148:151], v[52:55], a[232:235], v[148:151]
    v_cvt_pk_bf16_f32 v100, v100, v101
    v_cvt_pk_bf16_f32 v101, v102, v103
    s_waitcnt lgkmcnt(2)
    v_mfma_f32_16x16x32_bf16 v[116:119], v[56:59], a[172:175], v[116:119]
    v_mfma_f32_16x16x32_bf16 v[124:127], v[56:59], a[188:191], v[124:127]
    v_exp_f32 v105, v105
    v_mfma_f32_16x16x32_bf16 v[132:135], v[56:59], a[204:207], v[132:135]
    v_exp_f32 v106, v106
    v_mfma_f32_16x16x32_bf16 v[140:143], v[56:59], a[220:223], v[140:143]
    v_exp_f32 v107, v107
    v_mfma_f32_16x16x32_bf16 v[148:151], v[56:59], a[236:239], v[148:151]
    s_waitcnt lgkmcnt(1)
    v_mfma_f32_16x16x32_bf16 v[120:123], v[60:63], a[160:163], v[24:27]
    ds_read_b128 v[68:71], v6 offset:61440
    ds_read_b128 v[72:75], v7 offset:61440
    v_mfma_f32_16x16x32_bf16 v[128:131], v[60:63], a[176:179], v[28:31]
    v_cvt_pk_bf16_f32 v102, v104, v105
    v_cvt_pk_bf16_f32 v103, v106, v107
    v_mfma_f32_16x16x32_bf16 v[136:139], v[60:63], a[192:195], v[32:35]
    v_exp_f32 v108, v108
    v_mfma_f32_16x16x32_bf16 v[144:147], v[60:63], a[208:211], v[36:39]
    v_mfma_f32_16x16x32_bf16 v[152:155], v[60:63], a[224:227], v[40:43]
    v_exp_f32 v109, v109
    s_waitcnt lgkmcnt(2)
    v_mfma_f32_16x16x32_bf16 v[120:123], v[64:67], a[164:167], v[120:123]
    v_exp_f32 v110, v110
    v_mfma_f32_16x16x32_bf16 v[128:131], v[64:67], a[180:183], v[128:131]
    v_mfma_f32_16x16x32_bf16 v[136:139], v[64:67], a[196:199], v[136:139]
    v_exp_f32 v111, v111
    v_mfma_f32_16x16x32_bf16 v[144:147], v[64:67], a[212:215], v[144:147]
    v_exp_f32 v112, v112
    v_mfma_f32_16x16x32_bf16 v[152:155], v[64:67], a[228:231], v[152:155]
    v_cvt_pk_bf16_f32 v108, v108, v109
    v_cvt_pk_bf16_f32 v109, v110, v111
    s_waitcnt lgkmcnt(1)
    v_mfma_f32_16x16x32_bf16 v[120:123], v[68:71], a[168:171], v[120:123]
    ds_read_b64_tr_b16 v[44:45], v8 offset:49152
    ds_read_b64_tr_b16 v[46:47], v8 offset:53248
    v_mfma_f32_16x16x32_bf16 v[128:131], v[68:71], a[184:187], v[128:131]
    v_mfma_f32_16x16x32_bf16 v[136:139], v[68:71], a[200:203], v[136:139]
    v_exp_f32 v113, v113
    v_mfma_f32_16x16x32_bf16 v[144:147], v[68:71], a[216:219], v[144:147]
    v_exp_f32 v114, v114
    v_mfma_f32_16x16x32_bf16 v[152:155], v[68:71], a[232:235], v[152:155]
    s_waitcnt lgkmcnt(2)
    v_mfma_f32_16x16x32_bf16 v[120:123], v[72:75], a[172:175], v[120:123]
    ds_read_b64_tr_b16 v[48:49], v9 offset:49152
    ds_read_b64_tr_b16 v[50:51], v9 offset:53248
    v_mfma_f32_16x16x32_bf16 v[128:131], v[72:75], a[188:191], v[128:131]
    v_exp_f32 v115, v115
    v_mfma_f32_16x16x32_bf16 v[136:139], v[72:75], a[204:207], v[136:139]
    v_cvt_pk_bf16_f32 v110, v112, v113
    v_cvt_pk_bf16_f32 v111, v114, v115
    v_mfma_f32_16x16x32_bf16 v[144:147], v[72:75], a[220:223], v[144:147]
    v_mfma_f32_16x16x32_bf16 v[152:155], v[72:75], a[236:239], v[152:155]
    s_waitcnt lgkmcnt(2)
    v_mfma_f32_16x16x32_bf16 a[0:3], v[44:47], v[76:79], a[0:3]
    ds_read_b64_tr_b16 v[52:53], v10 offset:49152
    ds_read_b64_tr_b16 v[54:55], v10 offset:53248
    v_mfma_f32_16x16x32_bf16 a[32:35], v[44:47], v[84:87], a[32:35]
    v_mfma_f32_16x16x32_bf16 a[64:67], v[44:47], v[92:95], a[64:67]
    v_exp_f32 v116, v116
    v_exp_f32 v117, v117
    v_mfma_f32_16x16x32_bf16 a[96:99], v[44:47], v[100:103], a[96:99]
    v_exp_f32 v118, v118
    v_mfma_f32_16x16x32_bf16 a[128:131], v[44:47], v[108:111], a[128:131]
    v_exp_f32 v119, v119
    v_exp_f32 v120, v120
    s_waitcnt lgkmcnt(2)
    v_mfma_f32_16x16x32_bf16 a[4:7], v[48:51], v[76:79], a[4:7]
    ds_read_b64_tr_b16 v[56:57], v11 offset:49152
    ds_read_b64_tr_b16 v[58:59], v11 offset:53248
    v_mfma_f32_16x16x32_bf16 a[36:39], v[48:51], v[84:87], a[36:39]
    v_cvt_pk_bf16_f32 v116, v116, v117
    v_cvt_pk_bf16_f32 v117, v118, v119
    v_mfma_f32_16x16x32_bf16 a[68:71], v[48:51], v[92:95], a[68:71]
    v_exp_f32 v121, v121
    v_exp_f32 v122, v122
    v_mfma_f32_16x16x32_bf16 a[100:103], v[48:51], v[100:103], a[100:103]
    v_exp_f32 v123, v123
    v_mfma_f32_16x16x32_bf16 a[132:135], v[48:51], v[108:111], a[132:135]
    v_cvt_pk_bf16_f32 v118, v120, v121
    v_cvt_pk_bf16_f32 v119, v122, v123
    s_waitcnt lgkmcnt(2)
    v_mfma_f32_16x16x32_bf16 a[8:11], v[52:55], v[76:79], a[8:11]
    ds_read_b64_tr_b16 v[60:61], v12 offset:49152
    ds_read_b64_tr_b16 v[62:63], v12 offset:53248
    v_mfma_f32_16x16x32_bf16 a[40:43], v[52:55], v[84:87], a[40:43]
    v_exp_f32 v124, v124
    v_exp_f32 v125, v125
    v_mfma_f32_16x16x32_bf16 a[72:75], v[52:55], v[92:95], a[72:75]
    v_exp_f32 v126, v126
    v_mfma_f32_16x16x32_bf16 a[104:107], v[52:55], v[100:103], a[104:107]
    v_exp_f32 v127, v127
    v_exp_f32 v128, v128
    v_mfma_f32_16x16x32_bf16 a[136:139], v[52:55], v[108:111], a[136:139]
    v_cvt_pk_bf16_f32 v124, v124, v125
    v_cvt_pk_bf16_f32 v125, v126, v127
    s_waitcnt lgkmcnt(2)
    v_mfma_f32_16x16x32_bf16 a[12:15], v[56:59], v[76:79], a[12:15]
    ds_read_b64_tr_b16 v[64:65], v13 offset:49152
    ds_read_b64_tr_b16 v[66:67], v13 offset:53248
    v_mfma_f32_16x16x32_bf16 a[44:47], v[56:59], v[84:87], a[44:47]
    v_exp_f32 v129, v129
    v_exp_f32 v130, v130
    v_mfma_f32_16x16x32_bf16 a[76:79], v[56:59], v[92:95], a[76:79]
    v_exp_f32 v131, v131
    v_mfma_f32_16x16x32_bf16 a[108:111], v[56:59], v[100:103], a[108:111]
    v_cvt_pk_bf16_f32 v126, v128, v129
    v_cvt_pk_bf16_f32 v127, v130, v131
    v_mfma_f32_16x16x32_bf16 a[140:143], v[56:59], v[108:111], a[140:143]
    v_exp_f32 v132, v132
    v_exp_f32 v133, v133
    s_waitcnt lgkmcnt(2)
    v_mfma_f32_16x16x32_bf16 a[16:19], v[60:63], v[76:79], a[16:19]
    ds_read_b64_tr_b16 v[68:69], v14 offset:49152
    ds_read_b64_tr_b16 v[70:71], v14 offset:53248
    v_mfma_f32_16x16x32_bf16 a[48:51], v[60:63], v[84:87], a[48:51]
    v_exp_f32 v134, v134
    v_mfma_f32_16x16x32_bf16 a[80:83], v[60:63], v[92:95], a[80:83]
    v_exp_f32 v135, v135
    v_exp_f32 v136, v136
    v_mfma_f32_16x16x32_bf16 a[112:115], v[60:63], v[100:103], a[112:115]
    v_cvt_pk_bf16_f32 v132, v132, v133
    v_cvt_pk_bf16_f32 v133, v134, v135
    v_mfma_f32_16x16x32_bf16 a[144:147], v[60:63], v[108:111], a[144:147]
    v_exp_f32 v137, v137
    v_exp_f32 v138, v138
    s_waitcnt lgkmcnt(2)
    v_mfma_f32_16x16x32_bf16 a[20:23], v[64:67], v[76:79], a[20:23]
    ds_read_b64_tr_b16 v[72:73], v15 offset:49152
    ds_read_b64_tr_b16 v[74:75], v15 offset:53248
    v_mfma_f32_16x16x32_bf16 a[52:55], v[64:67], v[84:87], a[52:55]
    v_exp_f32 v139, v139
    v_mfma_f32_16x16x32_bf16 a[84:87], v[64:67], v[92:95], a[84:87]
    v_cvt_pk_bf16_f32 v134, v136, v137
    v_cvt_pk_bf16_f32 v135, v138, v139
    v_mfma_f32_16x16x32_bf16 a[116:119], v[64:67], v[100:103], a[116:119]
    v_exp_f32 v140, v140
    v_exp_f32 v141, v141
    v_mfma_f32_16x16x32_bf16 a[148:151], v[64:67], v[108:111], a[148:151]
    v_exp_f32 v142, v142
    s_waitcnt lgkmcnt(2)
    v_mfma_f32_16x16x32_bf16 a[24:27], v[68:71], v[76:79], a[24:27]
    ds_read_b64_tr_b16 v[44:45], v8 offset:57344
    ds_read_b64_tr_b16 v[46:47], v8 offset:61440
    v_mfma_f32_16x16x32_bf16 a[56:59], v[68:71], v[84:87], a[56:59]
    v_exp_f32 v143, v143
    v_exp_f32 v144, v144
    v_mfma_f32_16x16x32_bf16 a[88:91], v[68:71], v[92:95], a[88:91]
    v_cvt_pk_bf16_f32 v140, v140, v141
    v_cvt_pk_bf16_f32 v141, v142, v143
    v_mfma_f32_16x16x32_bf16 a[120:123], v[68:71], v[100:103], a[120:123]
    v_exp_f32 v145, v145
    v_exp_f32 v146, v146
    v_mfma_f32_16x16x32_bf16 a[152:155], v[68:71], v[108:111], a[152:155]
    v_exp_f32 v147, v147
    s_waitcnt lgkmcnt(2)
    v_mfma_f32_16x16x32_bf16 a[28:31], v[72:75], v[76:79], a[28:31]
    ds_read_b64_tr_b16 v[48:49], v9 offset:57344
    ds_read_b64_tr_b16 v[50:51], v9 offset:61440
    v_mfma_f32_16x16x32_bf16 a[60:63], v[72:75], v[84:87], a[60:63]
    v_cvt_pk_bf16_f32 v142, v144, v145
    v_cvt_pk_bf16_f32 v143, v146, v147
    v_mfma_f32_16x16x32_bf16 a[92:95], v[72:75], v[92:95], a[92:95]
    v_exp_f32 v148, v148
    v_exp_f32 v149, v149
    v_mfma_f32_16x16x32_bf16 a[124:127], v[72:75], v[100:103], a[124:127]
    v_exp_f32 v150, v150
    v_mfma_f32_16x16x32_bf16 a[156:159], v[72:75], v[108:111], a[156:159]
    v_exp_f32 v151, v151
    v_exp_f32 v152, v152
    v_mfma_f32_16x16x32_bf16 a[240:243], v[248:251], v[76:79], a[240:243]
    v_cvt_pk_bf16_f32 v148, v148, v149
    v_cvt_pk_bf16_f32 v149, v150, v151
    v_mfma_f32_16x16x32_bf16 a[244:247], v[248:251], v[84:87], a[244:247]
    v_exp_f32 v153, v153
    v_exp_f32 v154, v154
    v_mfma_f32_16x16x32_bf16 a[248:251], v[248:251], v[92:95], a[248:251]
    v_exp_f32 v155, v155
    v_mfma_f32_16x16x32_bf16 a[252:255], v[248:251], v[100:103], a[252:255]
    v_cvt_pk_bf16_f32 v150, v152, v153
    v_cvt_pk_bf16_f32 v151, v154, v155
    v_mfma_f32_16x16x32_bf16 v[20:23], v[248:251], v[108:111], v[20:23]
    s_nop 1
    v_mfma_f32_16x16x32_bf16 a[240:243], v[248:251], v[116:119], a[240:243]
    v_mfma_f32_16x16x32_bf16 a[244:247], v[248:251], v[124:127], a[244:247]
    v_mfma_f32_16x16x32_bf16 a[248:251], v[248:251], v[132:135], a[248:251]
    v_mfma_f32_16x16x32_bf16 a[252:255], v[248:251], v[140:143], a[252:255]
    v_mfma_f32_16x16x32_bf16 v[20:23], v[248:251], v[148:151], v[20:23]
    s_nop 7
    v_accvgpr_read_b32 v236, a240
    v_accvgpr_read_b32 v237, a244
    v_accvgpr_read_b32 v238, a248
    v_accvgpr_read_b32 v239, a252
    v_mov_b32 v240, v20
    v_cmp_nge_f32 s[42:43], s40, v236
    v_cmp_nge_f32 s[48:49], s40, v237
    s_nop 1
    s_or_b64 s[42:43], s[42:43], s[48:49]
    v_cmp_nge_f32 s[48:49], s40, v238
    s_nop 1
    s_or_b64 s[42:43], s[42:43], s[48:49]
    v_cmp_nge_f32 s[48:49], s40, v239
    s_nop 1
    s_or_b64 s[42:43], s[42:43], s[48:49]
    v_cmp_nge_f32 s[48:49], s40, v240
    s_nop 1
    s_or_b64 s[42:43], s[42:43], s[48:49]
    s_nop 1
    s_cmp_lg_u64 s[42:43], 0
    s_cselect_b32 s38, 1, 0
    v_mov_b32 v246, s38
    ds_write_b32 v18, v246
    s_waitcnt lgkmcnt(0)
    s_barrier
    ds_read_b128 v[240:243], v19
    s_waitcnt lgkmcnt(0)
    v_or3_b32 v240, v240, v241, v242
    v_or_b32 v240, v240, v243
    s_nop 0
    v_readfirstlane_b32 s38, v240
    s_nop 1
    s_cmp_lg_u32 s38, 0
    s_cbranch_scc1 L_c5_fallback
    s_waitcnt lgkmcnt(2)
    v_mfma_f32_16x16x32_bf16 a[0:3], v[44:47], v[116:119], a[0:3]
    ds_read_b64_tr_b16 v[52:53], v10 offset:57344
    ds_read_b64_tr_b16 v[54:55], v10 offset:61440
    v_mfma_f32_16x16x32_bf16 a[32:35], v[44:47], v[124:127], a[32:35]
    v_mfma_f32_16x16x32_bf16 a[64:67], v[44:47], v[132:135], a[64:67]
    v_mfma_f32_16x16x32_bf16 a[96:99], v[44:47], v[140:143], a[96:99]
    v_mfma_f32_16x16x32_bf16 a[128:131], v[44:47], v[148:151], a[128:131]
    s_waitcnt lgkmcnt(2)
    v_mfma_f32_16x16x32_bf16 a[4:7], v[48:51], v[116:119], a[4:7]
    ds_read_b64_tr_b16 v[56:57], v11 offset:57344
    ds_read_b64_tr_b16 v[58:59], v11 offset:61440
    v_mfma_f32_16x16x32_bf16 a[36:39], v[48:51], v[124:127], a[36:39]
    v_mfma_f32_16x16x32_bf16 a[68:71], v[48:51], v[132:135], a[68:71]
    v_mfma_f32_16x16x32_bf16 a[100:103], v[48:51], v[140:143], a[100:103]
    v_mfma_f32_16x16x32_bf16 a[132:135], v[48:51], v[148:151], a[132:135]
    s_waitcnt lgkmcnt(2)
    v_mfma_f32_16x16x32_bf16 a[8:11], v[52:55], v[116:119], a[8:11]
    ds_read_b64_tr_b16 v[60:61], v12 offset:57344
    ds_read_b64_tr_b16 v[62:63], v12 offset:61440
    v_mfma_f32_16x16x32_bf16 a[40:43], v[52:55], v[124:127], a[40:43]
    v_mfma_f32_16x16x32_bf16 a[72:75], v[52:55], v[132:135], a[72:75]
    v_mfma_f32_16x16x32_bf16 a[104:107], v[52:55], v[140:143], a[104:107]
    v_mfma_f32_16x16x32_bf16 a[136:139], v[52:55], v[148:151], a[136:139]
    s_waitcnt lgkmcnt(2)
    v_mfma_f32_16x16x32_bf16 a[12:15], v[56:59], v[116:119], a[12:15]
    ds_read_b64_tr_b16 v[64:65], v13 offset:57344
    ds_read_b64_tr_b16 v[66:67], v13 offset:61440
    v_mfma_f32_16x16x32_bf16 a[44:47], v[56:59], v[124:127], a[44:47]
    v_mfma_f32_16x16x32_bf16 a[76:79], v[56:59], v[132:135], a[76:79]
    v_mfma_f32_16x16x32_bf16 a[108:111], v[56:59], v[140:143], a[108:111]
    v_mfma_f32_16x16x32_bf16 a[140:143], v[56:59], v[148:151], a[140:143]
    s_waitcnt lgkmcnt(2)
    v_mfma_f32_16x16x32_bf16 a[16:19], v[60:63], v[116:119], a[16:19]
    ds_read_b64_tr_b16 v[68:69], v14 offset:57344
    ds_read_b64_tr_b16 v[70:71], v14 offset:61440
    v_mfma_f32_16x16x32_bf16 a[48:51], v[60:63], v[124:127], a[48:51]
    v_mfma_f32_16x16x32_bf16 a[80:83], v[60:63], v[132:135], a[80:83]
    v_mfma_f32_16x16x32_bf16 a[112:115], v[60:63], v[140:143], a[112:115]
    v_mfma_f32_16x16x32_bf16 a[144:147], v[60:63], v[148:151], a[144:147]
    s_waitcnt lgkmcnt(2)
    v_mfma_f32_16x16x32_bf16 a[20:23], v[64:67], v[116:119], a[20:23]
    ds_read_b64_tr_b16 v[72:73], v15 offset:57344
    ds_read_b64_tr_b16 v[74:75], v15 offset:61440
    v_mfma_f32_16x16x32_bf16 a[52:55], v[64:67], v[124:127], a[52:55]
    v_mfma_f32_16x16x32_bf16 a[84:87], v[64:67], v[132:135], a[84:87]
    v_mfma_f32_16x16x32_bf16 a[116:119], v[64:67], v[140:143], a[116:119]
    v_mfma_f32_16x16x32_bf16 a[148:151], v[64:67], v[148:151], a[148:151]
    s_waitcnt lgkmcnt(2)
    v_mfma_f32_16x16x32_bf16 a[24:27], v[68:71], v[116:119], a[24:27]
    v_mfma_f32_16x16x32_bf16 a[56:59], v[68:71], v[124:127], a[56:59]
    v_mfma_f32_16x16x32_bf16 a[88:91], v[68:71], v[132:135], a[88:91]
    v_mfma_f32_16x16x32_bf16 a[120:123], v[68:71], v[140:143], a[120:123]
    v_mfma_f32_16x16x32_bf16 a[152:155], v[68:71], v[148:151], a[152:155]
    s_waitcnt lgkmcnt(0)
    v_mfma_f32_16x16x32_bf16 a[28:31], v[72:75], v[116:119], a[28:31]
    v_mfma_f32_16x16x32_bf16 a[60:63], v[72:75], v[124:127], a[60:63]
    v_mfma_f32_16x16x32_bf16 a[92:95], v[72:75], v[132:135], a[92:95]
    v_mfma_f32_16x16x32_bf16 a[124:127], v[72:75], v[140:143], a[124:127]
    v_mfma_f32_16x16x32_bf16 a[156:159], v[72:75], v[148:151], a[156:159]
L_c5_fin:
    s_nop 7
    v_accvgpr_read_b32 v221, a240
    v_accvgpr_read_b32 v223, a244
    v_accvgpr_read_b32 v225, a248
    v_accvgpr_read_b32 v227, a252
    v_mov_b32 v229, v20
    v_rcp_f32 v220, v221
    v_rcp_f32 v222, v223
    v_rcp_f32 v224, v225
    v_rcp_f32 v226, v227
    v_rcp_f32 v228, v229
    s_nop 0
    v_mov_b32 v221, v220
    v_mov_b32 v223, v222
    v_mov_b32 v225, v224
    v_mov_b32 v227, v226
    v_mov_b32 v229, v228
    s_nop 0
    s_add_u32 s38, s32, 0
    v_accvgpr_read_b32 v156, a0
    v_accvgpr_read_b32 v157, a1
    v_accvgpr_read_b32 v158, a2
    v_accvgpr_read_b32 v159, a3
    v_accvgpr_read_b32 v160, a4
    v_accvgpr_read_b32 v161, a5
    v_accvgpr_read_b32 v162, a6
    v_accvgpr_read_b32 v163, a7
    v_pk_mul_f32 v[156:157], v[156:157], v[220:221]
    v_pk_mul_f32 v[158:159], v[158:159], v[220:221]
    v_pk_mul_f32 v[160:161], v[160:161], v[220:221]
    v_pk_mul_f32 v[162:163], v[162:163], v[220:221]
    v_cvt_pk_bf16_f32 v156, v156, v157
    v_cvt_pk_bf16_f32 v157, v158, v159
    v_cvt_pk_bf16_f32 v158, v160, v161
    v_cvt_pk_bf16_f32 v159, v162, v163
    s_nop 1
    v_permlane16_swap_b32 v156, v158
    v_permlane16_swap_b32 v157, v159
    buffer_store_dwordx4 v[156:159], v17, s[24:27], s38 offen offset:0
    v_accvgpr_read_b32 v164, a8
    v_accvgpr_read_b32 v165, a9
    v_accvgpr_read_b32 v166, a10
    v_accvgpr_read_b32 v167, a11
    v_accvgpr_read_b32 v168, a12
    v_accvgpr_read_b32 v169, a13
    v_accvgpr_read_b32 v170, a14
    v_accvgpr_read_b32 v171, a15
    v_pk_mul_f32 v[164:165], v[164:165], v[220:221]
    v_pk_mul_f32 v[166:167], v[166:167], v[220:221]
    v_pk_mul_f32 v[168:169], v[168:169], v[220:221]
    v_pk_mul_f32 v[170:171], v[170:171], v[220:221]
    v_cvt_pk_bf16_f32 v164, v164, v165
    v_cvt_pk_bf16_f32 v165, v166, v167
    v_cvt_pk_bf16_f32 v166, v168, v169
    v_cvt_pk_bf16_f32 v167, v170, v171
    s_nop 1
    v_permlane16_swap_b32 v164, v166
    v_permlane16_swap_b32 v165, v167
    buffer_store_dwordx4 v[164:167], v17, s[24:27], s38 offen offset:64
    v_accvgpr_read_b32 v172, a16
    v_accvgpr_read_b32 v173, a17
    v_accvgpr_read_b32 v174, a18
    v_accvgpr_read_b32 v175, a19
    v_accvgpr_read_b32 v176, a20
    v_accvgpr_read_b32 v177, a21
    v_accvgpr_read_b32 v178, a22
    v_accvgpr_read_b32 v179, a23
    v_pk_mul_f32 v[172:173], v[172:173], v[220:221]
    v_pk_mul_f32 v[174:175], v[174:175], v[220:221]
    v_pk_mul_f32 v[176:177], v[176:177], v[220:221]
    v_pk_mul_f32 v[178:179], v[178:179], v[220:221]
    v_cvt_pk_bf16_f32 v172, v172, v173
    v_cvt_pk_bf16_f32 v173, v174, v175
    v_cvt_pk_bf16_f32 v174, v176, v177
    v_cvt_pk_bf16_f32 v175, v178, v179
    s_nop 1
    v_permlane16_swap_b32 v172, v174
    v_permlane16_swap_b32 v173, v175
    buffer_store_dwordx4 v[172:175], v17, s[24:27], s38 offen offset:128
    v_accvgpr_read_b32 v180, a24
    v_accvgpr_read_b32 v181, a25
    v_accvgpr_read_b32 v182, a26
    v_accvgpr_read_b32 v183, a27
    v_accvgpr_read_b32 v184, a28
    v_accvgpr_read_b32 v185, a29
    v_accvgpr_read_b32 v186, a30
    v_accvgpr_read_b32 v187, a31
    v_pk_mul_f32 v[180:181], v[180:181], v[220:221]
    v_pk_mul_f32 v[182:183], v[182:183], v[220:221]
    v_pk_mul_f32 v[184:185], v[184:185], v[220:221]
    v_pk_mul_f32 v[186:187], v[186:187], v[220:221]
    v_cvt_pk_bf16_f32 v180, v180, v181
    v_cvt_pk_bf16_f32 v181, v182, v183
    v_cvt_pk_bf16_f32 v182, v184, v185
    v_cvt_pk_bf16_f32 v183, v186, v187
    s_nop 1
    v_permlane16_swap_b32 v180, v182
    v_permlane16_swap_b32 v181, v183
    buffer_store_dwordx4 v[180:183], v17, s[24:27], s38 offen offset:192
    s_add_u32 s38, s32, 4096
    v_accvgpr_read_b32 v188, a32
    v_accvgpr_read_b32 v189, a33
    v_accvgpr_read_b32 v190, a34
    v_accvgpr_read_b32 v191, a35
    v_accvgpr_read_b32 v192, a36
    v_accvgpr_read_b32 v193, a37
    v_accvgpr_read_b32 v194, a38
    v_accvgpr_read_b32 v195, a39
    v_pk_mul_f32 v[188:189], v[188:189], v[222:223]
    v_pk_mul_f32 v[190:191], v[190:191], v[222:223]
    v_pk_mul_f32 v[192:193], v[192:193], v[222:223]
    v_pk_mul_f32 v[194:195], v[194:195], v[222:223]
    v_cvt_pk_bf16_f32 v188, v188, v189
    v_cvt_pk_bf16_f32 v189, v190, v191
    v_cvt_pk_bf16_f32 v190, v192, v193
    v_cvt_pk_bf16_f32 v191, v194, v195
    s_nop 1
    v_permlane16_swap_b32 v188, v190
    v_permlane16_swap_b32 v189, v191
    buffer_store_dwordx4 v[188:191], v17, s[24:27], s38 offen offset:0
    v_accvgpr_read_b32 v196, a40
    v_accvgpr_read_b32 v197, a41
    v_accvgpr_read_b32 v198, a42
    v_accvgpr_read_b32 v199, a43
    v_accvgpr_read_b32 v200, a44
    v_accvgpr_read_b32 v201, a45
    v_accvgpr_read_b32 v202, a46
    v_accvgpr_read_b32 v203, a47
    v_pk_mul_f32 v[196:197], v[196:197], v[222:223]
    v_pk_mul_f32 v[198:199], v[198:199], v[222:223]
    v_pk_mul_f32 v[200:201], v[200:201], v[222:223]
    v_pk_mul_f32 v[202:203], v[202:203], v[222:223]
    v_cvt_pk_bf16_f32 v196, v196, v197
    v_cvt_pk_bf16_f32 v197, v198, v199
    v_cvt_pk_bf16_f32 v198, v200, v201
    v_cvt_pk_bf16_f32 v199, v202, v203
    s_nop 1
    v_permlane16_swap_b32 v196, v198
    v_permlane16_swap_b32 v197, v199
    buffer_store_dwordx4 v[196:199], v17, s[24:27], s38 offen offset:64
    v_accvgpr_read_b32 v204, a48
    v_accvgpr_read_b32 v205, a49
    v_accvgpr_read_b32 v206, a50
    v_accvgpr_read_b32 v207, a51
    v_accvgpr_read_b32 v208, a52
    v_accvgpr_read_b32 v209, a53
    v_accvgpr_read_b32 v210, a54
    v_accvgpr_read_b32 v211, a55
    v_pk_mul_f32 v[204:205], v[204:205], v[222:223]
    v_pk_mul_f32 v[206:207], v[206:207], v[222:223]
    v_pk_mul_f32 v[208:209], v[208:209], v[222:223]
    v_pk_mul_f32 v[210:211], v[210:211], v[222:223]
    v_cvt_pk_bf16_f32 v204, v204, v205
    v_cvt_pk_bf16_f32 v205, v206, v207
    v_cvt_pk_bf16_f32 v206, v208, v209
    v_cvt_pk_bf16_f32 v207, v210, v211
    s_nop 1
    v_permlane16_swap_b32 v204, v206
    v_permlane16_swap_b32 v205, v207
    buffer_store_dwordx4 v[204:207], v17, s[24:27], s38 offen offset:128
    v_accvgpr_read_b32 v212, a56
    v_accvgpr_read_b32 v213, a57
    v_accvgpr_read_b32 v214, a58
    v_accvgpr_read_b32 v215, a59
    v_accvgpr_read_b32 v216, a60
    v_accvgpr_read_b32 v217, a61
    v_accvgpr_read_b32 v218, a62
    v_accvgpr_read_b32 v219, a63
    v_pk_mul_f32 v[212:213], v[212:213], v[222:223]
    v_pk_mul_f32 v[214:215], v[214:215], v[222:223]
    v_pk_mul_f32 v[216:217], v[216:217], v[222:223]
    v_pk_mul_f32 v[218:219], v[218:219], v[222:223]
    v_cvt_pk_bf16_f32 v212, v212, v213
    v_cvt_pk_bf16_f32 v213, v214, v215
    v_cvt_pk_bf16_f32 v214, v216, v217
    v_cvt_pk_bf16_f32 v215, v218, v219
    s_nop 1
    v_permlane16_swap_b32 v212, v214
    v_permlane16_swap_b32 v213, v215
    buffer_store_dwordx4 v[212:215], v17, s[24:27], s38 offen offset:192
    s_add_u32 s38, s32, 8192
    v_accvgpr_read_b32 v156, a64
    v_accvgpr_read_b32 v157, a65
    v_accvgpr_read_b32 v158, a66
    v_accvgpr_read_b32 v159, a67
    v_accvgpr_read_b32 v160, a68
    v_accvgpr_read_b32 v161, a69
    v_accvgpr_read_b32 v162, a70
    v_accvgpr_read_b32 v163, a71
    v_pk_mul_f32 v[156:157], v[156:157], v[224:225]
    v_pk_mul_f32 v[158:159], v[158:159], v[224:225]
    v_pk_mul_f32 v[160:161], v[160:161], v[224:225]
    v_pk_mul_f32 v[162:163], v[162:163], v[224:225]
    v_cvt_pk_bf16_f32 v156, v156, v157
    v_cvt_pk_bf16_f32 v157, v158, v159
    v_cvt_pk_bf16_f32 v158, v160, v161
    v_cvt_pk_bf16_f32 v159, v162, v163
    s_nop 1
    v_permlane16_swap_b32 v156, v158
    v_permlane16_swap_b32 v157, v159
    buffer_store_dwordx4 v[156:159], v17, s[24:27], s38 offen offset:0
    v_accvgpr_read_b32 v164, a72
    v_accvgpr_read_b32 v165, a73
    v_accvgpr_read_b32 v166, a74
    v_accvgpr_read_b32 v167, a75
    v_accvgpr_read_b32 v168, a76
    v_accvgpr_read_b32 v169, a77
    v_accvgpr_read_b32 v170, a78
    v_accvgpr_read_b32 v171, a79
    v_pk_mul_f32 v[164:165], v[164:165], v[224:225]
    v_pk_mul_f32 v[166:167], v[166:167], v[224:225]
    v_pk_mul_f32 v[168:169], v[168:169], v[224:225]
    v_pk_mul_f32 v[170:171], v[170:171], v[224:225]
    v_cvt_pk_bf16_f32 v164, v164, v165
    v_cvt_pk_bf16_f32 v165, v166, v167
    v_cvt_pk_bf16_f32 v166, v168, v169
    v_cvt_pk_bf16_f32 v167, v170, v171
    s_nop 1
    v_permlane16_swap_b32 v164, v166
    v_permlane16_swap_b32 v165, v167
    buffer_store_dwordx4 v[164:167], v17, s[24:27], s38 offen offset:64
    v_accvgpr_read_b32 v172, a80
    v_accvgpr_read_b32 v173, a81
    v_accvgpr_read_b32 v174, a82
    v_accvgpr_read_b32 v175, a83
    v_accvgpr_read_b32 v176, a84
    v_accvgpr_read_b32 v177, a85
    v_accvgpr_read_b32 v178, a86
    v_accvgpr_read_b32 v179, a87
    v_pk_mul_f32 v[172:173], v[172:173], v[224:225]
    v_pk_mul_f32 v[174:175], v[174:175], v[224:225]
    v_pk_mul_f32 v[176:177], v[176:177], v[224:225]
    v_pk_mul_f32 v[178:179], v[178:179], v[224:225]
    v_cvt_pk_bf16_f32 v172, v172, v173
    v_cvt_pk_bf16_f32 v173, v174, v175
    v_cvt_pk_bf16_f32 v174, v176, v177
    v_cvt_pk_bf16_f32 v175, v178, v179
    s_nop 1
    v_permlane16_swap_b32 v172, v174
    v_permlane16_swap_b32 v173, v175
    buffer_store_dwordx4 v[172:175], v17, s[24:27], s38 offen offset:128
    v_accvgpr_read_b32 v180, a88
    v_accvgpr_read_b32 v181, a89
    v_accvgpr_read_b32 v182, a90
    v_accvgpr_read_b32 v183, a91
    v_accvgpr_read_b32 v184, a92
    v_accvgpr_read_b32 v185, a93
    v_accvgpr_read_b32 v186, a94
    v_accvgpr_read_b32 v187, a95
    v_pk_mul_f32 v[180:181], v[180:181], v[224:225]
    v_pk_mul_f32 v[182:183], v[182:183], v[224:225]
    v_pk_mul_f32 v[184:185], v[184:185], v[224:225]
    v_pk_mul_f32 v[186:187], v[186:187], v[224:225]
    v_cvt_pk_bf16_f32 v180, v180, v181
    v_cvt_pk_bf16_f32 v181, v182, v183
    v_cvt_pk_bf16_f32 v182, v184, v185
    v_cvt_pk_bf16_f32 v183, v186, v187
    s_nop 1
    v_permlane16_swap_b32 v180, v182
    v_permlane16_swap_b32 v181, v183
    buffer_store_dwordx4 v[180:183], v17, s[24:27], s38 offen offset:192
    s_add_u32 s38, s32, 12288
    v_accvgpr_read_b32 v188, a96
    v_accvgpr_read_b32 v189, a97
    v_accvgpr_read_b32 v190, a98
    v_accvgpr_read_b32 v191, a99
    v_accvgpr_read_b32 v192, a100
    v_accvgpr_read_b32 v193, a101
    v_accvgpr_read_b32 v194, a102
    v_accvgpr_read_b32 v195, a103
    v_pk_mul_f32 v[188:189], v[188:189], v[226:227]
    v_pk_mul_f32 v[190:191], v[190:191], v[226:227]
    v_pk_mul_f32 v[192:193], v[192:193], v[226:227]
    v_pk_mul_f32 v[194:195], v[194:195], v[226:227]
    v_cvt_pk_bf16_f32 v188, v188, v189
    v_cvt_pk_bf16_f32 v189, v190, v191
    v_cvt_pk_bf16_f32 v190, v192, v193
    v_cvt_pk_bf16_f32 v191, v194, v195
    s_nop 1
    v_permlane16_swap_b32 v188, v190
    v_permlane16_swap_b32 v189, v191
    buffer_store_dwordx4 v[188:191], v17, s[24:27], s38 offen offset:0
    v_accvgpr_read_b32 v196, a104
    v_accvgpr_read_b32 v197, a105
    v_accvgpr_read_b32 v198, a106
    v_accvgpr_read_b32 v199, a107
    v_accvgpr_read_b32 v200, a108
    v_accvgpr_read_b32 v201, a109
    v_accvgpr_read_b32 v202, a110
    v_accvgpr_read_b32 v203, a111
    v_pk_mul_f32 v[196:197], v[196:197], v[226:227]
    v_pk_mul_f32 v[198:199], v[198:199], v[226:227]
    v_pk_mul_f32 v[200:201], v[200:201], v[226:227]
    v_pk_mul_f32 v[202:203], v[202:203], v[226:227]
    v_cvt_pk_bf16_f32 v196, v196, v197
    v_cvt_pk_bf16_f32 v197, v198, v199
    v_cvt_pk_bf16_f32 v198, v200, v201
    v_cvt_pk_bf16_f32 v199, v202, v203
    s_nop 1
    v_permlane16_swap_b32 v196, v198
    v_permlane16_swap_b32 v197, v199
    buffer_store_dwordx4 v[196:199], v17, s[24:27], s38 offen offset:64
    v_accvgpr_read_b32 v204, a112
    v_accvgpr_read_b32 v205, a113
    v_accvgpr_read_b32 v206, a114
    v_accvgpr_read_b32 v207, a115
    v_accvgpr_read_b32 v208, a116
    v_accvgpr_read_b32 v209, a117
    v_accvgpr_read_b32 v210, a118
    v_accvgpr_read_b32 v211, a119
    v_pk_mul_f32 v[204:205], v[204:205], v[226:227]
    v_pk_mul_f32 v[206:207], v[206:207], v[226:227]
    v_pk_mul_f32 v[208:209], v[208:209], v[226:227]
    v_pk_mul_f32 v[210:211], v[210:211], v[226:227]
    v_cvt_pk_bf16_f32 v204, v204, v205
    v_cvt_pk_bf16_f32 v205, v206, v207
    v_cvt_pk_bf16_f32 v206, v208, v209
    v_cvt_pk_bf16_f32 v207, v210, v211
    s_nop 1
    v_permlane16_swap_b32 v204, v206
    v_permlane16_swap_b32 v205, v207
    buffer_store_dwordx4 v[204:207], v17, s[24:27], s38 offen offset:128
    v_accvgpr_read_b32 v212, a120
    v_accvgpr_read_b32 v213, a121
    v_accvgpr_read_b32 v214, a122
    v_accvgpr_read_b32 v215, a123
    v_accvgpr_read_b32 v216, a124
    v_accvgpr_read_b32 v217, a125
    v_accvgpr_read_b32 v218, a126
    v_accvgpr_read_b32 v219, a127
    v_pk_mul_f32 v[212:213], v[212:213], v[226:227]
    v_pk_mul_f32 v[214:215], v[214:215], v[226:227]
    v_pk_mul_f32 v[216:217], v[216:217], v[226:227]
    v_pk_mul_f32 v[218:219], v[218:219], v[226:227]
    v_cvt_pk_bf16_f32 v212, v212, v213
    v_cvt_pk_bf16_f32 v213, v214, v215
    v_cvt_pk_bf16_f32 v214, v216, v217
    v_cvt_pk_bf16_f32 v215, v218, v219
    s_nop 1
    v_permlane16_swap_b32 v212, v214
    v_permlane16_swap_b32 v213, v215
    buffer_store_dwordx4 v[212:215], v17, s[24:27], s38 offen offset:192
    s_add_u32 s38, s32, 16384
    v_accvgpr_read_b32 v156, a128
    v_accvgpr_read_b32 v157, a129
    v_accvgpr_read_b32 v158, a130
    v_accvgpr_read_b32 v159, a131
    v_accvgpr_read_b32 v160, a132
    v_accvgpr_read_b32 v161, a133
    v_accvgpr_read_b32 v162, a134
    v_accvgpr_read_b32 v163, a135
    v_pk_mul_f32 v[156:157], v[156:157], v[228:229]
    v_pk_mul_f32 v[158:159], v[158:159], v[228:229]
    v_pk_mul_f32 v[160:161], v[160:161], v[228:229]
    v_pk_mul_f32 v[162:163], v[162:163], v[228:229]
    v_cvt_pk_bf16_f32 v156, v156, v157
    v_cvt_pk_bf16_f32 v157, v158, v159
    v_cvt_pk_bf16_f32 v158, v160, v161
    v_cvt_pk_bf16_f32 v159, v162, v163
    s_nop 1
    v_permlane16_swap_b32 v156, v158
    v_permlane16_swap_b32 v157, v159
    buffer_store_dwordx4 v[156:159], v17, s[24:27], s38 offen offset:0
    v_accvgpr_read_b32 v164, a136
    v_accvgpr_read_b32 v165, a137
    v_accvgpr_read_b32 v166, a138
    v_accvgpr_read_b32 v167, a139
    v_accvgpr_read_b32 v168, a140
    v_accvgpr_read_b32 v169, a141
    v_accvgpr_read_b32 v170, a142
    v_accvgpr_read_b32 v171, a143
    v_pk_mul_f32 v[164:165], v[164:165], v[228:229]
    v_pk_mul_f32 v[166:167], v[166:167], v[228:229]
    v_pk_mul_f32 v[168:169], v[168:169], v[228:229]
    v_pk_mul_f32 v[170:171], v[170:171], v[228:229]
    v_cvt_pk_bf16_f32 v164, v164, v165
    v_cvt_pk_bf16_f32 v165, v166, v167
    v_cvt_pk_bf16_f32 v166, v168, v169
    v_cvt_pk_bf16_f32 v167, v170, v171
    s_nop 1
    v_permlane16_swap_b32 v164, v166
    v_permlane16_swap_b32 v165, v167
    buffer_store_dwordx4 v[164:167], v17, s[24:27], s38 offen offset:64
    v_accvgpr_read_b32 v172, a144
    v_accvgpr_read_b32 v173, a145
    v_accvgpr_read_b32 v174, a146
    v_accvgpr_read_b32 v175, a147
    v_accvgpr_read_b32 v176, a148
    v_accvgpr_read_b32 v177, a149
    v_accvgpr_read_b32 v178, a150
    v_accvgpr_read_b32 v179, a151
    v_pk_mul_f32 v[172:173], v[172:173], v[228:229]
    v_pk_mul_f32 v[174:175], v[174:175], v[228:229]
    v_pk_mul_f32 v[176:177], v[176:177], v[228:229]
    v_pk_mul_f32 v[178:179], v[178:179], v[228:229]
    v_cvt_pk_bf16_f32 v172, v172, v173
    v_cvt_pk_bf16_f32 v173, v174, v175
    v_cvt_pk_bf16_f32 v174, v176, v177
    v_cvt_pk_bf16_f32 v175, v178, v179
    s_nop 1
    v_permlane16_swap_b32 v172, v174
    v_permlane16_swap_b32 v173, v175
    buffer_store_dwordx4 v[172:175], v17, s[24:27], s38 offen offset:128
    v_accvgpr_read_b32 v180, a152
    v_accvgpr_read_b32 v181, a153
    v_accvgpr_read_b32 v182, a154
    v_accvgpr_read_b32 v183, a155
    v_accvgpr_read_b32 v184, a156
    v_accvgpr_read_b32 v185, a157
    v_accvgpr_read_b32 v186, a158
    v_accvgpr_read_b32 v187, a159
    v_pk_mul_f32 v[180:181], v[180:181], v[228:229]
    v_pk_mul_f32 v[182:183], v[182:183], v[228:229]
    v_pk_mul_f32 v[184:185], v[184:185], v[228:229]
    v_pk_mul_f32 v[186:187], v[186:187], v[228:229]
    v_cvt_pk_bf16_f32 v180, v180, v181
    v_cvt_pk_bf16_f32 v181, v182, v183
    v_cvt_pk_bf16_f32 v182, v184, v185
    v_cvt_pk_bf16_f32 v183, v186, v187
    s_nop 1
    v_permlane16_swap_b32 v180, v182
    v_permlane16_swap_b32 v181, v183
    buffer_store_dwordx4 v[180:183], v17, s[24:27], s38 offen offset:192
    s_endpgm
L_c5_fallback:
    s_waitcnt vmcnt(0)
    s_waitcnt lgkmcnt(0)
    s_barrier
    s_mov_b32 s33, s30
    s_mov_b32 s35, 0
    v_mov_b32 v24, 0xff800000
    v_mov_b32 v28, 0xff800000
    v_mov_b32 v32, 0xff800000
    v_mov_b32 v36, 0xff800000
    v_mov_b32 v40, 0xff800000
    v_mfma_f32_32x32x16_bf16 a[0:15], v[252:255], v[252:255], 0
    v_mfma_f32_32x32x16_bf16 a[16:31], v[252:255], v[252:255], 0
    v_mfma_f32_32x32x16_bf16 a[32:47], v[252:255], v[252:255], 0
    v_mfma_f32_32x32x16_bf16 a[48:63], v[252:255], v[252:255], 0
    v_mfma_f32_32x32x16_bf16 a[64:79], v[252:255], v[252:255], 0
    v_mfma_f32_32x32x16_bf16 a[80:95], v[252:255], v[252:255], 0
    v_mfma_f32_32x32x16_bf16 a[96:111], v[252:255], v[252:255], 0
    v_mfma_f32_32x32x16_bf16 a[112:127], v[252:255], v[252:255], 0
    v_mfma_f32_32x32x16_bf16 a[128:143], v[252:255], v[252:255], 0
    v_mfma_f32_32x32x16_bf16 a[144:159], v[252:255], v[252:255], 0
    v_mfma_f32_32x32x16_bf16 a[240:255], v[252:255], v[252:255], 0
    v_mov_b32 v20, 0
    v_mov_b32 v21, 0
    v_mov_b32 v22, 0
    v_mov_b32 v23, 0
L_c5_fbloop:
    s_add_u32 m0, s34, 0
    s_nop 0
    buffer_load_dwordx4 v1, s[16:19], s33 offen lds
    buffer_load_dwordx4 v2, s[16:19], s33 offen offset:1024 lds
    s_add_u32 m0, s34, 65536
    s_nop 0
    buffer_load_dwordx4 v1, s[20:23], s33 offen lds
    buffer_load_dwordx4 v2, s[20:23], s33 offen offset:1024 lds
    s_add_u32 s33, s33, 8192
    s_waitcnt vmcnt(0)
    s_barrier
    ds_read_b128 v[44:47], v4 offset:0
    ds_read_b128 v[48:51], v5 offset:0
    ds_read_b128 v[52:55], v6 offset:0
    s_waitcnt lgkmcnt(2)
    v_mfma_f32_16x16x32_bf16 v[76:79], v[44:47], a[160:163], 0
    ds_read_b128 v[56:59], v7 offset:0
    v_mfma_f32_16x16x32_bf16 v[84:87], v[44:47], a[176:179], 0
    v_mfma_f32_16x16x32_bf16 v[92:95], v[44:47], a[192:195], 0
    v_mfma_f32_16x16x32_bf16 v[100:103], v[44:47], a[208:211], 0
    v_mfma_f32_16x16x32_bf16 v[108:111], v[44:47], a[224:227], 0
    s_waitcnt lgkmcnt(2)
    v_mfma_f32_16x16x32_bf16 v[76:79], v[48:51], a[164:167], v[76:79]
    ds_read_b128 v[60:63], v4 offset:4096
    v_mfma_f32_16x16x32_bf16 v[84:87], v[48:51], a[180:183], v[84:87]
    v_mfma_f32_16x16x32_bf16 v[92:95], v[48:51], a[196:199], v[92:95]
    v_mfma_f32_16x16x32_bf16 v[100:103], v[48:51], a[212:215], v[100:103]
    v_mfma_f32_16x16x32_bf16 v[108:111], v[48:51], a[228:231], v[108:111]
    s_waitcnt lgkmcnt(2)
    v_mfma_f32_16x16x32_bf16 v[76:79], v[52:55], a[168:171], v[76:79]
    ds_read_b128 v[64:67], v5 offset:4096
    v_mfma_f32_16x16x32_bf16 v[84:87], v[52:55], a[184:187], v[84:87]
    v_mfma_f32_16x16x32_bf16 v[92:95], v[52:55], a[200:203], v[92:95]
    v_mfma_f32_16x16x32_bf16 v[100:103], v[52:55], a[216:219], v[100:103]
    v_mfma_f32_16x16x32_bf16 v[108:111], v[52:55], a[232:235], v[108:111]
    s_waitcnt lgkmcnt(2)
    v_mfma_f32_16x16x32_bf16 v[76:79], v[56:59], a[172:175], v[76:79]
    ds_read_b128 v[68:71], v6 offset:4096
    v_mfma_f32_16x16x32_bf16 v[84:87], v[56:59], a[188:191], v[84:87]
    v_mfma_f32_16x16x32_bf16 v[92:95], v[56:59], a[204:207], v[92:95]
    v_mfma_f32_16x16x32_bf16 v[100:103], v[56:59], a[220:223], v[100:103]
    v_mfma_f32_16x16x32_bf16 v[108:111], v[56:59], a[236:239], v[108:111]
    s_waitcnt lgkmcnt(2)
    v_mfma_f32_16x16x32_bf16 v[80:83], v[60:63], a[160:163], 0
    ds_read_b128 v[72:75], v7 offset:4096
    v_mfma_f32_16x16x32_bf16 v[88:91], v[60:63], a[176:179], 0
    v_mfma_f32_16x16x32_bf16 v[96:99], v[60:63], a[192:195], 0
    v_mfma_f32_16x16x32_bf16 v[104:107], v[60:63], a[208:211], 0
    v_mfma_f32_16x16x32_bf16 v[112:115], v[60:63], a[224:227], 0
    s_waitcnt lgkmcnt(2)
    v_mfma_f32_16x16x32_bf16 v[80:83], v[64:67], a[164:167], v[80:83]
    v_mfma_f32_16x16x32_bf16 v[88:91], v[64:67], a[180:183], v[88:91]
    v_mfma_f32_16x16x32_bf16 v[96:99], v[64:67], a[196:199], v[96:99]
    v_mfma_f32_16x16x32_bf16 v[104:107], v[64:67], a[212:215], v[104:107]
    v_mfma_f32_16x16x32_bf16 v[112:115], v[64:67], a[228:231], v[112:115]
    s_waitcnt lgkmcnt(1)
    v_mfma_f32_16x16x32_bf16 v[80:83], v[68:71], a[168:171], v[80:83]
    v_mfma_f32_16x16x32_bf16 v[88:91], v[68:71], a[184:187], v[88:91]
    v_mfma_f32_16x16x32_bf16 v[96:99], v[68:71], a[200:203], v[96:99]
    v_mfma_f32_16x16x32_bf16 v[104:107], v[68:71], a[216:219], v[104:107]
    v_mfma_f32_16x16x32_bf16 v[112:115], v[68:71], a[232:235], v[112:115]
    s_waitcnt lgkmcnt(0)
    v_mfma_f32_16x16x32_bf16 v[80:83], v[72:75], a[172:175], v[80:83]
    v_mfma_f32_16x16x32_bf16 v[88:91], v[72:75], a[188:191], v[88:91]
    v_mfma_f32_16x16x32_bf16 v[96:99], v[72:75], a[204:207], v[96:99]
    v_mfma_f32_16x16x32_bf16 v[104:107], v[72:75], a[220:223], v[104:107]
    v_mfma_f32_16x16x32_bf16 v[112:115], v[72:75], a[236:239], v[112:115]
    s_nop 7
    v_max3_f32 v236, v76, v77, v78
    v_max3_f32 v237, v79, v80, v81
    v_max3_f32 v236, v236, v82, v83
    v_max_f32 v236, v236, v237
    v_max3_f32 v238, v84, v85, v86
    v_max3_f32 v239, v87, v88, v89
    v_max3_f32 v238, v238, v90, v91
    v_max_f32 v238, v238, v239
    v_max3_f32 v240, v92, v93, v94
    v_max3_f32 v241, v95, v96, v97
    v_max3_f32 v240, v240, v98, v99
    v_max_f32 v240, v240, v241
    v_max3_f32 v242, v100, v101, v102
    v_max3_f32 v243, v103, v104, v105
    v_max3_f32 v242, v242, v106, v107
    v_max_f32 v242, v242, v243
    v_max3_f32 v244, v108, v109, v110
    v_max3_f32 v245, v111, v112, v113
    v_max3_f32 v244, v244, v114, v115
    v_max_f32 v244, v244, v245
    v_mov_b32 v237, v236
    v_mov_b32 v239, v238
    v_mov_b32 v241, v240
    v_mov_b32 v243, v242
    v_mov_b32 v245, v244
    s_nop 1
    v_permlane16_swap_b32 v236, v237
    v_permlane16_swap_b32 v238, v239
    v_permlane16_swap_b32 v240, v241
    v_permlane16_swap_b32 v242, v243
    v_permlane16_swap_b32 v244, v245
    v_max_f32 v236, v236, v237
    v_mov_b32 v237, v236
    v_max_f32 v238, v238, v239
    v_mov_b32 v239, v238
    v_max_f32 v240, v240, v241
    v_mov_b32 v241, v240
    v_max_f32 v242, v242, v243
    v_mov_b32 v243, v242
    v_max_f32 v244, v244, v245
    v_mov_b32 v245, v244
    s_nop 1
    v_permlane32_swap_b32 v236, v237
    v_permlane32_swap_b32 v238, v239
    v_permlane32_swap_b32 v240, v241
    v_permlane32_swap_b32 v242, v243
    v_permlane32_swap_b32 v244, v245
    v_max_f32 v236, v236, v237
    v_max_f32 v238, v238, v239
    v_max_f32 v240, v240, v241
    v_max_f32 v242, v242, v243
    v_max_f32 v244, v244, v245
    v_max_f32 v236, v236, v24
    v_sub_f32 v25, v24, v236
    v_exp_f32 v25, v25
    v_mov_b32 v24, v236
    v_accvgpr_read_b32 v116, a240
    v_mul_f32 v116, v116, v25
    v_accvgpr_write_b32 a240, v116
    v_accvgpr_read_b32 v117, a241
    v_mul_f32 v117, v117, v25
    v_accvgpr_write_b32 a241, v117
    v_accvgpr_read_b32 v118, a242
    v_mul_f32 v118, v118, v25
    v_accvgpr_write_b32 a242, v118
    v_accvgpr_read_b32 v119, a243
    v_mul_f32 v119, v119, v25
    v_accvgpr_write_b32 a243, v119
    v_accvgpr_read_b32 v116, a0
    v_mul_f32 v116, v116, v25
    v_accvgpr_write_b32 a0, v116
    v_accvgpr_read_b32 v117, a1
    v_mul_f32 v117, v117, v25
    v_accvgpr_write_b32 a1, v117
    v_accvgpr_read_b32 v118, a2
    v_mul_f32 v118, v118, v25
    v_accvgpr_write_b32 a2, v118
    v_accvgpr_read_b32 v119, a3
    v_mul_f32 v119, v119, v25
    v_accvgpr_write_b32 a3, v119
    v_accvgpr_read_b32 v120, a4
    v_mul_f32 v120, v120, v25
    v_accvgpr_write_b32 a4, v120
    v_accvgpr_read_b32 v121, a5
    v_mul_f32 v121, v121, v25
    v_accvgpr_write_b32 a5, v121
    v_accvgpr_read_b32 v122, a6
    v_mul_f32 v122, v122, v25
    v_accvgpr_write_b32 a6, v122
    v_accvgpr_read_b32 v123, a7
    v_mul_f32 v123, v123, v25
    v_accvgpr_write_b32 a7, v123
    v_accvgpr_read_b32 v124, a8
    v_mul_f32 v124, v124, v25
    v_accvgpr_write_b32 a8, v124
    v_accvgpr_read_b32 v125, a9
    v_mul_f32 v125, v125, v25
    v_accvgpr_write_b32 a9, v125
    v_accvgpr_read_b32 v126, a10
    v_mul_f32 v126, v126, v25
    v_accvgpr_write_b32 a10, v126
    v_accvgpr_read_b32 v127, a11
    v_mul_f32 v127, v127, v25
    v_accvgpr_write_b32 a11, v127
    v_accvgpr_read_b32 v128, a12
    v_mul_f32 v128, v128, v25
    v_accvgpr_write_b32 a12, v128
    v_accvgpr_read_b32 v129, a13
    v_mul_f32 v129, v129, v25
    v_accvgpr_write_b32 a13, v129
    v_accvgpr_read_b32 v130, a14
    v_mul_f32 v130, v130, v25
    v_accvgpr_write_b32 a14, v130
    v_accvgpr_read_b32 v131, a15
    v_mul_f32 v131, v131, v25
    v_accvgpr_write_b32 a15, v131
    v_accvgpr_read_b32 v132, a16
    v_mul_f32 v132, v132, v25
    v_accvgpr_write_b32 a16, v132
    v_accvgpr_read_b32 v133, a17
    v_mul_f32 v133, v133, v25
    v_accvgpr_write_b32 a17, v133
    v_accvgpr_read_b32 v134, a18
    v_mul_f32 v134, v134, v25
    v_accvgpr_write_b32 a18, v134
    v_accvgpr_read_b32 v135, a19
    v_mul_f32 v135, v135, v25
    v_accvgpr_write_b32 a19, v135
    v_accvgpr_read_b32 v136, a20
    v_mul_f32 v136, v136, v25
    v_accvgpr_write_b32 a20, v136
    v_accvgpr_read_b32 v137, a21
    v_mul_f32 v137, v137, v25
    v_accvgpr_write_b32 a21, v137
    v_accvgpr_read_b32 v138, a22
    v_mul_f32 v138, v138, v25
    v_accvgpr_write_b32 a22, v138
    v_accvgpr_read_b32 v139, a23
    v_mul_f32 v139, v139, v25
    v_accvgpr_write_b32 a23, v139
    v_accvgpr_read_b32 v140, a24
    v_mul_f32 v140, v140, v25
    v_accvgpr_write_b32 a24, v140
    v_accvgpr_read_b32 v141, a25
    v_mul_f32 v141, v141, v25
    v_accvgpr_write_b32 a25, v141
    v_accvgpr_read_b32 v142, a26
    v_mul_f32 v142, v142, v25
    v_accvgpr_write_b32 a26, v142
    v_accvgpr_read_b32 v143, a27
    v_mul_f32 v143, v143, v25
    v_accvgpr_write_b32 a27, v143
    v_accvgpr_read_b32 v144, a28
    v_mul_f32 v144, v144, v25
    v_accvgpr_write_b32 a28, v144
    v_accvgpr_read_b32 v145, a29
    v_mul_f32 v145, v145, v25
    v_accvgpr_write_b32 a29, v145
    v_accvgpr_read_b32 v146, a30
    v_mul_f32 v146, v146, v25
    v_accvgpr_write_b32 a30, v146
    v_accvgpr_read_b32 v147, a31
    v_mul_f32 v147, v147, v25
    v_accvgpr_write_b32 a31, v147
    v_sub_f32 v76, v76, v236
    v_sub_f32 v77, v77, v236
    v_sub_f32 v78, v78, v236
    v_sub_f32 v79, v79, v236
    v_sub_f32 v80, v80, v236
    v_sub_f32 v81, v81, v236
    v_sub_f32 v82, v82, v236
    v_sub_f32 v83, v83, v236
    v_max_f32 v238, v238, v28
    v_sub_f32 v29, v28, v238
    v_exp_f32 v29, v29
    v_mov_b32 v28, v238
    v_accvgpr_read_b32 v116, a244
    v_mul_f32 v116, v116, v29
    v_accvgpr_write_b32 a244, v116
    v_accvgpr_read_b32 v117, a245
    v_mul_f32 v117, v117, v29
    v_accvgpr_write_b32 a245, v117
    v_accvgpr_read_b32 v118, a246
    v_mul_f32 v118, v118, v29
    v_accvgpr_write_b32 a246, v118
    v_accvgpr_read_b32 v119, a247
    v_mul_f32 v119, v119, v29
    v_accvgpr_write_b32 a247, v119
    v_accvgpr_read_b32 v116, a32
    v_mul_f32 v116, v116, v29
    v_accvgpr_write_b32 a32, v116
    v_accvgpr_read_b32 v117, a33
    v_mul_f32 v117, v117, v29
    v_accvgpr_write_b32 a33, v117
    v_accvgpr_read_b32 v118, a34
    v_mul_f32 v118, v118, v29
    v_accvgpr_write_b32 a34, v118
    v_accvgpr_read_b32 v119, a35
    v_mul_f32 v119, v119, v29
    v_accvgpr_write_b32 a35, v119
    v_accvgpr_read_b32 v120, a36
    v_mul_f32 v120, v120, v29
    v_accvgpr_write_b32 a36, v120
    v_accvgpr_read_b32 v121, a37
    v_mul_f32 v121, v121, v29
    v_accvgpr_write_b32 a37, v121
    v_accvgpr_read_b32 v122, a38
    v_mul_f32 v122, v122, v29
    v_accvgpr_write_b32 a38, v122
    v_accvgpr_read_b32 v123, a39
    v_mul_f32 v123, v123, v29
    v_accvgpr_write_b32 a39, v123
    v_accvgpr_read_b32 v124, a40
    v_mul_f32 v124, v124, v29
    v_accvgpr_write_b32 a40, v124
    v_accvgpr_read_b32 v125, a41
    v_mul_f32 v125, v125, v29
    v_accvgpr_write_b32 a41, v125
    v_accvgpr_read_b32 v126, a42
    v_mul_f32 v126, v126, v29
    v_accvgpr_write_b32 a42, v126
    v_accvgpr_read_b32 v127, a43
    v_mul_f32 v127, v127, v29
    v_accvgpr_write_b32 a43, v127
    v_accvgpr_read_b32 v128, a44
    v_mul_f32 v128, v128, v29
    v_accvgpr_write_b32 a44, v128
    v_accvgpr_read_b32 v129, a45
    v_mul_f32 v129, v129, v29
    v_accvgpr_write_b32 a45, v129
    v_accvgpr_read_b32 v130, a46
    v_mul_f32 v130, v130, v29
    v_accvgpr_write_b32 a46, v130
    v_accvgpr_read_b32 v131, a47
    v_mul_f32 v131, v131, v29
    v_accvgpr_write_b32 a47, v131
    v_accvgpr_read_b32 v132, a48
    v_mul_f32 v132, v132, v29
    v_accvgpr_write_b32 a48, v132
    v_accvgpr_read_b32 v133, a49
    v_mul_f32 v133, v133, v29
    v_accvgpr_write_b32 a49, v133
    v_accvgpr_read_b32 v134, a50
    v_mul_f32 v134, v134, v29
    v_accvgpr_write_b32 a50, v134
    v_accvgpr_read_b32 v135, a51
    v_mul_f32 v135, v135, v29
    v_accvgpr_write_b32 a51, v135
    v_accvgpr_read_b32 v136, a52
    v_mul_f32 v136, v136, v29
    v_accvgpr_write_b32 a52, v136
    v_accvgpr_read_b32 v137, a53
    v_mul_f32 v137, v137, v29
    v_accvgpr_write_b32 a53, v137
    v_accvgpr_read_b32 v138, a54
    v_mul_f32 v138, v138, v29
    v_accvgpr_write_b32 a54, v138
    v_accvgpr_read_b32 v139, a55
    v_mul_f32 v139, v139, v29
    v_accvgpr_write_b32 a55, v139
    v_accvgpr_read_b32 v140, a56
    v_mul_f32 v140, v140, v29
    v_accvgpr_write_b32 a56, v140
    v_accvgpr_read_b32 v141, a57
    v_mul_f32 v141, v141, v29
    v_accvgpr_write_b32 a57, v141
    v_accvgpr_read_b32 v142, a58
    v_mul_f32 v142, v142, v29
    v_accvgpr_write_b32 a58, v142
    v_accvgpr_read_b32 v143, a59
    v_mul_f32 v143, v143, v29
    v_accvgpr_write_b32 a59, v143
    v_accvgpr_read_b32 v144, a60
    v_mul_f32 v144, v144, v29
    v_accvgpr_write_b32 a60, v144
    v_accvgpr_read_b32 v145, a61
    v_mul_f32 v145, v145, v29
    v_accvgpr_write_b32 a61, v145
    v_accvgpr_read_b32 v146, a62
    v_mul_f32 v146, v146, v29
    v_accvgpr_write_b32 a62, v146
    v_accvgpr_read_b32 v147, a63
    v_mul_f32 v147, v147, v29
    v_accvgpr_write_b32 a63, v147
    v_sub_f32 v84, v84, v238
    v_sub_f32 v85, v85, v238
    v_sub_f32 v86, v86, v238
    v_sub_f32 v87, v87, v238
    v_sub_f32 v88, v88, v238
    v_sub_f32 v89, v89, v238
    v_sub_f32 v90, v90, v238
    v_sub_f32 v91, v91, v238
    v_max_f32 v240, v240, v32
    v_sub_f32 v33, v32, v240
    v_exp_f32 v33, v33
    v_mov_b32 v32, v240
    v_accvgpr_read_b32 v116, a248
    v_mul_f32 v116, v116, v33
    v_accvgpr_write_b32 a248, v116
    v_accvgpr_read_b32 v117, a249
    v_mul_f32 v117, v117, v33
    v_accvgpr_write_b32 a249, v117
    v_accvgpr_read_b32 v118, a250
    v_mul_f32 v118, v118, v33
    v_accvgpr_write_b32 a250, v118
    v_accvgpr_read_b32 v119, a251
    v_mul_f32 v119, v119, v33
    v_accvgpr_write_b32 a251, v119
    v_accvgpr_read_b32 v116, a64
    v_mul_f32 v116, v116, v33
    v_accvgpr_write_b32 a64, v116
    v_accvgpr_read_b32 v117, a65
    v_mul_f32 v117, v117, v33
    v_accvgpr_write_b32 a65, v117
    v_accvgpr_read_b32 v118, a66
    v_mul_f32 v118, v118, v33
    v_accvgpr_write_b32 a66, v118
    v_accvgpr_read_b32 v119, a67
    v_mul_f32 v119, v119, v33
    v_accvgpr_write_b32 a67, v119
    v_accvgpr_read_b32 v120, a68
    v_mul_f32 v120, v120, v33
    v_accvgpr_write_b32 a68, v120
    v_accvgpr_read_b32 v121, a69
    v_mul_f32 v121, v121, v33
    v_accvgpr_write_b32 a69, v121
    v_accvgpr_read_b32 v122, a70
    v_mul_f32 v122, v122, v33
    v_accvgpr_write_b32 a70, v122
    v_accvgpr_read_b32 v123, a71
    v_mul_f32 v123, v123, v33
    v_accvgpr_write_b32 a71, v123
    v_accvgpr_read_b32 v124, a72
    v_mul_f32 v124, v124, v33
    v_accvgpr_write_b32 a72, v124
    v_accvgpr_read_b32 v125, a73
    v_mul_f32 v125, v125, v33
    v_accvgpr_write_b32 a73, v125
    v_accvgpr_read_b32 v126, a74
    v_mul_f32 v126, v126, v33
    v_accvgpr_write_b32 a74, v126
    v_accvgpr_read_b32 v127, a75
    v_mul_f32 v127, v127, v33
    v_accvgpr_write_b32 a75, v127
    v_accvgpr_read_b32 v128, a76
    v_mul_f32 v128, v128, v33
    v_accvgpr_write_b32 a76, v128
    v_accvgpr_read_b32 v129, a77
    v_mul_f32 v129, v129, v33
    v_accvgpr_write_b32 a77, v129
    v_accvgpr_read_b32 v130, a78
    v_mul_f32 v130, v130, v33
    v_accvgpr_write_b32 a78, v130
    v_accvgpr_read_b32 v131, a79
    v_mul_f32 v131, v131, v33
    v_accvgpr_write_b32 a79, v131
    v_accvgpr_read_b32 v132, a80
    v_mul_f32 v132, v132, v33
    v_accvgpr_write_b32 a80, v132
    v_accvgpr_read_b32 v133, a81
    v_mul_f32 v133, v133, v33
    v_accvgpr_write_b32 a81, v133
    v_accvgpr_read_b32 v134, a82
    v_mul_f32 v134, v134, v33
    v_accvgpr_write_b32 a82, v134
    v_accvgpr_read_b32 v135, a83
    v_mul_f32 v135, v135, v33
    v_accvgpr_write_b32 a83, v135
    v_accvgpr_read_b32 v136, a84
    v_mul_f32 v136, v136, v33
    v_accvgpr_write_b32 a84, v136
    v_accvgpr_read_b32 v137, a85
    v_mul_f32 v137, v137, v33
    v_accvgpr_write_b32 a85, v137
    v_accvgpr_read_b32 v138, a86
    v_mul_f32 v138, v138, v33
    v_accvgpr_write_b32 a86, v138
    v_accvgpr_read_b32 v139, a87
    v_mul_f32 v139, v139, v33
    v_accvgpr_write_b32 a87, v139
    v_accvgpr_read_b32 v140, a88
    v_mul_f32 v140, v140, v33
    v_accvgpr_write_b32 a88, v140
    v_accvgpr_read_b32 v141, a89
    v_mul_f32 v141, v141, v33
    v_accvgpr_write_b32 a89, v141
    v_accvgpr_read_b32 v142, a90
    v_mul_f32 v142, v142, v33
    v_accvgpr_write_b32 a90, v142
    v_accvgpr_read_b32 v143, a91
    v_mul_f32 v143, v143, v33
    v_accvgpr_write_b32 a91, v143
    v_accvgpr_read_b32 v144, a92
    v_mul_f32 v144, v144, v33
    v_accvgpr_write_b32 a92, v144
    v_accvgpr_read_b32 v145, a93
    v_mul_f32 v145, v145, v33
    v_accvgpr_write_b32 a93, v145
    v_accvgpr_read_b32 v146, a94
    v_mul_f32 v146, v146, v33
    v_accvgpr_write_b32 a94, v146
    v_accvgpr_read_b32 v147, a95
    v_mul_f32 v147, v147, v33
    v_accvgpr_write_b32 a95, v147
    v_sub_f32 v92, v92, v240
    v_sub_f32 v93, v93, v240
    v_sub_f32 v94, v94, v240
    v_sub_f32 v95, v95, v240
    v_sub_f32 v96, v96, v240
    v_sub_f32 v97, v97, v240
    v_sub_f32 v98, v98, v240
    v_sub_f32 v99, v99, v240
    v_max_f32 v242, v242, v36
    v_sub_f32 v37, v36, v242
    v_exp_f32 v37, v37
    v_mov_b32 v36, v242
    v_accvgpr_read_b32 v116, a252
    v_mul_f32 v116, v116, v37
    v_accvgpr_write_b32 a252, v116
    v_accvgpr_read_b32 v117, a253
    v_mul_f32 v117, v117, v37
    v_accvgpr_write_b32 a253, v117
    v_accvgpr_read_b32 v118, a254
    v_mul_f32 v118, v118, v37
    v_accvgpr_write_b32 a254, v118
    v_accvgpr_read_b32 v119, a255
    v_mul_f32 v119, v119, v37
    v_accvgpr_write_b32 a255, v119
    v_accvgpr_read_b32 v116, a96
    v_mul_f32 v116, v116, v37
    v_accvgpr_write_b32 a96, v116
    v_accvgpr_read_b32 v117, a97
    v_mul_f32 v117, v117, v37
    v_accvgpr_write_b32 a97, v117
    v_accvgpr_read_b32 v118, a98
    v_mul_f32 v118, v118, v37
    v_accvgpr_write_b32 a98, v118
    v_accvgpr_read_b32 v119, a99
    v_mul_f32 v119, v119, v37
    v_accvgpr_write_b32 a99, v119
    v_accvgpr_read_b32 v120, a100
    v_mul_f32 v120, v120, v37
    v_accvgpr_write_b32 a100, v120
    v_accvgpr_read_b32 v121, a101
    v_mul_f32 v121, v121, v37
    v_accvgpr_write_b32 a101, v121
    v_accvgpr_read_b32 v122, a102
    v_mul_f32 v122, v122, v37
    v_accvgpr_write_b32 a102, v122
    v_accvgpr_read_b32 v123, a103
    v_mul_f32 v123, v123, v37
    v_accvgpr_write_b32 a103, v123
    v_accvgpr_read_b32 v124, a104
    v_mul_f32 v124, v124, v37
    v_accvgpr_write_b32 a104, v124
    v_accvgpr_read_b32 v125, a105
    v_mul_f32 v125, v125, v37
    v_accvgpr_write_b32 a105, v125
    v_accvgpr_read_b32 v126, a106
    v_mul_f32 v126, v126, v37
    v_accvgpr_write_b32 a106, v126
    v_accvgpr_read_b32 v127, a107
    v_mul_f32 v127, v127, v37
    v_accvgpr_write_b32 a107, v127
    v_accvgpr_read_b32 v128, a108
    v_mul_f32 v128, v128, v37
    v_accvgpr_write_b32 a108, v128
    v_accvgpr_read_b32 v129, a109
    v_mul_f32 v129, v129, v37
    v_accvgpr_write_b32 a109, v129
    v_accvgpr_read_b32 v130, a110
    v_mul_f32 v130, v130, v37
    v_accvgpr_write_b32 a110, v130
    v_accvgpr_read_b32 v131, a111
    v_mul_f32 v131, v131, v37
    v_accvgpr_write_b32 a111, v131
    v_accvgpr_read_b32 v132, a112
    v_mul_f32 v132, v132, v37
    v_accvgpr_write_b32 a112, v132
    v_accvgpr_read_b32 v133, a113
    v_mul_f32 v133, v133, v37
    v_accvgpr_write_b32 a113, v133
    v_accvgpr_read_b32 v134, a114
    v_mul_f32 v134, v134, v37
    v_accvgpr_write_b32 a114, v134
    v_accvgpr_read_b32 v135, a115
    v_mul_f32 v135, v135, v37
    v_accvgpr_write_b32 a115, v135
    v_accvgpr_read_b32 v136, a116
    v_mul_f32 v136, v136, v37
    v_accvgpr_write_b32 a116, v136
    v_accvgpr_read_b32 v137, a117
    v_mul_f32 v137, v137, v37
    v_accvgpr_write_b32 a117, v137
    v_accvgpr_read_b32 v138, a118
    v_mul_f32 v138, v138, v37
    v_accvgpr_write_b32 a118, v138
    v_accvgpr_read_b32 v139, a119
    v_mul_f32 v139, v139, v37
    v_accvgpr_write_b32 a119, v139
    v_accvgpr_read_b32 v140, a120
    v_mul_f32 v140, v140, v37
    v_accvgpr_write_b32 a120, v140
    v_accvgpr_read_b32 v141, a121
    v_mul_f32 v141, v141, v37
    v_accvgpr_write_b32 a121, v141
    v_accvgpr_read_b32 v142, a122
    v_mul_f32 v142, v142, v37
    v_accvgpr_write_b32 a122, v142
    v_accvgpr_read_b32 v143, a123
    v_mul_f32 v143, v143, v37
    v_accvgpr_write_b32 a123, v143
    v_accvgpr_read_b32 v144, a124
    v_mul_f32 v144, v144, v37
    v_accvgpr_write_b32 a124, v144
    v_accvgpr_read_b32 v145, a125
    v_mul_f32 v145, v145, v37
    v_accvgpr_write_b32 a125, v145
    v_accvgpr_read_b32 v146, a126
    v_mul_f32 v146, v146, v37
    v_accvgpr_write_b32 a126, v146
    v_accvgpr_read_b32 v147, a127
    v_mul_f32 v147, v147, v37
    v_accvgpr_write_b32 a127, v147
    v_sub_f32 v100, v100, v242
    v_sub_f32 v101, v101, v242
    v_sub_f32 v102, v102, v242
    v_sub_f32 v103, v103, v242
    v_sub_f32 v104, v104, v242
    v_sub_f32 v105, v105, v242
    v_sub_f32 v106, v106, v242
    v_sub_f32 v107, v107, v242
    v_max_f32 v244, v244, v40
    v_sub_f32 v41, v40, v244
    v_exp_f32 v41, v41
    v_mov_b32 v40, v244
    v_mul_f32 v20, v20, v41
    v_mul_f32 v21, v21, v41
    v_mul_f32 v22, v22, v41
    v_mul_f32 v23, v23, v41
    v_accvgpr_read_b32 v116, a128
    v_mul_f32 v116, v116, v41
    v_accvgpr_write_b32 a128, v116
    v_accvgpr_read_b32 v117, a129
    v_mul_f32 v117, v117, v41
    v_accvgpr_write_b32 a129, v117
    v_accvgpr_read_b32 v118, a130
    v_mul_f32 v118, v118, v41
    v_accvgpr_write_b32 a130, v118
    v_accvgpr_read_b32 v119, a131
    v_mul_f32 v119, v119, v41
    v_accvgpr_write_b32 a131, v119
    v_accvgpr_read_b32 v120, a132
    v_mul_f32 v120, v120, v41
    v_accvgpr_write_b32 a132, v120
    v_accvgpr_read_b32 v121, a133
    v_mul_f32 v121, v121, v41
    v_accvgpr_write_b32 a133, v121
    v_accvgpr_read_b32 v122, a134
    v_mul_f32 v122, v122, v41
    v_accvgpr_write_b32 a134, v122
    v_accvgpr_read_b32 v123, a135
    v_mul_f32 v123, v123, v41
    v_accvgpr_write_b32 a135, v123
    v_accvgpr_read_b32 v124, a136
    v_mul_f32 v124, v124, v41
    v_accvgpr_write_b32 a136, v124
    v_accvgpr_read_b32 v125, a137
    v_mul_f32 v125, v125, v41
    v_accvgpr_write_b32 a137, v125
    v_accvgpr_read_b32 v126, a138
    v_mul_f32 v126, v126, v41
    v_accvgpr_write_b32 a138, v126
    v_accvgpr_read_b32 v127, a139
    v_mul_f32 v127, v127, v41
    v_accvgpr_write_b32 a139, v127
    v_accvgpr_read_b32 v128, a140
    v_mul_f32 v128, v128, v41
    v_accvgpr_write_b32 a140, v128
    v_accvgpr_read_b32 v129, a141
    v_mul_f32 v129, v129, v41
    v_accvgpr_write_b32 a141, v129
    v_accvgpr_read_b32 v130, a142
    v_mul_f32 v130, v130, v41
    v_accvgpr_write_b32 a142, v130
    v_accvgpr_read_b32 v131, a143
    v_mul_f32 v131, v131, v41
    v_accvgpr_write_b32 a143, v131
    v_accvgpr_read_b32 v132, a144
    v_mul_f32 v132, v132, v41
    v_accvgpr_write_b32 a144, v132
    v_accvgpr_read_b32 v133, a145
    v_mul_f32 v133, v133, v41
    v_accvgpr_write_b32 a145, v133
    v_accvgpr_read_b32 v134, a146
    v_mul_f32 v134, v134, v41
    v_accvgpr_write_b32 a146, v134
    v_accvgpr_read_b32 v135, a147
    v_mul_f32 v135, v135, v41
    v_accvgpr_write_b32 a147, v135
    v_accvgpr_read_b32 v136, a148
    v_mul_f32 v136, v136, v41
    v_accvgpr_write_b32 a148, v136
    v_accvgpr_read_b32 v137, a149
    v_mul_f32 v137, v137, v41
    v_accvgpr_write_b32 a149, v137
    v_accvgpr_read_b32 v138, a150
    v_mul_f32 v138, v138, v41
    v_accvgpr_write_b32 a150, v138
    v_accvgpr_read_b32 v139, a151
    v_mul_f32 v139, v139, v41
    v_accvgpr_write_b32 a151, v139
    v_accvgpr_read_b32 v140, a152
    v_mul_f32 v140, v140, v41
    v_accvgpr_write_b32 a152, v140
    v_accvgpr_read_b32 v141, a153
    v_mul_f32 v141, v141, v41
    v_accvgpr_write_b32 a153, v141
    v_accvgpr_read_b32 v142, a154
    v_mul_f32 v142, v142, v41
    v_accvgpr_write_b32 a154, v142
    v_accvgpr_read_b32 v143, a155
    v_mul_f32 v143, v143, v41
    v_accvgpr_write_b32 a155, v143
    v_accvgpr_read_b32 v144, a156
    v_mul_f32 v144, v144, v41
    v_accvgpr_write_b32 a156, v144
    v_accvgpr_read_b32 v145, a157
    v_mul_f32 v145, v145, v41
    v_accvgpr_write_b32 a157, v145
    v_accvgpr_read_b32 v146, a158
    v_mul_f32 v146, v146, v41
    v_accvgpr_write_b32 a158, v146
    v_accvgpr_read_b32 v147, a159
    v_mul_f32 v147, v147, v41
    v_accvgpr_write_b32 a159, v147
    v_sub_f32 v108, v108, v244
    v_sub_f32 v109, v109, v244
    v_sub_f32 v110, v110, v244
    v_sub_f32 v111, v111, v244
    v_sub_f32 v112, v112, v244
    v_sub_f32 v113, v113, v244
    v_sub_f32 v114, v114, v244
    v_sub_f32 v115, v115, v244
    v_exp_f32 v76, v76
    v_exp_f32 v77, v77
    v_exp_f32 v78, v78
    v_exp_f32 v79, v79
    v_exp_f32 v80, v80
    v_cvt_pk_bf16_f32 v76, v76, v77
    v_cvt_pk_bf16_f32 v77, v78, v79
    v_exp_f32 v81, v81
    v_exp_f32 v82, v82
    v_exp_f32 v83, v83
    v_cvt_pk_bf16_f32 v78, v80, v81
    v_cvt_pk_bf16_f32 v79, v82, v83
    v_exp_f32 v84, v84
    v_exp_f32 v85, v85
    v_exp_f32 v86, v86
    v_exp_f32 v87, v87
    v_exp_f32 v88, v88
    v_cvt_pk_bf16_f32 v84, v84, v85
    v_cvt_pk_bf16_f32 v85, v86, v87
    v_exp_f32 v89, v89
    v_exp_f32 v90, v90
    v_exp_f32 v91, v91
    v_cvt_pk_bf16_f32 v86, v88, v89
    v_cvt_pk_bf16_f32 v87, v90, v91
    v_exp_f32 v92, v92
    v_exp_f32 v93, v93
    v_exp_f32 v94, v94
    v_exp_f32 v95, v95
    v_exp_f32 v96, v96
    v_cvt_pk_bf16_f32 v92, v92, v93
    v_cvt_pk_bf16_f32 v93, v94, v95
    v_exp_f32 v97, v97
    v_exp_f32 v98, v98
    v_exp_f32 v99, v99
    v_cvt_pk_bf16_f32 v94, v96, v97
    v_cvt_pk_bf16_f32 v95, v98, v99
    v_exp_f32 v100, v100
    v_exp_f32 v101, v101
    v_exp_f32 v102, v102
    v_exp_f32 v103, v103
    v_exp_f32 v104, v104
    v_cvt_pk_bf16_f32 v100, v100, v101
    v_cvt_pk_bf16_f32 v101, v102, v103
    v_exp_f32 v105, v105
    v_exp_f32 v106, v106
    v_exp_f32 v107, v107
    v_cvt_pk_bf16_f32 v102, v104, v105
    v_cvt_pk_bf16_f32 v103, v106, v107
    v_exp_f32 v108, v108
    v_exp_f32 v109, v109
    v_exp_f32 v110, v110
    v_exp_f32 v111, v111
    v_exp_f32 v112, v112
    v_cvt_pk_bf16_f32 v108, v108, v109
    v_cvt_pk_bf16_f32 v109, v110, v111
    v_exp_f32 v113, v113
    v_exp_f32 v114, v114
    v_exp_f32 v115, v115
    v_cvt_pk_bf16_f32 v110, v112, v113
    v_cvt_pk_bf16_f32 v111, v114, v115
    s_nop 1
    ds_read_b64_tr_b16 v[44:45], v8 offset:0
    ds_read_b64_tr_b16 v[46:47], v8 offset:4096
    s_waitcnt lgkmcnt(0)
    v_mfma_f32_16x16x32_bf16 a[0:3], v[44:47], v[76:79], a[0:3]
    v_mfma_f32_16x16x32_bf16 a[32:35], v[44:47], v[84:87], a[32:35]
    v_mfma_f32_16x16x32_bf16 a[64:67], v[44:47], v[92:95], a[64:67]
    v_mfma_f32_16x16x32_bf16 a[96:99], v[44:47], v[100:103], a[96:99]
    v_mfma_f32_16x16x32_bf16 a[128:131], v[44:47], v[108:111], a[128:131]
    ds_read_b64_tr_b16 v[48:49], v9 offset:0
    ds_read_b64_tr_b16 v[50:51], v9 offset:4096
    s_waitcnt lgkmcnt(0)
    v_mfma_f32_16x16x32_bf16 a[4:7], v[48:51], v[76:79], a[4:7]
    v_mfma_f32_16x16x32_bf16 a[36:39], v[48:51], v[84:87], a[36:39]
    v_mfma_f32_16x16x32_bf16 a[68:71], v[48:51], v[92:95], a[68:71]
    v_mfma_f32_16x16x32_bf16 a[100:103], v[48:51], v[100:103], a[100:103]
    v_mfma_f32_16x16x32_bf16 a[132:135], v[48:51], v[108:111], a[132:135]
    ds_read_b64_tr_b16 v[52:53], v10 offset:0
    ds_read_b64_tr_b16 v[54:55], v10 offset:4096
    s_waitcnt lgkmcnt(0)
    v_mfma_f32_16x16x32_bf16 a[8:11], v[52:55], v[76:79], a[8:11]
    v_mfma_f32_16x16x32_bf16 a[40:43], v[52:55], v[84:87], a[40:43]
    v_mfma_f32_16x16x32_bf16 a[72:75], v[52:55], v[92:95], a[72:75]
    v_mfma_f32_16x16x32_bf16 a[104:107], v[52:55], v[100:103], a[104:107]
    v_mfma_f32_16x16x32_bf16 a[136:139], v[52:55], v[108:111], a[136:139]
    ds_read_b64_tr_b16 v[56:57], v11 offset:0
    ds_read_b64_tr_b16 v[58:59], v11 offset:4096
    s_waitcnt lgkmcnt(0)
    v_mfma_f32_16x16x32_bf16 a[12:15], v[56:59], v[76:79], a[12:15]
    v_mfma_f32_16x16x32_bf16 a[44:47], v[56:59], v[84:87], a[44:47]
    v_mfma_f32_16x16x32_bf16 a[76:79], v[56:59], v[92:95], a[76:79]
    v_mfma_f32_16x16x32_bf16 a[108:111], v[56:59], v[100:103], a[108:111]
    v_mfma_f32_16x16x32_bf16 a[140:143], v[56:59], v[108:111], a[140:143]
    ds_read_b64_tr_b16 v[60:61], v12 offset:0
    ds_read_b64_tr_b16 v[62:63], v12 offset:4096
    s_waitcnt lgkmcnt(0)
    v_mfma_f32_16x16x32_bf16 a[16:19], v[60:63], v[76:79], a[16:19]
    v_mfma_f32_16x16x32_bf16 a[48:51], v[60:63], v[84:87], a[48:51]
    v_mfma_f32_16x16x32_bf16 a[80:83], v[60:63], v[92:95], a[80:83]
    v_mfma_f32_16x16x32_bf16 a[112:115], v[60:63], v[100:103], a[112:115]
    v_mfma_f32_16x16x32_bf16 a[144:147], v[60:63], v[108:111], a[144:147]
    ds_read_b64_tr_b16 v[64:65], v13 offset:0
    ds_read_b64_tr_b16 v[66:67], v13 offset:4096
    s_waitcnt lgkmcnt(0)
    v_mfma_f32_16x16x32_bf16 a[20:23], v[64:67], v[76:79], a[20:23]
    v_mfma_f32_16x16x32_bf16 a[52:55], v[64:67], v[84:87], a[52:55]
    v_mfma_f32_16x16x32_bf16 a[84:87], v[64:67], v[92:95], a[84:87]
    v_mfma_f32_16x16x32_bf16 a[116:119], v[64:67], v[100:103], a[116:119]
    v_mfma_f32_16x16x32_bf16 a[148:151], v[64:67], v[108:111], a[148:151]
    ds_read_b64_tr_b16 v[68:69], v14 offset:0
    ds_read_b64_tr_b16 v[70:71], v14 offset:4096
    s_waitcnt lgkmcnt(0)
    v_mfma_f32_16x16x32_bf16 a[24:27], v[68:71], v[76:79], a[24:27]
    v_mfma_f32_16x16x32_bf16 a[56:59], v[68:71], v[84:87], a[56:59]
    v_mfma_f32_16x16x32_bf16 a[88:91], v[68:71], v[92:95], a[88:91]
    v_mfma_f32_16x16x32_bf16 a[120:123], v[68:71], v[100:103], a[120:123]
    v_mfma_f32_16x16x32_bf16 a[152:155], v[68:71], v[108:111], a[152:155]
    ds_read_b64_tr_b16 v[72:73], v15 offset:0
    ds_read_b64_tr_b16 v[74:75], v15 offset:4096
    s_waitcnt lgkmcnt(0)
    v_mfma_f32_16x16x32_bf16 a[28:31], v[72:75], v[76:79], a[28:31]
    v_mfma_f32_16x16x32_bf16 a[60:63], v[72:75], v[84:87], a[60:63]
    v_mfma_f32_16x16x32_bf16 a[92:95], v[72:75], v[92:95], a[92:95]
    v_mfma_f32_16x16x32_bf16 a[124:127], v[72:75], v[100:103], a[124:127]
    v_mfma_f32_16x16x32_bf16 a[156:159], v[72:75], v[108:111], a[156:159]
    v_mfma_f32_16x16x32_bf16 a[240:243], v[248:251], v[76:79], a[240:243]
    v_mfma_f32_16x16x32_bf16 a[244:247], v[248:251], v[84:87], a[244:247]
    v_mfma_f32_16x16x32_bf16 a[248:251], v[248:251], v[92:95], a[248:251]
    v_mfma_f32_16x16x32_bf16 a[252:255], v[248:251], v[100:103], a[252:255]
    v_mfma_f32_16x16x32_bf16 v[20:23], v[248:251], v[108:111], v[20:23]
    s_barrier
    s_add_u32 s35, s35, 1
    s_cmp_lt_u32 s35, 32
    s_cbranch_scc1 L_c5_fbloop
    s_nop 7
    s_mov_b32 s33, s45
    s_add_u32 m0, s34, 0
    s_nop 0
    buffer_load_dwordx4 v1, s[16:19], s33 offen lds
    buffer_load_dwordx4 v2, s[16:19], s33 offen offset:1024 lds
    s_add_u32 m0, s34, 65536
    s_nop 0
    buffer_load_dwordx4 v1, s[20:23], s33 offen lds
    buffer_load_dwordx4 v2, s[20:23], s33 offen offset:1024 lds
    s_add_u32 s33, s33, 8192
    s_add_u32 m0, s34, 8192
    s_nop 0
    buffer_load_dwordx4 v1, s[16:19], s33 offen lds
    buffer_load_dwordx4 v2, s[16:19], s33 offen offset:1024 lds
    s_add_u32 m0, s34, 73728
    s_nop 0
    buffer_load_dwordx4 v1, s[20:23], s33 offen lds
    buffer_load_dwordx4 v2, s[20:23], s33 offen offset:1024 lds
    s_add_u32 s33, s33, 8192
    s_add_u32 m0, s34, 16384
    s_nop 0
    buffer_load_dwordx4 v1, s[16:19], s33 offen lds
    buffer_load_dwordx4 v2, s[16:19], s33 offen offset:1024 lds
    s_add_u32 m0, s34, 81920
    s_nop 0
    buffer_load_dwordx4 v1, s[20:23], s33 offen lds
    buffer_load_dwordx4 v2, s[20:23], s33 offen offset:1024 lds
    s_add_u32 s33, s33, 8192
    s_add_u32 m0, s34, 24576
    s_nop 0
    buffer_load_dwordx4 v1, s[16:19], s33 offen lds
    buffer_load_dwordx4 v2, s[16:19], s33 offen offset:1024 lds
    s_add_u32 m0, s34, 90112
    s_nop 0
    buffer_load_dwordx4 v1, s[20:23], s33 offen lds
    buffer_load_dwordx4 v2, s[20:23], s33 offen offset:1024 lds
    s_add_u32 s33, s33, 8192
    s_add_u32 m0, s34, 32768
    s_nop 0
    buffer_load_dwordx4 v1, s[16:19], s33 offen lds
    buffer_load_dwordx4 v2, s[16:19], s33 offen offset:1024 lds
    s_add_u32 m0, s34, 98304
    s_nop 0
    buffer_load_dwordx4 v1, s[20:23], s33 offen lds
    buffer_load_dwordx4 v2, s[20:23], s33 offen offset:1024 lds
    s_add_u32 s33, s33, 8192
    s_add_u32 m0, s34, 40960
    s_nop 0
    buffer_load_dwordx4 v1, s[16:19], s33 offen lds
    buffer_load_dwordx4 v2, s[16:19], s33 offen offset:1024 lds
    s_add_u32 m0, s34, 106496
    s_nop 0
    buffer_load_dwordx4 v1, s[20:23], s33 offen lds
    buffer_load_dwordx4 v2, s[20:23], s33 offen offset:1024 lds
    s_add_u32 s33, s33, 8192
    v_lshlrev_b32 v236, 16, v220
    v_and_b32 v237, 0xffff0000, v220
    v_lshlrev_b32 v238, 16, v221
    v_and_b32 v239, 0xffff0000, v221
    v_pk_mul_f32 v[236:237], v[236:237], s[36:37]
    v_pk_mul_f32 v[238:239], v[238:239], s[36:37]
    v_cvt_pk_bf16_f32 v220, v236, v237
    v_cvt_pk_bf16_f32 v221, v238, v239
    v_lshlrev_b32 v240, 16, v222
    v_and_b32 v241, 0xffff0000, v222
    v_lshlrev_b32 v242, 16, v223
    v_and_b32 v243, 0xffff0000, v223
    v_pk_mul_f32 v[240:241], v[240:241], s[36:37]
    v_pk_mul_f32 v[242:243], v[242:243], s[36:37]
    v_cvt_pk_bf16_f32 v222, v240, v241
    v_cvt_pk_bf16_f32 v223, v242, v243
    v_lshlrev_b32 v236, 16, v224
    v_and_b32 v237, 0xffff0000, v224
    v_lshlrev_b32 v238, 16, v225
    v_and_b32 v239, 0xffff0000, v225
    v_pk_mul_f32 v[236:237], v[236:237], s[36:37]
    v_pk_mul_f32 v[238:239], v[238:239], s[36:37]
    v_cvt_pk_bf16_f32 v224, v236, v237
    v_cvt_pk_bf16_f32 v225, v238, v239
    v_lshlrev_b32 v240, 16, v226
    v_and_b32 v241, 0xffff0000, v226
    v_lshlrev_b32 v242, 16, v227
    v_and_b32 v243, 0xffff0000, v227
    v_pk_mul_f32 v[240:241], v[240:241], s[36:37]
    v_pk_mul_f32 v[242:243], v[242:243], s[36:37]
    v_cvt_pk_bf16_f32 v226, v240, v241
    v_cvt_pk_bf16_f32 v227, v242, v243
    v_lshlrev_b32 v236, 16, v228
    v_and_b32 v237, 0xffff0000, v228
    v_lshlrev_b32 v238, 16, v229
    v_and_b32 v239, 0xffff0000, v229
    v_pk_mul_f32 v[236:237], v[236:237], s[36:37]
    v_pk_mul_f32 v[238:239], v[238:239], s[36:37]
    v_cvt_pk_bf16_f32 v228, v236, v237
    v_cvt_pk_bf16_f32 v229, v238, v239
    v_lshlrev_b32 v240, 16, v230
    v_and_b32 v241, 0xffff0000, v230
    v_lshlrev_b32 v242, 16, v231
    v_and_b32 v243, 0xffff0000, v231
    v_pk_mul_f32 v[240:241], v[240:241], s[36:37]
    v_pk_mul_f32 v[242:243], v[242:243], s[36:37]
    v_cvt_pk_bf16_f32 v230, v240, v241
    v_cvt_pk_bf16_f32 v231, v242, v243
    v_lshlrev_b32 v236, 16, v232
    v_and_b32 v237, 0xffff0000, v232
    v_lshlrev_b32 v238, 16, v233
    v_and_b32 v239, 0xffff0000, v233
    v_pk_mul_f32 v[236:237], v[236:237], s[36:37]
    v_pk_mul_f32 v[238:239], v[238:239], s[36:37]
    v_cvt_pk_bf16_f32 v232, v236, v237
    v_cvt_pk_bf16_f32 v233, v238, v239
    v_lshlrev_b32 v240, 16, v234
    v_and_b32 v241, 0xffff0000, v234
    v_lshlrev_b32 v242, 16, v235
    v_and_b32 v243, 0xffff0000, v235
    v_pk_mul_f32 v[240:241], v[240:241], s[36:37]
    v_pk_mul_f32 v[242:243], v[242:243], s[36:37]
    v_cvt_pk_bf16_f32 v234, v240, v241
    v_cvt_pk_bf16_f32 v235, v242, v243
    v_accvgpr_write_b32 a160, v156
    v_accvgpr_write_b32 a161, v157
    v_accvgpr_write_b32 a162, v158
    v_accvgpr_write_b32 a163, v159
    v_accvgpr_write_b32 a164, v160
    v_accvgpr_write_b32 a165, v161
    v_accvgpr_write_b32 a166, v162
    v_accvgpr_write_b32 a167, v163
    v_accvgpr_write_b32 a168, v164
    v_accvgpr_write_b32 a169, v165
    v_accvgpr_write_b32 a170, v166
    v_accvgpr_write_b32 a171, v167
    v_accvgpr_write_b32 a172, v168
    v_accvgpr_write_b32 a173, v169
    v_accvgpr_write_b32 a174, v170
    v_accvgpr_write_b32 a175, v171
    v_accvgpr_write_b32 a176, v172
    v_accvgpr_write_b32 a177, v173
    v_accvgpr_write_b32 a178, v174
    v_accvgpr_write_b32 a179, v175
    v_accvgpr_write_b32 a180, v176
    v_accvgpr_write_b32 a181, v177
    v_accvgpr_write_b32 a182, v178
    v_accvgpr_write_b32 a183, v179
    v_accvgpr_write_b32 a184, v180
    v_accvgpr_write_b32 a185, v181
    v_accvgpr_write_b32 a186, v182
    v_accvgpr_write_b32 a187, v183
    v_accvgpr_write_b32 a188, v184
    v_accvgpr_write_b32 a189, v185
    v_accvgpr_write_b32 a190, v186
    v_accvgpr_write_b32 a191, v187
    v_accvgpr_write_b32 a192, v188
    v_accvgpr_write_b32 a193, v189
    v_accvgpr_write_b32 a194, v190
    v_accvgpr_write_b32 a195, v191
    v_accvgpr_write_b32 a196, v192
    v_accvgpr_write_b32 a197, v193
    v_accvgpr_write_b32 a198, v194
    v_accvgpr_write_b32 a199, v195
    v_accvgpr_write_b32 a200, v196
    v_accvgpr_write_b32 a201, v197
    v_accvgpr_write_b32 a202, v198
    v_accvgpr_write_b32 a203, v199
    v_accvgpr_write_b32 a204, v200
    v_accvgpr_write_b32 a205, v201
    v_accvgpr_write_b32 a206, v202
    v_accvgpr_write_b32 a207, v203
    v_accvgpr_write_b32 a208, v204
    v_accvgpr_write_b32 a209, v205
    v_accvgpr_write_b32 a210, v206
    v_accvgpr_write_b32 a211, v207
    v_accvgpr_write_b32 a212, v208
    v_accvgpr_write_b32 a213, v209
    v_accvgpr_write_b32 a214, v210
    v_accvgpr_write_b32 a215, v211
    v_accvgpr_write_b32 a216, v212
    v_accvgpr_write_b32 a217, v213
    v_accvgpr_write_b32 a218, v214
    v_accvgpr_write_b32 a219, v215
    v_accvgpr_write_b32 a220, v216
    v_accvgpr_write_b32 a221, v217
    v_accvgpr_write_b32 a222, v218
    v_accvgpr_write_b32 a223, v219
    v_accvgpr_write_b32 a224, v220
    v_accvgpr_write_b32 a225, v221
    v_accvgpr_write_b32 a226, v222
    v_accvgpr_write_b32 a227, v223
    v_accvgpr_write_b32 a228, v224
    v_accvgpr_write_b32 a229, v225
    v_accvgpr_write_b32 a230, v226
    v_accvgpr_write_b32 a231, v227
    v_accvgpr_write_b32 a232, v228
    v_accvgpr_write_b32 a233, v229
    v_accvgpr_write_b32 a234, v230
    v_accvgpr_write_b32 a235, v231
    v_accvgpr_write_b32 a236, v232
    v_accvgpr_write_b32 a237, v233
    v_accvgpr_write_b32 a238, v234
    v_accvgpr_write_b32 a239, v235
    s_waitcnt vmcnt(0)
    s_barrier
    s_cmp_eq_u32 s46, 0
    s_cbranch_scc1 L_c5_bnd
    s_branch L_c5_fin
L_c4_start:
    s_add_u32 m0, s34, 0
    s_nop 0
    buffer_load_dwordx4 v1, s[16:19], s33 offen lds
    buffer_load_dwordx4 v2, s[16:19], s33 offen offset:1024 lds
    s_add_u32 m0, s34, 65536
    s_nop 0
    buffer_load_dwordx4 v1, s[20:23], s33 offen lds
    buffer_load_dwordx4 v2, s[20:23], s33 offen offset:1024 lds
    s_add_u32 s33, s33, 8192
    s_add_u32 s38, s32, 0
    buffer_load_dwordx4 v[156:159], v16, s[12:15], s38 offen offset:0
    buffer_load_dwordx4 v[160:163], v16, s[12:15], s38 offen offset:64
    buffer_load_dwordx4 v[164:167], v16, s[12:15], s38 offen offset:128
    buffer_load_dwordx4 v[168:171], v16, s[12:15], s38 offen offset:192
    s_add_u32 m0, s34, 8192
    s_nop 0
    buffer_load_dwordx4 v1, s[16:19], s33 offen lds
    buffer_load_dwordx4 v2, s[16:19], s33 offen offset:1024 lds
    s_add_u32 m0, s34, 73728
    s_nop 0
    buffer_load_dwordx4 v1, s[20:23], s33 offen lds
    buffer_load_dwordx4 v2, s[20:23], s33 offen offset:1024 lds
    s_add_u32 s33, s33, 8192
    s_add_u32 s38, s32, 4096
    buffer_load_dwordx4 v[172:175], v16, s[12:15], s38 offen offset:0
    buffer_load_dwordx4 v[176:179], v16, s[12:15], s38 offen offset:64
    buffer_load_dwordx4 v[180:183], v16, s[12:15], s38 offen offset:128
    buffer_load_dwordx4 v[184:187], v16, s[12:15], s38 offen offset:192
    s_waitcnt vmcnt(4)
    s_barrier
    ds_read_b128 v[44:47], v4 offset:0
    ds_read_b128 v[48:51], v5 offset:0
    ds_read_b128 v[52:55], v6 offset:0
    ds_read_b128 v[56:59], v7 offset:0
    ds_read_b128 v[60:63], v4 offset:4096
    ds_read_b128 v[64:67], v5 offset:4096
    ds_read_b128 v[68:71], v6 offset:4096
    ds_read_b128 v[72:75], v7 offset:4096
    ds_read_b128 a[0:3], v4 offset:8192
    ds_read_b128 a[4:7], v5 offset:8192
    ds_read_b128 a[8:11], v6 offset:8192
    ds_read_b128 a[12:15], v7 offset:8192
    ds_read_b128 a[16:19], v4 offset:12288
    ds_read_b128 a[20:23], v5 offset:12288
    ds_read_b128 a[24:27], v6 offset:12288
    ds_read_b128 a[28:31], v7 offset:12288
    s_waitcnt lgkmcnt(0)
    s_add_u32 s38, s32, 8192
    buffer_load_dwordx4 v[188:191], v16, s[12:15], s38 offen offset:0
    buffer_load_dwordx4 v[192:195], v16, s[12:15], s38 offen offset:64
    buffer_load_dwordx4 v[196:199], v16, s[12:15], s38 offen offset:128
    buffer_load_dwordx4 v[200:203], v16, s[12:15], s38 offen offset:192
    s_waitcnt vmcnt(12)
    v_lshlrev_b32 v236, 16, v156
    v_and_b32 v237, 0xffff0000, v156
    v_lshlrev_b32 v238, 16, v157
    v_and_b32 v239, 0xffff0000, v157
    v_pk_mul_f32 v[236:237], v[236:237], s[36:37]
    v_pk_mul_f32 v[238:239], v[238:239], s[36:37]
    v_cvt_pk_bf16_f32 v156, v236, v237
    v_cvt_pk_bf16_f32 v157, v238, v239
    v_lshlrev_b32 v240, 16, v158
    v_and_b32 v241, 0xffff0000, v158
    v_lshlrev_b32 v242, 16, v159
    v_and_b32 v243, 0xffff0000, v159
    v_pk_mul_f32 v[240:241], v[240:241], s[36:37]
    v_pk_mul_f32 v[242:243], v[242:243], s[36:37]
    v_cvt_pk_bf16_f32 v158, v240, v241
    v_cvt_pk_bf16_f32 v159, v242, v243
    v_lshlrev_b32 v236, 16, v160
    v_and_b32 v237, 0xffff0000, v160
    v_lshlrev_b32 v238, 16, v161
    v_and_b32 v239, 0xffff0000, v161
    v_pk_mul_f32 v[236:237], v[236:237], s[36:37]
    v_pk_mul_f32 v[238:239], v[238:239], s[36:37]
    v_cvt_pk_bf16_f32 v160, v236, v237
    v_cvt_pk_bf16_f32 v161, v238, v239
    v_lshlrev_b32 v240, 16, v162
    v_and_b32 v241, 0xffff0000, v162
    v_lshlrev_b32 v242, 16, v163
    v_and_b32 v243, 0xffff0000, v163
    v_pk_mul_f32 v[240:241], v[240:241], s[36:37]
    v_pk_mul_f32 v[242:243], v[242:243], s[36:37]
    v_cvt_pk_bf16_f32 v162, v240, v241
    v_cvt_pk_bf16_f32 v163, v242, v243
    v_lshlrev_b32 v236, 16, v164
    v_and_b32 v237, 0xffff0000, v164
    v_lshlrev_b32 v238, 16, v165
    v_and_b32 v239, 0xffff0000, v165
    v_pk_mul_f32 v[236:237], v[236:237], s[36:37]
    v_pk_mul_f32 v[238:239], v[238:239], s[36:37]
    v_cvt_pk_bf16_f32 v164, v236, v237
    v_cvt_pk_bf16_f32 v165, v238, v239
    v_lshlrev_b32 v240, 16, v166
    v_and_b32 v241, 0xffff0000, v166
    v_lshlrev_b32 v242, 16, v167
    v_and_b32 v243, 0xffff0000, v167
    v_pk_mul_f32 v[240:241], v[240:241], s[36:37]
    v_pk_mul_f32 v[242:243], v[242:243], s[36:37]
    v_cvt_pk_bf16_f32 v166, v240, v241
    v_cvt_pk_bf16_f32 v167, v242, v243
    v_lshlrev_b32 v236, 16, v168
    v_and_b32 v237, 0xffff0000, v168
    v_lshlrev_b32 v238, 16, v169
    v_and_b32 v239, 0xffff0000, v169
    v_pk_mul_f32 v[236:237], v[236:237], s[36:37]
    v_pk_mul_f32 v[238:239], v[238:239], s[36:37]
    v_cvt_pk_bf16_f32 v168, v236, v237
    v_cvt_pk_bf16_f32 v169, v238, v239
    v_lshlrev_b32 v240, 16, v170
    v_and_b32 v241, 0xffff0000, v170
    v_lshlrev_b32 v242, 16, v171
    v_and_b32 v243, 0xffff0000, v171
    v_pk_mul_f32 v[240:241], v[240:241], s[36:37]
    v_pk_mul_f32 v[242:243], v[242:243], s[36:37]
    v_cvt_pk_bf16_f32 v170, v240, v241
    v_cvt_pk_bf16_f32 v171, v242, v243
    v_accvgpr_write_b32 a160, v156
    v_accvgpr_write_b32 a161, v157
    v_accvgpr_write_b32 a162, v158
    v_accvgpr_write_b32 a163, v159
    v_accvgpr_write_b32 a164, v160
    v_accvgpr_write_b32 a165, v161
    v_accvgpr_write_b32 a166, v162
    v_accvgpr_write_b32 a167, v163
    v_accvgpr_write_b32 a168, v164
    v_accvgpr_write_b32 a169, v165
    v_accvgpr_write_b32 a170, v166
    v_accvgpr_write_b32 a171, v167
    v_accvgpr_write_b32 a172, v168
    v_accvgpr_write_b32 a173, v169
    v_accvgpr_write_b32 a174, v170
    v_accvgpr_write_b32 a175, v171
    s_nop 1
    v_mfma_f32_16x16x32_bf16 v[76:79], v[44:47], a[160:163], 0
    v_mfma_f32_16x16x32_bf16 v[80:83], v[60:63], a[160:163], 0
    v_mfma_f32_16x16x32_bf16 v[76:79], v[48:51], a[164:167], v[76:79]
    v_mfma_f32_16x16x32_bf16 v[80:83], v[64:67], a[164:167], v[80:83]
    v_mfma_f32_16x16x32_bf16 v[76:79], v[52:55], a[168:171], v[76:79]
    v_mfma_f32_16x16x32_bf16 v[80:83], v[68:71], a[168:171], v[80:83]
    v_mfma_f32_16x16x32_bf16 v[76:79], v[56:59], a[172:175], v[76:79]
    v_mfma_f32_16x16x32_bf16 v[80:83], v[72:75], a[172:175], v[80:83]
    s_nop 7
    v_max3_f32 v244, v76, v77, v78
    v_max3_f32 v245, v79, v80, v81
    v_max3_f32 v244, v244, v82, v83
    v_max_f32 v244, v244, v245
    v_mov_b32 v245, v244
    s_nop 1
    v_permlane16_swap_b32 v244, v245
    v_max_f32 v244, v244, v245
    v_mov_b32 v245, v244
    s_nop 1
    v_permlane32_swap_b32 v244, v245
    v_max_f32 v244, v244, v245
    v_sub_f32 v24, 0, v244
    v_sub_f32 v25, 0, v244
    v_sub_f32 v26, 0, v244
    v_sub_f32 v27, 0, v244
    s_nop 1
    v_mfma_f32_16x16x32_bf16 v[116:119], a[0:3], a[160:163], v[24:27]
    v_sub_f32 v76, v76, v244
    v_sub_f32 v77, v77, v244
    v_mfma_f32_16x16x32_bf16 v[120:123], a[16:19], a[160:163], v[24:27]
    v_sub_f32 v78, v78, v244
    v_sub_f32 v79, v79, v244
    v_sub_f32 v80, v80, v244
    v_mfma_f32_16x16x32_bf16 v[116:119], a[4:7], a[164:167], v[116:119]
    v_sub_f32 v81, v81, v244
    v_sub_f32 v82, v82, v244
    v_mfma_f32_16x16x32_bf16 v[120:123], a[20:23], a[164:167], v[120:123]
    v_sub_f32 v83, v83, v244
    v_exp_f32 v76, v76
    v_exp_f32 v77, v77
    v_mfma_f32_16x16x32_bf16 v[116:119], a[8:11], a[168:171], v[116:119]
    v_exp_f32 v78, v78
    v_exp_f32 v79, v79
    v_mfma_f32_16x16x32_bf16 v[120:123], a[24:27], a[168:171], v[120:123]
    v_exp_f32 v80, v80
    v_cvt_pk_bf16_f32 v76, v76, v77
    v_cvt_pk_bf16_f32 v77, v78, v79
    v_mfma_f32_16x16x32_bf16 v[116:119], a[12:15], a[172:175], v[116:119]
    v_exp_f32 v81, v81
    v_exp_f32 v82, v82
    v_mfma_f32_16x16x32_bf16 v[120:123], a[28:31], a[172:175], v[120:123]
    v_exp_f32 v83, v83
    v_cvt_pk_bf16_f32 v78, v80, v81
    v_cvt_pk_bf16_f32 v79, v82, v83
    s_add_u32 s38, s32, 12288
    buffer_load_dwordx4 v[204:207], v16, s[12:15], s38 offen offset:0
    buffer_load_dwordx4 v[208:211], v16, s[12:15], s38 offen offset:64
    buffer_load_dwordx4 v[212:215], v16, s[12:15], s38 offen offset:128
    buffer_load_dwordx4 v[216:219], v16, s[12:15], s38 offen offset:192
    s_waitcnt vmcnt(8)
    v_lshlrev_b32 v236, 16, v172
    v_and_b32 v237, 0xffff0000, v172
    v_lshlrev_b32 v238, 16, v173
    v_and_b32 v239, 0xffff0000, v173
    v_pk_mul_f32 v[236:237], v[236:237], s[36:37]
    v_pk_mul_f32 v[238:239], v[238:239], s[36:37]
    v_cvt_pk_bf16_f32 v172, v236, v237
    v_cvt_pk_bf16_f32 v173, v238, v239
    v_lshlrev_b32 v240, 16, v174
    v_and_b32 v241, 0xffff0000, v174
    v_lshlrev_b32 v242, 16, v175
    v_and_b32 v243, 0xffff0000, v175
    v_pk_mul_f32 v[240:241], v[240:241], s[36:37]
    v_pk_mul_f32 v[242:243], v[242:243], s[36:37]
    v_cvt_pk_bf16_f32 v174, v240, v241
    v_cvt_pk_bf16_f32 v175, v242, v243
    v_lshlrev_b32 v236, 16, v176
    v_and_b32 v237, 0xffff0000, v176
    v_lshlrev_b32 v238, 16, v177
    v_and_b32 v239, 0xffff0000, v177
    v_pk_mul_f32 v[236:237], v[236:237], s[36:37]
    v_pk_mul_f32 v[238:239], v[238:239], s[36:37]
    v_cvt_pk_bf16_f32 v176, v236, v237
    v_cvt_pk_bf16_f32 v177, v238, v239
    v_lshlrev_b32 v240, 16, v178
    v_and_b32 v241, 0xffff0000, v178
    v_lshlrev_b32 v242, 16, v179
    v_and_b32 v243, 0xffff0000, v179
    v_pk_mul_f32 v[240:241], v[240:241], s[36:37]
    v_pk_mul_f32 v[242:243], v[242:243], s[36:37]
    v_cvt_pk_bf16_f32 v178, v240, v241
    v_cvt_pk_bf16_f32 v179, v242, v243
    v_lshlrev_b32 v236, 16, v180
    v_and_b32 v237, 0xffff0000, v180
    v_lshlrev_b32 v238, 16, v181
    v_and_b32 v239, 0xffff0000, v181
    v_pk_mul_f32 v[236:237], v[236:237], s[36:37]
    v_pk_mul_f32 v[238:239], v[238:239], s[36:37]
    v_cvt_pk_bf16_f32 v180, v236, v237
    v_cvt_pk_bf16_f32 v181, v238, v239
    v_lshlrev_b32 v240, 16, v182
    v_and_b32 v241, 0xffff0000, v182
    v_lshlrev_b32 v242, 16, v183
    v_and_b32 v243, 0xffff0000, v183
    v_pk_mul_f32 v[240:241], v[240:241], s[36:37]
    v_pk_mul_f32 v[242:243], v[242:243], s[36:37]
    v_cvt_pk_bf16_f32 v182, v240, v241
    v_cvt_pk_bf16_f32 v183, v242, v243
    v_lshlrev_b32 v236, 16, v184
    v_and_b32 v237, 0xffff0000, v184
    v_lshlrev_b32 v238, 16, v185
    v_and_b32 v239, 0xffff0000, v185
    v_pk_mul_f32 v[236:237], v[236:237], s[36:37]
    v_pk_mul_f32 v[238:239], v[238:239], s[36:37]
    v_cvt_pk_bf16_f32 v184, v236, v237
    v_cvt_pk_bf16_f32 v185, v238, v239
    v_lshlrev_b32 v240, 16, v186
    v_and_b32 v241, 0xffff0000, v186
    v_lshlrev_b32 v242, 16, v187
    v_and_b32 v243, 0xffff0000, v187
    v_pk_mul_f32 v[240:241], v[240:241], s[36:37]
    v_pk_mul_f32 v[242:243], v[242:243], s[36:37]
    v_cvt_pk_bf16_f32 v186, v240, v241
    v_cvt_pk_bf16_f32 v187, v242, v243
    v_accvgpr_write_b32 a176, v172
    v_accvgpr_write_b32 a177, v173
    v_accvgpr_write_b32 a178, v174
    v_accvgpr_write_b32 a179, v175
    v_accvgpr_write_b32 a180, v176
    v_accvgpr_write_b32 a181, v177
    v_accvgpr_write_b32 a182, v178
    v_accvgpr_write_b32 a183, v179
    v_accvgpr_write_b32 a184, v180
    v_accvgpr_write_b32 a185, v181
    v_accvgpr_write_b32 a186, v182
    v_accvgpr_write_b32 a187, v183
    v_accvgpr_write_b32 a188, v184
    v_accvgpr_write_b32 a189, v185
    v_accvgpr_write_b32 a190, v186
    v_accvgpr_write_b32 a191, v187
    s_nop 1
    v_mfma_f32_16x16x32_bf16 v[84:87], v[44:47], a[176:179], 0
    v_mfma_f32_16x16x32_bf16 v[88:91], v[60:63], a[176:179], 0
    v_mfma_f32_16x16x32_bf16 v[84:87], v[48:51], a[180:183], v[84:87]
    v_mfma_f32_16x16x32_bf16 v[88:91], v[64:67], a[180:183], v[88:91]
    v_mfma_f32_16x16x32_bf16 v[84:87], v[52:55], a[184:187], v[84:87]
    v_mfma_f32_16x16x32_bf16 v[88:91], v[68:71], a[184:187], v[88:91]
    v_mfma_f32_16x16x32_bf16 v[84:87], v[56:59], a[188:191], v[84:87]
    v_mfma_f32_16x16x32_bf16 v[88:91], v[72:75], a[188:191], v[88:91]
    s_nop 7
    v_max3_f32 v244, v84, v85, v86
    v_max3_f32 v245, v87, v88, v89
    v_max3_f32 v244, v244, v90, v91
    v_max_f32 v244, v244, v245
    v_mov_b32 v245, v244
    s_nop 1
    v_permlane16_swap_b32 v244, v245
    v_max_f32 v244, v244, v245
    v_mov_b32 v245, v244
    s_nop 1
    v_permlane32_swap_b32 v244, v245
    v_max_f32 v244, v244, v245
    v_sub_f32 v28, 0, v244
    v_sub_f32 v29, 0, v244
    v_sub_f32 v30, 0, v244
    v_sub_f32 v31, 0, v244
    s_nop 1
    v_mfma_f32_16x16x32_bf16 v[124:127], a[0:3], a[176:179], v[28:31]
    v_sub_f32 v84, v84, v244
    v_sub_f32 v85, v85, v244
    v_mfma_f32_16x16x32_bf16 v[128:131], a[16:19], a[176:179], v[28:31]
    v_sub_f32 v86, v86, v244
    v_sub_f32 v87, v87, v244
    v_sub_f32 v88, v88, v244
    v_mfma_f32_16x16x32_bf16 v[124:127], a[4:7], a[180:183], v[124:127]
    v_sub_f32 v89, v89, v244
    v_sub_f32 v90, v90, v244
    v_mfma_f32_16x16x32_bf16 v[128:131], a[20:23], a[180:183], v[128:131]
    v_sub_f32 v91, v91, v244
    v_exp_f32 v84, v84
    v_exp_f32 v85, v85
    v_mfma_f32_16x16x32_bf16 v[124:127], a[8:11], a[184:187], v[124:127]
    v_exp_f32 v86, v86
    v_exp_f32 v87, v87
    v_mfma_f32_16x16x32_bf16 v[128:131], a[24:27], a[184:187], v[128:131]
    v_exp_f32 v88, v88
    v_cvt_pk_bf16_f32 v84, v84, v85
    v_cvt_pk_bf16_f32 v85, v86, v87
    v_mfma_f32_16x16x32_bf16 v[124:127], a[12:15], a[188:191], v[124:127]
    v_exp_f32 v89, v89
    v_exp_f32 v90, v90
    v_mfma_f32_16x16x32_bf16 v[128:131], a[28:31], a[188:191], v[128:131]
    v_exp_f32 v91, v91
    v_cvt_pk_bf16_f32 v86, v88, v89
    v_cvt_pk_bf16_f32 v87, v90, v91
    s_add_u32 m0, s34, 16384
    s_nop 0
    buffer_load_dwordx4 v1, s[16:19], s33 offen lds
    buffer_load_dwordx4 v2, s[16:19], s33 offen offset:1024 lds
    s_add_u32 m0, s34, 81920
    s_nop 0
    buffer_load_dwordx4 v1, s[20:23], s33 offen lds
    buffer_load_dwordx4 v2, s[20:23], s33 offen offset:1024 lds
    s_add_u32 s33, s33, 8192
    s_waitcnt vmcnt(8)
    v_lshlrev_b32 v236, 16, v188
    v_and_b32 v237, 0xffff0000, v188
    v_lshlrev_b32 v238, 16, v189
    v_and_b32 v239, 0xffff0000, v189
    v_pk_mul_f32 v[236:237], v[236:237], s[36:37]
    v_pk_mul_f32 v[238:239], v[238:239], s[36:37]
    v_cvt_pk_bf16_f32 v188, v236, v237
    v_cvt_pk_bf16_f32 v189, v238, v239
    v_lshlrev_b32 v240, 16, v190
    v_and_b32 v241, 0xffff0000, v190
    v_lshlrev_b32 v242, 16, v191
    v_and_b32 v243, 0xffff0000, v191
    v_pk_mul_f32 v[240:241], v[240:241], s[36:37]
    v_pk_mul_f32 v[242:243], v[242:243], s[36:37]
    v_cvt_pk_bf16_f32 v190, v240, v241
    v_cvt_pk_bf16_f32 v191, v242, v243
    v_lshlrev_b32 v236, 16, v192
    v_and_b32 v237, 0xffff0000, v192
    v_lshlrev_b32 v238, 16, v193
    v_and_b32 v239, 0xffff0000, v193
    v_pk_mul_f32 v[236:237], v[236:237], s[36:37]
    v_pk_mul_f32 v[238:239], v[238:239], s[36:37]
    v_cvt_pk_bf16_f32 v192, v236, v237
    v_cvt_pk_bf16_f32 v193, v238, v239
    v_lshlrev_b32 v240, 16, v194
    v_and_b32 v241, 0xffff0000, v194
    v_lshlrev_b32 v242, 16, v195
    v_and_b32 v243, 0xffff0000, v195
    v_pk_mul_f32 v[240:241], v[240:241], s[36:37]
    v_pk_mul_f32 v[242:243], v[242:243], s[36:37]
    v_cvt_pk_bf16_f32 v194, v240, v241
    v_cvt_pk_bf16_f32 v195, v242, v243
    v_lshlrev_b32 v236, 16, v196
    v_and_b32 v237, 0xffff0000, v196
    v_lshlrev_b32 v238, 16, v197
    v_and_b32 v239, 0xffff0000, v197
    v_pk_mul_f32 v[236:237], v[236:237], s[36:37]
    v_pk_mul_f32 v[238:239], v[238:239], s[36:37]
    v_cvt_pk_bf16_f32 v196, v236, v237
    v_cvt_pk_bf16_f32 v197, v238, v239
    v_lshlrev_b32 v240, 16, v198
    v_and_b32 v241, 0xffff0000, v198
    v_lshlrev_b32 v242, 16, v199
    v_and_b32 v243, 0xffff0000, v199
    v_pk_mul_f32 v[240:241], v[240:241], s[36:37]
    v_pk_mul_f32 v[242:243], v[242:243], s[36:37]
    v_cvt_pk_bf16_f32 v198, v240, v241
    v_cvt_pk_bf16_f32 v199, v242, v243
    v_lshlrev_b32 v236, 16, v200
    v_and_b32 v237, 0xffff0000, v200
    v_lshlrev_b32 v238, 16, v201
    v_and_b32 v239, 0xffff0000, v201
    v_pk_mul_f32 v[236:237], v[236:237], s[36:37]
    v_pk_mul_f32 v[238:239], v[238:239], s[36:37]
    v_cvt_pk_bf16_f32 v200, v236, v237
    v_cvt_pk_bf16_f32 v201, v238, v239
    v_lshlrev_b32 v240, 16, v202
    v_and_b32 v241, 0xffff0000, v202
    v_lshlrev_b32 v242, 16, v203
    v_and_b32 v243, 0xffff0000, v203
    v_pk_mul_f32 v[240:241], v[240:241], s[36:37]
    v_pk_mul_f32 v[242:243], v[242:243], s[36:37]
    v_cvt_pk_bf16_f32 v202, v240, v241
    v_cvt_pk_bf16_f32 v203, v242, v243
    v_accvgpr_write_b32 a192, v188
    v_accvgpr_write_b32 a193, v189
    v_accvgpr_write_b32 a194, v190
    v_accvgpr_write_b32 a195, v191
    v_accvgpr_write_b32 a196, v192
    v_accvgpr_write_b32 a197, v193
    v_accvgpr_write_b32 a198, v194
    v_accvgpr_write_b32 a199, v195
    v_accvgpr_write_b32 a200, v196
    v_accvgpr_write_b32 a201, v197
    v_accvgpr_write_b32 a202, v198
    v_accvgpr_write_b32 a203, v199
    v_accvgpr_write_b32 a204, v200
    v_accvgpr_write_b32 a205, v201
    v_accvgpr_write_b32 a206, v202
    v_accvgpr_write_b32 a207, v203
    s_nop 1
    v_mfma_f32_16x16x32_bf16 v[92:95], v[44:47], a[192:195], 0
    v_mfma_f32_16x16x32_bf16 v[96:99], v[60:63], a[192:195], 0
    v_mfma_f32_16x16x32_bf16 v[92:95], v[48:51], a[196:199], v[92:95]
    v_mfma_f32_16x16x32_bf16 v[96:99], v[64:67], a[196:199], v[96:99]
    v_mfma_f32_16x16x32_bf16 v[92:95], v[52:55], a[200:203], v[92:95]
    v_mfma_f32_16x16x32_bf16 v[96:99], v[68:71], a[200:203], v[96:99]
    v_mfma_f32_16x16x32_bf16 v[92:95], v[56:59], a[204:207], v[92:95]
    v_mfma_f32_16x16x32_bf16 v[96:99], v[72:75], a[204:207], v[96:99]
    s_nop 7
    v_max3_f32 v244, v92, v93, v94
    v_max3_f32 v245, v95, v96, v97
    v_max3_f32 v244, v244, v98, v99
    v_max_f32 v244, v244, v245
    v_mov_b32 v245, v244
    s_nop 1
    v_permlane16_swap_b32 v244, v245
    v_max_f32 v244, v244, v245
    v_mov_b32 v245, v244
    s_nop 1
    v_permlane32_swap_b32 v244, v245
    v_max_f32 v244, v244, v245
    v_sub_f32 v32, 0, v244
    v_sub_f32 v33, 0, v244
    v_sub_f32 v34, 0, v244
    v_sub_f32 v35, 0, v244
    s_nop 1
    v_mfma_f32_16x16x32_bf16 v[132:135], a[0:3], a[192:195], v[32:35]
    v_sub_f32 v92, v92, v244
    v_sub_f32 v93, v93, v244
    v_mfma_f32_16x16x32_bf16 v[136:139], a[16:19], a[192:195], v[32:35]
    v_sub_f32 v94, v94, v244
    v_sub_f32 v95, v95, v244
    v_sub_f32 v96, v96, v244
    v_mfma_f32_16x16x32_bf16 v[132:135], a[4:7], a[196:199], v[132:135]
    v_sub_f32 v97, v97, v244
    v_sub_f32 v98, v98, v244
    v_mfma_f32_16x16x32_bf16 v[136:139], a[20:23], a[196:199], v[136:139]
    v_sub_f32 v99, v99, v244
    v_exp_f32 v92, v92
    v_exp_f32 v93, v93
    v_mfma_f32_16x16x32_bf16 v[132:135], a[8:11], a[200:203], v[132:135]
    v_exp_f32 v94, v94
    v_exp_f32 v95, v95
    v_mfma_f32_16x16x32_bf16 v[136:139], a[24:27], a[200:203], v[136:139]
    v_exp_f32 v96, v96
    v_cvt_pk_bf16_f32 v92, v92, v93
    v_cvt_pk_bf16_f32 v93, v94, v95
    v_mfma_f32_16x16x32_bf16 v[132:135], a[12:15], a[204:207], v[132:135]
    v_exp_f32 v97, v97
    v_exp_f32 v98, v98
    v_mfma_f32_16x16x32_bf16 v[136:139], a[28:31], a[204:207], v[136:139]
    v_exp_f32 v99, v99
    v_cvt_pk_bf16_f32 v94, v96, v97
    v_cvt_pk_bf16_f32 v95, v98, v99
    s_add_u32 m0, s34, 24576
    s_nop 0
    buffer_load_dwordx4 v1, s[16:19], s33 offen lds
    buffer_load_dwordx4 v2, s[16:19], s33 offen offset:1024 lds
    s_add_u32 m0, s34, 90112
    s_nop 0
    buffer_load_dwordx4 v1, s[20:23], s33 offen lds
    buffer_load_dwordx4 v2, s[20:23], s33 offen offset:1024 lds
    s_add_u32 s33, s33, 8192
    s_waitcnt vmcnt(8)
    v_lshlrev_b32 v236, 16, v204
    v_and_b32 v237, 0xffff0000, v204
    v_lshlrev_b32 v238, 16, v205
    v_and_b32 v239, 0xffff0000, v205
    v_pk_mul_f32 v[236:237], v[236:237], s[36:37]
    v_pk_mul_f32 v[238:239], v[238:239], s[36:37]
    v_cvt_pk_bf16_f32 v204, v236, v237
    v_cvt_pk_bf16_f32 v205, v238, v239
    v_lshlrev_b32 v240, 16, v206
    v_and_b32 v241, 0xffff0000, v206
    v_lshlrev_b32 v242, 16, v207
    v_and_b32 v243, 0xffff0000, v207
    v_pk_mul_f32 v[240:241], v[240:241], s[36:37]
    v_pk_mul_f32 v[242:243], v[242:243], s[36:37]
    v_cvt_pk_bf16_f32 v206, v240, v241
    v_cvt_pk_bf16_f32 v207, v242, v243
    v_lshlrev_b32 v236, 16, v208
    v_and_b32 v237, 0xffff0000, v208
    v_lshlrev_b32 v238, 16, v209
    v_and_b32 v239, 0xffff0000, v209
    v_pk_mul_f32 v[236:237], v[236:237], s[36:37]
    v_pk_mul_f32 v[238:239], v[238:239], s[36:37]
    v_cvt_pk_bf16_f32 v208, v236, v237
    v_cvt_pk_bf16_f32 v209, v238, v239
    v_lshlrev_b32 v240, 16, v210
    v_and_b32 v241, 0xffff0000, v210
    v_lshlrev_b32 v242, 16, v211
    v_and_b32 v243, 0xffff0000, v211
    v_pk_mul_f32 v[240:241], v[240:241], s[36:37]
    v_pk_mul_f32 v[242:243], v[242:243], s[36:37]
    v_cvt_pk_bf16_f32 v210, v240, v241
    v_cvt_pk_bf16_f32 v211, v242, v243
    v_lshlrev_b32 v236, 16, v212
    v_and_b32 v237, 0xffff0000, v212
    v_lshlrev_b32 v238, 16, v213
    v_and_b32 v239, 0xffff0000, v213
    v_pk_mul_f32 v[236:237], v[236:237], s[36:37]
    v_pk_mul_f32 v[238:239], v[238:239], s[36:37]
    v_cvt_pk_bf16_f32 v212, v236, v237
    v_cvt_pk_bf16_f32 v213, v238, v239
    v_lshlrev_b32 v240, 16, v214
    v_and_b32 v241, 0xffff0000, v214
    v_lshlrev_b32 v242, 16, v215
    v_and_b32 v243, 0xffff0000, v215
    v_pk_mul_f32 v[240:241], v[240:241], s[36:37]
    v_pk_mul_f32 v[242:243], v[242:243], s[36:37]
    v_cvt_pk_bf16_f32 v214, v240, v241
    v_cvt_pk_bf16_f32 v215, v242, v243
    v_lshlrev_b32 v236, 16, v216
    v_and_b32 v237, 0xffff0000, v216
    v_lshlrev_b32 v238, 16, v217
    v_and_b32 v239, 0xffff0000, v217
    v_pk_mul_f32 v[236:237], v[236:237], s[36:37]
    v_pk_mul_f32 v[238:239], v[238:239], s[36:37]
    v_cvt_pk_bf16_f32 v216, v236, v237
    v_cvt_pk_bf16_f32 v217, v238, v239
    v_lshlrev_b32 v240, 16, v218
    v_and_b32 v241, 0xffff0000, v218
    v_lshlrev_b32 v242, 16, v219
    v_and_b32 v243, 0xffff0000, v219
    v_pk_mul_f32 v[240:241], v[240:241], s[36:37]
    v_pk_mul_f32 v[242:243], v[242:243], s[36:37]
    v_cvt_pk_bf16_f32 v218, v240, v241
    v_cvt_pk_bf16_f32 v219, v242, v243
    v_accvgpr_write_b32 a208, v204
    v_accvgpr_write_b32 a209, v205
    v_accvgpr_write_b32 a210, v206
    v_accvgpr_write_b32 a211, v207
    v_accvgpr_write_b32 a212, v208
    v_accvgpr_write_b32 a213, v209
    v_accvgpr_write_b32 a214, v210
    v_accvgpr_write_b32 a215, v211
    v_accvgpr_write_b32 a216, v212
    v_accvgpr_write_b32 a217, v213
    v_accvgpr_write_b32 a218, v214
    v_accvgpr_write_b32 a219, v215
    v_accvgpr_write_b32 a220, v216
    v_accvgpr_write_b32 a221, v217
    v_accvgpr_write_b32 a222, v218
    v_accvgpr_write_b32 a223, v219
    s_nop 1
    v_mfma_f32_16x16x32_bf16 v[100:103], v[44:47], a[208:211], 0
    v_mfma_f32_16x16x32_bf16 v[104:107], v[60:63], a[208:211], 0
    v_mfma_f32_16x16x32_bf16 v[100:103], v[48:51], a[212:215], v[100:103]
    v_mfma_f32_16x16x32_bf16 v[104:107], v[64:67], a[212:215], v[104:107]
    v_mfma_f32_16x16x32_bf16 v[100:103], v[52:55], a[216:219], v[100:103]
    v_mfma_f32_16x16x32_bf16 v[104:107], v[68:71], a[216:219], v[104:107]
    v_mfma_f32_16x16x32_bf16 v[100:103], v[56:59], a[220:223], v[100:103]
    v_mfma_f32_16x16x32_bf16 v[104:107], v[72:75], a[220:223], v[104:107]
    s_nop 7
    v_max3_f32 v244, v100, v101, v102
    v_max3_f32 v245, v103, v104, v105
    v_max3_f32 v244, v244, v106, v107
    v_max_f32 v244, v244, v245
    v_mov_b32 v245, v244
    s_nop 1
    v_permlane16_swap_b32 v244, v245
    v_max_f32 v244, v244, v245
    v_mov_b32 v245, v244
    s_nop 1
    v_permlane32_swap_b32 v244, v245
    v_max_f32 v244, v244, v245
    v_sub_f32 v36, 0, v244
    v_sub_f32 v37, 0, v244
    v_sub_f32 v38, 0, v244
    v_sub_f32 v39, 0, v244
    s_nop 1
    v_mfma_f32_16x16x32_bf16 v[140:143], a[0:3], a[208:211], v[36:39]
    v_sub_f32 v100, v100, v244
    v_sub_f32 v101, v101, v244
    v_mfma_f32_16x16x32_bf16 v[144:147], a[16:19], a[208:211], v[36:39]
    v_sub_f32 v102, v102, v244
    v_sub_f32 v103, v103, v244
    v_sub_f32 v104, v104, v244
    v_mfma_f32_16x16x32_bf16 v[140:143], a[4:7], a[212:215], v[140:143]
    v_sub_f32 v105, v105, v244
    v_sub_f32 v106, v106, v244
    v_mfma_f32_16x16x32_bf16 v[144:147], a[20:23], a[212:215], v[144:147]
    v_sub_f32 v107, v107, v244
    v_exp_f32 v100, v100
    v_exp_f32 v101, v101
    v_mfma_f32_16x16x32_bf16 v[140:143], a[8:11], a[216:219], v[140:143]
    v_exp_f32 v102, v102
    v_exp_f32 v103, v103
    v_mfma_f32_16x16x32_bf16 v[144:147], a[24:27], a[216:219], v[144:147]
    v_exp_f32 v104, v104
    v_cvt_pk_bf16_f32 v100, v100, v101
    v_cvt_pk_bf16_f32 v101, v102, v103
    v_mfma_f32_16x16x32_bf16 v[140:143], a[12:15], a[220:223], v[140:143]
    v_exp_f32 v105, v105
    v_exp_f32 v106, v106
    v_mfma_f32_16x16x32_bf16 v[144:147], a[28:31], a[220:223], v[144:147]
    v_exp_f32 v107, v107
    v_cvt_pk_bf16_f32 v102, v104, v105
    v_cvt_pk_bf16_f32 v103, v106, v107
    s_add_u32 m0, s34, 32768
    s_nop 0
    buffer_load_dwordx4 v1, s[16:19], s33 offen lds
    buffer_load_dwordx4 v2, s[16:19], s33 offen offset:1024 lds
    s_add_u32 m0, s34, 98304
    s_nop 0
    buffer_load_dwordx4 v1, s[20:23], s33 offen lds
    buffer_load_dwordx4 v2, s[20:23], s33 offen offset:1024 lds
    s_add_u32 s33, s33, 8192
    s_add_u32 m0, s34, 40960
    s_nop 0
    buffer_load_dwordx4 v1, s[16:19], s33 offen lds
    buffer_load_dwordx4 v2, s[16:19], s33 offen offset:1024 lds
    s_add_u32 m0, s34, 106496
    s_nop 0
    buffer_load_dwordx4 v1, s[20:23], s33 offen lds
    buffer_load_dwordx4 v2, s[20:23], s33 offen offset:1024 lds
    s_add_u32 s33, s33, 8192
    v_mfma_f32_32x32x16_bf16 a[0:15], v[252:255], v[252:255], 0
    v_mfma_f32_32x32x16_bf16 a[16:31], v[252:255], v[252:255], 0
    v_mfma_f32_32x32x16_bf16 a[32:47], v[252:255], v[252:255], 0
    v_mfma_f32_32x32x16_bf16 a[48:63], v[252:255], v[252:255], 0
    v_mfma_f32_32x32x16_bf16 a[64:79], v[252:255], v[252:255], 0
    v_mfma_f32_32x32x16_bf16 a[80:95], v[252:255], v[252:255], 0
    v_mfma_f32_32x32x16_bf16 a[96:111], v[252:255], v[252:255], 0
    v_mfma_f32_32x32x16_bf16 a[112:127], v[252:255], v[252:255], 0
    v_mfma_f32_32x32x16_bf16 a[240:255], v[252:255], v[252:255], 0
    s_waitcnt vmcnt(12)
    s_barrier
    ds_read_b64_tr_b16 v[44:45], v8 offset:0
    ds_read_b64_tr_b16 v[46:47], v8 offset:4096
    ds_read_b64_tr_b16 v[48:49], v9 offset:0
    ds_read_b64_tr_b16 v[50:51], v9 offset:4096
L_c4_go:
    s_mov_b32 s35, 0
    s_lshl_b32 s50, s46, 4
L_c4_loop:
    s_waitcnt lgkmcnt(2)
    v_mfma_f32_16x16x32_bf16 a[0:3], v[44:47], v[76:79], a[0:3]
    ds_read_b64_tr_b16 v[52:53], v10 offset:0
    ds_read_b64_tr_b16 v[54:55], v10 offset:4096
    v_mfma_f32_16x16x32_bf16 a[32:35], v[44:47], v[84:87], a[32:35]
    v_mfma_f32_16x16x32_bf16 a[64:67], v[44:47], v[92:95], a[64:67]
    v_exp_f32 v116, v116
    v_mfma_f32_16x16x32_bf16 a[96:99], v[44:47], v[100:103], a[96:99]
    v_exp_f32 v117, v117
    s_waitcnt lgkmcnt(2)
    v_mfma_f32_16x16x32_bf16 a[4:7], v[48:51], v[76:79], a[4:7]
    ds_read_b64_tr_b16 v[56:57], v11 offset:0
    ds_read_b64_tr_b16 v[58:59], v11 offset:4096
    v_mfma_f32_16x16x32_bf16 a[36:39], v[48:51], v[84:87], a[36:39]
    v_exp_f32 v118, v118
    v_mfma_f32_16x16x32_bf16 a[68:71], v[48:51], v[92:95], a[68:71]
    v_exp_f32 v119, v119
    v_mfma_f32_16x16x32_bf16 a[100:103], v[48:51], v[100:103], a[100:103]
    v_exp_f32 v120, v120
    s_waitcnt lgkmcnt(2)
    v_mfma_f32_16x16x32_bf16 a[8:11], v[52:55], v[76:79], a[8:11]
    ds_read_b64_tr_b16 v[60:61], v12 offset:0
    ds_read_b64_tr_b16 v[62:63], v12 offset:4096
    v_mfma_f32_16x16x32_bf16 a[40:43], v[52:55], v[84:87], a[40:43]
    v_mfma_f32_16x16x32_bf16 a[72:75], v[52:55], v[92:95], a[72:75]
    v_cvt_pk_bf16_f32 v116, v116, v117
    v_cvt_pk_bf16_f32 v117, v118, v119
    v_mfma_f32_16x16x32_bf16 a[104:107], v[52:55], v[100:103], a[104:107]
    v_exp_f32 v121, v121
    s_waitcnt lgkmcnt(2)
    v_mfma_f32_16x16x32_bf16 a[12:15], v[56:59], v[76:79], a[12:15]
    ds_read_b64_tr_b16 v[64:65], v13 offset:0
    ds_read_b64_tr_b16 v[66:67], v13 offset:4096
    v_mfma_f32_16x16x32_bf16 a[44:47], v[56:59], v[84:87], a[44:47]
    v_exp_f32 v122, v122
    v_mfma_f32_16x16x32_bf16 a[76:79], v[56:59], v[92:95], a[76:79]
    v_exp_f32 v123, v123
    v_mfma_f32_16x16x32_bf16 a[108:111], v[56:59], v[100:103], a[108:111]
    s_waitcnt lgkmcnt(2)
    v_mfma_f32_16x16x32_bf16 a[16:19], v[60:63], v[76:79], a[16:19]
    ds_read_b64_tr_b16 v[68:69], v14 offset:0
    ds_read_b64_tr_b16 v[70:71], v14 offset:4096
    v_mfma_f32_16x16x32_bf16 a[48:51], v[60:63], v[84:87], a[48:51]
    v_cvt_pk_bf16_f32 v118, v120, v121
    v_cvt_pk_bf16_f32 v119, v122, v123
    v_mfma_f32_16x16x32_bf16 a[80:83], v[60:63], v[92:95], a[80:83]
    v_exp_f32 v124, v124
    v_mfma_f32_16x16x32_bf16 a[112:115], v[60:63], v[100:103], a[112:115]
    v_exp_f32 v125, v125
    s_waitcnt lgkmcnt(2)
    v_mfma_f32_16x16x32_bf16 a[20:23], v[64:67], v[76:79], a[20:23]
    ds_read_b64_tr_b16 v[72:73], v15 offset:0
    ds_read_b64_tr_b16 v[74:75], v15 offset:4096
    v_mfma_f32_16x16x32_bf16 a[52:55], v[64:67], v[84:87], a[52:55]
    v_exp_f32 v126, v126
    v_mfma_f32_16x16x32_bf16 a[84:87], v[64:67], v[92:95], a[84:87]
    v_exp_f32 v127, v127
    v_mfma_f32_16x16x32_bf16 a[116:119], v[64:67], v[100:103], a[116:119]
    s_waitcnt lgkmcnt(2)
    v_mfma_f32_16x16x32_bf16 a[24:27], v[68:71], v[76:79], a[24:27]
    ds_read_b128 v[44:47], v4 offset:16384
    ds_read_b128 v[48:51], v5 offset:16384
    v_mfma_f32_16x16x32_bf16 a[56:59], v[68:71], v[84:87], a[56:59]
    v_exp_f32 v128, v128
    v_mfma_f32_16x16x32_bf16 a[88:91], v[68:71], v[92:95], a[88:91]
    v_cvt_pk_bf16_f32 v124, v124, v125
    v_cvt_pk_bf16_f32 v125, v126, v127
    v_mfma_f32_16x16x32_bf16 a[120:123], v[68:71], v[100:103], a[120:123]
    v_exp_f32 v129, v129
    s_waitcnt lgkmcnt(2)
    v_mfma_f32_16x16x32_bf16 a[28:31], v[72:75], v[76:79], a[28:31]
    v_exp_f32 v130, v130
    v_mfma_f32_16x16x32_bf16 a[60:63], v[72:75], v[84:87], a[60:63]
    v_mfma_f32_16x16x32_bf16 a[92:95], v[72:75], v[92:95], a[92:95]
    v_exp_f32 v131, v131
    v_mfma_f32_16x16x32_bf16 a[124:127], v[72:75], v[100:103], a[124:127]
    v_cvt_pk_bf16_f32 v126, v128, v129
    v_cvt_pk_bf16_f32 v127, v130, v131
    v_mfma_f32_16x16x32_bf16 a[240:243], v[248:251], v[76:79], a[240:243]
    v_exp_f32 v132, v132
    v_mfma_f32_16x16x32_bf16 a[244:247], v[248:251], v[84:87], a[244:247]
    v_exp_f32 v133, v133
    s_waitcnt vmcnt(8)
    s_barrier
    v_mfma_f32_16x16x32_bf16 a[248:251], v[248:251], v[92:95], a[248:251]
    s_add_u32 m0, s34, 49152
    s_nop 0
    buffer_load_dwordx4 v1, s[16:19], s33 offen lds
    v_mfma_f32_16x16x32_bf16 a[252:255], v[248:251], v[100:103], a[252:255]
    buffer_load_dwordx4 v2, s[16:19], s33 offen offset:1024 lds
    s_waitcnt lgkmcnt(1)
    v_mfma_f32_16x16x32_bf16 v[76:79], v[44:47], a[160:163], v[24:27]
    ds_read_b128 v[52:55], v6 offset:16384
    ds_read_b128 v[56:59], v7 offset:16384
    v_mfma_f32_16x16x32_bf16 v[84:87], v[44:47], a[176:179], v[28:31]
    s_add_u32 m0, s34, 114688
    s_nop 0
    buffer_load_dwordx4 v1, s[20:23], s33 offen lds
    v_mfma_f32_16x16x32_bf16 v[92:95], v[44:47], a[192:195], v[32:35]
    buffer_load_dwordx4 v2, s[20:23], s33 offen offset:1024 lds
    s_add_u32 s33, s33, 8192
    v_mfma_f32_16x16x32_bf16 v[100:103], v[44:47], a[208:211], v[36:39]
    s_cmp_eq_u32 s50, 1
    s_cbranch_scc1 L_c4_q0a
    s_cmp_eq_u32 s50, 2
    s_cbranch_scc0 L_c4_q0e
    s_add_u32 s38, s44, 8192
    buffer_load_dwordx4 v[188:191], v16, s[12:15], s38 offen offset:0
    s_branch L_c4_q0e
L_c4_q0a:
    s_add_u32 s38, s44, 0
    buffer_load_dwordx4 v[156:159], v16, s[12:15], s38 offen offset:0
L_c4_q0e:
    s_waitcnt lgkmcnt(2)
    v_mfma_f32_16x16x32_bf16 v[76:79], v[48:51], a[164:167], v[76:79]
    v_exp_f32 v134, v134
    v_mfma_f32_16x16x32_bf16 v[84:87], v[48:51], a[180:183], v[84:87]
    v_mfma_f32_16x16x32_bf16 v[92:95], v[48:51], a[196:199], v[92:95]
    v_exp_f32 v135, v135
    v_mfma_f32_16x16x32_bf16 v[100:103], v[48:51], a[212:215], v[100:103]
    v_exp_f32 v136, v136
    s_waitcnt lgkmcnt(1)
    v_mfma_f32_16x16x32_bf16 v[76:79], v[52:55], a[168:171], v[76:79]
    ds_read_b128 v[60:63], v4 offset:20480
    ds_read_b128 v[64:67], v5 offset:20480
    v_mfma_f32_16x16x32_bf16 v[84:87], v[52:55], a[184:187], v[84:87]
    v_cvt_pk_bf16_f32 v132, v132, v133
    v_cvt_pk_bf16_f32 v133, v134, v135
    v_mfma_f32_16x16x32_bf16 v[92:95], v[52:55], a[200:203], v[92:95]
    v_exp_f32 v137, v137
    v_mfma_f32_16x16x32_bf16 v[100:103], v[52:55], a[216:219], v[100:103]
    s_waitcnt lgkmcnt(2)
    v_mfma_f32_16x16x32_bf16 v[76:79], v[56:59], a[172:175], v[76:79]
    v_exp_f32 v138, v138
    v_mfma_f32_16x16x32_bf16 v[84:87], v[56:59], a[188:191], v[84:87]
    v_exp_f32 v139, v139
    v_mfma_f32_16x16x32_bf16 v[92:95], v[56:59], a[204:207], v[92:95]
    v_cvt_pk_bf16_f32 v134, v136, v137
    v_cvt_pk_bf16_f32 v135, v138, v139
    v_mfma_f32_16x16x32_bf16 v[100:103], v[56:59], a[220:223], v[100:103]
    v_exp_f32 v140, v140
    s_waitcnt lgkmcnt(1)
    v_mfma_f32_16x16x32_bf16 v[80:83], v[60:63], a[160:163], v[24:27]
    ds_read_b128 v[68:71], v6 offset:20480
    ds_read_b128 v[72:75], v7 offset:20480
    v_mfma_f32_16x16x32_bf16 v[88:91], v[60:63], a[176:179], v[28:31]
    v_exp_f32 v141, v141
    v_mfma_f32_16x16x32_bf16 v[96:99], v[60:63], a[192:195], v[32:35]
    v_mfma_f32_16x16x32_bf16 v[104:107], v[60:63], a[208:211], v[36:39]
    v_exp_f32 v142, v142
    s_waitcnt lgkmcnt(2)
    v_mfma_f32_16x16x32_bf16 v[80:83], v[64:67], a[164:167], v[80:83]
    v_exp_f32 v143, v143
    v_mfma_f32_16x16x32_bf16 v[88:91], v[64:67], a[180:183], v[88:91]
    v_exp_f32 v144, v144
    v_mfma_f32_16x16x32_bf16 v[96:99], v[64:67], a[196:199], v[96:99]
    v_cvt_pk_bf16_f32 v140, v140, v141
    v_cvt_pk_bf16_f32 v141, v142, v143
    v_mfma_f32_16x16x32_bf16 v[104:107], v[64:67], a[212:215], v[104:107]
    s_waitcnt lgkmcnt(1)
    v_mfma_f32_16x16x32_bf16 v[80:83], v[68:71], a[168:171], v[80:83]
    ds_read_b64_tr_b16 v[44:45], v8 offset:8192
    ds_read_b64_tr_b16 v[46:47], v8 offset:12288
    v_mfma_f32_16x16x32_bf16 v[88:91], v[68:71], a[184:187], v[88:91]
    v_exp_f32 v145, v145
    v_mfma_f32_16x16x32_bf16 v[96:99], v[68:71], a[200:203], v[96:99]
    v_exp_f32 v146, v146
    v_mfma_f32_16x16x32_bf16 v[104:107], v[68:71], a[216:219], v[104:107]
    v_exp_f32 v147, v147
    s_waitcnt lgkmcnt(2)
    v_mfma_f32_16x16x32_bf16 v[80:83], v[72:75], a[172:175], v[80:83]
    ds_read_b64_tr_b16 v[48:49], v9 offset:8192
    ds_read_b64_tr_b16 v[50:51], v9 offset:12288
    v_mfma_f32_16x16x32_bf16 v[88:91], v[72:75], a[188:191], v[88:91]
    v_cvt_pk_bf16_f32 v142, v144, v145
    v_cvt_pk_bf16_f32 v143, v146, v147
    v_mfma_f32_16x16x32_bf16 v[96:99], v[72:75], a[204:207], v[96:99]
    v_mfma_f32_16x16x32_bf16 v[104:107], v[72:75], a[220:223], v[104:107]
    s_waitcnt lgkmcnt(2)
    v_mfma_f32_16x16x32_bf16 a[0:3], v[44:47], v[116:119], a[0:3]
    ds_read_b64_tr_b16 v[52:53], v10 offset:8192
    ds_read_b64_tr_b16 v[54:55], v10 offset:12288
    v_mfma_f32_16x16x32_bf16 a[32:35], v[44:47], v[124:127], a[32:35]
    v_mfma_f32_16x16x32_bf16 a[64:67], v[44:47], v[132:135], a[64:67]
    v_exp_f32 v76, v76
    v_mfma_f32_16x16x32_bf16 a[96:99], v[44:47], v[140:143], a[96:99]
    v_exp_f32 v77, v77
    s_waitcnt lgkmcnt(2)
    v_mfma_f32_16x16x32_bf16 a[4:7], v[48:51], v[116:119], a[4:7]
    ds_read_b64_tr_b16 v[56:57], v11 offset:8192
    ds_read_b64_tr_b16 v[58:59], v11 offset:12288
    v_mfma_f32_16x16x32_bf16 a[36:39], v[48:51], v[124:127], a[36:39]
    v_exp_f32 v78, v78
    v_mfma_f32_16x16x32_bf16 a[68:71], v[48:51], v[132:135], a[68:71]
    v_exp_f32 v79, v79
    v_mfma_f32_16x16x32_bf16 a[100:103], v[48:51], v[140:143], a[100:103]
    v_exp_f32 v80, v80
    s_waitcnt lgkmcnt(2)
    v_mfma_f32_16x16x32_bf16 a[8:11], v[52:55], v[116:119], a[8:11]
    ds_read_b64_tr_b16 v[60:61], v12 offset:8192
    ds_read_b64_tr_b16 v[62:63], v12 offset:12288
    v_mfma_f32_16x16x32_bf16 a[40:43], v[52:55], v[124:127], a[40:43]
    v_mfma_f32_16x16x32_bf16 a[72:75], v[52:55], v[132:135], a[72:75]
    v_cvt_pk_bf16_f32 v76, v76, v77
    v_cvt_pk_bf16_f32 v77, v78, v79
    v_mfma_f32_16x16x32_bf16 a[104:107], v[52:55], v[140:143], a[104:107]
    v_exp_f32 v81, v81
    s_waitcnt lgkmcnt(2)
    v_mfma_f32_16x16x32_bf16 a[12:15], v[56:59], v[116:119], a[12:15]
    ds_read_b64_tr_b16 v[64:65], v13 offset:8192
    ds_read_b64_tr_b16 v[66:67], v13 offset:12288
    v_mfma_f32_16x16x32_bf16 a[44:47], v[56:59], v[124:127], a[44:47]
    v_exp_f32 v82, v82
    v_mfma_f32_16x16x32_bf16 a[76:79], v[56:59], v[132:135], a[76:79]
    v_exp_f32 v83, v83
    v_mfma_f32_16x16x32_bf16 a[108:111], v[56:59], v[140:143], a[108:111]
    s_waitcnt lgkmcnt(2)
    v_mfma_f32_16x16x32_bf16 a[16:19], v[60:63], v[116:119], a[16:19]
    ds_read_b64_tr_b16 v[68:69], v14 offset:8192
    ds_read_b64_tr_b16 v[70:71], v14 offset:12288
    v_mfma_f32_16x16x32_bf16 a[48:51], v[60:63], v[124:127], a[48:51]
    v_cvt_pk_bf16_f32 v78, v80, v81
    v_cvt_pk_bf16_f32 v79, v82, v83
    v_mfma_f32_16x16x32_bf16 a[80:83], v[60:63], v[132:135], a[80:83]
    v_exp_f32 v84, v84
    v_mfma_f32_16x16x32_bf16 a[112:115], v[60:63], v[140:143], a[112:115]
    v_exp_f32 v85, v85
    s_waitcnt lgkmcnt(2)
    v_mfma_f32_16x16x32_bf16 a[20:23], v[64:67], v[116:119], a[20:23]
    ds_read_b64_tr_b16 v[72:73], v15 offset:8192
    ds_read_b64_tr_b16 v[74:75], v15 offset:12288
    v_mfma_f32_16x16x32_bf16 a[52:55], v[64:67], v[124:127], a[52:55]
    v_exp_f32 v86, v86
    s_nop 1
    v_mfma_f32_16x16x32_bf16 a[84:87], v[64:67], v[132:135], a[84:87]
    v_exp_f32 v87, v87
    v_mfma_f32_16x16x32_bf16 a[116:119], v[64:67], v[140:143], a[116:119]
    s_waitcnt lgkmcnt(2)
    v_mfma_f32_16x16x32_bf16 a[24:27], v[68:71], v[116:119], a[24:27]
    ds_read_b128 v[44:47], v4 offset:24576
    ds_read_b128 v[48:51], v5 offset:24576
    v_mfma_f32_16x16x32_bf16 a[56:59], v[68:71], v[124:127], a[56:59]
    v_exp_f32 v88, v88
    s_nop 1
    v_mfma_f32_16x16x32_bf16 a[88:91], v[68:71], v[132:135], a[88:91]
    v_cvt_pk_bf16_f32 v84, v84, v85
    v_cvt_pk_bf16_f32 v85, v86, v87
    v_mfma_f32_16x16x32_bf16 a[120:123], v[68:71], v[140:143], a[120:123]
    v_exp_f32 v89, v89
    s_waitcnt lgkmcnt(2)
    v_mfma_f32_16x16x32_bf16 a[28:31], v[72:75], v[116:119], a[28:31]
    v_exp_f32 v90, v90
    v_mfma_f32_16x16x32_bf16 a[60:63], v[72:75], v[124:127], a[60:63]
    v_mfma_f32_16x16x32_bf16 a[92:95], v[72:75], v[132:135], a[92:95]
    v_exp_f32 v91, v91
    v_mfma_f32_16x16x32_bf16 a[124:127], v[72:75], v[140:143], a[124:127]
    v_cvt_pk_bf16_f32 v86, v88, v89
    v_cvt_pk_bf16_f32 v87, v90, v91
    v_mfma_f32_16x16x32_bf16 a[240:243], v[248:251], v[116:119], a[240:243]
    v_exp_f32 v92, v92
    v_mfma_f32_16x16x32_bf16 a[244:247], v[248:251], v[124:127], a[244:247]
    v_exp_f32 v93, v93
    s_waitcnt vmcnt(8)
    s_barrier
    v_mfma_f32_16x16x32_bf16 a[248:251], v[248:251], v[132:135], a[248:251]
    s_add_u32 m0, s34, 57344
    s_nop 0
    buffer_load_dwordx4 v1, s[16:19], s33 offen lds
    v_mfma_f32_16x16x32_bf16 a[252:255], v[248:251], v[140:143], a[252:255]
    buffer_load_dwordx4 v2, s[16:19], s33 offen offset:1024 lds
    s_waitcnt lgkmcnt(1)
    v_mfma_f32_16x16x32_bf16 v[116:119], v[44:47], a[160:163], v[24:27]
    ds_read_b128 v[52:55], v6 offset:24576
    ds_read_b128 v[56:59], v7 offset:24576
    v_mfma_f32_16x16x32_bf16 v[124:127], v[44:47], a[176:179], v[28:31]
    s_add_u32 m0, s34, 122880
    s_nop 0
    buffer_load_dwordx4 v1, s[20:23], s33 offen lds
    v_mfma_f32_16x16x32_bf16 v[132:135], v[44:47], a[192:195], v[32:35]
    buffer_load_dwordx4 v2, s[20:23], s33 offen offset:1024 lds
    s_add_u32 s33, s33, 8192
    v_mfma_f32_16x16x32_bf16 v[140:143], v[44:47], a[208:211], v[36:39]
    s_cmp_eq_u32 s50, 1
    s_cbranch_scc1 L_c4_q1a
    s_cmp_eq_u32 s50, 2
    s_cbranch_scc0 L_c4_q1e
    s_add_u32 s38, s44, 8192
    buffer_load_dwordx4 v[192:195], v16, s[12:15], s38 offen offset:64
    s_branch L_c4_q1e
L_c4_q1a:
    s_add_u32 s38, s44, 0
    buffer_load_dwordx4 v[160:163], v16, s[12:15], s38 offen offset:64
L_c4_q1e:
    s_waitcnt lgkmcnt(2)
    v_mfma_f32_16x16x32_bf16 v[116:119], v[48:51], a[164:167], v[116:119]
    v_exp_f32 v94, v94
    v_mfma_f32_16x16x32_bf16 v[124:127], v[48:51], a[180:183], v[124:127]
    v_mfma_f32_16x16x32_bf16 v[132:135], v[48:51], a[196:199], v[132:135]
    v_exp_f32 v95, v95
    v_mfma_f32_16x16x32_bf16 v[140:143], v[48:51], a[212:215], v[140:143]
    v_exp_f32 v96, v96
    s_waitcnt lgkmcnt(1)
    v_mfma_f32_16x16x32_bf16 v[116:119], v[52:55], a[168:171], v[116:119]
    ds_read_b128 v[60:63], v4 offset:28672
    ds_read_b128 v[64:67], v5 offset:28672
    v_mfma_f32_16x16x32_bf16 v[124:127], v[52:55], a[184:187], v[124:127]
    v_cvt_pk_bf16_f32 v92, v92, v93
    v_cvt_pk_bf16_f32 v93, v94, v95
    v_mfma_f32_16x16x32_bf16 v[132:135], v[52:55], a[200:203], v[132:135]
    v_exp_f32 v97, v97
    v_mfma_f32_16x16x32_bf16 v[140:143], v[52:55], a[216:219], v[140:143]
    s_waitcnt lgkmcnt(2)
    v_mfma_f32_16x16x32_bf16 v[116:119], v[56:59], a[172:175], v[116:119]
    v_exp_f32 v98, v98
    v_mfma_f32_16x16x32_bf16 v[124:127], v[56:59], a[188:191], v[124:127]
    v_exp_f32 v99, v99
    v_mfma_f32_16x16x32_bf16 v[132:135], v[56:59], a[204:207], v[132:135]
    v_cvt_pk_bf16_f32 v94, v96, v97
    v_cvt_pk_bf16_f32 v95, v98, v99
    v_mfma_f32_16x16x32_bf16 v[140:143], v[56:59], a[220:223], v[140:143]
    v_exp_f32 v100, v100
    s_waitcnt lgkmcnt(1)
    v_mfma_f32_16x16x32_bf16 v[120:123], v[60:63], a[160:163], v[24:27]
    ds_read_b128 v[68:71], v6 offset:28672
    ds_read_b128 v[72:75], v7 offset:28672
    v_mfma_f32_16x16x32_bf16 v[128:131], v[60:63], a[176:179], v[28:31]
    v_exp_f32 v101, v101
    v_mfma_f32_16x16x32_bf16 v[136:139], v[60:63], a[192:195], v[32:35]
    v_mfma_f32_16x16x32_bf16 v[144:147], v[60:63], a[208:211], v[36:39]
    v_exp_f32 v102, v102
    s_waitcnt lgkmcnt(2)
    v_mfma_f32_16x16x32_bf16 v[120:123], v[64:67], a[164:167], v[120:123]
    v_exp_f32 v103, v103
    v_mfma_f32_16x16x32_bf16 v[128:131], v[64:67], a[180:183], v[128:131]
    v_exp_f32 v104, v104
    v_mfma_f32_16x16x32_bf16 v[136:139], v[64:67], a[196:199], v[136:139]
    v_cvt_pk_bf16_f32 v100, v100, v101
    v_cvt_pk_bf16_f32 v101, v102, v103
    v_mfma_f32_16x16x32_bf16 v[144:147], v[64:67], a[212:215], v[144:147]
    s_waitcnt lgkmcnt(1)
    v_mfma_f32_16x16x32_bf16 v[120:123], v[68:71], a[168:171], v[120:123]
    ds_read_b64_tr_b16 v[44:45], v8 offset:16384
    ds_read_b64_tr_b16 v[46:47], v8 offset:20480
    v_mfma_f32_16x16x32_bf16 v[128:131], v[68:71], a[184:187], v[128:131]
    v_exp_f32 v105, v105
    v_mfma_f32_16x16x32_bf16 v[136:139], v[68:71], a[200:203], v[136:139]
    v_exp_f32 v106, v106
    v_mfma_f32_16x16x32_bf16 v[144:147], v[68:71], a[216:219], v[144:147]
    v_exp_f32 v107, v107
    s_waitcnt lgkmcnt(2)
    v_mfma_f32_16x16x32_bf16 v[120:123], v[72:75], a[172:175], v[120:123]
    ds_read_b64_tr_b16 v[48:49], v9 offset:16384
    ds_read_b64_tr_b16 v[50:51], v9 offset:20480
    v_mfma_f32_16x16x32_bf16 v[128:131], v[72:75], a[188:191], v[128:131]
    v_cvt_pk_bf16_f32 v102, v104, v105
    v_cvt_pk_bf16_f32 v103, v106, v107
    v_mfma_f32_16x16x32_bf16 v[136:139], v[72:75], a[204:207], v[136:139]
    v_mfma_f32_16x16x32_bf16 v[144:147], v[72:75], a[220:223], v[144:147]
    s_waitcnt lgkmcnt(2)
    v_mfma_f32_16x16x32_bf16 a[0:3], v[44:47], v[76:79], a[0:3]
    ds_read_b64_tr_b16 v[52:53], v10 offset:16384
    ds_read_b64_tr_b16 v[54:55], v10 offset:20480
    v_mfma_f32_16x16x32_bf16 a[32:35], v[44:47], v[84:87], a[32:35]
    v_mfma_f32_16x16x32_bf16 a[64:67], v[44:47], v[92:95], a[64:67]
    v_exp_f32 v116, v116
    v_mfma_f32_16x16x32_bf16 a[96:99], v[44:47], v[100:103], a[96:99]
    v_exp_f32 v117, v117
    s_waitcnt lgkmcnt(2)
    v_mfma_f32_16x16x32_bf16 a[4:7], v[48:51], v[76:79], a[4:7]
    ds_read_b64_tr_b16 v[56:57], v11 offset:16384
    ds_read_b64_tr_b16 v[58:59], v11 offset:20480
    v_mfma_f32_16x16x32_bf16 a[36:39], v[48:51], v[84:87], a[36:39]
    v_exp_f32 v118, v118
    v_mfma_f32_16x16x32_bf16 a[68:71], v[48:51], v[92:95], a[68:71]
    v_exp_f32 v119, v119
    v_mfma_f32_16x16x32_bf16 a[100:103], v[48:51], v[100:103], a[100:103]
    v_exp_f32 v120, v120
    s_waitcnt lgkmcnt(2)
    v_mfma_f32_16x16x32_bf16 a[8:11], v[52:55], v[76:79], a[8:11]
    ds_read_b64_tr_b16 v[60:61], v12 offset:16384
    ds_read_b64_tr_b16 v[62:63], v12 offset:20480
    v_mfma_f32_16x16x32_bf16 a[40:43], v[52:55], v[84:87], a[40:43]
    v_mfma_f32_16x16x32_bf16 a[72:75], v[52:55], v[92:95], a[72:75]
    v_cvt_pk_bf16_f32 v116, v116, v117
    v_cvt_pk_bf16_f32 v117, v118, v119
    v_mfma_f32_16x16x32_bf16 a[104:107], v[52:55], v[100:103], a[104:107]
    v_exp_f32 v121, v121
    s_waitcnt lgkmcnt(2)
    v_mfma_f32_16x16x32_bf16 a[12:15], v[56:59], v[76:79], a[12:15]
    ds_read_b64_tr_b16 v[64:65], v13 offset:16384
    ds_read_b64_tr_b16 v[66:67], v13 offset:20480
    v_mfma_f32_16x16x32_bf16 a[44:47], v[56:59], v[84:87], a[44:47]
    v_exp_f32 v122, v122
    v_mfma_f32_16x16x32_bf16 a[76:79], v[56:59], v[92:95], a[76:79]
    v_exp_f32 v123, v123
    v_mfma_f32_16x16x32_bf16 a[108:111], v[56:59], v[100:103], a[108:111]
    s_waitcnt lgkmcnt(2)
    v_mfma_f32_16x16x32_bf16 a[16:19], v[60:63], v[76:79], a[16:19]
    ds_read_b64_tr_b16 v[68:69], v14 offset:16384
    ds_read_b64_tr_b16 v[70:71], v14 offset:20480
    v_mfma_f32_16x16x32_bf16 a[48:51], v[60:63], v[84:87], a[48:51]
    v_cvt_pk_bf16_f32 v118, v120, v121
    v_cvt_pk_bf16_f32 v119, v122, v123
    v_mfma_f32_16x16x32_bf16 a[80:83], v[60:63], v[92:95], a[80:83]
    v_exp_f32 v124, v124
    v_mfma_f32_16x16x32_bf16 a[112:115], v[60:63], v[100:103], a[112:115]
    v_exp_f32 v125, v125
    s_waitcnt lgkmcnt(2)
    v_mfma_f32_16x16x32_bf16 a[20:23], v[64:67], v[76:79], a[20:23]
    ds_read_b64_tr_b16 v[72:73], v15 offset:16384
    ds_read_b64_tr_b16 v[74:75], v15 offset:20480
    v_mfma_f32_16x16x32_bf16 a[52:55], v[64:67], v[84:87], a[52:55]
    v_exp_f32 v126, v126
    v_mfma_f32_16x16x32_bf16 a[84:87], v[64:67], v[92:95], a[84:87]
    v_exp_f32 v127, v127
    v_mfma_f32_16x16x32_bf16 a[116:119], v[64:67], v[100:103], a[116:119]
    s_waitcnt lgkmcnt(2)
    v_mfma_f32_16x16x32_bf16 a[24:27], v[68:71], v[76:79], a[24:27]
    ds_read_b128 v[44:47], v4 offset:32768
    ds_read_b128 v[48:51], v5 offset:32768
    v_mfma_f32_16x16x32_bf16 a[56:59], v[68:71], v[84:87], a[56:59]
    v_exp_f32 v128, v128
    v_mfma_f32_16x16x32_bf16 a[88:91], v[68:71], v[92:95], a[88:91]
    v_cvt_pk_bf16_f32 v124, v124, v125
    v_cvt_pk_bf16_f32 v125, v126, v127
    v_mfma_f32_16x16x32_bf16 a[120:123], v[68:71], v[100:103], a[120:123]
    v_exp_f32 v129, v129
    s_waitcnt lgkmcnt(2)
    v_mfma_f32_16x16x32_bf16 a[28:31], v[72:75], v[76:79], a[28:31]
    v_exp_f32 v130, v130
    v_mfma_f32_16x16x32_bf16 a[60:63], v[72:75], v[84:87], a[60:63]
    v_mfma_f32_16x16x32_bf16 a[92:95], v[72:75], v[92:95], a[92:95]
    v_exp_f32 v131, v131
    v_mfma_f32_16x16x32_bf16 a[124:127], v[72:75], v[100:103], a[124:127]
    v_cvt_pk_bf16_f32 v126, v128, v129
    v_cvt_pk_bf16_f32 v127, v130, v131
    v_mfma_f32_16x16x32_bf16 a[240:243], v[248:251], v[76:79], a[240:243]
    v_exp_f32 v132, v132
    v_mfma_f32_16x16x32_bf16 a[244:247], v[248:251], v[84:87], a[244:247]
    v_exp_f32 v133, v133
    s_waitcnt vmcnt(8)
    s_barrier
    v_mfma_f32_16x16x32_bf16 a[248:251], v[248:251], v[92:95], a[248:251]
    s_add_u32 m0, s34, 0
    s_nop 0
    buffer_load_dwordx4 v1, s[16:19], s33 offen lds
    v_mfma_f32_16x16x32_bf16 a[252:255], v[248:251], v[100:103], a[252:255]
    buffer_load_dwordx4 v2, s[16:19], s33 offen offset:1024 lds
    s_waitcnt lgkmcnt(1)
    v_mfma_f32_16x16x32_bf16 v[76:79], v[44:47], a[160:163], v[24:27]
    ds_read_b128 v[52:55], v6 offset:32768
    ds_read_b128 v[56:59], v7 offset:32768
    v_mfma_f32_16x16x32_bf16 v[84:87], v[44:47], a[176:179], v[28:31]
    s_add_u32 m0, s34, 65536
    s_nop 0
    buffer_load_dwordx4 v1, s[20:23], s33 offen lds
    v_mfma_f32_16x16x32_bf16 v[92:95], v[44:47], a[192:195], v[32:35]
    buffer_load_dwordx4 v2, s[20:23], s33 offen offset:1024 lds
    s_add_u32 s33, s33, 8192
    v_mfma_f32_16x16x32_bf16 v[100:103], v[44:47], a[208:211], v[36:39]
    s_cmp_eq_u32 s50, 1
    s_cbranch_scc1 L_c4_q2a
    s_cmp_eq_u32 s50, 2
    s_cbranch_scc0 L_c4_q2e
    s_add_u32 s38, s44, 8192
    buffer_load_dwordx4 v[196:199], v16, s[12:15], s38 offen offset:128
    s_branch L_c4_q2e
L_c4_q2a:
    s_add_u32 s38, s44, 0
    buffer_load_dwordx4 v[164:167], v16, s[12:15], s38 offen offset:128
L_c4_q2e:
    s_waitcnt lgkmcnt(2)
    v_mfma_f32_16x16x32_bf16 v[76:79], v[48:51], a[164:167], v[76:79]
    v_exp_f32 v134, v134
    v_mfma_f32_16x16x32_bf16 v[84:87], v[48:51], a[180:183], v[84:87]
    v_mfma_f32_16x16x32_bf16 v[92:95], v[48:51], a[196:199], v[92:95]
    v_exp_f32 v135, v135
    v_mfma_f32_16x16x32_bf16 v[100:103], v[48:51], a[212:215], v[100:103]
    v_exp_f32 v136, v136
    s_waitcnt lgkmcnt(1)
    v_mfma_f32_16x16x32_bf16 v[76:79], v[52:55], a[168:171], v[76:79]
    ds_read_b128 v[60:63], v4 offset:36864
    ds_read_b128 v[64:67], v5 offset:36864
    v_mfma_f32_16x16x32_bf16 v[84:87], v[52:55], a[184:187], v[84:87]
    v_cvt_pk_bf16_f32 v132, v132, v133
    v_cvt_pk_bf16_f32 v133, v134, v135
    v_mfma_f32_16x16x32_bf16 v[92:95], v[52:55], a[200:203], v[92:95]
    v_exp_f32 v137, v137
    v_mfma_f32_16x16x32_bf16 v[100:103], v[52:55], a[216:219], v[100:103]
    s_waitcnt lgkmcnt(2)
    v_mfma_f32_16x16x32_bf16 v[76:79], v[56:59], a[172:175], v[76:79]
    v_exp_f32 v138, v138
    v_mfma_f32_16x16x32_bf16 v[84:87], v[56:59], a[188:191], v[84:87]
    v_exp_f32 v139, v139
    v_mfma_f32_16x16x32_bf16 v[92:95], v[56:59], a[204:207], v[92:95]
    v_cvt_pk_bf16_f32 v134, v136, v137
    v_cvt_pk_bf16_f32 v135, v138, v139
    v_mfma_f32_16x16x32_bf16 v[100:103], v[56:59], a[220:223], v[100:103]
    v_exp_f32 v140, v140
    s_waitcnt lgkmcnt(1)
    v_mfma_f32_16x16x32_bf16 v[80:83], v[60:63], a[160:163], v[24:27]
    ds_read_b128 v[68:71], v6 offset:36864
    ds_read_b128 v[72:75], v7 offset:36864
    v_mfma_f32_16x16x32_bf16 v[88:91], v[60:63], a[176:179], v[28:31]
    v_exp_f32 v141, v141
    v_mfma_f32_16x16x32_bf16 v[96:99], v[60:63], a[192:195], v[32:35]
    v_mfma_f32_16x16x32_bf16 v[104:107], v[60:63], a[208:211], v[36:39]
    v_exp_f32 v142, v142
    s_waitcnt lgkmcnt(2)
    v_mfma_f32_16x16x32_bf16 v[80:83], v[64:67], a[164:167], v[80:83]
    v_exp_f32 v143, v143
    v_mfma_f32_16x16x32_bf16 v[88:91], v[64:67], a[180:183], v[88:91]
    v_exp_f32 v144, v144
    v_mfma_f32_16x16x32_bf16 v[96:99], v[64:67], a[196:199], v[96:99]
    v_cvt_pk_bf16_f32 v140, v140, v141
    v_cvt_pk_bf16_f32 v141, v142, v143
    v_mfma_f32_16x16x32_bf16 v[104:107], v[64:67], a[212:215], v[104:107]
    s_waitcnt lgkmcnt(1)
    v_mfma_f32_16x16x32_bf16 v[80:83], v[68:71], a[168:171], v[80:83]
    ds_read_b64_tr_b16 v[44:45], v8 offset:24576
    ds_read_b64_tr_b16 v[46:47], v8 offset:28672
    v_mfma_f32_16x16x32_bf16 v[88:91], v[68:71], a[184:187], v[88:91]
    v_exp_f32 v145, v145
    v_mfma_f32_16x16x32_bf16 v[96:99], v[68:71], a[200:203], v[96:99]
    v_exp_f32 v146, v146
    v_mfma_f32_16x16x32_bf16 v[104:107], v[68:71], a[216:219], v[104:107]
    v_exp_f32 v147, v147
    s_waitcnt lgkmcnt(2)
    v_mfma_f32_16x16x32_bf16 v[80:83], v[72:75], a[172:175], v[80:83]
    ds_read_b64_tr_b16 v[48:49], v9 offset:24576
    ds_read_b64_tr_b16 v[50:51], v9 offset:28672
    v_mfma_f32_16x16x32_bf16 v[88:91], v[72:75], a[188:191], v[88:91]
    v_cvt_pk_bf16_f32 v142, v144, v145
    v_cvt_pk_bf16_f32 v143, v146, v147
    v_mfma_f32_16x16x32_bf16 v[96:99], v[72:75], a[204:207], v[96:99]
    v_mfma_f32_16x16x32_bf16 v[104:107], v[72:75], a[220:223], v[104:107]
    s_waitcnt lgkmcnt(2)
    v_mfma_f32_16x16x32_bf16 a[0:3], v[44:47], v[116:119], a[0:3]
    ds_read_b64_tr_b16 v[52:53], v10 offset:24576
    ds_read_b64_tr_b16 v[54:55], v10 offset:28672
    v_mfma_f32_16x16x32_bf16 a[32:35], v[44:47], v[124:127], a[32:35]
    v_mfma_f32_16x16x32_bf16 a[64:67], v[44:47], v[132:135], a[64:67]
    v_exp_f32 v76, v76
    v_mfma_f32_16x16x32_bf16 a[96:99], v[44:47], v[140:143], a[96:99]
    v_exp_f32 v77, v77
    s_waitcnt lgkmcnt(2)
    v_mfma_f32_16x16x32_bf16 a[4:7], v[48:51], v[116:119], a[4:7]
    ds_read_b64_tr_b16 v[56:57], v11 offset:24576
    ds_read_b64_tr_b16 v[58:59], v11 offset:28672
    v_mfma_f32_16x16x32_bf16 a[36:39], v[48:51], v[124:127], a[36:39]
    v_exp_f32 v78, v78
    v_mfma_f32_16x16x32_bf16 a[68:71], v[48:51], v[132:135], a[68:71]
    v_exp_f32 v79, v79
    v_mfma_f32_16x16x32_bf16 a[100:103], v[48:51], v[140:143], a[100:103]
    v_exp_f32 v80, v80
    s_waitcnt lgkmcnt(2)
    v_mfma_f32_16x16x32_bf16 a[8:11], v[52:55], v[116:119], a[8:11]
    ds_read_b64_tr_b16 v[60:61], v12 offset:24576
    ds_read_b64_tr_b16 v[62:63], v12 offset:28672
    v_mfma_f32_16x16x32_bf16 a[40:43], v[52:55], v[124:127], a[40:43]
    v_mfma_f32_16x16x32_bf16 a[72:75], v[52:55], v[132:135], a[72:75]
    v_cvt_pk_bf16_f32 v76, v76, v77
    v_cvt_pk_bf16_f32 v77, v78, v79
    v_mfma_f32_16x16x32_bf16 a[104:107], v[52:55], v[140:143], a[104:107]
    v_exp_f32 v81, v81
    s_waitcnt lgkmcnt(2)
    v_mfma_f32_16x16x32_bf16 a[12:15], v[56:59], v[116:119], a[12:15]
    ds_read_b64_tr_b16 v[64:65], v13 offset:24576
    ds_read_b64_tr_b16 v[66:67], v13 offset:28672
    v_mfma_f32_16x16x32_bf16 a[44:47], v[56:59], v[124:127], a[44:47]
    v_exp_f32 v82, v82
    v_mfma_f32_16x16x32_bf16 a[76:79], v[56:59], v[132:135], a[76:79]
    v_exp_f32 v83, v83
    v_mfma_f32_16x16x32_bf16 a[108:111], v[56:59], v[140:143], a[108:111]
    s_waitcnt lgkmcnt(2)
    v_mfma_f32_16x16x32_bf16 a[16:19], v[60:63], v[116:119], a[16:19]
    ds_read_b64_tr_b16 v[68:69], v14 offset:24576
    ds_read_b64_tr_b16 v[70:71], v14 offset:28672
    v_mfma_f32_16x16x32_bf16 a[48:51], v[60:63], v[124:127], a[48:51]
    v_cvt_pk_bf16_f32 v78, v80, v81
    v_cvt_pk_bf16_f32 v79, v82, v83
    v_mfma_f32_16x16x32_bf16 a[80:83], v[60:63], v[132:135], a[80:83]
    v_exp_f32 v84, v84
    v_mfma_f32_16x16x32_bf16 a[112:115], v[60:63], v[140:143], a[112:115]
    v_exp_f32 v85, v85
    s_waitcnt lgkmcnt(2)
    v_mfma_f32_16x16x32_bf16 a[20:23], v[64:67], v[116:119], a[20:23]
    ds_read_b64_tr_b16 v[72:73], v15 offset:24576
    ds_read_b64_tr_b16 v[74:75], v15 offset:28672
    v_mfma_f32_16x16x32_bf16 a[52:55], v[64:67], v[124:127], a[52:55]
    v_exp_f32 v86, v86
    s_nop 1
    v_mfma_f32_16x16x32_bf16 a[84:87], v[64:67], v[132:135], a[84:87]
    v_exp_f32 v87, v87
    v_mfma_f32_16x16x32_bf16 a[116:119], v[64:67], v[140:143], a[116:119]
    s_waitcnt lgkmcnt(2)
    v_mfma_f32_16x16x32_bf16 a[24:27], v[68:71], v[116:119], a[24:27]
    ds_read_b128 v[44:47], v4 offset:40960
    ds_read_b128 v[48:51], v5 offset:40960
    v_mfma_f32_16x16x32_bf16 a[56:59], v[68:71], v[124:127], a[56:59]
    v_exp_f32 v88, v88
    s_nop 1
    v_mfma_f32_16x16x32_bf16 a[88:91], v[68:71], v[132:135], a[88:91]
    v_cvt_pk_bf16_f32 v84, v84, v85
    v_cvt_pk_bf16_f32 v85, v86, v87
    v_mfma_f32_16x16x32_bf16 a[120:123], v[68:71], v[140:143], a[120:123]
    v_exp_f32 v89, v89
    s_waitcnt lgkmcnt(2)
    v_mfma_f32_16x16x32_bf16 a[28:31], v[72:75], v[116:119], a[28:31]
    v_exp_f32 v90, v90
    v_mfma_f32_16x16x32_bf16 a[60:63], v[72:75], v[124:127], a[60:63]
    v_mfma_f32_16x16x32_bf16 a[92:95], v[72:75], v[132:135], a[92:95]
    v_exp_f32 v91, v91
    v_mfma_f32_16x16x32_bf16 a[124:127], v[72:75], v[140:143], a[124:127]
    v_cvt_pk_bf16_f32 v86, v88, v89
    v_cvt_pk_bf16_f32 v87, v90, v91
    v_mfma_f32_16x16x32_bf16 a[240:243], v[248:251], v[116:119], a[240:243]
    v_exp_f32 v92, v92
    v_mfma_f32_16x16x32_bf16 a[244:247], v[248:251], v[124:127], a[244:247]
    v_exp_f32 v93, v93
    s_waitcnt vmcnt(8)
    s_barrier
    v_mfma_f32_16x16x32_bf16 a[248:251], v[248:251], v[132:135], a[248:251]
    s_add_u32 m0, s34, 8192
    s_nop 0
    buffer_load_dwordx4 v1, s[16:19], s33 offen lds
    v_mfma_f32_16x16x32_bf16 a[252:255], v[248:251], v[140:143], a[252:255]
    buffer_load_dwordx4 v2, s[16:19], s33 offen offset:1024 lds
    s_waitcnt lgkmcnt(1)
    v_mfma_f32_16x16x32_bf16 v[116:119], v[44:47], a[160:163], v[24:27]
    ds_read_b128 v[52:55], v6 offset:40960
    ds_read_b128 v[56:59], v7 offset:40960
    v_mfma_f32_16x16x32_bf16 v[124:127], v[44:47], a[176:179], v[28:31]
    s_add_u32 m0, s34, 73728
    s_nop 0
    buffer_load_dwordx4 v1, s[20:23], s33 offen lds
    v_mfma_f32_16x16x32_bf16 v[132:135], v[44:47], a[192:195], v[32:35]
    buffer_load_dwordx4 v2, s[20:23], s33 offen offset:1024 lds
    s_add_u32 s33, s33, 8192
    v_mfma_f32_16x16x32_bf16 v[140:143], v[44:47], a[208:211], v[36:39]
    s_cmp_eq_u32 s50, 1
    s_cbranch_scc1 L_c4_q3a
    s_cmp_eq_u32 s50, 2
    s_cbranch_scc0 L_c4_q3e
    s_add_u32 s38, s44, 8192
    buffer_load_dwordx4 v[200:203], v16, s[12:15], s38 offen offset:192
    s_branch L_c4_q3e
L_c4_q3a:
    s_add_u32 s38, s44, 0
    buffer_load_dwordx4 v[168:171], v16, s[12:15], s38 offen offset:192
L_c4_q3e:
    s_waitcnt lgkmcnt(2)
    v_mfma_f32_16x16x32_bf16 v[116:119], v[48:51], a[164:167], v[116:119]
    v_exp_f32 v94, v94
    v_mfma_f32_16x16x32_bf16 v[124:127], v[48:51], a[180:183], v[124:127]
    v_mfma_f32_16x16x32_bf16 v[132:135], v[48:51], a[196:199], v[132:135]
    v_exp_f32 v95, v95
    v_mfma_f32_16x16x32_bf16 v[140:143], v[48:51], a[212:215], v[140:143]
    v_exp_f32 v96, v96
    s_waitcnt lgkmcnt(1)
    v_mfma_f32_16x16x32_bf16 v[116:119], v[52:55], a[168:171], v[116:119]
    ds_read_b128 v[60:63], v4 offset:45056
    ds_read_b128 v[64:67], v5 offset:45056
    v_mfma_f32_16x16x32_bf16 v[124:127], v[52:55], a[184:187], v[124:127]
    v_cvt_pk_bf16_f32 v92, v92, v93
    v_cvt_pk_bf16_f32 v93, v94, v95
    v_mfma_f32_16x16x32_bf16 v[132:135], v[52:55], a[200:203], v[132:135]
    v_exp_f32 v97, v97
    v_mfma_f32_16x16x32_bf16 v[140:143], v[52:55], a[216:219], v[140:143]
    s_waitcnt lgkmcnt(2)
    v_mfma_f32_16x16x32_bf16 v[116:119], v[56:59], a[172:175], v[116:119]
    v_exp_f32 v98, v98
    v_mfma_f32_16x16x32_bf16 v[124:127], v[56:59], a[188:191], v[124:127]
    v_exp_f32 v99, v99
    v_mfma_f32_16x16x32_bf16 v[132:135], v[56:59], a[204:207], v[132:135]
    v_cvt_pk_bf16_f32 v94, v96, v97
    v_cvt_pk_bf16_f32 v95, v98, v99
    v_mfma_f32_16x16x32_bf16 v[140:143], v[56:59], a[220:223], v[140:143]
    v_exp_f32 v100, v100
    s_waitcnt lgkmcnt(1)
    v_mfma_f32_16x16x32_bf16 v[120:123], v[60:63], a[160:163], v[24:27]
    ds_read_b128 v[68:71], v6 offset:45056
    ds_read_b128 v[72:75], v7 offset:45056
    v_mfma_f32_16x16x32_bf16 v[128:131], v[60:63], a[176:179], v[28:31]
    v_exp_f32 v101, v101
    v_mfma_f32_16x16x32_bf16 v[136:139], v[60:63], a[192:195], v[32:35]
    v_mfma_f32_16x16x32_bf16 v[144:147], v[60:63], a[208:211], v[36:39]
    v_exp_f32 v102, v102
    s_waitcnt lgkmcnt(2)
    v_mfma_f32_16x16x32_bf16 v[120:123], v[64:67], a[164:167], v[120:123]
    v_exp_f32 v103, v103
    v_mfma_f32_16x16x32_bf16 v[128:131], v[64:67], a[180:183], v[128:131]
    v_exp_f32 v104, v104
    v_mfma_f32_16x16x32_bf16 v[136:139], v[64:67], a[196:199], v[136:139]
    v_cvt_pk_bf16_f32 v100, v100, v101
    v_cvt_pk_bf16_f32 v101, v102, v103
    v_mfma_f32_16x16x32_bf16 v[144:147], v[64:67], a[212:215], v[144:147]
    s_waitcnt lgkmcnt(1)
    v_mfma_f32_16x16x32_bf16 v[120:123], v[68:71], a[168:171], v[120:123]
    ds_read_b64_tr_b16 v[44:45], v8 offset:32768
    ds_read_b64_tr_b16 v[46:47], v8 offset:36864
    v_mfma_f32_16x16x32_bf16 v[128:131], v[68:71], a[184:187], v[128:131]
    v_exp_f32 v105, v105
    v_mfma_f32_16x16x32_bf16 v[136:139], v[68:71], a[200:203], v[136:139]
    v_exp_f32 v106, v106
    v_mfma_f32_16x16x32_bf16 v[144:147], v[68:71], a[216:219], v[144:147]
    v_exp_f32 v107, v107
    s_waitcnt lgkmcnt(2)
    v_mfma_f32_16x16x32_bf16 v[120:123], v[72:75], a[172:175], v[120:123]
    ds_read_b64_tr_b16 v[48:49], v9 offset:32768
    ds_read_b64_tr_b16 v[50:51], v9 offset:36864
    v_mfma_f32_16x16x32_bf16 v[128:131], v[72:75], a[188:191], v[128:131]
    v_cvt_pk_bf16_f32 v102, v104, v105
    v_cvt_pk_bf16_f32 v103, v106, v107
    v_mfma_f32_16x16x32_bf16 v[136:139], v[72:75], a[204:207], v[136:139]
    v_mfma_f32_16x16x32_bf16 v[144:147], v[72:75], a[220:223], v[144:147]
    s_waitcnt lgkmcnt(2)
    v_mfma_f32_16x16x32_bf16 a[0:3], v[44:47], v[76:79], a[0:3]
    ds_read_b64_tr_b16 v[52:53], v10 offset:32768
    ds_read_b64_tr_b16 v[54:55], v10 offset:36864
    v_mfma_f32_16x16x32_bf16 a[32:35], v[44:47], v[84:87], a[32:35]
    v_mfma_f32_16x16x32_bf16 a[64:67], v[44:47], v[92:95], a[64:67]
    v_exp_f32 v116, v116
    v_mfma_f32_16x16x32_bf16 a[96:99], v[44:47], v[100:103], a[96:99]
    v_exp_f32 v117, v117
    s_waitcnt lgkmcnt(2)
    v_mfma_f32_16x16x32_bf16 a[4:7], v[48:51], v[76:79], a[4:7]
    ds_read_b64_tr_b16 v[56:57], v11 offset:32768
    ds_read_b64_tr_b16 v[58:59], v11 offset:36864
    v_mfma_f32_16x16x32_bf16 a[36:39], v[48:51], v[84:87], a[36:39]
    v_exp_f32 v118, v118
    v_mfma_f32_16x16x32_bf16 a[68:71], v[48:51], v[92:95], a[68:71]
    v_exp_f32 v119, v119
    v_mfma_f32_16x16x32_bf16 a[100:103], v[48:51], v[100:103], a[100:103]
    v_exp_f32 v120, v120
    s_waitcnt lgkmcnt(2)
    v_mfma_f32_16x16x32_bf16 a[8:11], v[52:55], v[76:79], a[8:11]
    ds_read_b64_tr_b16 v[60:61], v12 offset:32768
    ds_read_b64_tr_b16 v[62:63], v12 offset:36864
    v_mfma_f32_16x16x32_bf16 a[40:43], v[52:55], v[84:87], a[40:43]
    v_mfma_f32_16x16x32_bf16 a[72:75], v[52:55], v[92:95], a[72:75]
    v_cvt_pk_bf16_f32 v116, v116, v117
    v_cvt_pk_bf16_f32 v117, v118, v119
    v_mfma_f32_16x16x32_bf16 a[104:107], v[52:55], v[100:103], a[104:107]
    v_exp_f32 v121, v121
    s_waitcnt lgkmcnt(2)
    v_mfma_f32_16x16x32_bf16 a[12:15], v[56:59], v[76:79], a[12:15]
    ds_read_b64_tr_b16 v[64:65], v13 offset:32768
    ds_read_b64_tr_b16 v[66:67], v13 offset:36864
    v_mfma_f32_16x16x32_bf16 a[44:47], v[56:59], v[84:87], a[44:47]
    v_exp_f32 v122, v122
    v_mfma_f32_16x16x32_bf16 a[76:79], v[56:59], v[92:95], a[76:79]
    v_exp_f32 v123, v123
    v_mfma_f32_16x16x32_bf16 a[108:111], v[56:59], v[100:103], a[108:111]
    s_waitcnt lgkmcnt(2)
    v_mfma_f32_16x16x32_bf16 a[16:19], v[60:63], v[76:79], a[16:19]
    ds_read_b64_tr_b16 v[68:69], v14 offset:32768
    ds_read_b64_tr_b16 v[70:71], v14 offset:36864
    v_mfma_f32_16x16x32_bf16 a[48:51], v[60:63], v[84:87], a[48:51]
    v_cvt_pk_bf16_f32 v118, v120, v121
    v_cvt_pk_bf16_f32 v119, v122, v123
    v_mfma_f32_16x16x32_bf16 a[80:83], v[60:63], v[92:95], a[80:83]
    v_exp_f32 v124, v124
    v_mfma_f32_16x16x32_bf16 a[112:115], v[60:63], v[100:103], a[112:115]
    v_exp_f32 v125, v125
    s_waitcnt lgkmcnt(2)
    v_mfma_f32_16x16x32_bf16 a[20:23], v[64:67], v[76:79], a[20:23]
    ds_read_b64_tr_b16 v[72:73], v15 offset:32768
    ds_read_b64_tr_b16 v[74:75], v15 offset:36864
    v_mfma_f32_16x16x32_bf16 a[52:55], v[64:67], v[84:87], a[52:55]
    v_exp_f32 v126, v126
    v_mfma_f32_16x16x32_bf16 a[84:87], v[64:67], v[92:95], a[84:87]
    v_exp_f32 v127, v127
    v_mfma_f32_16x16x32_bf16 a[116:119], v[64:67], v[100:103], a[116:119]
    s_waitcnt lgkmcnt(2)
    v_mfma_f32_16x16x32_bf16 a[24:27], v[68:71], v[76:79], a[24:27]
    ds_read_b128 v[44:47], v4 offset:49152
    ds_read_b128 v[48:51], v5 offset:49152
    v_mfma_f32_16x16x32_bf16 a[56:59], v[68:71], v[84:87], a[56:59]
    v_exp_f32 v128, v128
    v_mfma_f32_16x16x32_bf16 a[88:91], v[68:71], v[92:95], a[88:91]
    v_cvt_pk_bf16_f32 v124, v124, v125
    v_cvt_pk_bf16_f32 v125, v126, v127
    v_mfma_f32_16x16x32_bf16 a[120:123], v[68:71], v[100:103], a[120:123]
    v_exp_f32 v129, v129
    s_waitcnt lgkmcnt(2)
    v_mfma_f32_16x16x32_bf16 a[28:31], v[72:75], v[76:79], a[28:31]
    v_exp_f32 v130, v130
    v_mfma_f32_16x16x32_bf16 a[60:63], v[72:75], v[84:87], a[60:63]
    v_mfma_f32_16x16x32_bf16 a[92:95], v[72:75], v[92:95], a[92:95]
    v_exp_f32 v131, v131
    v_mfma_f32_16x16x32_bf16 a[124:127], v[72:75], v[100:103], a[124:127]
    v_cvt_pk_bf16_f32 v126, v128, v129
    v_cvt_pk_bf16_f32 v127, v130, v131
    v_mfma_f32_16x16x32_bf16 a[240:243], v[248:251], v[76:79], a[240:243]
    v_exp_f32 v132, v132
    v_mfma_f32_16x16x32_bf16 a[244:247], v[248:251], v[84:87], a[244:247]
    v_exp_f32 v133, v133
    s_waitcnt vmcnt(8)
    s_barrier
    v_mfma_f32_16x16x32_bf16 a[248:251], v[248:251], v[92:95], a[248:251]
    s_add_u32 m0, s34, 16384
    s_nop 0
    buffer_load_dwordx4 v1, s[16:19], s33 offen lds
    v_mfma_f32_16x16x32_bf16 a[252:255], v[248:251], v[100:103], a[252:255]
    buffer_load_dwordx4 v2, s[16:19], s33 offen offset:1024 lds
    s_waitcnt lgkmcnt(1)
    v_mfma_f32_16x16x32_bf16 v[76:79], v[44:47], a[160:163], v[24:27]
    ds_read_b128 v[52:55], v6 offset:49152
    ds_read_b128 v[56:59], v7 offset:49152
    v_mfma_f32_16x16x32_bf16 v[84:87], v[44:47], a[176:179], v[28:31]
    s_add_u32 m0, s34, 81920
    s_nop 0
    buffer_load_dwordx4 v1, s[20:23], s33 offen lds
    v_mfma_f32_16x16x32_bf16 v[92:95], v[44:47], a[192:195], v[32:35]
    buffer_load_dwordx4 v2, s[20:23], s33 offen offset:1024 lds
    s_add_u32 s33, s33, 8192
    v_mfma_f32_16x16x32_bf16 v[100:103], v[44:47], a[208:211], v[36:39]
    s_cmp_eq_u32 s50, 1
    s_cbranch_scc1 L_c4_q4a
    s_cmp_eq_u32 s50, 2
    s_cbranch_scc0 L_c4_q4e
    s_add_u32 s38, s44, 12288
    buffer_load_dwordx4 v[204:207], v16, s[12:15], s38 offen offset:0
    s_branch L_c4_q4e
L_c4_q4a:
    s_add_u32 s38, s44, 4096
    buffer_load_dwordx4 v[172:175], v16, s[12:15], s38 offen offset:0
L_c4_q4e:
    s_waitcnt lgkmcnt(2)
    v_mfma_f32_16x16x32_bf16 v[76:79], v[48:51], a[164:167], v[76:79]
    v_exp_f32 v134, v134
    v_mfma_f32_16x16x32_bf16 v[84:87], v[48:51], a[180:183], v[84:87]
    v_mfma_f32_16x16x32_bf16 v[92:95], v[48:51], a[196:199], v[92:95]
    v_exp_f32 v135, v135
    v_mfma_f32_16x16x32_bf16 v[100:103], v[48:51], a[212:215], v[100:103]
    v_exp_f32 v136, v136
    s_waitcnt lgkmcnt(1)
    v_mfma_f32_16x16x32_bf16 v[76:79], v[52:55], a[168:171], v[76:79]
    ds_read_b128 v[60:63], v4 offset:53248
    ds_read_b128 v[64:67], v5 offset:53248
    v_mfma_f32_16x16x32_bf16 v[84:87], v[52:55], a[184:187], v[84:87]
    v_cvt_pk_bf16_f32 v132, v132, v133
    v_cvt_pk_bf16_f32 v133, v134, v135
    v_mfma_f32_16x16x32_bf16 v[92:95], v[52:55], a[200:203], v[92:95]
    v_exp_f32 v137, v137
    v_mfma_f32_16x16x32_bf16 v[100:103], v[52:55], a[216:219], v[100:103]
    s_waitcnt lgkmcnt(2)
    v_mfma_f32_16x16x32_bf16 v[76:79], v[56:59], a[172:175], v[76:79]
    v_exp_f32 v138, v138
    v_mfma_f32_16x16x32_bf16 v[84:87], v[56:59], a[188:191], v[84:87]
    v_exp_f32 v139, v139
    v_mfma_f32_16x16x32_bf16 v[92:95], v[56:59], a[204:207], v[92:95]
    v_cvt_pk_bf16_f32 v134, v136, v137
    v_cvt_pk_bf16_f32 v135, v138, v139
    v_mfma_f32_16x16x32_bf16 v[100:103], v[56:59], a[220:223], v[100:103]
    v_exp_f32 v140, v140
    s_waitcnt lgkmcnt(1)
    v_mfma_f32_16x16x32_bf16 v[80:83], v[60:63], a[160:163], v[24:27]
    ds_read_b128 v[68:71], v6 offset:53248
    ds_read_b128 v[72:75], v7 offset:53248
    v_mfma_f32_16x16x32_bf16 v[88:91], v[60:63], a[176:179], v[28:31]
    v_exp_f32 v141, v141
    v_mfma_f32_16x16x32_bf16 v[96:99], v[60:63], a[192:195], v[32:35]
    v_mfma_f32_16x16x32_bf16 v[104:107], v[60:63], a[208:211], v[36:39]
    v_exp_f32 v142, v142
    s_waitcnt lgkmcnt(2)
    v_mfma_f32_16x16x32_bf16 v[80:83], v[64:67], a[164:167], v[80:83]
    v_exp_f32 v143, v143
    v_mfma_f32_16x16x32_bf16 v[88:91], v[64:67], a[180:183], v[88:91]
    v_exp_f32 v144, v144
    v_mfma_f32_16x16x32_bf16 v[96:99], v[64:67], a[196:199], v[96:99]
    v_cvt_pk_bf16_f32 v140, v140, v141
    v_cvt_pk_bf16_f32 v141, v142, v143
    v_mfma_f32_16x16x32_bf16 v[104:107], v[64:67], a[212:215], v[104:107]
    s_waitcnt lgkmcnt(1)
    v_mfma_f32_16x16x32_bf16 v[80:83], v[68:71], a[168:171], v[80:83]
    ds_read_b64_tr_b16 v[44:45], v8 offset:40960
    ds_read_b64_tr_b16 v[46:47], v8 offset:45056
    v_mfma_f32_16x16x32_bf16 v[88:91], v[68:71], a[184:187], v[88:91]
    v_exp_f32 v145, v145
    v_mfma_f32_16x16x32_bf16 v[96:99], v[68:71], a[200:203], v[96:99]
    v_exp_f32 v146, v146
    v_mfma_f32_16x16x32_bf16 v[104:107], v[68:71], a[216:219], v[104:107]
    v_exp_f32 v147, v147
    s_waitcnt lgkmcnt(2)
    v_mfma_f32_16x16x32_bf16 v[80:83], v[72:75], a[172:175], v[80:83]
    ds_read_b64_tr_b16 v[48:49], v9 offset:40960
    ds_read_b64_tr_b16 v[50:51], v9 offset:45056
    v_mfma_f32_16x16x32_bf16 v[88:91], v[72:75], a[188:191], v[88:91]
    v_cvt_pk_bf16_f32 v142, v144, v145
    v_cvt_pk_bf16_f32 v143, v146, v147
    v_mfma_f32_16x16x32_bf16 v[96:99], v[72:75], a[204:207], v[96:99]
    v_mfma_f32_16x16x32_bf16 v[104:107], v[72:75], a[220:223], v[104:107]
    s_waitcnt lgkmcnt(2)
    v_mfma_f32_16x16x32_bf16 a[0:3], v[44:47], v[116:119], a[0:3]
    ds_read_b64_tr_b16 v[52:53], v10 offset:40960
    ds_read_b64_tr_b16 v[54:55], v10 offset:45056
    v_mfma_f32_16x16x32_bf16 a[32:35], v[44:47], v[124:127], a[32:35]
    v_mfma_f32_16x16x32_bf16 a[64:67], v[44:47], v[132:135], a[64:67]
    v_exp_f32 v76, v76
    v_mfma_f32_16x16x32_bf16 a[96:99], v[44:47], v[140:143], a[96:99]
    v_exp_f32 v77, v77
    s_waitcnt lgkmcnt(2)
    v_mfma_f32_16x16x32_bf16 a[4:7], v[48:51], v[116:119], a[4:7]
    ds_read_b64_tr_b16 v[56:57], v11 offset:40960
    ds_read_b64_tr_b16 v[58:59], v11 offset:45056
    v_mfma_f32_16x16x32_bf16 a[36:39], v[48:51], v[124:127], a[36:39]
    v_exp_f32 v78, v78
    v_mfma_f32_16x16x32_bf16 a[68:71], v[48:51], v[132:135], a[68:71]
    v_exp_f32 v79, v79
    v_mfma_f32_16x16x32_bf16 a[100:103], v[48:51], v[140:143], a[100:103]
    v_exp_f32 v80, v80
    s_waitcnt lgkmcnt(2)
    v_mfma_f32_16x16x32_bf16 a[8:11], v[52:55], v[116:119], a[8:11]
    ds_read_b64_tr_b16 v[60:61], v12 offset:40960
    ds_read_b64_tr_b16 v[62:63], v12 offset:45056
    v_mfma_f32_16x16x32_bf16 a[40:43], v[52:55], v[124:127], a[40:43]
    v_mfma_f32_16x16x32_bf16 a[72:75], v[52:55], v[132:135], a[72:75]
    v_cvt_pk_bf16_f32 v76, v76, v77
    v_cvt_pk_bf16_f32 v77, v78, v79
    v_mfma_f32_16x16x32_bf16 a[104:107], v[52:55], v[140:143], a[104:107]
    v_exp_f32 v81, v81
    s_waitcnt lgkmcnt(2)
    v_mfma_f32_16x16x32_bf16 a[12:15], v[56:59], v[116:119], a[12:15]
    ds_read_b64_tr_b16 v[64:65], v13 offset:40960
    ds_read_b64_tr_b16 v[66:67], v13 offset:45056
    v_mfma_f32_16x16x32_bf16 a[44:47], v[56:59], v[124:127], a[44:47]
    v_exp_f32 v82, v82
    v_mfma_f32_16x16x32_bf16 a[76:79], v[56:59], v[132:135], a[76:79]
    v_exp_f32 v83, v83
    v_mfma_f32_16x16x32_bf16 a[108:111], v[56:59], v[140:143], a[108:111]
    s_waitcnt lgkmcnt(2)
    v_mfma_f32_16x16x32_bf16 a[16:19], v[60:63], v[116:119], a[16:19]
    ds_read_b64_tr_b16 v[68:69], v14 offset:40960
    ds_read_b64_tr_b16 v[70:71], v14 offset:45056
    v_mfma_f32_16x16x32_bf16 a[48:51], v[60:63], v[124:127], a[48:51]
    v_cvt_pk_bf16_f32 v78, v80, v81
    v_cvt_pk_bf16_f32 v79, v82, v83
    v_mfma_f32_16x16x32_bf16 a[80:83], v[60:63], v[132:135], a[80:83]
    v_exp_f32 v84, v84
    v_mfma_f32_16x16x32_bf16 a[112:115], v[60:63], v[140:143], a[112:115]
    v_exp_f32 v85, v85
    s_waitcnt lgkmcnt(2)
    v_mfma_f32_16x16x32_bf16 a[20:23], v[64:67], v[116:119], a[20:23]
    ds_read_b64_tr_b16 v[72:73], v15 offset:40960
    ds_read_b64_tr_b16 v[74:75], v15 offset:45056
    v_mfma_f32_16x16x32_bf16 a[52:55], v[64:67], v[124:127], a[52:55]
    v_exp_f32 v86, v86
    s_nop 1
    v_mfma_f32_16x16x32_bf16 a[84:87], v[64:67], v[132:135], a[84:87]
    v_exp_f32 v87, v87
    v_mfma_f32_16x16x32_bf16 a[116:119], v[64:67], v[140:143], a[116:119]
    s_waitcnt lgkmcnt(2)
    v_mfma_f32_16x16x32_bf16 a[24:27], v[68:71], v[116:119], a[24:27]
    ds_read_b128 v[44:47], v4 offset:57344
    ds_read_b128 v[48:51], v5 offset:57344
    v_mfma_f32_16x16x32_bf16 a[56:59], v[68:71], v[124:127], a[56:59]
    v_exp_f32 v88, v88
    s_nop 1
    v_mfma_f32_16x16x32_bf16 a[88:91], v[68:71], v[132:135], a[88:91]
    v_cvt_pk_bf16_f32 v84, v84, v85
    v_cvt_pk_bf16_f32 v85, v86, v87
    v_mfma_f32_16x16x32_bf16 a[120:123], v[68:71], v[140:143], a[120:123]
    v_exp_f32 v89, v89
    s_waitcnt lgkmcnt(2)
    v_mfma_f32_16x16x32_bf16 a[28:31], v[72:75], v[116:119], a[28:31]
    v_exp_f32 v90, v90
    v_mfma_f32_16x16x32_bf16 a[60:63], v[72:75], v[124:127], a[60:63]
    v_mfma_f32_16x16x32_bf16 a[92:95], v[72:75], v[132:135], a[92:95]
    v_exp_f32 v91, v91
    v_mfma_f32_16x16x32_bf16 a[124:127], v[72:75], v[140:143], a[124:127]
    v_cvt_pk_bf16_f32 v86, v88, v89
    v_cvt_pk_bf16_f32 v87, v90, v91
    v_mfma_f32_16x16x32_bf16 a[240:243], v[248:251], v[116:119], a[240:243]
    v_exp_f32 v92, v92
    v_mfma_f32_16x16x32_bf16 a[244:247], v[248:251], v[124:127], a[244:247]
    v_exp_f32 v93, v93
    s_waitcnt vmcnt(8)
    s_barrier
    v_mfma_f32_16x16x32_bf16 a[248:251], v[248:251], v[132:135], a[248:251]
    s_add_u32 m0, s34, 24576
    s_nop 0
    buffer_load_dwordx4 v1, s[16:19], s33 offen lds
    v_mfma_f32_16x16x32_bf16 a[252:255], v[248:251], v[140:143], a[252:255]
    buffer_load_dwordx4 v2, s[16:19], s33 offen offset:1024 lds
    s_waitcnt lgkmcnt(1)
    v_mfma_f32_16x16x32_bf16 v[116:119], v[44:47], a[160:163], v[24:27]
    ds_read_b128 v[52:55], v6 offset:57344
    ds_read_b128 v[56:59], v7 offset:57344
    v_mfma_f32_16x16x32_bf16 v[124:127], v[44:47], a[176:179], v[28:31]
    s_add_u32 m0, s34, 90112
    s_nop 0
    buffer_load_dwordx4 v1, s[20:23], s33 offen lds
    v_mfma_f32_16x16x32_bf16 v[132:135], v[44:47], a[192:195], v[32:35]
    buffer_load_dwordx4 v2, s[20:23], s33 offen offset:1024 lds
    s_add_u32 s33, s33, 8192
    v_mfma_f32_16x16x32_bf16 v[140:143], v[44:47], a[208:211], v[36:39]
    s_cmp_eq_u32 s50, 1
    s_cbranch_scc1 L_c4_q5a
    s_cmp_eq_u32 s50, 2
    s_cbranch_scc0 L_c4_q5e
    s_add_u32 s38, s44, 12288
    buffer_load_dwordx4 v[208:211], v16, s[12:15], s38 offen offset:64
    s_branch L_c4_q5e
L_c4_q5a:
    s_add_u32 s38, s44, 4096
    buffer_load_dwordx4 v[176:179], v16, s[12:15], s38 offen offset:64
L_c4_q5e:
    s_waitcnt lgkmcnt(2)
    v_mfma_f32_16x16x32_bf16 v[116:119], v[48:51], a[164:167], v[116:119]
    v_exp_f32 v94, v94
    v_mfma_f32_16x16x32_bf16 v[124:127], v[48:51], a[180:183], v[124:127]
    v_mfma_f32_16x16x32_bf16 v[132:135], v[48:51], a[196:199], v[132:135]
    v_exp_f32 v95, v95
    v_mfma_f32_16x16x32_bf16 v[140:143], v[48:51], a[212:215], v[140:143]
    v_exp_f32 v96, v96
    s_waitcnt lgkmcnt(1)
    v_mfma_f32_16x16x32_bf16 v[116:119], v[52:55], a[168:171], v[116:119]
    ds_read_b128 v[60:63], v4 offset:61440
    ds_read_b128 v[64:67], v5 offset:61440
    v_mfma_f32_16x16x32_bf16 v[124:127], v[52:55], a[184:187], v[124:127]
    v_cvt_pk_bf16_f32 v92, v92, v93
    v_cvt_pk_bf16_f32 v93, v94, v95
    v_mfma_f32_16x16x32_bf16 v[132:135], v[52:55], a[200:203], v[132:135]
    v_exp_f32 v97, v97
    v_mfma_f32_16x16x32_bf16 v[140:143], v[52:55], a[216:219], v[140:143]
    s_waitcnt lgkmcnt(2)
    v_mfma_f32_16x16x32_bf16 v[116:119], v[56:59], a[172:175], v[116:119]
    v_exp_f32 v98, v98
    v_mfma_f32_16x16x32_bf16 v[124:127], v[56:59], a[188:191], v[124:127]
    v_exp_f32 v99, v99
    v_mfma_f32_16x16x32_bf16 v[132:135], v[56:59], a[204:207], v[132:135]
    v_cvt_pk_bf16_f32 v94, v96, v97
    v_cvt_pk_bf16_f32 v95, v98, v99
    v_mfma_f32_16x16x32_bf16 v[140:143], v[56:59], a[220:223], v[140:143]
    v_exp_f32 v100, v100
    s_waitcnt lgkmcnt(1)
    v_mfma_f32_16x16x32_bf16 v[120:123], v[60:63], a[160:163], v[24:27]
    ds_read_b128 v[68:71], v6 offset:61440
    ds_read_b128 v[72:75], v7 offset:61440
    v_mfma_f32_16x16x32_bf16 v[128:131], v[60:63], a[176:179], v[28:31]
    v_exp_f32 v101, v101
    v_mfma_f32_16x16x32_bf16 v[136:139], v[60:63], a[192:195], v[32:35]
    v_mfma_f32_16x16x32_bf16 v[144:147], v[60:63], a[208:211], v[36:39]
    v_exp_f32 v102, v102
    s_waitcnt lgkmcnt(2)
    v_mfma_f32_16x16x32_bf16 v[120:123], v[64:67], a[164:167], v[120:123]
    v_exp_f32 v103, v103
    v_mfma_f32_16x16x32_bf16 v[128:131], v[64:67], a[180:183], v[128:131]
    v_exp_f32 v104, v104
    v_mfma_f32_16x16x32_bf16 v[136:139], v[64:67], a[196:199], v[136:139]
    v_cvt_pk_bf16_f32 v100, v100, v101
    v_cvt_pk_bf16_f32 v101, v102, v103
    v_mfma_f32_16x16x32_bf16 v[144:147], v[64:67], a[212:215], v[144:147]
    s_waitcnt lgkmcnt(1)
    v_mfma_f32_16x16x32_bf16 v[120:123], v[68:71], a[168:171], v[120:123]
    ds_read_b64_tr_b16 v[44:45], v8 offset:49152
    ds_read_b64_tr_b16 v[46:47], v8 offset:53248
    v_mfma_f32_16x16x32_bf16 v[128:131], v[68:71], a[184:187], v[128:131]
    v_exp_f32 v105, v105
    v_mfma_f32_16x16x32_bf16 v[136:139], v[68:71], a[200:203], v[136:139]
    v_exp_f32 v106, v106
    v_mfma_f32_16x16x32_bf16 v[144:147], v[68:71], a[216:219], v[144:147]
    v_exp_f32 v107, v107
    s_waitcnt lgkmcnt(2)
    v_mfma_f32_16x16x32_bf16 v[120:123], v[72:75], a[172:175], v[120:123]
    ds_read_b64_tr_b16 v[48:49], v9 offset:49152
    ds_read_b64_tr_b16 v[50:51], v9 offset:53248
    v_mfma_f32_16x16x32_bf16 v[128:131], v[72:75], a[188:191], v[128:131]
    v_cvt_pk_bf16_f32 v102, v104, v105
    v_cvt_pk_bf16_f32 v103, v106, v107
    v_mfma_f32_16x16x32_bf16 v[136:139], v[72:75], a[204:207], v[136:139]
    v_mfma_f32_16x16x32_bf16 v[144:147], v[72:75], a[220:223], v[144:147]
    s_waitcnt lgkmcnt(2)
    v_mfma_f32_16x16x32_bf16 a[0:3], v[44:47], v[76:79], a[0:3]
    ds_read_b64_tr_b16 v[52:53], v10 offset:49152
    ds_read_b64_tr_b16 v[54:55], v10 offset:53248
    v_mfma_f32_16x16x32_bf16 a[32:35], v[44:47], v[84:87], a[32:35]
    v_mfma_f32_16x16x32_bf16 a[64:67], v[44:47], v[92:95], a[64:67]
    v_exp_f32 v116, v116
    v_mfma_f32_16x16x32_bf16 a[96:99], v[44:47], v[100:103], a[96:99]
    v_exp_f32 v117, v117
    s_waitcnt lgkmcnt(2)
    v_mfma_f32_16x16x32_bf16 a[4:7], v[48:51], v[76:79], a[4:7]
    ds_read_b64_tr_b16 v[56:57], v11 offset:49152
    ds_read_b64_tr_b16 v[58:59], v11 offset:53248
    v_mfma_f32_16x16x32_bf16 a[36:39], v[48:51], v[84:87], a[36:39]
    v_exp_f32 v118, v118
    v_mfma_f32_16x16x32_bf16 a[68:71], v[48:51], v[92:95], a[68:71]
    v_exp_f32 v119, v119
    v_mfma_f32_16x16x32_bf16 a[100:103], v[48:51], v[100:103], a[100:103]
    v_exp_f32 v120, v120
    s_waitcnt lgkmcnt(2)
    v_mfma_f32_16x16x32_bf16 a[8:11], v[52:55], v[76:79], a[8:11]
    ds_read_b64_tr_b16 v[60:61], v12 offset:49152
    ds_read_b64_tr_b16 v[62:63], v12 offset:53248
    v_mfma_f32_16x16x32_bf16 a[40:43], v[52:55], v[84:87], a[40:43]
    v_mfma_f32_16x16x32_bf16 a[72:75], v[52:55], v[92:95], a[72:75]
    v_cvt_pk_bf16_f32 v116, v116, v117
    v_cvt_pk_bf16_f32 v117, v118, v119
    v_mfma_f32_16x16x32_bf16 a[104:107], v[52:55], v[100:103], a[104:107]
    v_exp_f32 v121, v121
    s_waitcnt lgkmcnt(2)
    v_mfma_f32_16x16x32_bf16 a[12:15], v[56:59], v[76:79], a[12:15]
    ds_read_b64_tr_b16 v[64:65], v13 offset:49152
    ds_read_b64_tr_b16 v[66:67], v13 offset:53248
    v_mfma_f32_16x16x32_bf16 a[44:47], v[56:59], v[84:87], a[44:47]
    v_exp_f32 v122, v122
    v_mfma_f32_16x16x32_bf16 a[76:79], v[56:59], v[92:95], a[76:79]
    v_exp_f32 v123, v123
    v_mfma_f32_16x16x32_bf16 a[108:111], v[56:59], v[100:103], a[108:111]
    s_waitcnt lgkmcnt(2)
    v_mfma_f32_16x16x32_bf16 a[16:19], v[60:63], v[76:79], a[16:19]
    ds_read_b64_tr_b16 v[68:69], v14 offset:49152
    ds_read_b64_tr_b16 v[70:71], v14 offset:53248
    v_mfma_f32_16x16x32_bf16 a[48:51], v[60:63], v[84:87], a[48:51]
    v_cvt_pk_bf16_f32 v118, v120, v121
    v_cvt_pk_bf16_f32 v119, v122, v123
    v_mfma_f32_16x16x32_bf16 a[80:83], v[60:63], v[92:95], a[80:83]
    v_exp_f32 v124, v124
    v_mfma_f32_16x16x32_bf16 a[112:115], v[60:63], v[100:103], a[112:115]
    v_exp_f32 v125, v125
    s_waitcnt lgkmcnt(2)
    v_mfma_f32_16x16x32_bf16 a[20:23], v[64:67], v[76:79], a[20:23]
    ds_read_b64_tr_b16 v[72:73], v15 offset:49152
    ds_read_b64_tr_b16 v[74:75], v15 offset:53248
    v_mfma_f32_16x16x32_bf16 a[52:55], v[64:67], v[84:87], a[52:55]
    v_exp_f32 v126, v126
    v_mfma_f32_16x16x32_bf16 a[84:87], v[64:67], v[92:95], a[84:87]
    v_exp_f32 v127, v127
    v_mfma_f32_16x16x32_bf16 a[116:119], v[64:67], v[100:103], a[116:119]
    s_waitcnt lgkmcnt(2)
    v_mfma_f32_16x16x32_bf16 a[24:27], v[68:71], v[76:79], a[24:27]
    ds_read_b128 v[44:47], v4 offset:0
    ds_read_b128 v[48:51], v5 offset:0
    v_mfma_f32_16x16x32_bf16 a[56:59], v[68:71], v[84:87], a[56:59]
    v_exp_f32 v128, v128
    v_mfma_f32_16x16x32_bf16 a[88:91], v[68:71], v[92:95], a[88:91]
    v_cvt_pk_bf16_f32 v124, v124, v125
    v_cvt_pk_bf16_f32 v125, v126, v127
    v_mfma_f32_16x16x32_bf16 a[120:123], v[68:71], v[100:103], a[120:123]
    v_exp_f32 v129, v129
    s_waitcnt lgkmcnt(2)
    v_mfma_f32_16x16x32_bf16 a[28:31], v[72:75], v[76:79], a[28:31]
    v_exp_f32 v130, v130
    v_mfma_f32_16x16x32_bf16 a[60:63], v[72:75], v[84:87], a[60:63]
    v_mfma_f32_16x16x32_bf16 a[92:95], v[72:75], v[92:95], a[92:95]
    v_exp_f32 v131, v131
    v_mfma_f32_16x16x32_bf16 a[124:127], v[72:75], v[100:103], a[124:127]
    v_cvt_pk_bf16_f32 v126, v128, v129
    v_cvt_pk_bf16_f32 v127, v130, v131
    v_mfma_f32_16x16x32_bf16 a[240:243], v[248:251], v[76:79], a[240:243]
    v_exp_f32 v132, v132
    v_mfma_f32_16x16x32_bf16 a[244:247], v[248:251], v[84:87], a[244:247]
    v_exp_f32 v133, v133
    s_waitcnt vmcnt(8)
    s_barrier
    v_mfma_f32_16x16x32_bf16 a[248:251], v[248:251], v[92:95], a[248:251]
    s_add_u32 m0, s34, 32768
    s_nop 0
    buffer_load_dwordx4 v1, s[16:19], s33 offen lds
    v_mfma_f32_16x16x32_bf16 a[252:255], v[248:251], v[100:103], a[252:255]
    buffer_load_dwordx4 v2, s[16:19], s33 offen offset:1024 lds
    s_waitcnt lgkmcnt(1)
    v_mfma_f32_16x16x32_bf16 v[76:79], v[44:47], a[160:163], v[24:27]
    ds_read_b128 v[52:55], v6 offset:0
    ds_read_b128 v[56:59], v7 offset:0
    v_mfma_f32_16x16x32_bf16 v[84:87], v[44:47], a[176:179], v[28:31]
    s_add_u32 m0, s34, 98304
    s_nop 0
    buffer_load_dwordx4 v1, s[20:23], s33 offen lds
    v_mfma_f32_16x16x32_bf16 v[92:95], v[44:47], a[192:195], v[32:35]
    buffer_load_dwordx4 v2, s[20:23], s33 offen offset:1024 lds
    s_add_u32 s33, s33, 8192
    v_mfma_f32_16x16x32_bf16 v[100:103], v[44:47], a[208:211], v[36:39]
    s_cmp_eq_u32 s50, 1
    s_cbranch_scc1 L_c4_q6a
    s_cmp_eq_u32 s50, 2
    s_cbranch_scc0 L_c4_q6e
    s_add_u32 s38, s44, 12288
    buffer_load_dwordx4 v[212:215], v16, s[12:15], s38 offen offset:128
    s_branch L_c4_q6e
L_c4_q6a:
    s_add_u32 s38, s44, 4096
    buffer_load_dwordx4 v[180:183], v16, s[12:15], s38 offen offset:128
L_c4_q6e:
    s_waitcnt lgkmcnt(2)
    v_mfma_f32_16x16x32_bf16 v[76:79], v[48:51], a[164:167], v[76:79]
    v_exp_f32 v134, v134
    v_mfma_f32_16x16x32_bf16 v[84:87], v[48:51], a[180:183], v[84:87]
    v_mfma_f32_16x16x32_bf16 v[92:95], v[48:51], a[196:199], v[92:95]
    v_exp_f32 v135, v135
    v_mfma_f32_16x16x32_bf16 v[100:103], v[48:51], a[212:215], v[100:103]
    v_exp_f32 v136, v136
    s_waitcnt lgkmcnt(1)
    v_mfma_f32_16x16x32_bf16 v[76:79], v[52:55], a[168:171], v[76:79]
    ds_read_b128 v[60:63], v4 offset:4096
    ds_read_b128 v[64:67], v5 offset:4096
    v_mfma_f32_16x16x32_bf16 v[84:87], v[52:55], a[184:187], v[84:87]
    v_cvt_pk_bf16_f32 v132, v132, v133
    v_cvt_pk_bf16_f32 v133, v134, v135
    v_mfma_f32_16x16x32_bf16 v[92:95], v[52:55], a[200:203], v[92:95]
    v_exp_f32 v137, v137
    v_mfma_f32_16x16x32_bf16 v[100:103], v[52:55], a[216:219], v[100:103]
    s_waitcnt lgkmcnt(2)
    v_mfma_f32_16x16x32_bf16 v[76:79], v[56:59], a[172:175], v[76:79]
    v_exp_f32 v138, v138
    v_mfma_f32_16x16x32_bf16 v[84:87], v[56:59], a[188:191], v[84:87]
    v_exp_f32 v139, v139
    v_mfma_f32_16x16x32_bf16 v[92:95], v[56:59], a[204:207], v[92:95]
    v_cvt_pk_bf16_f32 v134, v136, v137
    v_cvt_pk_bf16_f32 v135, v138, v139
    v_mfma_f32_16x16x32_bf16 v[100:103], v[56:59], a[220:223], v[100:103]
    v_exp_f32 v140, v140
    s_waitcnt lgkmcnt(1)
    v_mfma_f32_16x16x32_bf16 v[80:83], v[60:63], a[160:163], v[24:27]
    ds_read_b128 v[68:71], v6 offset:4096
    ds_read_b128 v[72:75], v7 offset:4096
    v_mfma_f32_16x16x32_bf16 v[88:91], v[60:63], a[176:179], v[28:31]
    v_exp_f32 v141, v141
    v_mfma_f32_16x16x32_bf16 v[96:99], v[60:63], a[192:195], v[32:35]
    v_mfma_f32_16x16x32_bf16 v[104:107], v[60:63], a[208:211], v[36:39]
    v_exp_f32 v142, v142
    s_waitcnt lgkmcnt(2)
    v_mfma_f32_16x16x32_bf16 v[80:83], v[64:67], a[164:167], v[80:83]
    v_exp_f32 v143, v143
    v_mfma_f32_16x16x32_bf16 v[88:91], v[64:67], a[180:183], v[88:91]
    v_exp_f32 v144, v144
    v_mfma_f32_16x16x32_bf16 v[96:99], v[64:67], a[196:199], v[96:99]
    v_cvt_pk_bf16_f32 v140, v140, v141
    v_cvt_pk_bf16_f32 v141, v142, v143
    v_mfma_f32_16x16x32_bf16 v[104:107], v[64:67], a[212:215], v[104:107]
    s_waitcnt lgkmcnt(1)
    v_mfma_f32_16x16x32_bf16 v[80:83], v[68:71], a[168:171], v[80:83]
    ds_read_b64_tr_b16 v[44:45], v8 offset:57344
    ds_read_b64_tr_b16 v[46:47], v8 offset:61440
    v_mfma_f32_16x16x32_bf16 v[88:91], v[68:71], a[184:187], v[88:91]
    v_exp_f32 v145, v145
    v_mfma_f32_16x16x32_bf16 v[96:99], v[68:71], a[200:203], v[96:99]
    v_exp_f32 v146, v146
    v_mfma_f32_16x16x32_bf16 v[104:107], v[68:71], a[216:219], v[104:107]
    v_exp_f32 v147, v147
    s_waitcnt lgkmcnt(2)
    v_mfma_f32_16x16x32_bf16 v[80:83], v[72:75], a[172:175], v[80:83]
    ds_read_b64_tr_b16 v[48:49], v9 offset:57344
    ds_read_b64_tr_b16 v[50:51], v9 offset:61440
    v_mfma_f32_16x16x32_bf16 v[88:91], v[72:75], a[188:191], v[88:91]
    v_cvt_pk_bf16_f32 v142, v144, v145
    v_cvt_pk_bf16_f32 v143, v146, v147
    v_mfma_f32_16x16x32_bf16 v[96:99], v[72:75], a[204:207], v[96:99]
    v_mfma_f32_16x16x32_bf16 v[104:107], v[72:75], a[220:223], v[104:107]
    s_waitcnt lgkmcnt(2)
    v_mfma_f32_16x16x32_bf16 a[0:3], v[44:47], v[116:119], a[0:3]
    ds_read_b64_tr_b16 v[52:53], v10 offset:57344
    ds_read_b64_tr_b16 v[54:55], v10 offset:61440
    v_mfma_f32_16x16x32_bf16 a[32:35], v[44:47], v[124:127], a[32:35]
    v_mfma_f32_16x16x32_bf16 a[64:67], v[44:47], v[132:135], a[64:67]
    v_exp_f32 v76, v76
    v_mfma_f32_16x16x32_bf16 a[96:99], v[44:47], v[140:143], a[96:99]
    v_exp_f32 v77, v77
    s_waitcnt lgkmcnt(2)
    v_mfma_f32_16x16x32_bf16 a[4:7], v[48:51], v[116:119], a[4:7]
    ds_read_b64_tr_b16 v[56:57], v11 offset:57344
    ds_read_b64_tr_b16 v[58:59], v11 offset:61440
    v_mfma_f32_16x16x32_bf16 a[36:39], v[48:51], v[124:127], a[36:39]
    v_exp_f32 v78, v78
    v_mfma_f32_16x16x32_bf16 a[68:71], v[48:51], v[132:135], a[68:71]
    v_exp_f32 v79, v79
    v_mfma_f32_16x16x32_bf16 a[100:103], v[48:51], v[140:143], a[100:103]
    v_exp_f32 v80, v80
    s_waitcnt lgkmcnt(2)
    v_mfma_f32_16x16x32_bf16 a[8:11], v[52:55], v[116:119], a[8:11]
    ds_read_b64_tr_b16 v[60:61], v12 offset:57344
    ds_read_b64_tr_b16 v[62:63], v12 offset:61440
    v_mfma_f32_16x16x32_bf16 a[40:43], v[52:55], v[124:127], a[40:43]
    v_mfma_f32_16x16x32_bf16 a[72:75], v[52:55], v[132:135], a[72:75]
    v_cvt_pk_bf16_f32 v76, v76, v77
    v_cvt_pk_bf16_f32 v77, v78, v79
    v_mfma_f32_16x16x32_bf16 a[104:107], v[52:55], v[140:143], a[104:107]
    v_exp_f32 v81, v81
    s_waitcnt lgkmcnt(2)
    v_mfma_f32_16x16x32_bf16 a[12:15], v[56:59], v[116:119], a[12:15]
    ds_read_b64_tr_b16 v[64:65], v13 offset:57344
    ds_read_b64_tr_b16 v[66:67], v13 offset:61440
    v_mfma_f32_16x16x32_bf16 a[44:47], v[56:59], v[124:127], a[44:47]
    v_exp_f32 v82, v82
    v_mfma_f32_16x16x32_bf16 a[76:79], v[56:59], v[132:135], a[76:79]
    v_exp_f32 v83, v83
    v_mfma_f32_16x16x32_bf16 a[108:111], v[56:59], v[140:143], a[108:111]
    s_waitcnt lgkmcnt(2)
    v_mfma_f32_16x16x32_bf16 a[16:19], v[60:63], v[116:119], a[16:19]
    ds_read_b64_tr_b16 v[68:69], v14 offset:57344
    ds_read_b64_tr_b16 v[70:71], v14 offset:61440
    v_mfma_f32_16x16x32_bf16 a[48:51], v[60:63], v[124:127], a[48:51]
    v_cvt_pk_bf16_f32 v78, v80, v81
    v_cvt_pk_bf16_f32 v79, v82, v83
    v_mfma_f32_16x16x32_bf16 a[80:83], v[60:63], v[132:135], a[80:83]
    v_exp_f32 v84, v84
    v_mfma_f32_16x16x32_bf16 a[112:115], v[60:63], v[140:143], a[112:115]
    v_exp_f32 v85, v85
    s_waitcnt lgkmcnt(2)
    v_mfma_f32_16x16x32_bf16 a[20:23], v[64:67], v[116:119], a[20:23]
    ds_read_b64_tr_b16 v[72:73], v15 offset:57344
    ds_read_b64_tr_b16 v[74:75], v15 offset:61440
    v_mfma_f32_16x16x32_bf16 a[52:55], v[64:67], v[124:127], a[52:55]
    v_exp_f32 v86, v86
    s_nop 1
    v_mfma_f32_16x16x32_bf16 a[84:87], v[64:67], v[132:135], a[84:87]
    v_exp_f32 v87, v87
    v_mfma_f32_16x16x32_bf16 a[116:119], v[64:67], v[140:143], a[116:119]
    s_waitcnt lgkmcnt(2)
    v_mfma_f32_16x16x32_bf16 a[24:27], v[68:71], v[116:119], a[24:27]
    ds_read_b128 v[44:47], v4 offset:8192
    ds_read_b128 v[48:51], v5 offset:8192
    v_mfma_f32_16x16x32_bf16 a[56:59], v[68:71], v[124:127], a[56:59]
    v_exp_f32 v88, v88
    s_nop 1
    v_mfma_f32_16x16x32_bf16 a[88:91], v[68:71], v[132:135], a[88:91]
    v_cvt_pk_bf16_f32 v84, v84, v85
    v_cvt_pk_bf16_f32 v85, v86, v87
    v_mfma_f32_16x16x32_bf16 a[120:123], v[68:71], v[140:143], a[120:123]
    v_exp_f32 v89, v89
    s_waitcnt lgkmcnt(2)
    v_mfma_f32_16x16x32_bf16 a[28:31], v[72:75], v[116:119], a[28:31]
    v_exp_f32 v90, v90
    v_mfma_f32_16x16x32_bf16 a[60:63], v[72:75], v[124:127], a[60:63]
    v_mfma_f32_16x16x32_bf16 a[92:95], v[72:75], v[132:135], a[92:95]
    v_exp_f32 v91, v91
    v_mfma_f32_16x16x32_bf16 a[124:127], v[72:75], v[140:143], a[124:127]
    v_cvt_pk_bf16_f32 v86, v88, v89
    v_cvt_pk_bf16_f32 v87, v90, v91
    v_mfma_f32_16x16x32_bf16 a[240:243], v[248:251], v[116:119], a[240:243]
    v_exp_f32 v92, v92
    v_mfma_f32_16x16x32_bf16 a[244:247], v[248:251], v[124:127], a[244:247]
    v_exp_f32 v93, v93
    s_waitcnt vmcnt(8)
    s_barrier
    v_mfma_f32_16x16x32_bf16 a[248:251], v[248:251], v[132:135], a[248:251]
    s_add_u32 m0, s34, 40960
    s_nop 0
    buffer_load_dwordx4 v1, s[16:19], s33 offen lds
    v_mfma_f32_16x16x32_bf16 a[252:255], v[248:251], v[140:143], a[252:255]
    buffer_load_dwordx4 v2, s[16:19], s33 offen offset:1024 lds
    s_waitcnt lgkmcnt(1)
    v_mfma_f32_16x16x32_bf16 v[116:119], v[44:47], a[160:163], v[24:27]
    ds_read_b128 v[52:55], v6 offset:8192
    ds_read_b128 v[56:59], v7 offset:8192
    v_mfma_f32_16x16x32_bf16 v[124:127], v[44:47], a[176:179], v[28:31]
    s_add_u32 m0, s34, 106496
    s_nop 0
    buffer_load_dwordx4 v1, s[20:23], s33 offen lds
    v_mfma_f32_16x16x32_bf16 v[132:135], v[44:47], a[192:195], v[32:35]
    buffer_load_dwordx4 v2, s[20:23], s33 offen offset:1024 lds
    s_add_u32 s33, s33, 8192
    v_mfma_f32_16x16x32_bf16 v[140:143], v[44:47], a[208:211], v[36:39]
    s_cmp_eq_u32 s50, 1
    s_cbranch_scc1 L_c4_q7a
    s_cmp_eq_u32 s50, 2
    s_cbranch_scc0 L_c4_q7e
    s_add_u32 s38, s44, 12288
    buffer_load_dwordx4 v[216:219], v16, s[12:15], s38 offen offset:192
    s_branch L_c4_q7e
L_c4_q7a:
    s_add_u32 s38, s44, 4096
    buffer_load_dwordx4 v[184:187], v16, s[12:15], s38 offen offset:192
L_c4_q7e:
    s_waitcnt lgkmcnt(2)
    v_mfma_f32_16x16x32_bf16 v[116:119], v[48:51], a[164:167], v[116:119]
    v_exp_f32 v94, v94
    v_mfma_f32_16x16x32_bf16 v[124:127], v[48:51], a[180:183], v[124:127]
    v_mfma_f32_16x16x32_bf16 v[132:135], v[48:51], a[196:199], v[132:135]
    v_exp_f32 v95, v95
    v_mfma_f32_16x16x32_bf16 v[140:143], v[48:51], a[212:215], v[140:143]
    v_exp_f32 v96, v96
    s_waitcnt lgkmcnt(1)
    v_mfma_f32_16x16x32_bf16 v[116:119], v[52:55], a[168:171], v[116:119]
    ds_read_b128 v[60:63], v4 offset:12288
    ds_read_b128 v[64:67], v5 offset:12288
    v_mfma_f32_16x16x32_bf16 v[124:127], v[52:55], a[184:187], v[124:127]
    v_cvt_pk_bf16_f32 v92, v92, v93
    v_cvt_pk_bf16_f32 v93, v94, v95
    v_mfma_f32_16x16x32_bf16 v[132:135], v[52:55], a[200:203], v[132:135]
    v_exp_f32 v97, v97
    v_mfma_f32_16x16x32_bf16 v[140:143], v[52:55], a[216:219], v[140:143]
    s_waitcnt lgkmcnt(2)
    v_mfma_f32_16x16x32_bf16 v[116:119], v[56:59], a[172:175], v[116:119]
    v_exp_f32 v98, v98
    v_mfma_f32_16x16x32_bf16 v[124:127], v[56:59], a[188:191], v[124:127]
    v_exp_f32 v99, v99
    v_mfma_f32_16x16x32_bf16 v[132:135], v[56:59], a[204:207], v[132:135]
    v_cvt_pk_bf16_f32 v94, v96, v97
    v_cvt_pk_bf16_f32 v95, v98, v99
    v_mfma_f32_16x16x32_bf16 v[140:143], v[56:59], a[220:223], v[140:143]
    v_exp_f32 v100, v100
    s_waitcnt lgkmcnt(1)
    v_mfma_f32_16x16x32_bf16 v[120:123], v[60:63], a[160:163], v[24:27]
    ds_read_b128 v[68:71], v6 offset:12288
    ds_read_b128 v[72:75], v7 offset:12288
    v_mfma_f32_16x16x32_bf16 v[128:131], v[60:63], a[176:179], v[28:31]
    v_exp_f32 v101, v101
    v_mfma_f32_16x16x32_bf16 v[136:139], v[60:63], a[192:195], v[32:35]
    v_mfma_f32_16x16x32_bf16 v[144:147], v[60:63], a[208:211], v[36:39]
    v_exp_f32 v102, v102
    s_waitcnt lgkmcnt(2)
    v_mfma_f32_16x16x32_bf16 v[120:123], v[64:67], a[164:167], v[120:123]
    v_exp_f32 v103, v103
    v_mfma_f32_16x16x32_bf16 v[128:131], v[64:67], a[180:183], v[128:131]
    v_exp_f32 v104, v104
    v_mfma_f32_16x16x32_bf16 v[136:139], v[64:67], a[196:199], v[136:139]
    v_cvt_pk_bf16_f32 v100, v100, v101
    v_cvt_pk_bf16_f32 v101, v102, v103
    v_mfma_f32_16x16x32_bf16 v[144:147], v[64:67], a[212:215], v[144:147]
    s_waitcnt lgkmcnt(1)
    v_mfma_f32_16x16x32_bf16 v[120:123], v[68:71], a[168:171], v[120:123]
    ds_read_b64_tr_b16 v[44:45], v8 offset:0
    ds_read_b64_tr_b16 v[46:47], v8 offset:4096
    v_mfma_f32_16x16x32_bf16 v[128:131], v[68:71], a[184:187], v[128:131]
    v_exp_f32 v105, v105
    v_mfma_f32_16x16x32_bf16 v[136:139], v[68:71], a[200:203], v[136:139]
    v_exp_f32 v106, v106
    v_mfma_f32_16x16x32_bf16 v[144:147], v[68:71], a[216:219], v[144:147]
    v_exp_f32 v107, v107
    s_waitcnt lgkmcnt(2)
    v_mfma_f32_16x16x32_bf16 v[120:123], v[72:75], a[172:175], v[120:123]
    ds_read_b64_tr_b16 v[48:49], v9 offset:0
    ds_read_b64_tr_b16 v[50:51], v9 offset:4096
    v_mfma_f32_16x16x32_bf16 v[128:131], v[72:75], a[188:191], v[128:131]
    v_cvt_pk_bf16_f32 v102, v104, v105
    v_cvt_pk_bf16_f32 v103, v106, v107
    v_mfma_f32_16x16x32_bf16 v[136:139], v[72:75], a[204:207], v[136:139]
    v_mfma_f32_16x16x32_bf16 v[144:147], v[72:75], a[220:223], v[144:147]
    s_add_u32 s50, s50, 1
    s_add_u32 s35, s35, 1
    s_cmp_lt_u32 s35, 3
    s_cbranch_scc1 L_c4_loop
    s_cmp_lg_u32 s46, 0
    s_cbranch_scc1 L_c4_tail2
    s_waitcnt lgkmcnt(2)
    v_mfma_f32_16x16x32_bf16 a[0:3], v[44:47], v[76:79], a[0:3]
    ds_read_b64_tr_b16 v[52:53], v10 offset:0
    ds_read_b64_tr_b16 v[54:55], v10 offset:4096
    v_mfma_f32_16x16x32_bf16 a[32:35], v[44:47], v[84:87], a[32:35]
    v_mfma_f32_16x16x32_bf16 a[64:67], v[44:47], v[92:95], a[64:67]
    v_exp_f32 v116, v116
    v_mfma_f32_16x16x32_bf16 a[96:99], v[44:47], v[100:103], a[96:99]
    v_exp_f32 v117, v117
    s_waitcnt lgkmcnt(2)
    v_mfma_f32_16x16x32_bf16 a[4:7], v[48:51], v[76:79], a[4:7]
    ds_read_b64_tr_b16 v[56:57], v11 offset:0
    ds_read_b64_tr_b16 v[58:59], v11 offset:4096
    v_mfma_f32_16x16x32_bf16 a[36:39], v[48:51], v[84:87], a[36:39]
    v_exp_f32 v118, v118
    v_mfma_f32_16x16x32_bf16 a[68:71], v[48:51], v[92:95], a[68:71]
    v_exp_f32 v119, v119
    v_mfma_f32_16x16x32_bf16 a[100:103], v[48:51], v[100:103], a[100:103]
    s_waitcnt lgkmcnt(2)
    v_mfma_f32_16x16x32_bf16 a[8:11], v[52:55], v[76:79], a[8:11]
    ds_read_b64_tr_b16 v[60:61], v12 offset:0
    ds_read_b64_tr_b16 v[62:63], v12 offset:4096
    v_mfma_f32_16x16x32_bf16 a[40:43], v[52:55], v[84:87], a[40:43]
    v_exp_f32 v120, v120
    v_mfma_f32_16x16x32_bf16 a[72:75], v[52:55], v[92:95], a[72:75]
    v_cvt_pk_bf16_f32 v116, v116, v117
    v_cvt_pk_bf16_f32 v117, v118, v119
    v_mfma_f32_16x16x32_bf16 a[104:107], v[52:55], v[100:103], a[104:107]
    v_exp_f32 v121, v121
    s_waitcnt lgkmcnt(2)
    v_mfma_f32_16x16x32_bf16 a[12:15], v[56:59], v[76:79], a[12:15]
    ds_read_b64_tr_b16 v[64:65], v13 offset:0
    ds_read_b64_tr_b16 v[66:67], v13 offset:4096
    v_mfma_f32_16x16x32_bf16 a[44:47], v[56:59], v[84:87], a[44:47]
    v_exp_f32 v122, v122
    v_mfma_f32_16x16x32_bf16 a[76:79], v[56:59], v[92:95], a[76:79]
    v_mfma_f32_16x16x32_bf16 a[108:111], v[56:59], v[100:103], a[108:111]
    v_exp_f32 v123, v123
    s_waitcnt lgkmcnt(2)
    v_mfma_f32_16x16x32_bf16 a[16:19], v[60:63], v[76:79], a[16:19]
    ds_read_b64_tr_b16 v[68:69], v14 offset:0
    ds_read_b64_tr_b16 v[70:71], v14 offset:4096
    v_mfma_f32_16x16x32_bf16 a[48:51], v[60:63], v[84:87], a[48:51]
    v_cvt_pk_bf16_f32 v118, v120, v121
    v_cvt_pk_bf16_f32 v119, v122, v123
    v_mfma_f32_16x16x32_bf16 a[80:83], v[60:63], v[92:95], a[80:83]
    v_exp_f32 v124, v124
    v_mfma_f32_16x16x32_bf16 a[112:115], v[60:63], v[100:103], a[112:115]
    v_exp_f32 v125, v125
    s_waitcnt lgkmcnt(2)
    v_mfma_f32_16x16x32_bf16 a[20:23], v[64:67], v[76:79], a[20:23]
    ds_read_b64_tr_b16 v[72:73], v15 offset:0
    ds_read_b64_tr_b16 v[74:75], v15 offset:4096
    v_mfma_f32_16x16x32_bf16 a[52:55], v[64:67], v[84:87], a[52:55]
    v_mfma_f32_16x16x32_bf16 a[84:87], v[64:67], v[92:95], a[84:87]
    v_exp_f32 v126, v126
    v_mfma_f32_16x16x32_bf16 a[116:119], v[64:67], v[100:103], a[116:119]
    v_exp_f32 v127, v127
    s_waitcnt lgkmcnt(2)
    v_mfma_f32_16x16x32_bf16 a[24:27], v[68:71], v[76:79], a[24:27]
    ds_read_b128 v[44:47], v4 offset:16384
    ds_read_b128 v[48:51], v5 offset:16384
    v_mfma_f32_16x16x32_bf16 a[56:59], v[68:71], v[84:87], a[56:59]
    v_exp_f32 v128, v128
    v_mfma_f32_16x16x32_bf16 a[88:91], v[68:71], v[92:95], a[88:91]
    v_cvt_pk_bf16_f32 v124, v124, v125
    v_cvt_pk_bf16_f32 v125, v126, v127
    v_mfma_f32_16x16x32_bf16 a[120:123], v[68:71], v[100:103], a[120:123]
    s_waitcnt lgkmcnt(2)
    v_mfma_f32_16x16x32_bf16 a[28:31], v[72:75], v[76:79], a[28:31]
    v_exp_f32 v129, v129
    v_mfma_f32_16x16x32_bf16 a[60:63], v[72:75], v[84:87], a[60:63]
    v_exp_f32 v130, v130
    v_mfma_f32_16x16x32_bf16 a[92:95], v[72:75], v[92:95], a[92:95]
    v_exp_f32 v131, v131
    v_mfma_f32_16x16x32_bf16 a[124:127], v[72:75], v[100:103], a[124:127]
    v_cvt_pk_bf16_f32 v126, v128, v129
    v_cvt_pk_bf16_f32 v127, v130, v131
    v_mfma_f32_16x16x32_bf16 a[240:243], v[248:251], v[76:79], a[240:243]
    v_mfma_f32_16x16x32_bf16 a[244:247], v[248:251], v[84:87], a[244:247]
    v_exp_f32 v132, v132
    s_waitcnt vmcnt(11)
    s_barrier
    v_mfma_f32_16x16x32_bf16 a[248:251], v[248:251], v[92:95], a[248:251]
    s_add_u32 m0, s34, 49152
    s_nop 0
    buffer_load_dwordx4 v1, s[16:19], s33 offen lds
    v_mfma_f32_16x16x32_bf16 a[252:255], v[248:251], v[100:103], a[252:255]
    buffer_load_dwordx4 v2, s[16:19], s33 offen offset:1024 lds
    s_waitcnt lgkmcnt(1)
    v_mfma_f32_16x16x32_bf16 v[76:79], v[44:47], a[160:163], v[24:27]
    ds_read_b128 v[52:55], v6 offset:16384
    ds_read_b128 v[56:59], v7 offset:16384
    v_mfma_f32_16x16x32_bf16 v[84:87], v[44:47], a[176:179], v[28:31]
    s_add_u32 m0, s34, 114688
    s_nop 0
    buffer_load_dwordx4 v1, s[20:23], s33 offen lds
    v_mfma_f32_16x16x32_bf16 v[92:95], v[44:47], a[192:195], v[32:35]
    buffer_load_dwordx4 v2, s[20:23], s33 offen offset:1024 lds
    s_add_u32 s33, s33, 8192
    v_mfma_f32_16x16x32_bf16 v[100:103], v[44:47], a[208:211], v[36:39]
    v_exp_f32 v133, v133
    s_waitcnt lgkmcnt(2)
    v_mfma_f32_16x16x32_bf16 v[76:79], v[48:51], a[164:167], v[76:79]
    v_exp_f32 v134, v134
    v_mfma_f32_16x16x32_bf16 v[84:87], v[48:51], a[180:183], v[84:87]
    v_exp_f32 v135, v135
    v_mfma_f32_16x16x32_bf16 v[92:95], v[48:51], a[196:199], v[92:95]
    v_mfma_f32_16x16x32_bf16 v[100:103], v[48:51], a[212:215], v[100:103]
    v_exp_f32 v136, v136
    s_waitcnt lgkmcnt(1)
    v_mfma_f32_16x16x32_bf16 v[76:79], v[52:55], a[168:171], v[76:79]
    ds_read_b128 v[60:63], v4 offset:20480
    ds_read_b128 v[64:67], v5 offset:20480
    v_mfma_f32_16x16x32_bf16 v[84:87], v[52:55], a[184:187], v[84:87]
    v_cvt_pk_bf16_f32 v132, v132, v133
    v_cvt_pk_bf16_f32 v133, v134, v135
    v_mfma_f32_16x16x32_bf16 v[92:95], v[52:55], a[200:203], v[92:95]
    v_exp_f32 v137, v137
    v_mfma_f32_16x16x32_bf16 v[100:103], v[52:55], a[216:219], v[100:103]
    v_exp_f32 v138, v138
    s_waitcnt lgkmcnt(2)
    v_mfma_f32_16x16x32_bf16 v[76:79], v[56:59], a[172:175], v[76:79]
    v_mfma_f32_16x16x32_bf16 v[84:87], v[56:59], a[188:191], v[84:87]
    v_exp_f32 v139, v139
    v_mfma_f32_16x16x32_bf16 v[92:95], v[56:59], a[204:207], v[92:95]
    v_cvt_pk_bf16_f32 v134, v136, v137
    v_cvt_pk_bf16_f32 v135, v138, v139
    v_mfma_f32_16x16x32_bf16 v[100:103], v[56:59], a[220:223], v[100:103]
    v_exp_f32 v140, v140
    s_waitcnt lgkmcnt(1)
    v_mfma_f32_16x16x32_bf16 v[80:83], v[60:63], a[160:163], v[24:27]
    ds_read_b128 v[68:71], v6 offset:20480
    ds_read_b128 v[72:75], v7 offset:20480
    v_mfma_f32_16x16x32_bf16 v[88:91], v[60:63], a[176:179], v[28:31]
    v_exp_f32 v141, v141
    v_mfma_f32_16x16x32_bf16 v[96:99], v[60:63], a[192:195], v[32:35]
    v_mfma_f32_16x16x32_bf16 v[104:107], v[60:63], a[208:211], v[36:39]
    v_exp_f32 v142, v142
    s_waitcnt lgkmcnt(2)
    v_mfma_f32_16x16x32_bf16 v[80:83], v[64:67], a[164:167], v[80:83]
    v_exp_f32 v143, v143
    v_mfma_f32_16x16x32_bf16 v[88:91], v[64:67], a[180:183], v[88:91]
    v_exp_f32 v144, v144
    v_mfma_f32_16x16x32_bf16 v[96:99], v[64:67], a[196:199], v[96:99]
    v_cvt_pk_bf16_f32 v140, v140, v141
    v_cvt_pk_bf16_f32 v141, v142, v143
    v_mfma_f32_16x16x32_bf16 v[104:107], v[64:67], a[212:215], v[104:107]
    s_waitcnt lgkmcnt(1)
    v_mfma_f32_16x16x32_bf16 v[80:83], v[68:71], a[168:171], v[80:83]
    ds_read_b64_tr_b16 v[44:45], v8 offset:8192
    ds_read_b64_tr_b16 v[46:47], v8 offset:12288
    v_mfma_f32_16x16x32_bf16 v[88:91], v[68:71], a[184:187], v[88:91]
    v_exp_f32 v145, v145
    v_mfma_f32_16x16x32_bf16 v[96:99], v[68:71], a[200:203], v[96:99]
    v_exp_f32 v146, v146
    v_mfma_f32_16x16x32_bf16 v[104:107], v[68:71], a[216:219], v[104:107]
    v_exp_f32 v147, v147
    s_waitcnt lgkmcnt(2)
    v_mfma_f32_16x16x32_bf16 v[80:83], v[72:75], a[172:175], v[80:83]
    ds_read_b64_tr_b16 v[48:49], v9 offset:8192
    ds_read_b64_tr_b16 v[50:51], v9 offset:12288
    v_mfma_f32_16x16x32_bf16 v[88:91], v[72:75], a[188:191], v[88:91]
    v_cvt_pk_bf16_f32 v142, v144, v145
    v_cvt_pk_bf16_f32 v143, v146, v147
    v_mfma_f32_16x16x32_bf16 v[96:99], v[72:75], a[204:207], v[96:99]
    v_mfma_f32_16x16x32_bf16 v[104:107], v[72:75], a[220:223], v[104:107]
    s_waitcnt lgkmcnt(2)
    v_mfma_f32_16x16x32_bf16 a[0:3], v[44:47], v[116:119], a[0:3]
    ds_read_b64_tr_b16 v[52:53], v10 offset:8192
    ds_read_b64_tr_b16 v[54:55], v10 offset:12288
    v_mfma_f32_16x16x32_bf16 a[32:35], v[44:47], v[124:127], a[32:35]
    v_mfma_f32_16x16x32_bf16 a[64:67], v[44:47], v[132:135], a[64:67]
    v_exp_f32 v76, v76
    v_lshlrev_b32 v236, 16, v156
    v_and_b32 v237, 0xffff0000, v156
    v_mfma_f32_16x16x32_bf16 a[96:99], v[44:47], v[140:143], a[96:99]
    v_exp_f32 v77, v77
    s_waitcnt lgkmcnt(2)
    v_mfma_f32_16x16x32_bf16 a[4:7], v[48:51], v[116:119], a[4:7]
    ds_read_b64_tr_b16 v[56:57], v11 offset:8192
    ds_read_b64_tr_b16 v[58:59], v11 offset:12288
    v_mfma_f32_16x16x32_bf16 a[36:39], v[48:51], v[124:127], a[36:39]
    v_exp_f32 v78, v78
    v_mfma_f32_16x16x32_bf16 a[68:71], v[48:51], v[132:135], a[68:71]
    v_lshlrev_b32 v238, 16, v157
    v_and_b32 v239, 0xffff0000, v157
    v_mfma_f32_16x16x32_bf16 a[100:103], v[48:51], v[140:143], a[100:103]
    v_exp_f32 v79, v79
    s_waitcnt lgkmcnt(2)
    v_mfma_f32_16x16x32_bf16 a[8:11], v[52:55], v[116:119], a[8:11]
    ds_read_b64_tr_b16 v[60:61], v12 offset:8192
    ds_read_b64_tr_b16 v[62:63], v12 offset:12288
    v_mfma_f32_16x16x32_bf16 a[40:43], v[52:55], v[124:127], a[40:43]
    v_exp_f32 v80, v80
    v_mfma_f32_16x16x32_bf16 a[72:75], v[52:55], v[132:135], a[72:75]
    v_cvt_pk_bf16_f32 v76, v76, v77
    v_cvt_pk_bf16_f32 v77, v78, v79
    v_mfma_f32_16x16x32_bf16 a[104:107], v[52:55], v[140:143], a[104:107]
    v_pk_mul_f32 v[236:237], v[236:237], s[36:37]
    v_pk_mul_f32 v[238:239], v[238:239], s[36:37]
    v_cvt_pk_bf16_f32 v156, v236, v237
    v_cvt_pk_bf16_f32 v157, v238, v239
    s_waitcnt lgkmcnt(2)
    v_mfma_f32_16x16x32_bf16 a[12:15], v[56:59], v[116:119], a[12:15]
    ds_read_b64_tr_b16 v[64:65], v13 offset:8192
    ds_read_b64_tr_b16 v[66:67], v13 offset:12288
    v_mfma_f32_16x16x32_bf16 a[44:47], v[56:59], v[124:127], a[44:47]
    v_exp_f32 v81, v81
    v_exp_f32 v82, v82
    v_mfma_f32_16x16x32_bf16 a[76:79], v[56:59], v[132:135], a[76:79]
    v_lshlrev_b32 v240, 16, v158
    v_and_b32 v241, 0xffff0000, v158
    v_mfma_f32_16x16x32_bf16 a[108:111], v[56:59], v[140:143], a[108:111]
    v_exp_f32 v83, v83
    s_waitcnt lgkmcnt(2)
    v_mfma_f32_16x16x32_bf16 a[16:19], v[60:63], v[116:119], a[16:19]
    ds_read_b64_tr_b16 v[68:69], v14 offset:8192
    ds_read_b64_tr_b16 v[70:71], v14 offset:12288
    v_mfma_f32_16x16x32_bf16 a[48:51], v[60:63], v[124:127], a[48:51]
    v_cvt_pk_bf16_f32 v78, v80, v81
    v_cvt_pk_bf16_f32 v79, v82, v83
    v_mfma_f32_16x16x32_bf16 a[80:83], v[60:63], v[132:135], a[80:83]
    v_exp_f32 v84, v84
    v_mfma_f32_16x16x32_bf16 a[112:115], v[60:63], v[140:143], a[112:115]
    v_lshlrev_b32 v242, 16, v159
    v_and_b32 v243, 0xffff0000, v159
    s_waitcnt lgkmcnt(2)
    v_mfma_f32_16x16x32_bf16 a[20:23], v[64:67], v[116:119], a[20:23]
    ds_read_b64_tr_b16 v[72:73], v15 offset:8192
    ds_read_b64_tr_b16 v[74:75], v15 offset:12288
    v_mfma_f32_16x16x32_bf16 a[52:55], v[64:67], v[124:127], a[52:55]
    v_exp_f32 v85, v85
    s_nop 1
    v_mfma_f32_16x16x32_bf16 a[84:87], v[64:67], v[132:135], a[84:87]
    v_exp_f32 v86, v86
    v_mfma_f32_16x16x32_bf16 a[116:119], v[64:67], v[140:143], a[116:119]
    v_pk_mul_f32 v[240:241], v[240:241], s[36:37]
    v_pk_mul_f32 v[242:243], v[242:243], s[36:37]
    v_cvt_pk_bf16_f32 v158, v240, v241
    v_cvt_pk_bf16_f32 v159, v242, v243
    v_exp_f32 v87, v87
    s_waitcnt lgkmcnt(2)
    v_mfma_f32_16x16x32_bf16 a[24:27], v[68:71], v[116:119], a[24:27]
    ds_read_b128 v[44:47], v4 offset:24576
    ds_read_b128 v[48:51], v5 offset:24576
    v_mfma_f32_16x16x32_bf16 a[56:59], v[68:71], v[124:127], a[56:59]
    v_exp_f32 v88, v88
    s_nop 1
    v_mfma_f32_16x16x32_bf16 a[88:91], v[68:71], v[132:135], a[88:91]
    v_cvt_pk_bf16_f32 v84, v84, v85
    v_cvt_pk_bf16_f32 v85, v86, v87
    v_mfma_f32_16x16x32_bf16 a[120:123], v[68:71], v[140:143], a[120:123]
    v_lshlrev_b32 v236, 16, v160
    v_and_b32 v237, 0xffff0000, v160
    s_waitcnt lgkmcnt(2)
    v_mfma_f32_16x16x32_bf16 a[28:31], v[72:75], v[116:119], a[28:31]
    v_exp_f32 v89, v89
    v_mfma_f32_16x16x32_bf16 a[60:63], v[72:75], v[124:127], a[60:63]
    v_exp_f32 v90, v90
    v_mfma_f32_16x16x32_bf16 a[92:95], v[72:75], v[132:135], a[92:95]
    v_lshlrev_b32 v238, 16, v161
    v_and_b32 v239, 0xffff0000, v161
    v_mfma_f32_16x16x32_bf16 a[124:127], v[72:75], v[140:143], a[124:127]
    v_exp_f32 v91, v91
    v_mfma_f32_16x16x32_bf16 a[240:243], v[248:251], v[116:119], a[240:243]
    v_cvt_pk_bf16_f32 v86, v88, v89
    v_cvt_pk_bf16_f32 v87, v90, v91
    v_mfma_f32_16x16x32_bf16 a[244:247], v[248:251], v[124:127], a[244:247]
    v_exp_f32 v92, v92
    v_pk_mul_f32 v[236:237], v[236:237], s[36:37]
    v_pk_mul_f32 v[238:239], v[238:239], s[36:37]
    v_cvt_pk_bf16_f32 v160, v236, v237
    v_cvt_pk_bf16_f32 v161, v238, v239
    s_waitcnt vmcnt(10)
    s_barrier
    v_mfma_f32_16x16x32_bf16 a[248:251], v[248:251], v[132:135], a[248:251]
    s_add_u32 m0, s34, 57344
    s_nop 0
    buffer_load_dwordx4 v1, s[16:19], s33 offen lds
    v_mfma_f32_16x16x32_bf16 a[252:255], v[248:251], v[140:143], a[252:255]
    buffer_load_dwordx4 v2, s[16:19], s33 offen offset:1024 lds
    s_waitcnt lgkmcnt(1)
    v_mfma_f32_16x16x32_bf16 v[116:119], v[44:47], a[160:163], v[24:27]
    ds_read_b128 v[52:55], v6 offset:24576
    ds_read_b128 v[56:59], v7 offset:24576
    v_mfma_f32_16x16x32_bf16 v[124:127], v[44:47], a[176:179], v[28:31]
    s_add_u32 m0, s34, 122880
    s_nop 0
    buffer_load_dwordx4 v1, s[20:23], s33 offen lds
    v_mfma_f32_16x16x32_bf16 v[132:135], v[44:47], a[192:195], v[32:35]
    buffer_load_dwordx4 v2, s[20:23], s33 offen offset:1024 lds
    s_add_u32 s33, s33, 8192
    v_mfma_f32_16x16x32_bf16 v[140:143], v[44:47], a[208:211], v[36:39]
    v_exp_f32 v93, v93
    s_waitcnt lgkmcnt(2)
    v_mfma_f32_16x16x32_bf16 v[116:119], v[48:51], a[164:167], v[116:119]
    v_exp_f32 v94, v94
    v_mfma_f32_16x16x32_bf16 v[124:127], v[48:51], a[180:183], v[124:127]
    v_lshlrev_b32 v240, 16, v162
    v_and_b32 v241, 0xffff0000, v162
    v_mfma_f32_16x16x32_bf16 v[132:135], v[48:51], a[196:199], v[132:135]
    v_exp_f32 v95, v95
    v_mfma_f32_16x16x32_bf16 v[140:143], v[48:51], a[212:215], v[140:143]
    v_exp_f32 v96, v96
    s_waitcnt lgkmcnt(1)
    v_mfma_f32_16x16x32_bf16 v[116:119], v[52:55], a[168:171], v[116:119]
    ds_read_b128 v[60:63], v4 offset:28672
    ds_read_b128 v[64:67], v5 offset:28672
    v_mfma_f32_16x16x32_bf16 v[124:127], v[52:55], a[184:187], v[124:127]
    v_cvt_pk_bf16_f32 v92, v92, v93
    v_cvt_pk_bf16_f32 v93, v94, v95
    v_mfma_f32_16x16x32_bf16 v[132:135], v[52:55], a[200:203], v[132:135]
    v_lshlrev_b32 v242, 16, v163
    v_and_b32 v243, 0xffff0000, v163
    v_mfma_f32_16x16x32_bf16 v[140:143], v[52:55], a[216:219], v[140:143]
    v_exp_f32 v97, v97
    v_exp_f32 v98, v98
    s_waitcnt lgkmcnt(2)
    v_mfma_f32_16x16x32_bf16 v[116:119], v[56:59], a[172:175], v[116:119]
    v_pk_mul_f32 v[240:241], v[240:241], s[36:37]
    v_pk_mul_f32 v[242:243], v[242:243], s[36:37]
    v_cvt_pk_bf16_f32 v162, v240, v241
    v_cvt_pk_bf16_f32 v163, v242, v243
    v_mfma_f32_16x16x32_bf16 v[124:127], v[56:59], a[188:191], v[124:127]
    v_exp_f32 v99, v99
    v_mfma_f32_16x16x32_bf16 v[132:135], v[56:59], a[204:207], v[132:135]
    v_cvt_pk_bf16_f32 v94, v96, v97
    v_cvt_pk_bf16_f32 v95, v98, v99
    v_mfma_f32_16x16x32_bf16 v[140:143], v[56:59], a[220:223], v[140:143]
    v_exp_f32 v100, v100
    s_waitcnt lgkmcnt(1)
    v_mfma_f32_16x16x32_bf16 v[120:123], v[60:63], a[160:163], v[24:27]
    ds_read_b128 v[68:71], v6 offset:28672
    ds_read_b128 v[72:75], v7 offset:28672
    v_mfma_f32_16x16x32_bf16 v[128:131], v[60:63], a[176:179], v[28:31]
    v_lshlrev_b32 v236, 16, v164
    v_and_b32 v237, 0xffff0000, v164
    v_mfma_f32_16x16x32_bf16 v[136:139], v[60:63], a[192:195], v[32:35]
    v_exp_f32 v101, v101
    v_mfma_f32_16x16x32_bf16 v[144:147], v[60:63], a[208:211], v[36:39]
    v_exp_f32 v102, v102
    s_waitcnt lgkmcnt(2)
    v_mfma_f32_16x16x32_bf16 v[120:123], v[64:67], a[164:167], v[120:123]
    v_lshlrev_b32 v238, 16, v165
    v_and_b32 v239, 0xffff0000, v165
    v_exp_f32 v103, v103
    v_mfma_f32_16x16x32_bf16 v[128:131], v[64:67], a[180:183], v[128:131]
    v_exp_f32 v104, v104
    v_mfma_f32_16x16x32_bf16 v[136:139], v[64:67], a[196:199], v[136:139]
    v_cvt_pk_bf16_f32 v100, v100, v101
    v_cvt_pk_bf16_f32 v101, v102, v103
    v_mfma_f32_16x16x32_bf16 v[144:147], v[64:67], a[212:215], v[144:147]
    v_pk_mul_f32 v[236:237], v[236:237], s[36:37]
    v_pk_mul_f32 v[238:239], v[238:239], s[36:37]
    v_cvt_pk_bf16_f32 v164, v236, v237
    v_cvt_pk_bf16_f32 v165, v238, v239
    s_waitcnt lgkmcnt(1)
    v_mfma_f32_16x16x32_bf16 v[120:123], v[68:71], a[168:171], v[120:123]
    ds_read_b64_tr_b16 v[44:45], v8 offset:16384
    ds_read_b64_tr_b16 v[46:47], v8 offset:20480
    v_mfma_f32_16x16x32_bf16 v[128:131], v[68:71], a[184:187], v[128:131]
    v_exp_f32 v105, v105
    v_mfma_f32_16x16x32_bf16 v[136:139], v[68:71], a[200:203], v[136:139]
    v_exp_f32 v106, v106
    v_mfma_f32_16x16x32_bf16 v[144:147], v[68:71], a[216:219], v[144:147]
    v_lshlrev_b32 v240, 16, v166
    v_and_b32 v241, 0xffff0000, v166
    s_waitcnt lgkmcnt(2)
    v_mfma_f32_16x16x32_bf16 v[120:123], v[72:75], a[172:175], v[120:123]
    ds_read_b64_tr_b16 v[48:49], v9 offset:16384
    ds_read_b64_tr_b16 v[50:51], v9 offset:20480
    v_mfma_f32_16x16x32_bf16 v[128:131], v[72:75], a[188:191], v[128:131]
    v_exp_f32 v107, v107
    v_mfma_f32_16x16x32_bf16 v[136:139], v[72:75], a[204:207], v[136:139]
    v_cvt_pk_bf16_f32 v102, v104, v105
    v_cvt_pk_bf16_f32 v103, v106, v107
    v_mfma_f32_16x16x32_bf16 v[144:147], v[72:75], a[220:223], v[144:147]
    s_mov_b32 s33, s45
    s_waitcnt lgkmcnt(2)
    v_mfma_f32_16x16x32_bf16 a[0:3], v[44:47], v[76:79], a[0:3]
    ds_read_b64_tr_b16 v[52:53], v10 offset:16384
    ds_read_b64_tr_b16 v[54:55], v10 offset:20480
    v_mfma_f32_16x16x32_bf16 a[32:35], v[44:47], v[84:87], a[32:35]
    v_mfma_f32_16x16x32_bf16 a[64:67], v[44:47], v[92:95], a[64:67]
    v_exp_f32 v116, v116
    v_lshlrev_b32 v242, 16, v167
    v_and_b32 v243, 0xffff0000, v167
    v_mfma_f32_16x16x32_bf16 a[96:99], v[44:47], v[100:103], a[96:99]
    v_exp_f32 v117, v117
    s_waitcnt lgkmcnt(2)
    v_mfma_f32_16x16x32_bf16 a[4:7], v[48:51], v[76:79], a[4:7]
    ds_read_b64_tr_b16 v[56:57], v11 offset:16384
    ds_read_b64_tr_b16 v[58:59], v11 offset:20480
    v_mfma_f32_16x16x32_bf16 a[36:39], v[48:51], v[84:87], a[36:39]
    v_exp_f32 v118, v118
    v_mfma_f32_16x16x32_bf16 a[68:71], v[48:51], v[92:95], a[68:71]
    v_pk_mul_f32 v[240:241], v[240:241], s[36:37]
    v_pk_mul_f32 v[242:243], v[242:243], s[36:37]
    v_cvt_pk_bf16_f32 v166, v240, v241
    v_cvt_pk_bf16_f32 v167, v242, v243
    v_mfma_f32_16x16x32_bf16 a[100:103], v[48:51], v[100:103], a[100:103]
    v_exp_f32 v119, v119
    s_waitcnt lgkmcnt(2)
    v_mfma_f32_16x16x32_bf16 a[8:11], v[52:55], v[76:79], a[8:11]
    ds_read_b64_tr_b16 v[60:61], v12 offset:16384
    ds_read_b64_tr_b16 v[62:63], v12 offset:20480
    v_mfma_f32_16x16x32_bf16 a[40:43], v[52:55], v[84:87], a[40:43]
    v_exp_f32 v120, v120
    v_mfma_f32_16x16x32_bf16 a[72:75], v[52:55], v[92:95], a[72:75]
    v_cvt_pk_bf16_f32 v116, v116, v117
    v_cvt_pk_bf16_f32 v117, v118, v119
    v_mfma_f32_16x16x32_bf16 a[104:107], v[52:55], v[100:103], a[104:107]
    v_lshlrev_b32 v236, 16, v168
    v_and_b32 v237, 0xffff0000, v168
    s_waitcnt lgkmcnt(2)
    v_mfma_f32_16x16x32_bf16 a[12:15], v[56:59], v[76:79], a[12:15]
    ds_read_b64_tr_b16 v[64:65], v13 offset:16384
    ds_read_b64_tr_b16 v[66:67], v13 offset:20480
    v_mfma_f32_16x16x32_bf16 a[44:47], v[56:59], v[84:87], a[44:47]
    v_exp_f32 v121, v121
    v_exp_f32 v122, v122
    v_mfma_f32_16x16x32_bf16 a[76:79], v[56:59], v[92:95], a[76:79]
    v_lshlrev_b32 v238, 16, v169
    v_and_b32 v239, 0xffff0000, v169
    v_mfma_f32_16x16x32_bf16 a[108:111], v[56:59], v[100:103], a[108:111]
    v_exp_f32 v123, v123
    s_waitcnt lgkmcnt(2)
    v_mfma_f32_16x16x32_bf16 a[16:19], v[60:63], v[76:79], a[16:19]
    ds_read_b64_tr_b16 v[68:69], v14 offset:16384
    ds_read_b64_tr_b16 v[70:71], v14 offset:20480
    v_mfma_f32_16x16x32_bf16 a[48:51], v[60:63], v[84:87], a[48:51]
    v_cvt_pk_bf16_f32 v118, v120, v121
    v_cvt_pk_bf16_f32 v119, v122, v123
    v_mfma_f32_16x16x32_bf16 a[80:83], v[60:63], v[92:95], a[80:83]
    v_exp_f32 v124, v124
    v_mfma_f32_16x16x32_bf16 a[112:115], v[60:63], v[100:103], a[112:115]
    v_pk_mul_f32 v[236:237], v[236:237], s[36:37]
    v_pk_mul_f32 v[238:239], v[238:239], s[36:37]
    v_cvt_pk_bf16_f32 v168, v236, v237
    v_cvt_pk_bf16_f32 v169, v238, v239
    s_waitcnt lgkmcnt(2)
    v_mfma_f32_16x16x32_bf16 a[20:23], v[64:67], v[76:79], a[20:23]
    ds_read_b64_tr_b16 v[72:73], v15 offset:16384
    ds_read_b64_tr_b16 v[74:75], v15 offset:20480
    v_mfma_f32_16x16x32_bf16 a[52:55], v[64:67], v[84:87], a[52:55]
    v_exp_f32 v125, v125
    v_mfma_f32_16x16x32_bf16 a[84:87], v[64:67], v[92:95], a[84:87]
    v_exp_f32 v126, v126
    v_mfma_f32_16x16x32_bf16 a[116:119], v[64:67], v[100:103], a[116:119]
    v_lshlrev_b32 v240, 16, v170
    v_and_b32 v241, 0xffff0000, v170
    v_exp_f32 v127, v127
    s_waitcnt lgkmcnt(2)
    v_mfma_f32_16x16x32_bf16 a[24:27], v[68:71], v[76:79], a[24:27]
    ds_read_b128 v[44:47], v4 offset:32768
    ds_read_b128 v[48:51], v5 offset:32768
    v_mfma_f32_16x16x32_bf16 a[56:59], v[68:71], v[84:87], a[56:59]
    v_exp_f32 v128, v128
    v_mfma_f32_16x16x32_bf16 a[88:91], v[68:71], v[92:95], a[88:91]
    v_cvt_pk_bf16_f32 v124, v124, v125
    v_cvt_pk_bf16_f32 v125, v126, v127
    v_mfma_f32_16x16x32_bf16 a[120:123], v[68:71], v[100:103], a[120:123]
    v_lshlrev_b32 v242, 16, v171
    v_and_b32 v243, 0xffff0000, v171
    s_waitcnt lgkmcnt(2)
    v_mfma_f32_16x16x32_bf16 a[28:31], v[72:75], v[76:79], a[28:31]
    v_exp_f32 v129, v129
    v_mfma_f32_16x16x32_bf16 a[60:63], v[72:75], v[84:87], a[60:63]
    v_exp_f32 v130, v130
    v_mfma_f32_16x16x32_bf16 a[92:95], v[72:75], v[92:95], a[92:95]
    v_pk_mul_f32 v[240:241], v[240:241], s[36:37]
    v_pk_mul_f32 v[242:243], v[242:243], s[36:37]
    v_cvt_pk_bf16_f32 v170, v240, v241
    v_cvt_pk_bf16_f32 v171, v242, v243
    v_mfma_f32_16x16x32_bf16 a[124:127], v[72:75], v[100:103], a[124:127]
    v_exp_f32 v131, v131
    v_mfma_f32_16x16x32_bf16 a[240:243], v[248:251], v[76:79], a[240:243]
    v_cvt_pk_bf16_f32 v126, v128, v129
    v_cvt_pk_bf16_f32 v127, v130, v131
    v_mfma_f32_16x16x32_bf16 a[244:247], v[248:251], v[84:87], a[244:247]
    v_exp_f32 v132, v132
    v_lshlrev_b32 v236, 16, v172
    v_and_b32 v237, 0xffff0000, v172
    s_waitcnt vmcnt(9)
    s_barrier
    v_mfma_f32_16x16x32_bf16 a[248:251], v[248:251], v[92:95], a[248:251]
    s_add_u32 m0, s34, 0
    s_nop 0
    buffer_load_dwordx4 v1, s[16:19], s33 offen lds
    v_mfma_f32_16x16x32_bf16 a[252:255], v[248:251], v[100:103], a[252:255]
    buffer_load_dwordx4 v2, s[16:19], s33 offen offset:1024 lds
    s_waitcnt lgkmcnt(1)
    v_mfma_f32_16x16x32_bf16 v[76:79], v[44:47], a[160:163], v[24:27]
    ds_read_b128 v[52:55], v6 offset:32768
    ds_read_b128 v[56:59], v7 offset:32768
    v_mfma_f32_16x16x32_bf16 v[84:87], v[44:47], a[176:179], v[28:31]
    s_add_u32 m0, s34, 65536
    s_nop 0
    buffer_load_dwordx4 v1, s[20:23], s33 offen lds
    v_mfma_f32_16x16x32_bf16 v[92:95], v[44:47], a[192:195], v[32:35]
    buffer_load_dwordx4 v2, s[20:23], s33 offen offset:1024 lds
    s_add_u32 s33, s33, 8192
    v_mfma_f32_16x16x32_bf16 v[100:103], v[44:47], a[208:211], v[36:39]
    v_exp_f32 v133, v133
    s_waitcnt lgkmcnt(2)
    v_mfma_f32_16x16x32_bf16 v[76:79], v[48:51], a[164:167], v[76:79]
    v_exp_f32 v134, v134
    v_mfma_f32_16x16x32_bf16 v[84:87], v[48:51], a[180:183], v[84:87]
    v_lshlrev_b32 v238, 16, v173
    v_and_b32 v239, 0xffff0000, v173
    v_mfma_f32_16x16x32_bf16 v[92:95], v[48:51], a[196:199], v[92:95]
    v_exp_f32 v135, v135
    v_mfma_f32_16x16x32_bf16 v[100:103], v[48:51], a[212:215], v[100:103]
    v_exp_f32 v136, v136
    s_waitcnt lgkmcnt(1)
    v_mfma_f32_16x16x32_bf16 v[76:79], v[52:55], a[168:171], v[76:79]
    ds_read_b128 v[60:63], v4 offset:36864
    ds_read_b128 v[64:67], v5 offset:36864
    v_mfma_f32_16x16x32_bf16 v[84:87], v[52:55], a[184:187], v[84:87]
    v_cvt_pk_bf16_f32 v132, v132, v133
    v_cvt_pk_bf16_f32 v133, v134, v135
    v_mfma_f32_16x16x32_bf16 v[92:95], v[52:55], a[200:203], v[92:95]
    v_pk_mul_f32 v[236:237], v[236:237], s[36:37]
    v_pk_mul_f32 v[238:239], v[238:239], s[36:37]
    v_cvt_pk_bf16_f32 v172, v236, v237
    v_cvt_pk_bf16_f32 v173, v238, v239
    v_mfma_f32_16x16x32_bf16 v[100:103], v[52:55], a[216:219], v[100:103]
    v_exp_f32 v137, v137
    v_exp_f32 v138, v138
    s_waitcnt lgkmcnt(2)
    v_mfma_f32_16x16x32_bf16 v[76:79], v[56:59], a[172:175], v[76:79]
    v_lshlrev_b32 v240, 16, v174
    v_and_b32 v241, 0xffff0000, v174
    v_mfma_f32_16x16x32_bf16 v[84:87], v[56:59], a[188:191], v[84:87]
    v_exp_f32 v139, v139
    v_mfma_f32_16x16x32_bf16 v[92:95], v[56:59], a[204:207], v[92:95]
    v_cvt_pk_bf16_f32 v134, v136, v137
    v_cvt_pk_bf16_f32 v135, v138, v139
    v_mfma_f32_16x16x32_bf16 v[100:103], v[56:59], a[220:223], v[100:103]
    v_exp_f32 v140, v140
    s_waitcnt lgkmcnt(1)
    v_mfma_f32_16x16x32_bf16 v[80:83], v[60:63], a[160:163], v[24:27]
    ds_read_b128 v[68:71], v6 offset:36864
    ds_read_b128 v[72:75], v7 offset:36864
    v_mfma_f32_16x16x32_bf16 v[88:91], v[60:63], a[176:179], v[28:31]
    v_lshlrev_b32 v242, 16, v175
    v_and_b32 v243, 0xffff0000, v175
    v_mfma_f32_16x16x32_bf16 v[96:99], v[60:63], a[192:195], v[32:35]
    v_exp_f32 v141, v141
    v_mfma_f32_16x16x32_bf16 v[104:107], v[60:63], a[208:211], v[36:39]
    v_exp_f32 v142, v142
    s_waitcnt lgkmcnt(2)
    v_mfma_f32_16x16x32_bf16 v[80:83], v[64:67], a[164:167], v[80:83]
    v_pk_mul_f32 v[240:241], v[240:241], s[36:37]
    v_pk_mul_f32 v[242:243], v[242:243], s[36:37]
    v_cvt_pk_bf16_f32 v174, v240, v241
    v_cvt_pk_bf16_f32 v175, v242, v243
    v_exp_f32 v143, v143
    v_mfma_f32_16x16x32_bf16 v[88:91], v[64:67], a[180:183], v[88:91]
    v_exp_f32 v144, v144
    v_mfma_f32_16x16x32_bf16 v[96:99], v[64:67], a[196:199], v[96:99]
    v_cvt_pk_bf16_f32 v140, v140, v141
    v_cvt_pk_bf16_f32 v141, v142, v143
    v_mfma_f32_16x16x32_bf16 v[104:107], v[64:67], a[212:215], v[104:107]
    v_lshlrev_b32 v236, 16, v176
    v_and_b32 v237, 0xffff0000, v176
    s_waitcnt lgkmcnt(1)
    v_mfma_f32_16x16x32_bf16 v[80:83], v[68:71], a[168:171], v[80:83]
    ds_read_b64_tr_b16 v[44:45], v8 offset:24576
    ds_read_b64_tr_b16 v[46:47], v8 offset:28672
    v_mfma_f32_16x16x32_bf16 v[88:91], v[68:71], a[184:187], v[88:91]
    v_exp_f32 v145, v145
    v_mfma_f32_16x16x32_bf16 v[96:99], v[68:71], a[200:203], v[96:99]
    v_exp_f32 v146, v146
    v_mfma_f32_16x16x32_bf16 v[104:107], v[68:71], a[216:219], v[104:107]
    v_lshlrev_b32 v238, 16, v177
    v_and_b32 v239, 0xffff0000, v177
    s_waitcnt lgkmcnt(2)
    v_mfma_f32_16x16x32_bf16 v[80:83], v[72:75], a[172:175], v[80:83]
    ds_read_b64_tr_b16 v[48:49], v9 offset:24576
    ds_read_b64_tr_b16 v[50:51], v9 offset:28672
    v_mfma_f32_16x16x32_bf16 v[88:91], v[72:75], a[188:191], v[88:91]
    v_exp_f32 v147, v147
    v_mfma_f32_16x16x32_bf16 v[96:99], v[72:75], a[204:207], v[96:99]
    v_cvt_pk_bf16_f32 v142, v144, v145
    v_cvt_pk_bf16_f32 v143, v146, v147
    v_mfma_f32_16x16x32_bf16 v[104:107], v[72:75], a[220:223], v[104:107]
    s_waitcnt lgkmcnt(2)
    v_mfma_f32_16x16x32_bf16 a[0:3], v[44:47], v[116:119], a[0:3]
    ds_read_b64_tr_b16 v[52:53], v10 offset:24576
    ds_read_b64_tr_b16 v[54:55], v10 offset:28672
    v_mfma_f32_16x16x32_bf16 a[32:35], v[44:47], v[124:127], a[32:35]
    v_mfma_f32_16x16x32_bf16 a[64:67], v[44:47], v[132:135], a[64:67]
    v_exp_f32 v76, v76
    v_pk_mul_f32 v[236:237], v[236:237], s[36:37]
    v_pk_mul_f32 v[238:239], v[238:239], s[36:37]
    v_cvt_pk_bf16_f32 v176, v236, v237
    v_cvt_pk_bf16_f32 v177, v238, v239
    v_mfma_f32_16x16x32_bf16 a[96:99], v[44:47], v[140:143], a[96:99]
    v_exp_f32 v77, v77
    s_waitcnt lgkmcnt(2)
    v_mfma_f32_16x16x32_bf16 a[4:7], v[48:51], v[116:119], a[4:7]
    ds_read_b64_tr_b16 v[56:57], v11 offset:24576
    ds_read_b64_tr_b16 v[58:59], v11 offset:28672
    v_mfma_f32_16x16x32_bf16 a[36:39], v[48:51], v[124:127], a[36:39]
    v_exp_f32 v78, v78
    v_mfma_f32_16x16x32_bf16 a[68:71], v[48:51], v[132:135], a[68:71]
    v_lshlrev_b32 v240, 16, v178
    v_and_b32 v241, 0xffff0000, v178
    v_mfma_f32_16x16x32_bf16 a[100:103], v[48:51], v[140:143], a[100:103]
    v_exp_f32 v79, v79
    s_waitcnt lgkmcnt(2)
    v_mfma_f32_16x16x32_bf16 a[8:11], v[52:55], v[116:119], a[8:11]
    ds_read_b64_tr_b16 v[60:61], v12 offset:24576
    ds_read_b64_tr_b16 v[62:63], v12 offset:28672
    v_mfma_f32_16x16x32_bf16 a[40:43], v[52:55], v[124:127], a[40:43]
    v_exp_f32 v80, v80
    v_mfma_f32_16x16x32_bf16 a[72:75], v[52:55], v[132:135], a[72:75]
    v_cvt_pk_bf16_f32 v76, v76, v77
    v_cvt_pk_bf16_f32 v77, v78, v79
    v_mfma_f32_16x16x32_bf16 a[104:107], v[52:55], v[140:143], a[104:107]
    v_lshlrev_b32 v242, 16, v179
    v_and_b32 v243, 0xffff0000, v179
    s_waitcnt lgkmcnt(2)
    v_mfma_f32_16x16x32_bf16 a[12:15], v[56:59], v[116:119], a[12:15]
    ds_read_b64_tr_b16 v[64:65], v13 offset:24576
    ds_read_b64_tr_b16 v[66:67], v13 offset:28672
    v_mfma_f32_16x16x32_bf16 a[44:47], v[56:59], v[124:127], a[44:47]
    v_exp_f32 v81, v81
    v_exp_f32 v82, v82
    v_mfma_f32_16x16x32_bf16 a[76:79], v[56:59], v[132:135], a[76:79]
    v_pk_mul_f32 v[240:241], v[240:241], s[36:37]
    v_pk_mul_f32 v[242:243], v[242:243], s[36:37]
    v_cvt_pk_bf16_f32 v178, v240, v241
    v_cvt_pk_bf16_f32 v179, v242, v243
    v_mfma_f32_16x16x32_bf16 a[108:111], v[56:59], v[140:143], a[108:111]
    v_exp_f32 v83, v83
    s_waitcnt lgkmcnt(2)
    v_mfma_f32_16x16x32_bf16 a[16:19], v[60:63], v[116:119], a[16:19]
    ds_read_b64_tr_b16 v[68:69], v14 offset:24576
    ds_read_b64_tr_b16 v[70:71], v14 offset:28672
    v_mfma_f32_16x16x32_bf16 a[48:51], v[60:63], v[124:127], a[48:51]
    v_cvt_pk_bf16_f32 v78, v80, v81
    v_cvt_pk_bf16_f32 v79, v82, v83
    v_mfma_f32_16x16x32_bf16 a[80:83], v[60:63], v[132:135], a[80:83]
    v_exp_f32 v84, v84
    v_mfma_f32_16x16x32_bf16 a[112:115], v[60:63], v[140:143], a[112:115]
    v_lshlrev_b32 v236, 16, v180
    v_and_b32 v237, 0xffff0000, v180
    s_waitcnt lgkmcnt(2)
    v_mfma_f32_16x16x32_bf16 a[20:23], v[64:67], v[116:119], a[20:23]
    ds_read_b64_tr_b16 v[72:73], v15 offset:24576
    ds_read_b64_tr_b16 v[74:75], v15 offset:28672
    v_mfma_f32_16x16x32_bf16 a[52:55], v[64:67], v[124:127], a[52:55]
    v_exp_f32 v85, v85
    s_nop 1
    v_mfma_f32_16x16x32_bf16 a[84:87], v[64:67], v[132:135], a[84:87]
    v_exp_f32 v86, v86
    v_mfma_f32_16x16x32_bf16 a[116:119], v[64:67], v[140:143], a[116:119]
    v_lshlrev_b32 v238, 16, v181
    v_and_b32 v239, 0xffff0000, v181
    v_exp_f32 v87, v87
    s_waitcnt lgkmcnt(2)
    v_mfma_f32_16x16x32_bf16 a[24:27], v[68:71], v[116:119], a[24:27]
    ds_read_b128 v[44:47], v4 offset:40960
    ds_read_b128 v[48:51], v5 offset:40960
    v_mfma_f32_16x16x32_bf16 a[56:59], v[68:71], v[124:127], a[56:59]
    v_exp_f32 v88, v88
    s_nop 1
    v_mfma_f32_16x16x32_bf16 a[88:91], v[68:71], v[132:135], a[88:91]
    v_cvt_pk_bf16_f32 v84, v84, v85
    v_cvt_pk_bf16_f32 v85, v86, v87
    v_mfma_f32_16x16x32_bf16 a[120:123], v[68:71], v[140:143], a[120:123]
    v_pk_mul_f32 v[236:237], v[236:237], s[36:37]
    v_pk_mul_f32 v[238:239], v[238:239], s[36:37]
    v_cvt_pk_bf16_f32 v180, v236, v237
    v_cvt_pk_bf16_f32 v181, v238, v239
    s_waitcnt lgkmcnt(2)
    v_mfma_f32_16x16x32_bf16 a[28:31], v[72:75], v[116:119], a[28:31]
    v_exp_f32 v89, v89
    v_mfma_f32_16x16x32_bf16 a[60:63], v[72:75], v[124:127], a[60:63]
    v_exp_f32 v90, v90
    v_mfma_f32_16x16x32_bf16 a[92:95], v[72:75], v[132:135], a[92:95]
    v_lshlrev_b32 v240, 16, v182
    v_and_b32 v241, 0xffff0000, v182
    v_mfma_f32_16x16x32_bf16 a[124:127], v[72:75], v[140:143], a[124:127]
    v_exp_f32 v91, v91
    v_mfma_f32_16x16x32_bf16 a[240:243], v[248:251], v[116:119], a[240:243]
    v_cvt_pk_bf16_f32 v86, v88, v89
    v_cvt_pk_bf16_f32 v87, v90, v91
    v_mfma_f32_16x16x32_bf16 a[244:247], v[248:251], v[124:127], a[244:247]
    v_exp_f32 v92, v92
    v_lshlrev_b32 v242, 16, v183
    v_and_b32 v243, 0xffff0000, v183
    s_waitcnt vmcnt(8)
    s_barrier
    v_mfma_f32_16x16x32_bf16 a[248:251], v[248:251], v[132:135], a[248:251]
    s_add_u32 m0, s34, 8192
    s_nop 0
    buffer_load_dwordx4 v1, s[16:19], s33 offen lds
    v_mfma_f32_16x16x32_bf16 a[252:255], v[248:251], v[140:143], a[252:255]
    buffer_load_dwordx4 v2, s[16:19], s33 offen offset:1024 lds
    s_waitcnt lgkmcnt(1)
    v_mfma_f32_16x16x32_bf16 v[116:119], v[44:47], a[160:163], v[24:27]
    ds_read_b128 v[52:55], v6 offset:40960
    ds_read_b128 v[56:59], v7 offset:40960
    v_mfma_f32_16x16x32_bf16 v[124:127], v[44:47], a[176:179], v[28:31]
    s_add_u32 m0, s34, 73728
    s_nop 0
    buffer_load_dwordx4 v1, s[20:23], s33 offen lds
    v_mfma_f32_16x16x32_bf16 v[132:135], v[44:47], a[192:195], v[32:35]
    buffer_load_dwordx4 v2, s[20:23], s33 offen offset:1024 lds
    s_add_u32 s33, s33, 8192
    v_mfma_f32_16x16x32_bf16 v[140:143], v[44:47], a[208:211], v[36:39]
    v_exp_f32 v93, v93
    s_waitcnt lgkmcnt(2)
    v_mfma_f32_16x16x32_bf16 v[116:119], v[48:51], a[164:167], v[116:119]
    v_exp_f32 v94, v94
    v_mfma_f32_16x16x32_bf16 v[124:127], v[48:51], a[180:183], v[124:127]
    v_pk_mul_f32 v[240:241], v[240:241], s[36:37]
    v_pk_mul_f32 v[242:243], v[242:243], s[36:37]
    v_cvt_pk_bf16_f32 v182, v240, v241
    v_cvt_pk_bf16_f32 v183, v242, v243
    v_mfma_f32_16x16x32_bf16 v[132:135], v[48:51], a[196:199], v[132:135]
    v_exp_f32 v95, v95
    v_mfma_f32_16x16x32_bf16 v[140:143], v[48:51], a[212:215], v[140:143]
    v_exp_f32 v96, v96
    s_waitcnt lgkmcnt(1)
    v_mfma_f32_16x16x32_bf16 v[116:119], v[52:55], a[168:171], v[116:119]
    ds_read_b128 v[60:63], v4 offset:45056
    ds_read_b128 v[64:67], v5 offset:45056
    v_mfma_f32_16x16x32_bf16 v[124:127], v[52:55], a[184:187], v[124:127]
    v_cvt_pk_bf16_f32 v92, v92, v93
    v_cvt_pk_bf16_f32 v93, v94, v95
    v_mfma_f32_16x16x32_bf16 v[132:135], v[52:55], a[200:203], v[132:135]
    v_lshlrev_b32 v236, 16, v184
    v_and_b32 v237, 0xffff0000, v184
    v_mfma_f32_16x16x32_bf16 v[140:143], v[52:55], a[216:219], v[140:143]
    v_exp_f32 v97, v97
    v_exp_f32 v98, v98
    s_waitcnt lgkmcnt(2)
    v_mfma_f32_16x16x32_bf16 v[116:119], v[56:59], a[172:175], v[116:119]
    v_lshlrev_b32 v238, 16, v185
    v_and_b32 v239, 0xffff0000, v185
    v_mfma_f32_16x16x32_bf16 v[124:127], v[56:59], a[188:191], v[124:127]
    v_exp_f32 v99, v99
    v_mfma_f32_16x16x32_bf16 v[132:135], v[56:59], a[204:207], v[132:135]
    v_cvt_pk_bf16_f32 v94, v96, v97
    v_cvt_pk_bf16_f32 v95, v98, v99
    v_mfma_f32_16x16x32_bf16 v[140:143], v[56:59], a[220:223], v[140:143]
    v_exp_f32 v100, v100
    s_waitcnt lgkmcnt(1)
    v_mfma_f32_16x16x32_bf16 v[120:123], v[60:63], a[160:163], v[24:27]
    ds_read_b128 v[68:71], v6 offset:45056
    ds_read_b128 v[72:75], v7 offset:45056
    v_mfma_f32_16x16x32_bf16 v[128:131], v[60:63], a[176:179], v[28:31]
    v_pk_mul_f32 v[236:237], v[236:237], s[36:37]
    v_pk_mul_f32 v[238:239], v[238:239], s[36:37]
    v_cvt_pk_bf16_f32 v184, v236, v237
    v_cvt_pk_bf16_f32 v185, v238, v239
    v_mfma_f32_16x16x32_bf16 v[136:139], v[60:63], a[192:195], v[32:35]
    v_exp_f32 v101, v101
    v_mfma_f32_16x16x32_bf16 v[144:147], v[60:63], a[208:211], v[36:39]
    v_exp_f32 v102, v102
    s_waitcnt lgkmcnt(2)
    v_mfma_f32_16x16x32_bf16 v[120:123], v[64:67], a[164:167], v[120:123]
    v_lshlrev_b32 v240, 16, v186
    v_and_b32 v241, 0xffff0000, v186
    v_exp_f32 v103, v103
    v_mfma_f32_16x16x32_bf16 v[128:131], v[64:67], a[180:183], v[128:131]
    v_exp_f32 v104, v104
    v_mfma_f32_16x16x32_bf16 v[136:139], v[64:67], a[196:199], v[136:139]
    v_cvt_pk_bf16_f32 v100, v100, v101
    v_cvt_pk_bf16_f32 v101, v102, v103
    v_mfma_f32_16x16x32_bf16 v[144:147], v[64:67], a[212:215], v[144:147]
    v_lshlrev_b32 v242, 16, v187
    v_and_b32 v243, 0xffff0000, v187
    s_waitcnt lgkmcnt(1)
    v_mfma_f32_16x16x32_bf16 v[120:123], v[68:71], a[168:171], v[120:123]
    ds_read_b64_tr_b16 v[44:45], v8 offset:32768
    ds_read_b64_tr_b16 v[46:47], v8 offset:36864
    v_mfma_f32_16x16x32_bf16 v[128:131], v[68:71], a[184:187], v[128:131]
    v_exp_f32 v105, v105
    v_mfma_f32_16x16x32_bf16 v[136:139], v[68:71], a[200:203], v[136:139]
    v_exp_f32 v106, v106
    v_mfma_f32_16x16x32_bf16 v[144:147], v[68:71], a[216:219], v[144:147]
    v_pk_mul_f32 v[240:241], v[240:241], s[36:37]
    v_pk_mul_f32 v[242:243], v[242:243], s[36:37]
    v_cvt_pk_bf16_f32 v186, v240, v241
    v_cvt_pk_bf16_f32 v187, v242, v243
    s_waitcnt lgkmcnt(2)
    v_mfma_f32_16x16x32_bf16 v[120:123], v[72:75], a[172:175], v[120:123]
    ds_read_b64_tr_b16 v[48:49], v9 offset:32768
    ds_read_b64_tr_b16 v[50:51], v9 offset:36864
    v_mfma_f32_16x16x32_bf16 v[128:131], v[72:75], a[188:191], v[128:131]
    v_exp_f32 v107, v107
    v_mfma_f32_16x16x32_bf16 v[136:139], v[72:75], a[204:207], v[136:139]
    v_cvt_pk_bf16_f32 v102, v104, v105
    v_cvt_pk_bf16_f32 v103, v106, v107
    v_mfma_f32_16x16x32_bf16 v[144:147], v[72:75], a[220:223], v[144:147]
    s_waitcnt vmcnt(36)
    s_waitcnt lgkmcnt(2)
    v_mfma_f32_16x16x32_bf16 a[0:3], v[44:47], v[76:79], a[0:3]
    ds_read_b64_tr_b16 v[52:53], v10 offset:32768
    ds_read_b64_tr_b16 v[54:55], v10 offset:36864
    v_mfma_f32_16x16x32_bf16 a[32:35], v[44:47], v[84:87], a[32:35]
    v_mfma_f32_16x16x32_bf16 a[64:67], v[44:47], v[92:95], a[64:67]
    v_exp_f32 v116, v116
    v_lshlrev_b32 v236, 16, v188
    v_and_b32 v237, 0xffff0000, v188
    v_mfma_f32_16x16x32_bf16 a[96:99], v[44:47], v[100:103], a[96:99]
    v_exp_f32 v117, v117
    s_waitcnt lgkmcnt(2)
    v_mfma_f32_16x16x32_bf16 a[4:7], v[48:51], v[76:79], a[4:7]
    ds_read_b64_tr_b16 v[56:57], v11 offset:32768
    ds_read_b64_tr_b16 v[58:59], v11 offset:36864
    v_mfma_f32_16x16x32_bf16 a[36:39], v[48:51], v[84:87], a[36:39]
    v_exp_f32 v118, v118
    v_mfma_f32_16x16x32_bf16 a[68:71], v[48:51], v[92:95], a[68:71]
    v_lshlrev_b32 v238, 16, v189
    v_and_b32 v239, 0xffff0000, v189
    v_mfma_f32_16x16x32_bf16 a[100:103], v[48:51], v[100:103], a[100:103]
    v_exp_f32 v119, v119
    s_waitcnt lgkmcnt(2)
    v_mfma_f32_16x16x32_bf16 a[8:11], v[52:55], v[76:79], a[8:11]
    ds_read_b64_tr_b16 v[60:61], v12 offset:32768
    ds_read_b64_tr_b16 v[62:63], v12 offset:36864
    v_mfma_f32_16x16x32_bf16 a[40:43], v[52:55], v[84:87], a[40:43]
    v_exp_f32 v120, v120
    v_mfma_f32_16x16x32_bf16 a[72:75], v[52:55], v[92:95], a[72:75]
    v_cvt_pk_bf16_f32 v116, v116, v117
    v_cvt_pk_bf16_f32 v117, v118, v119
    v_mfma_f32_16x16x32_bf16 a[104:107], v[52:55], v[100:103], a[104:107]
    v_pk_mul_f32 v[236:237], v[236:237], s[36:37]
    v_pk_mul_f32 v[238:239], v[238:239], s[36:37]
    v_cvt_pk_bf16_f32 v188, v236, v237
    v_cvt_pk_bf16_f32 v189, v238, v239
    s_waitcnt lgkmcnt(2)
    v_mfma_f32_16x16x32_bf16 a[12:15], v[56:59], v[76:79], a[12:15]
    ds_read_b64_tr_b16 v[64:65], v13 offset:32768
    ds_read_b64_tr_b16 v[66:67], v13 offset:36864
    v_mfma_f32_16x16x32_bf16 a[44:47], v[56:59], v[84:87], a[44:47]
    v_exp_f32 v121, v121
    v_exp_f32 v122, v122
    v_mfma_f32_16x16x32_bf16 a[76:79], v[56:59], v[92:95], a[76:79]
    v_lshlrev_b32 v240, 16, v190
    v_and_b32 v241, 0xffff0000, v190
    v_mfma_f32_16x16x32_bf16 a[108:111], v[56:59], v[100:103], a[108:111]
    v_exp_f32 v123, v123
    s_waitcnt lgkmcnt(2)
    v_mfma_f32_16x16x32_bf16 a[16:19], v[60:63], v[76:79], a[16:19]
    ds_read_b64_tr_b16 v[68:69], v14 offset:32768
    ds_read_b64_tr_b16 v[70:71], v14 offset:36864
    v_mfma_f32_16x16x32_bf16 a[48:51], v[60:63], v[84:87], a[48:51]
    v_cvt_pk_bf16_f32 v118, v120, v121
    v_cvt_pk_bf16_f32 v119, v122, v123
    v_mfma_f32_16x16x32_bf16 a[80:83], v[60:63], v[92:95], a[80:83]
    v_exp_f32 v124, v124
    v_mfma_f32_16x16x32_bf16 a[112:115], v[60:63], v[100:103], a[112:115]
    v_lshlrev_b32 v242, 16, v191
    v_and_b32 v243, 0xffff0000, v191
    s_waitcnt lgkmcnt(2)
    v_mfma_f32_16x16x32_bf16 a[20:23], v[64:67], v[76:79], a[20:23]
    ds_read_b64_tr_b16 v[72:73], v15 offset:32768
    ds_read_b64_tr_b16 v[74:75], v15 offset:36864
    v_mfma_f32_16x16x32_bf16 a[52:55], v[64:67], v[84:87], a[52:55]
    v_exp_f32 v125, v125
    v_mfma_f32_16x16x32_bf16 a[84:87], v[64:67], v[92:95], a[84:87]
    v_exp_f32 v126, v126
    v_mfma_f32_16x16x32_bf16 a[116:119], v[64:67], v[100:103], a[116:119]
    v_pk_mul_f32 v[240:241], v[240:241], s[36:37]
    v_pk_mul_f32 v[242:243], v[242:243], s[36:37]
    v_cvt_pk_bf16_f32 v190, v240, v241
    v_cvt_pk_bf16_f32 v191, v242, v243
    v_exp_f32 v127, v127
    s_waitcnt lgkmcnt(2)
    v_mfma_f32_16x16x32_bf16 a[24:27], v[68:71], v[76:79], a[24:27]
    ds_read_b128 v[44:47], v4 offset:49152
    ds_read_b128 v[48:51], v5 offset:49152
    v_mfma_f32_16x16x32_bf16 a[56:59], v[68:71], v[84:87], a[56:59]
    v_exp_f32 v128, v128
    v_mfma_f32_16x16x32_bf16 a[88:91], v[68:71], v[92:95], a[88:91]
    v_cvt_pk_bf16_f32 v124, v124, v125
    v_cvt_pk_bf16_f32 v125, v126, v127
    v_mfma_f32_16x16x32_bf16 a[120:123], v[68:71], v[100:103], a[120:123]
    v_lshlrev_b32 v236, 16, v192
    v_and_b32 v237, 0xffff0000, v192
    s_waitcnt lgkmcnt(2)
    v_mfma_f32_16x16x32_bf16 a[28:31], v[72:75], v[76:79], a[28:31]
    v_exp_f32 v129, v129
    v_mfma_f32_16x16x32_bf16 a[60:63], v[72:75], v[84:87], a[60:63]
    v_exp_f32 v130, v130
    v_mfma_f32_16x16x32_bf16 a[92:95], v[72:75], v[92:95], a[92:95]
    v_lshlrev_b32 v238, 16, v193
    v_and_b32 v239, 0xffff0000, v193
    v_mfma_f32_16x16x32_bf16 a[124:127], v[72:75], v[100:103], a[124:127]
    v_exp_f32 v131, v131
    v_mfma_f32_16x16x32_bf16 a[240:243], v[248:251], v[76:79], a[240:243]
    v_cvt_pk_bf16_f32 v126, v128, v129
    v_cvt_pk_bf16_f32 v127, v130, v131
    v_mfma_f32_16x16x32_bf16 a[244:247], v[248:251], v[84:87], a[244:247]
    v_exp_f32 v132, v132
    v_pk_mul_f32 v[236:237], v[236:237], s[36:37]
    v_pk_mul_f32 v[238:239], v[238:239], s[36:37]
    v_cvt_pk_bf16_f32 v192, v236, v237
    v_cvt_pk_bf16_f32 v193, v238, v239
    s_waitcnt vmcnt(8)
    s_barrier
    v_mfma_f32_16x16x32_bf16 a[248:251], v[248:251], v[92:95], a[248:251]
    s_add_u32 m0, s34, 16384
    s_nop 0
    buffer_load_dwordx4 v1, s[16:19], s33 offen lds
    v_mfma_f32_16x16x32_bf16 a[252:255], v[248:251], v[100:103], a[252:255]
    buffer_load_dwordx4 v2, s[16:19], s33 offen offset:1024 lds
    s_waitcnt lgkmcnt(1)
    v_mfma_f32_16x16x32_bf16 v[76:79], v[44:47], a[160:163], v[24:27]
    ds_read_b128 v[52:55], v6 offset:49152
    ds_read_b128 v[56:59], v7 offset:49152
    v_mfma_f32_16x16x32_bf16 v[84:87], v[44:47], a[176:179], v[28:31]
    s_add_u32 m0, s34, 81920
    s_nop 0
    buffer_load_dwordx4 v1, s[20:23], s33 offen lds
    v_mfma_f32_16x16x32_bf16 v[92:95], v[44:47], a[192:195], v[32:35]
    buffer_load_dwordx4 v2, s[20:23], s33 offen offset:1024 lds
    s_add_u32 s33, s33, 8192
    v_mfma_f32_16x16x32_bf16 v[100:103], v[44:47], a[208:211], v[36:39]
    v_exp_f32 v133, v133
    s_waitcnt lgkmcnt(2)
    v_mfma_f32_16x16x32_bf16 v[76:79], v[48:51], a[164:167], v[76:79]
    v_exp_f32 v134, v134
    v_mfma_f32_16x16x32_bf16 v[84:87], v[48:51], a[180:183], v[84:87]
    v_lshlrev_b32 v240, 16, v194
    v_and_b32 v241, 0xffff0000, v194
    v_mfma_f32_16x16x32_bf16 v[92:95], v[48:51], a[196:199], v[92:95]
    v_exp_f32 v135, v135
    v_mfma_f32_16x16x32_bf16 v[100:103], v[48:51], a[212:215], v[100:103]
    v_exp_f32 v136, v136
    s_waitcnt lgkmcnt(1)
    v_mfma_f32_16x16x32_bf16 v[76:79], v[52:55], a[168:171], v[76:79]
    ds_read_b128 v[60:63], v4 offset:53248
    ds_read_b128 v[64:67], v5 offset:53248
    v_mfma_f32_16x16x32_bf16 v[84:87], v[52:55], a[184:187], v[84:87]
    v_cvt_pk_bf16_f32 v132, v132, v133
    v_cvt_pk_bf16_f32 v133, v134, v135
    v_mfma_f32_16x16x32_bf16 v[92:95], v[52:55], a[200:203], v[92:95]
    v_lshlrev_b32 v242, 16, v195
    v_and_b32 v243, 0xffff0000, v195
    v_mfma_f32_16x16x32_bf16 v[100:103], v[52:55], a[216:219], v[100:103]
    v_exp_f32 v137, v137
    v_exp_f32 v138, v138
    s_waitcnt lgkmcnt(2)
    v_mfma_f32_16x16x32_bf16 v[76:79], v[56:59], a[172:175], v[76:79]
    v_pk_mul_f32 v[240:241], v[240:241], s[36:37]
    v_pk_mul_f32 v[242:243], v[242:243], s[36:37]
    v_cvt_pk_bf16_f32 v194, v240, v241
    v_cvt_pk_bf16_f32 v195, v242, v243
    v_mfma_f32_16x16x32_bf16 v[84:87], v[56:59], a[188:191], v[84:87]
    v_exp_f32 v139, v139
    v_mfma_f32_16x16x32_bf16 v[92:95], v[56:59], a[204:207], v[92:95]
    v_cvt_pk_bf16_f32 v134, v136, v137
    v_cvt_pk_bf16_f32 v135, v138, v139
    v_mfma_f32_16x16x32_bf16 v[100:103], v[56:59], a[220:223], v[100:103]
    v_exp_f32 v140, v140
    s_waitcnt lgkmcnt(1)
    v_mfma_f32_16x16x32_bf16 v[80:83], v[60:63], a[160:163], v[24:27]
    ds_read_b128 v[68:71], v6 offset:53248
    ds_read_b128 v[72:75], v7 offset:53248
    v_mfma_f32_16x16x32_bf16 v[88:91], v[60:63], a[176:179], v[28:31]
    v_lshlrev_b32 v236, 16, v196
    v_and_b32 v237, 0xffff0000, v196
    v_mfma_f32_16x16x32_bf16 v[96:99], v[60:63], a[192:195], v[32:35]
    v_exp_f32 v141, v141
    v_mfma_f32_16x16x32_bf16 v[104:107], v[60:63], a[208:211], v[36:39]
    v_exp_f32 v142, v142
    s_waitcnt lgkmcnt(2)
    v_mfma_f32_16x16x32_bf16 v[80:83], v[64:67], a[164:167], v[80:83]
    v_lshlrev_b32 v238, 16, v197
    v_and_b32 v239, 0xffff0000, v197
    v_exp_f32 v143, v143
    v_mfma_f32_16x16x32_bf16 v[88:91], v[64:67], a[180:183], v[88:91]
    v_exp_f32 v144, v144
    v_mfma_f32_16x16x32_bf16 v[96:99], v[64:67], a[196:199], v[96:99]
    v_cvt_pk_bf16_f32 v140, v140, v141
    v_cvt_pk_bf16_f32 v141, v142, v143
    v_mfma_f32_16x16x32_bf16 v[104:107], v[64:67], a[212:215], v[104:107]
    v_pk_mul_f32 v[236:237], v[236:237], s[36:37]
    v_pk_mul_f32 v[238:239], v[238:239], s[36:37]
    v_cvt_pk_bf16_f32 v196, v236, v237
    v_cvt_pk_bf16_f32 v197, v238, v239
    s_waitcnt lgkmcnt(1)
    v_mfma_f32_16x16x32_bf16 v[80:83], v[68:71], a[168:171], v[80:83]
    ds_read_b64_tr_b16 v[44:45], v8 offset:40960
    ds_read_b64_tr_b16 v[46:47], v8 offset:45056
    v_mfma_f32_16x16x32_bf16 v[88:91], v[68:71], a[184:187], v[88:91]
    v_exp_f32 v145, v145
    v_mfma_f32_16x16x32_bf16 v[96:99], v[68:71], a[200:203], v[96:99]
    v_exp_f32 v146, v146
    v_mfma_f32_16x16x32_bf16 v[104:107], v[68:71], a[216:219], v[104:107]
    v_lshlrev_b32 v240, 16, v198
    v_and_b32 v241, 0xffff0000, v198
    s_waitcnt lgkmcnt(2)
    v_mfma_f32_16x16x32_bf16 v[80:83], v[72:75], a[172:175], v[80:83]
    ds_read_b64_tr_b16 v[48:49], v9 offset:40960
    ds_read_b64_tr_b16 v[50:51], v9 offset:45056
    v_mfma_f32_16x16x32_bf16 v[88:91], v[72:75], a[188:191], v[88:91]
    v_exp_f32 v147, v147
    v_mfma_f32_16x16x32_bf16 v[96:99], v[72:75], a[204:207], v[96:99]
    v_cvt_pk_bf16_f32 v142, v144, v145
    v_cvt_pk_bf16_f32 v143, v146, v147
    v_mfma_f32_16x16x32_bf16 v[104:107], v[72:75], a[220:223], v[104:107]
    s_waitcnt vmcnt(20)
    s_waitcnt lgkmcnt(2)
    v_mfma_f32_16x16x32_bf16 a[0:3], v[44:47], v[116:119], a[0:3]
    ds_read_b64_tr_b16 v[52:53], v10 offset:40960
    ds_read_b64_tr_b16 v[54:55], v10 offset:45056
    v_mfma_f32_16x16x32_bf16 a[32:35], v[44:47], v[124:127], a[32:35]
    v_mfma_f32_16x16x32_bf16 a[64:67], v[44:47], v[132:135], a[64:67]
    v_exp_f32 v76, v76
    v_lshlrev_b32 v242, 16, v199
    v_and_b32 v243, 0xffff0000, v199
    v_mfma_f32_16x16x32_bf16 a[96:99], v[44:47], v[140:143], a[96:99]
    v_exp_f32 v77, v77
    s_waitcnt lgkmcnt(2)
    v_mfma_f32_16x16x32_bf16 a[4:7], v[48:51], v[116:119], a[4:7]
    ds_read_b64_tr_b16 v[56:57], v11 offset:40960
    ds_read_b64_tr_b16 v[58:59], v11 offset:45056
    v_mfma_f32_16x16x32_bf16 a[36:39], v[48:51], v[124:127], a[36:39]
    v_exp_f32 v78, v78
    v_mfma_f32_16x16x32_bf16 a[68:71], v[48:51], v[132:135], a[68:71]
    v_pk_mul_f32 v[240:241], v[240:241], s[36:37]
    v_pk_mul_f32 v[242:243], v[242:243], s[36:37]
    v_cvt_pk_bf16_f32 v198, v240, v241
    v_cvt_pk_bf16_f32 v199, v242, v243
    v_mfma_f32_16x16x32_bf16 a[100:103], v[48:51], v[140:143], a[100:103]
    v_exp_f32 v79, v79
    s_waitcnt lgkmcnt(2)
    v_mfma_f32_16x16x32_bf16 a[8:11], v[52:55], v[116:119], a[8:11]
    ds_read_b64_tr_b16 v[60:61], v12 offset:40960
    ds_read_b64_tr_b16 v[62:63], v12 offset:45056
    v_mfma_f32_16x16x32_bf16 a[40:43], v[52:55], v[124:127], a[40:43]
    v_exp_f32 v80, v80
    v_mfma_f32_16x16x32_bf16 a[72:75], v[52:55], v[132:135], a[72:75]
    v_cvt_pk_bf16_f32 v76, v76, v77
    v_cvt_pk_bf16_f32 v77, v78, v79
    v_mfma_f32_16x16x32_bf16 a[104:107], v[52:55], v[140:143], a[104:107]
    v_lshlrev_b32 v236, 16, v200
    v_and_b32 v237, 0xffff0000, v200
    s_waitcnt lgkmcnt(2)
    v_mfma_f32_16x16x32_bf16 a[12:15], v[56:59], v[116:119], a[12:15]
    ds_read_b64_tr_b16 v[64:65], v13 offset:40960
    ds_read_b64_tr_b16 v[66:67], v13 offset:45056
    v_mfma_f32_16x16x32_bf16 a[44:47], v[56:59], v[124:127], a[44:47]
    v_exp_f32 v81, v81
    v_exp_f32 v82, v82
    v_mfma_f32_16x16x32_bf16 a[76:79], v[56:59], v[132:135], a[76:79]
    v_lshlrev_b32 v238, 16, v201
    v_and_b32 v239, 0xffff0000, v201
    v_mfma_f32_16x16x32_bf16 a[108:111], v[56:59], v[140:143], a[108:111]
    v_exp_f32 v83, v83
    s_waitcnt lgkmcnt(2)
    v_mfma_f32_16x16x32_bf16 a[16:19], v[60:63], v[116:119], a[16:19]
    ds_read_b64_tr_b16 v[68:69], v14 offset:40960
    ds_read_b64_tr_b16 v[70:71], v14 offset:45056
    v_mfma_f32_16x16x32_bf16 a[48:51], v[60:63], v[124:127], a[48:51]
    v_cvt_pk_bf16_f32 v78, v80, v81
    v_cvt_pk_bf16_f32 v79, v82, v83
    v_mfma_f32_16x16x32_bf16 a[80:83], v[60:63], v[132:135], a[80:83]
    v_exp_f32 v84, v84
    v_mfma_f32_16x16x32_bf16 a[112:115], v[60:63], v[140:143], a[112:115]
    v_pk_mul_f32 v[236:237], v[236:237], s[36:37]
    v_pk_mul_f32 v[238:239], v[238:239], s[36:37]
    v_cvt_pk_bf16_f32 v200, v236, v237
    v_cvt_pk_bf16_f32 v201, v238, v239
    s_waitcnt lgkmcnt(2)
    v_mfma_f32_16x16x32_bf16 a[20:23], v[64:67], v[116:119], a[20:23]
    ds_read_b64_tr_b16 v[72:73], v15 offset:40960
    ds_read_b64_tr_b16 v[74:75], v15 offset:45056
    v_mfma_f32_16x16x32_bf16 a[52:55], v[64:67], v[124:127], a[52:55]
    v_exp_f32 v85, v85
    s_nop 1
    v_mfma_f32_16x16x32_bf16 a[84:87], v[64:67], v[132:135], a[84:87]
    v_exp_f32 v86, v86
    v_mfma_f32_16x16x32_bf16 a[116:119], v[64:67], v[140:143], a[116:119]
    v_lshlrev_b32 v240, 16, v202
    v_and_b32 v241, 0xffff0000, v202
    v_exp_f32 v87, v87
    s_waitcnt lgkmcnt(2)
    v_mfma_f32_16x16x32_bf16 a[24:27], v[68:71], v[116:119], a[24:27]
    ds_read_b128 v[44:47], v4 offset:57344
    ds_read_b128 v[48:51], v5 offset:57344
    v_mfma_f32_16x16x32_bf16 a[56:59], v[68:71], v[124:127], a[56:59]
    v_exp_f32 v88, v88
    s_nop 1
    v_mfma_f32_16x16x32_bf16 a[88:91], v[68:71], v[132:135], a[88:91]
    v_cvt_pk_bf16_f32 v84, v84, v85
    v_cvt_pk_bf16_f32 v85, v86, v87
    v_mfma_f32_16x16x32_bf16 a[120:123], v[68:71], v[140:143], a[120:123]
    v_lshlrev_b32 v242, 16, v203
    v_and_b32 v243, 0xffff0000, v203
    s_waitcnt lgkmcnt(2)
    v_mfma_f32_16x16x32_bf16 a[28:31], v[72:75], v[116:119], a[28:31]
    v_exp_f32 v89, v89
    v_mfma_f32_16x16x32_bf16 a[60:63], v[72:75], v[124:127], a[60:63]
    v_exp_f32 v90, v90
    v_mfma_f32_16x16x32_bf16 a[92:95], v[72:75], v[132:135], a[92:95]
    v_pk_mul_f32 v[240:241], v[240:241], s[36:37]
    v_pk_mul_f32 v[242:243], v[242:243], s[36:37]
    v_cvt_pk_bf16_f32 v202, v240, v241
    v_cvt_pk_bf16_f32 v203, v242, v243
    v_mfma_f32_16x16x32_bf16 a[124:127], v[72:75], v[140:143], a[124:127]
    v_exp_f32 v91, v91
    v_mfma_f32_16x16x32_bf16 a[240:243], v[248:251], v[116:119], a[240:243]
    v_cvt_pk_bf16_f32 v86, v88, v89
    v_cvt_pk_bf16_f32 v87, v90, v91
    v_mfma_f32_16x16x32_bf16 a[244:247], v[248:251], v[124:127], a[244:247]
    v_exp_f32 v92, v92
    v_lshlrev_b32 v236, 16, v204
    v_and_b32 v237, 0xffff0000, v204
    s_barrier
    v_mfma_f32_16x16x32_bf16 a[248:251], v[248:251], v[132:135], a[248:251]
    s_add_u32 m0, s34, 24576
    s_nop 0
    buffer_load_dwordx4 v1, s[16:19], s33 offen lds
    v_mfma_f32_16x16x32_bf16 a[252:255], v[248:251], v[140:143], a[252:255]
    buffer_load_dwordx4 v2, s[16:19], s33 offen offset:1024 lds
    s_waitcnt lgkmcnt(1)
    v_mfma_f32_16x16x32_bf16 v[116:119], v[44:47], a[160:163], v[24:27]
    ds_read_b128 v[52:55], v6 offset:57344
    ds_read_b128 v[56:59], v7 offset:57344
    v_mfma_f32_16x16x32_bf16 v[124:127], v[44:47], a[176:179], v[28:31]
    s_add_u32 m0, s34, 90112
    s_nop 0
    buffer_load_dwordx4 v1, s[20:23], s33 offen lds
    v_mfma_f32_16x16x32_bf16 v[132:135], v[44:47], a[192:195], v[32:35]
    buffer_load_dwordx4 v2, s[20:23], s33 offen offset:1024 lds
    s_add_u32 s33, s33, 8192
    v_mfma_f32_16x16x32_bf16 v[140:143], v[44:47], a[208:211], v[36:39]
    v_exp_f32 v93, v93
    s_waitcnt lgkmcnt(2)
    v_mfma_f32_16x16x32_bf16 v[116:119], v[48:51], a[164:167], v[116:119]
    v_exp_f32 v94, v94
    v_mfma_f32_16x16x32_bf16 v[124:127], v[48:51], a[180:183], v[124:127]
    v_lshlrev_b32 v238, 16, v205
    v_and_b32 v239, 0xffff0000, v205
    v_mfma_f32_16x16x32_bf16 v[132:135], v[48:51], a[196:199], v[132:135]
    v_exp_f32 v95, v95
    v_mfma_f32_16x16x32_bf16 v[140:143], v[48:51], a[212:215], v[140:143]
    v_exp_f32 v96, v96
    s_waitcnt lgkmcnt(1)
    v_mfma_f32_16x16x32_bf16 v[116:119], v[52:55], a[168:171], v[116:119]
    ds_read_b128 v[60:63], v4 offset:61440
    ds_read_b128 v[64:67], v5 offset:61440
    v_mfma_f32_16x16x32_bf16 v[124:127], v[52:55], a[184:187], v[124:127]
    v_cvt_pk_bf16_f32 v92, v92, v93
    v_cvt_pk_bf16_f32 v93, v94, v95
    v_mfma_f32_16x16x32_bf16 v[132:135], v[52:55], a[200:203], v[132:135]
    v_pk_mul_f32 v[236:237], v[236:237], s[36:37]
    v_pk_mul_f32 v[238:239], v[238:239], s[36:37]
    v_cvt_pk_bf16_f32 v204, v236, v237
    v_cvt_pk_bf16_f32 v205, v238, v239
    v_mfma_f32_16x16x32_bf16 v[140:143], v[52:55], a[216:219], v[140:143]
    v_exp_f32 v97, v97
    v_exp_f32 v98, v98
    s_waitcnt lgkmcnt(2)
    v_mfma_f32_16x16x32_bf16 v[116:119], v[56:59], a[172:175], v[116:119]
    v_lshlrev_b32 v240, 16, v206
    v_and_b32 v241, 0xffff0000, v206
    v_mfma_f32_16x16x32_bf16 v[124:127], v[56:59], a[188:191], v[124:127]
    v_exp_f32 v99, v99
    v_mfma_f32_16x16x32_bf16 v[132:135], v[56:59], a[204:207], v[132:135]
    v_cvt_pk_bf16_f32 v94, v96, v97
    v_cvt_pk_bf16_f32 v95, v98, v99
    v_mfma_f32_16x16x32_bf16 v[140:143], v[56:59], a[220:223], v[140:143]
    v_exp_f32 v100, v100
    s_waitcnt lgkmcnt(1)
    v_mfma_f32_16x16x32_bf16 v[120:123], v[60:63], a[160:163], v[24:27]
    ds_read_b128 v[68:71], v6 offset:61440
    ds_read_b128 v[72:75], v7 offset:61440
    v_mfma_f32_16x16x32_bf16 v[128:131], v[60:63], a[176:179], v[28:31]
    v_lshlrev_b32 v242, 16, v207
    v_and_b32 v243, 0xffff0000, v207
    v_mfma_f32_16x16x32_bf16 v[136:139], v[60:63], a[192:195], v[32:35]
    v_exp_f32 v101, v101
    v_mfma_f32_16x16x32_bf16 v[144:147], v[60:63], a[208:211], v[36:39]
    v_exp_f32 v102, v102
    s_waitcnt lgkmcnt(2)
    v_mfma_f32_16x16x32_bf16 v[120:123], v[64:67], a[164:167], v[120:123]
    v_pk_mul_f32 v[240:241], v[240:241], s[36:37]
    v_pk_mul_f32 v[242:243], v[242:243], s[36:37]
    v_cvt_pk_bf16_f32 v206, v240, v241
    v_cvt_pk_bf16_f32 v207, v242, v243
    v_exp_f32 v103, v103
    v_mfma_f32_16x16x32_bf16 v[128:131], v[64:67], a[180:183], v[128:131]
    v_exp_f32 v104, v104
    v_mfma_f32_16x16x32_bf16 v[136:139], v[64:67], a[196:199], v[136:139]
    v_cvt_pk_bf16_f32 v100, v100, v101
    v_cvt_pk_bf16_f32 v101, v102, v103
    v_mfma_f32_16x16x32_bf16 v[144:147], v[64:67], a[212:215], v[144:147]
    v_lshlrev_b32 v236, 16, v208
    v_and_b32 v237, 0xffff0000, v208
    s_waitcnt lgkmcnt(1)
    v_mfma_f32_16x16x32_bf16 v[120:123], v[68:71], a[168:171], v[120:123]
    ds_read_b64_tr_b16 v[44:45], v8 offset:49152
    ds_read_b64_tr_b16 v[46:47], v8 offset:53248
    v_mfma_f32_16x16x32_bf16 v[128:131], v[68:71], a[184:187], v[128:131]
    v_exp_f32 v105, v105
    v_mfma_f32_16x16x32_bf16 v[136:139], v[68:71], a[200:203], v[136:139]
    v_exp_f32 v106, v106
    v_mfma_f32_16x16x32_bf16 v[144:147], v[68:71], a[216:219], v[144:147]
    v_lshlrev_b32 v238, 16, v209
    v_and_b32 v239, 0xffff0000, v209
    s_waitcnt lgkmcnt(2)
    v_mfma_f32_16x16x32_bf16 v[120:123], v[72:75], a[172:175], v[120:123]
    ds_read_b64_tr_b16 v[48:49], v9 offset:49152
    ds_read_b64_tr_b16 v[50:51], v9 offset:53248
    v_mfma_f32_16x16x32_bf16 v[128:131], v[72:75], a[188:191], v[128:131]
    v_exp_f32 v107, v107
    v_mfma_f32_16x16x32_bf16 v[136:139], v[72:75], a[204:207], v[136:139]
    v_cvt_pk_bf16_f32 v102, v104, v105
    v_cvt_pk_bf16_f32 v103, v106, v107
    v_mfma_f32_16x16x32_bf16 v[144:147], v[72:75], a[220:223], v[144:147]
    s_waitcnt vmcnt(24)
    s_waitcnt lgkmcnt(2)
    v_mfma_f32_16x16x32_bf16 a[0:3], v[44:47], v[76:79], a[0:3]
    ds_read_b64_tr_b16 v[52:53], v10 offset:49152
    ds_read_b64_tr_b16 v[54:55], v10 offset:53248
    v_mfma_f32_16x16x32_bf16 a[32:35], v[44:47], v[84:87], a[32:35]
    v_mfma_f32_16x16x32_bf16 a[64:67], v[44:47], v[92:95], a[64:67]
    v_exp_f32 v116, v116
    v_pk_mul_f32 v[236:237], v[236:237], s[36:37]
    v_pk_mul_f32 v[238:239], v[238:239], s[36:37]
    v_cvt_pk_bf16_f32 v208, v236, v237
    v_cvt_pk_bf16_f32 v209, v238, v239
    v_exp_f32 v117, v117
    v_mfma_f32_16x16x32_bf16 a[96:99], v[44:47], v[100:103], a[96:99]
    v_exp_f32 v118, v118
    v_lshlrev_b32 v240, 16, v210
    v_and_b32 v241, 0xffff0000, v210
    s_waitcnt lgkmcnt(2)
    v_mfma_f32_16x16x32_bf16 a[4:7], v[48:51], v[76:79], a[4:7]
    ds_read_b64_tr_b16 v[56:57], v11 offset:49152
    ds_read_b64_tr_b16 v[58:59], v11 offset:53248
    v_mfma_f32_16x16x32_bf16 a[36:39], v[48:51], v[84:87], a[36:39]
    v_exp_f32 v119, v119
    v_exp_f32 v120, v120
    v_mfma_f32_16x16x32_bf16 a[68:71], v[48:51], v[92:95], a[68:71]
    v_cvt_pk_bf16_f32 v116, v116, v117
    v_cvt_pk_bf16_f32 v117, v118, v119
    v_lshlrev_b32 v242, 16, v211
    v_and_b32 v243, 0xffff0000, v211
    v_mfma_f32_16x16x32_bf16 a[100:103], v[48:51], v[100:103], a[100:103]
    v_exp_f32 v121, v121
    v_exp_f32 v122, v122
    s_waitcnt lgkmcnt(2)
    v_mfma_f32_16x16x32_bf16 a[8:11], v[52:55], v[76:79], a[8:11]
    ds_read_b64_tr_b16 v[60:61], v12 offset:49152
    ds_read_b64_tr_b16 v[62:63], v12 offset:53248
    v_mfma_f32_16x16x32_bf16 a[40:43], v[52:55], v[84:87], a[40:43]
    v_pk_mul_f32 v[240:241], v[240:241], s[36:37]
    v_pk_mul_f32 v[242:243], v[242:243], s[36:37]
    v_cvt_pk_bf16_f32 v210, v240, v241
    v_cvt_pk_bf16_f32 v211, v242, v243
    v_exp_f32 v123, v123
    v_mfma_f32_16x16x32_bf16 a[72:75], v[52:55], v[92:95], a[72:75]
    v_cvt_pk_bf16_f32 v118, v120, v121
    v_cvt_pk_bf16_f32 v119, v122, v123
    v_exp_f32 v124, v124
    v_lshlrev_b32 v236, 16, v212
    v_and_b32 v237, 0xffff0000, v212
    v_mfma_f32_16x16x32_bf16 a[104:107], v[52:55], v[100:103], a[104:107]
    v_exp_f32 v125, v125
    v_exp_f32 v126, v126
    s_waitcnt lgkmcnt(2)
    v_mfma_f32_16x16x32_bf16 a[12:15], v[56:59], v[76:79], a[12:15]
    ds_read_b64_tr_b16 v[64:65], v13 offset:49152
    ds_read_b64_tr_b16 v[66:67], v13 offset:53248
    v_mfma_f32_16x16x32_bf16 a[44:47], v[56:59], v[84:87], a[44:47]
    v_lshlrev_b32 v238, 16, v213
    v_and_b32 v239, 0xffff0000, v213
    v_exp_f32 v127, v127
    v_mfma_f32_16x16x32_bf16 a[76:79], v[56:59], v[92:95], a[76:79]
    v_exp_f32 v128, v128
    v_cvt_pk_bf16_f32 v124, v124, v125
    v_cvt_pk_bf16_f32 v125, v126, v127
    v_mfma_f32_16x16x32_bf16 a[108:111], v[56:59], v[100:103], a[108:111]
    v_pk_mul_f32 v[236:237], v[236:237], s[36:37]
    v_pk_mul_f32 v[238:239], v[238:239], s[36:37]
    v_cvt_pk_bf16_f32 v212, v236, v237
    v_cvt_pk_bf16_f32 v213, v238, v239
    v_exp_f32 v129, v129
    s_waitcnt lgkmcnt(2)
    v_mfma_f32_16x16x32_bf16 a[16:19], v[60:63], v[76:79], a[16:19]
    ds_read_b64_tr_b16 v[68:69], v14 offset:49152
    ds_read_b64_tr_b16 v[70:71], v14 offset:53248
    v_mfma_f32_16x16x32_bf16 a[48:51], v[60:63], v[84:87], a[48:51]
    v_exp_f32 v130, v130
    v_lshlrev_b32 v240, 16, v214
    v_and_b32 v241, 0xffff0000, v214
    v_mfma_f32_16x16x32_bf16 a[80:83], v[60:63], v[92:95], a[80:83]
    v_exp_f32 v131, v131
    v_cvt_pk_bf16_f32 v126, v128, v129
    v_cvt_pk_bf16_f32 v127, v130, v131
    v_mfma_f32_16x16x32_bf16 a[112:115], v[60:63], v[100:103], a[112:115]
    v_exp_f32 v132, v132
    v_lshlrev_b32 v242, 16, v215
    v_and_b32 v243, 0xffff0000, v215
    v_exp_f32 v133, v133
    s_waitcnt lgkmcnt(2)
    v_mfma_f32_16x16x32_bf16 a[20:23], v[64:67], v[76:79], a[20:23]
    ds_read_b64_tr_b16 v[72:73], v15 offset:49152
    ds_read_b64_tr_b16 v[74:75], v15 offset:53248
    v_mfma_f32_16x16x32_bf16 a[52:55], v[64:67], v[84:87], a[52:55]
    v_exp_f32 v134, v134
    v_pk_mul_f32 v[240:241], v[240:241], s[36:37]
    v_pk_mul_f32 v[242:243], v[242:243], s[36:37]
    v_cvt_pk_bf16_f32 v214, v240, v241
    v_cvt_pk_bf16_f32 v215, v242, v243
    v_mfma_f32_16x16x32_bf16 a[84:87], v[64:67], v[92:95], a[84:87]
    v_exp_f32 v135, v135
    v_exp_f32 v136, v136
    v_mfma_f32_16x16x32_bf16 a[116:119], v[64:67], v[100:103], a[116:119]
    v_cvt_pk_bf16_f32 v132, v132, v133
    v_cvt_pk_bf16_f32 v133, v134, v135
    v_lshlrev_b32 v236, 16, v216
    v_and_b32 v237, 0xffff0000, v216
    s_waitcnt lgkmcnt(2)
    v_mfma_f32_16x16x32_bf16 a[24:27], v[68:71], v[76:79], a[24:27]
    ds_read_b64_tr_b16 v[44:45], v8 offset:57344
    ds_read_b64_tr_b16 v[46:47], v8 offset:61440
    v_mfma_f32_16x16x32_bf16 a[56:59], v[68:71], v[84:87], a[56:59]
    v_exp_f32 v137, v137
    v_exp_f32 v138, v138
    v_mfma_f32_16x16x32_bf16 a[88:91], v[68:71], v[92:95], a[88:91]
    v_lshlrev_b32 v238, 16, v217
    v_and_b32 v239, 0xffff0000, v217
    v_exp_f32 v139, v139
    v_mfma_f32_16x16x32_bf16 a[120:123], v[68:71], v[100:103], a[120:123]
    v_cvt_pk_bf16_f32 v134, v136, v137
    v_cvt_pk_bf16_f32 v135, v138, v139
    v_exp_f32 v140, v140
    v_pk_mul_f32 v[236:237], v[236:237], s[36:37]
    v_pk_mul_f32 v[238:239], v[238:239], s[36:37]
    v_cvt_pk_bf16_f32 v216, v236, v237
    v_cvt_pk_bf16_f32 v217, v238, v239
    s_waitcnt lgkmcnt(2)
    v_mfma_f32_16x16x32_bf16 a[28:31], v[72:75], v[76:79], a[28:31]
    ds_read_b64_tr_b16 v[48:49], v9 offset:57344
    ds_read_b64_tr_b16 v[50:51], v9 offset:61440
    v_mfma_f32_16x16x32_bf16 a[60:63], v[72:75], v[84:87], a[60:63]
    v_exp_f32 v141, v141
    v_exp_f32 v142, v142
    v_mfma_f32_16x16x32_bf16 a[92:95], v[72:75], v[92:95], a[92:95]
    v_lshlrev_b32 v240, 16, v218
    v_and_b32 v241, 0xffff0000, v218
    v_exp_f32 v143, v143
    v_mfma_f32_16x16x32_bf16 a[124:127], v[72:75], v[100:103], a[124:127]
    v_exp_f32 v144, v144
    v_cvt_pk_bf16_f32 v140, v140, v141
    v_cvt_pk_bf16_f32 v141, v142, v143
    v_mfma_f32_16x16x32_bf16 a[240:243], v[248:251], v[76:79], a[240:243]
    v_lshlrev_b32 v242, 16, v219
    v_and_b32 v243, 0xffff0000, v219
    v_exp_f32 v145, v145
    v_mfma_f32_16x16x32_bf16 a[244:247], v[248:251], v[84:87], a[244:247]
    v_exp_f32 v146, v146
    v_pk_mul_f32 v[240:241], v[240:241], s[36:37]
    v_pk_mul_f32 v[242:243], v[242:243], s[36:37]
    v_cvt_pk_bf16_f32 v218, v240, v241
    v_cvt_pk_bf16_f32 v219, v242, v243
    v_mfma_f32_16x16x32_bf16 a[248:251], v[248:251], v[92:95], a[248:251]
    v_exp_f32 v147, v147
    v_cvt_pk_bf16_f32 v142, v144, v145
    v_cvt_pk_bf16_f32 v143, v146, v147
    v_mfma_f32_16x16x32_bf16 a[252:255], v[248:251], v[100:103], a[252:255]
    s_nop 1
    v_mfma_f32_16x16x32_bf16 a[240:243], v[248:251], v[116:119], a[240:243]
    v_mfma_f32_16x16x32_bf16 a[244:247], v[248:251], v[124:127], a[244:247]
    v_mfma_f32_16x16x32_bf16 a[248:251], v[248:251], v[132:135], a[248:251]
    v_mfma_f32_16x16x32_bf16 a[252:255], v[248:251], v[140:143], a[252:255]
    s_nop 7
    v_accvgpr_read_b32 v236, a240
    v_accvgpr_read_b32 v237, a244
    v_accvgpr_read_b32 v238, a248
    v_accvgpr_read_b32 v239, a252
    v_cmp_nge_f32 s[42:43], s40, v236
    v_cmp_nge_f32 s[48:49], s40, v237
    s_nop 1
    s_or_b64 s[42:43], s[42:43], s[48:49]
    v_cmp_nge_f32 s[48:49], s40, v238
    s_nop 1
    s_or_b64 s[42:43], s[42:43], s[48:49]
    v_cmp_nge_f32 s[48:49], s40, v239
    s_nop 1
    s_or_b64 s[42:43], s[42:43], s[48:49]
    s_nop 1
    s_cmp_lg_u64 s[42:43], 0
    s_cselect_b32 s38, 1, 0
    v_mov_b32 v246, s38
    ds_write_b32 v18, v246
    s_waitcnt lgkmcnt(0)
    s_barrier
    ds_read_b128 v[240:243], v19
    s_waitcnt lgkmcnt(0)
    v_or3_b32 v240, v240, v241, v242
    v_or_b32 v240, v240, v243
    s_nop 0
    v_readfirstlane_b32 s38, v240
    s_nop 1
    s_cmp_lg_u32 s38, 0
    s_cbranch_scc1 L_c4_fallback
    s_add_u32 m0, s34, 32768
    s_nop 0
    buffer_load_dwordx4 v1, s[16:19], s33 offen lds
    buffer_load_dwordx4 v2, s[16:19], s33 offen offset:1024 lds
    s_add_u32 m0, s34, 98304
    s_nop 0
    buffer_load_dwordx4 v1, s[20:23], s33 offen lds
    buffer_load_dwordx4 v2, s[20:23], s33 offen offset:1024 lds
    s_add_u32 s33, s33, 8192
    s_waitcnt lgkmcnt(2)
    v_mfma_f32_16x16x32_bf16 a[0:3], v[44:47], v[116:119], a[0:3]
    ds_read_b64_tr_b16 v[52:53], v10 offset:57344
    ds_read_b64_tr_b16 v[54:55], v10 offset:61440
    v_mfma_f32_16x16x32_bf16 a[32:35], v[44:47], v[124:127], a[32:35]
    v_mfma_f32_16x16x32_bf16 a[64:67], v[44:47], v[132:135], a[64:67]
    v_accvgpr_write_b32 a160, v156
    v_accvgpr_write_b32 a161, v157
    v_accvgpr_write_b32 a162, v158
    v_accvgpr_write_b32 a163, v159
    v_mfma_f32_16x16x32_bf16 a[96:99], v[44:47], v[140:143], a[96:99]
    v_accvgpr_write_b32 a164, v160
    v_accvgpr_write_b32 a165, v161
    s_waitcnt lgkmcnt(2)
    v_mfma_f32_16x16x32_bf16 a[4:7], v[48:51], v[116:119], a[4:7]
    ds_read_b64_tr_b16 v[56:57], v11 offset:57344
    ds_read_b64_tr_b16 v[58:59], v11 offset:61440
    v_mfma_f32_16x16x32_bf16 a[36:39], v[48:51], v[124:127], a[36:39]
    v_accvgpr_write_b32 a166, v162
    v_accvgpr_write_b32 a167, v163
    v_mfma_f32_16x16x32_bf16 a[68:71], v[48:51], v[132:135], a[68:71]
    v_accvgpr_write_b32 a168, v164
    v_accvgpr_write_b32 a169, v165
    v_accvgpr_write_b32 a170, v166
    v_accvgpr_write_b32 a171, v167
    v_mfma_f32_16x16x32_bf16 a[100:103], v[48:51], v[140:143], a[100:103]
    v_accvgpr_write_b32 a172, v168
    v_accvgpr_write_b32 a173, v169
    s_waitcnt lgkmcnt(2)
    v_mfma_f32_16x16x32_bf16 a[8:11], v[52:55], v[116:119], a[8:11]
    ds_read_b64_tr_b16 v[60:61], v12 offset:57344
    ds_read_b64_tr_b16 v[62:63], v12 offset:61440
    v_mfma_f32_16x16x32_bf16 a[40:43], v[52:55], v[124:127], a[40:43]
    v_accvgpr_write_b32 a174, v170
    v_accvgpr_write_b32 a175, v171
    v_mfma_f32_16x16x32_bf16 a[72:75], v[52:55], v[132:135], a[72:75]
    v_accvgpr_write_b32 a176, v172
    v_accvgpr_write_b32 a177, v173
    v_accvgpr_write_b32 a178, v174
    v_accvgpr_write_b32 a179, v175
    v_mfma_f32_16x16x32_bf16 a[104:107], v[52:55], v[140:143], a[104:107]
    v_accvgpr_write_b32 a180, v176
    v_accvgpr_write_b32 a181, v177
    s_waitcnt lgkmcnt(2)
    v_mfma_f32_16x16x32_bf16 a[12:15], v[56:59], v[116:119], a[12:15]
    ds_read_b64_tr_b16 v[64:65], v13 offset:57344
    ds_read_b64_tr_b16 v[66:67], v13 offset:61440
    v_mfma_f32_16x16x32_bf16 a[44:47], v[56:59], v[124:127], a[44:47]
    v_accvgpr_write_b32 a182, v178
    v_accvgpr_write_b32 a183, v179
    v_mfma_f32_16x16x32_bf16 a[76:79], v[56:59], v[132:135], a[76:79]
    v_accvgpr_write_b32 a184, v180
    v_accvgpr_write_b32 a185, v181
    v_accvgpr_write_b32 a186, v182
    v_accvgpr_write_b32 a187, v183
    v_mfma_f32_16x16x32_bf16 a[108:111], v[56:59], v[140:143], a[108:111]
    v_accvgpr_write_b32 a188, v184
    v_accvgpr_write_b32 a189, v185
    s_waitcnt lgkmcnt(2)
    v_mfma_f32_16x16x32_bf16 a[16:19], v[60:63], v[116:119], a[16:19]
    ds_read_b64_tr_b16 v[68:69], v14 offset:57344
    ds_read_b64_tr_b16 v[70:71], v14 offset:61440
    v_mfma_f32_16x16x32_bf16 a[48:51], v[60:63], v[124:127], a[48:51]
    v_accvgpr_write_b32 a190, v186
    v_accvgpr_write_b32 a191, v187
    v_mfma_f32_16x16x32_bf16 a[80:83], v[60:63], v[132:135], a[80:83]
    v_accvgpr_write_b32 a192, v188
    v_accvgpr_write_b32 a193, v189
    v_accvgpr_write_b32 a194, v190
    v_accvgpr_write_b32 a195, v191
    v_mfma_f32_16x16x32_bf16 a[112:115], v[60:63], v[140:143], a[112:115]
    v_accvgpr_write_b32 a196, v192
    v_accvgpr_write_b32 a197, v193
    s_waitcnt lgkmcnt(2)
    v_mfma_f32_16x16x32_bf16 a[20:23], v[64:67], v[116:119], a[20:23]
    ds_read_b64_tr_b16 v[72:73], v15 offset:57344
    ds_read_b64_tr_b16 v[74:75], v15 offset:61440
    v_mfma_f32_16x16x32_bf16 a[52:55], v[64:67], v[124:127], a[52:55]
    v_accvgpr_write_b32 a198, v194
    v_accvgpr_write_b32 a199, v195
    v_mfma_f32_16x16x32_bf16 a[84:87], v[64:67], v[132:135], a[84:87]
    v_accvgpr_write_b32 a200, v196
    v_accvgpr_write_b32 a201, v197
    v_accvgpr_write_b32 a202, v198
    v_accvgpr_write_b32 a203, v199
    v_mfma_f32_16x16x32_bf16 a[116:119], v[64:67], v[140:143], a[116:119]
    v_accvgpr_write_b32 a204, v200
    v_accvgpr_write_b32 a205, v201
    s_waitcnt lgkmcnt(2)
    v_mfma_f32_16x16x32_bf16 a[24:27], v[68:71], v[116:119], a[24:27]
    v_accvgpr_write_b32 a206, v202
    v_accvgpr_write_b32 a207, v203
    v_mfma_f32_16x16x32_bf16 a[56:59], v[68:71], v[124:127], a[56:59]
    v_accvgpr_write_b32 a208, v204
    v_accvgpr_write_b32 a209, v205
    v_accvgpr_write_b32 a210, v206
    v_accvgpr_write_b32 a211, v207
    v_mfma_f32_16x16x32_bf16 a[88:91], v[68:71], v[132:135], a[88:91]
    v_accvgpr_write_b32 a212, v208
    v_accvgpr_write_b32 a213, v209
    v_mfma_f32_16x16x32_bf16 a[120:123], v[68:71], v[140:143], a[120:123]
    v_accvgpr_write_b32 a214, v210
    v_accvgpr_write_b32 a215, v211
    s_waitcnt lgkmcnt(0)
    v_mfma_f32_16x16x32_bf16 a[28:31], v[72:75], v[116:119], a[28:31]
    v_accvgpr_write_b32 a216, v212
    v_accvgpr_write_b32 a217, v213
    v_accvgpr_write_b32 a218, v214
    v_accvgpr_write_b32 a219, v215
    v_mfma_f32_16x16x32_bf16 a[60:63], v[72:75], v[124:127], a[60:63]
    v_accvgpr_write_b32 a220, v216
    v_accvgpr_write_b32 a221, v217
    v_mfma_f32_16x16x32_bf16 a[92:95], v[72:75], v[132:135], a[92:95]
    v_accvgpr_write_b32 a222, v218
    v_accvgpr_write_b32 a223, v219
    v_mfma_f32_16x16x32_bf16 a[124:127], v[72:75], v[140:143], a[124:127]
    s_waitcnt vmcnt(8)
    s_barrier
    s_add_u32 m0, s34, 40960
    s_nop 0
    buffer_load_dwordx4 v1, s[16:19], s33 offen lds
    buffer_load_dwordx4 v2, s[16:19], s33 offen offset:1024 lds
    s_add_u32 m0, s34, 106496
    s_nop 0
    buffer_load_dwordx4 v1, s[20:23], s33 offen lds
    buffer_load_dwordx4 v2, s[20:23], s33 offen offset:1024 lds
    s_add_u32 s33, s33, 8192
L_c4_bnd:
    s_nop 7
    v_accvgpr_read_b32 v221, a240
    v_accvgpr_read_b32 v223, a244
    v_accvgpr_read_b32 v225, a248
    v_accvgpr_read_b32 v227, a252
    v_rcp_f32 v220, v221
    v_rcp_f32 v222, v223
    v_rcp_f32 v224, v225
    v_rcp_f32 v226, v227
    s_nop 0
    v_mov_b32 v221, v220
    v_mov_b32 v223, v222
    v_mov_b32 v225, v224
    v_mov_b32 v227, v226
    ds_read_b128 v[44:47], v4 offset:0
    ds_read_b128 v[48:51], v5 offset:0
    ds_read_b128 v[52:55], v6 offset:0
    s_waitcnt lgkmcnt(2)
    v_mfma_f32_16x16x32_bf16 v[76:79], v[44:47], a[160:163], 0
    ds_read_b128 v[56:59], v7 offset:0
    s_nop 0
    s_add_u32 s38, s32, 0
    v_accvgpr_read_b32 v156, a0
    v_accvgpr_read_b32 v157, a1
    v_accvgpr_read_b32 v158, a2
    v_accvgpr_read_b32 v159, a3
    v_mfma_f32_16x16x32_bf16 v[84:87], v[44:47], a[176:179], 0
    v_accvgpr_read_b32 v160, a4
    v_accvgpr_read_b32 v161, a5
    v_accvgpr_read_b32 v162, a6
    v_accvgpr_read_b32 v163, a7
    v_pk_mul_f32 v[156:157], v[156:157], v[220:221]
    v_pk_mul_f32 v[158:159], v[158:159], v[220:221]
    s_nop 1
    v_mfma_f32_16x16x32_bf16 v[92:95], v[44:47], a[192:195], 0
    v_pk_mul_f32 v[160:161], v[160:161], v[220:221]
    v_pk_mul_f32 v[162:163], v[162:163], v[220:221]
    v_cvt_pk_bf16_f32 v156, v156, v157
    v_cvt_pk_bf16_f32 v157, v158, v159
    v_cvt_pk_bf16_f32 v158, v160, v161
    v_cvt_pk_bf16_f32 v159, v162, v163
    v_mfma_f32_16x16x32_bf16 v[100:103], v[44:47], a[208:211], 0
    s_nop 1
    v_permlane16_swap_b32 v156, v158
    v_permlane16_swap_b32 v157, v159
    buffer_store_dwordx4 v[156:159], v17, s[24:27], s38 offen offset:0
    v_accvgpr_read_b32 v164, a8
    v_accvgpr_read_b32 v165, a9
    s_waitcnt lgkmcnt(2)
    s_nop 0
    v_mfma_f32_16x16x32_bf16 v[76:79], v[48:51], a[164:167], v[76:79]
    ds_read_b128 v[60:63], v4 offset:4096
    v_accvgpr_read_b32 v166, a10
    v_accvgpr_read_b32 v167, a11
    v_accvgpr_read_b32 v168, a12
    v_accvgpr_read_b32 v169, a13
    v_accvgpr_read_b32 v170, a14
    v_accvgpr_read_b32 v171, a15
    v_mfma_f32_16x16x32_bf16 v[84:87], v[48:51], a[180:183], v[84:87]
    v_pk_mul_f32 v[164:165], v[164:165], v[220:221]
    v_pk_mul_f32 v[166:167], v[166:167], v[220:221]
    v_pk_mul_f32 v[168:169], v[168:169], v[220:221]
    v_pk_mul_f32 v[170:171], v[170:171], v[220:221]
    v_cvt_pk_bf16_f32 v164, v164, v165
    v_cvt_pk_bf16_f32 v165, v166, v167
    v_mfma_f32_16x16x32_bf16 v[92:95], v[48:51], a[196:199], v[92:95]
    v_cvt_pk_bf16_f32 v166, v168, v169
    v_cvt_pk_bf16_f32 v167, v170, v171
    s_nop 1
    v_permlane16_swap_b32 v164, v166
    v_permlane16_swap_b32 v165, v167
    buffer_store_dwordx4 v[164:167], v17, s[24:27], s38 offen offset:64
    v_mfma_f32_16x16x32_bf16 v[100:103], v[48:51], a[212:215], v[100:103]
    v_accvgpr_read_b32 v172, a16
    v_accvgpr_read_b32 v173, a17
    v_accvgpr_read_b32 v174, a18
    v_accvgpr_read_b32 v175, a19
    v_accvgpr_read_b32 v176, a20
    v_accvgpr_read_b32 v177, a21
    s_waitcnt lgkmcnt(2)
    v_mfma_f32_16x16x32_bf16 v[76:79], v[52:55], a[168:171], v[76:79]
    ds_read_b128 v[64:67], v5 offset:4096
    v_accvgpr_read_b32 v178, a22
    v_accvgpr_read_b32 v179, a23
    v_pk_mul_f32 v[172:173], v[172:173], v[220:221]
    v_pk_mul_f32 v[174:175], v[174:175], v[220:221]
    v_pk_mul_f32 v[176:177], v[176:177], v[220:221]
    v_pk_mul_f32 v[178:179], v[178:179], v[220:221]
    s_nop 1
    v_mfma_f32_16x16x32_bf16 v[84:87], v[52:55], a[184:187], v[84:87]
    v_cvt_pk_bf16_f32 v172, v172, v173
    v_cvt_pk_bf16_f32 v173, v174, v175
    v_cvt_pk_bf16_f32 v174, v176, v177
    v_cvt_pk_bf16_f32 v175, v178, v179
    s_nop 1
    v_permlane16_swap_b32 v172, v174
    v_mfma_f32_16x16x32_bf16 v[92:95], v[52:55], a[200:203], v[92:95]
    v_permlane16_swap_b32 v173, v175
    buffer_store_dwordx4 v[172:175], v17, s[24:27], s38 offen offset:128
    v_accvgpr_read_b32 v180, a24
    v_accvgpr_read_b32 v181, a25
    v_accvgpr_read_b32 v182, a26
    v_accvgpr_read_b32 v183, a27
    v_accvgpr_read_b32 v184, a28
    v_mfma_f32_16x16x32_bf16 v[100:103], v[52:55], a[216:219], v[100:103]
    v_accvgpr_read_b32 v185, a29
    v_accvgpr_read_b32 v186, a30
    v_accvgpr_read_b32 v187, a31
    v_pk_mul_f32 v[180:181], v[180:181], v[220:221]
    v_pk_mul_f32 v[182:183], v[182:183], v[220:221]
    v_pk_mul_f32 v[184:185], v[184:185], v[220:221]
    s_waitcnt lgkmcnt(2)
    s_nop 0
    v_mfma_f32_16x16x32_bf16 v[76:79], v[56:59], a[172:175], v[76:79]
    ds_read_b128 v[68:71], v6 offset:4096
    v_pk_mul_f32 v[186:187], v[186:187], v[220:221]
    v_cvt_pk_bf16_f32 v180, v180, v181
    v_cvt_pk_bf16_f32 v181, v182, v183
    v_cvt_pk_bf16_f32 v182, v184, v185
    v_cvt_pk_bf16_f32 v183, v186, v187
    s_nop 1
    v_mfma_f32_16x16x32_bf16 v[84:87], v[56:59], a[188:191], v[84:87]
    v_permlane16_swap_b32 v180, v182
    v_permlane16_swap_b32 v181, v183
    buffer_store_dwordx4 v[180:183], v17, s[24:27], s38 offen offset:192
    s_add_u32 s38, s32, 4096
    v_accvgpr_read_b32 v188, a32
    v_accvgpr_read_b32 v189, a33
    v_mfma_f32_16x16x32_bf16 v[92:95], v[56:59], a[204:207], v[92:95]
    v_accvgpr_read_b32 v190, a34
    v_accvgpr_read_b32 v191, a35
    v_accvgpr_read_b32 v192, a36
    v_accvgpr_read_b32 v193, a37
    v_accvgpr_read_b32 v194, a38
    v_accvgpr_read_b32 v195, a39
    v_mfma_f32_16x16x32_bf16 v[100:103], v[56:59], a[220:223], v[100:103]
    v_pk_mul_f32 v[188:189], v[188:189], v[222:223]
    v_pk_mul_f32 v[190:191], v[190:191], v[222:223]
    v_pk_mul_f32 v[192:193], v[192:193], v[222:223]
    v_pk_mul_f32 v[194:195], v[194:195], v[222:223]
    v_cvt_pk_bf16_f32 v188, v188, v189
    v_cvt_pk_bf16_f32 v189, v190, v191
    s_waitcnt lgkmcnt(2)
    v_mfma_f32_16x16x32_bf16 v[80:83], v[60:63], a[160:163], 0
    ds_read_b128 v[72:75], v7 offset:4096
    v_cvt_pk_bf16_f32 v190, v192, v193
    v_cvt_pk_bf16_f32 v191, v194, v195
    s_nop 1
    v_permlane16_swap_b32 v188, v190
    v_permlane16_swap_b32 v189, v191
    buffer_store_dwordx4 v[188:191], v17, s[24:27], s38 offen offset:0
    v_mfma_f32_16x16x32_bf16 v[88:91], v[60:63], a[176:179], 0
    v_accvgpr_read_b32 v196, a40
    v_accvgpr_read_b32 v197, a41
    v_accvgpr_read_b32 v198, a42
    v_accvgpr_read_b32 v199, a43
    v_accvgpr_read_b32 v200, a44
    v_accvgpr_read_b32 v201, a45
    v_mfma_f32_16x16x32_bf16 v[96:99], v[60:63], a[192:195], 0
    v_accvgpr_read_b32 v202, a46
    v_accvgpr_read_b32 v203, a47
    v_pk_mul_f32 v[196:197], v[196:197], v[222:223]
    v_pk_mul_f32 v[198:199], v[198:199], v[222:223]
    v_pk_mul_f32 v[200:201], v[200:201], v[222:223]
    v_pk_mul_f32 v[202:203], v[202:203], v[222:223]
    s_nop 1
    v_mfma_f32_16x16x32_bf16 v[104:107], v[60:63], a[208:211], 0
    v_cvt_pk_bf16_f32 v196, v196, v197
    v_cvt_pk_bf16_f32 v197, v198, v199
    v_cvt_pk_bf16_f32 v198, v200, v201
    v_cvt_pk_bf16_f32 v199, v202, v203
    s_nop 1
    v_permlane16_swap_b32 v196, v198
    s_waitcnt lgkmcnt(2)
    v_mfma_f32_16x16x32_bf16 v[80:83], v[64:67], a[164:167], v[80:83]
    v_permlane16_swap_b32 v197, v199
    buffer_store_dwordx4 v[196:199], v17, s[24:27], s38 offen offset:64
    v_accvgpr_read_b32 v204, a48
    v_accvgpr_read_b32 v205, a49
    v_accvgpr_read_b32 v206, a50
    v_accvgpr_read_b32 v207, a51
    v_mfma_f32_16x16x32_bf16 v[88:91], v[64:67], a[180:183], v[88:91]
    v_accvgpr_read_b32 v208, a52
    v_accvgpr_read_b32 v209, a53
    v_accvgpr_read_b32 v210, a54
    v_accvgpr_read_b32 v211, a55
    v_pk_mul_f32 v[204:205], v[204:205], v[222:223]
    v_pk_mul_f32 v[206:207], v[206:207], v[222:223]
    v_pk_mul_f32 v[208:209], v[208:209], v[222:223]
    s_nop 1
    v_mfma_f32_16x16x32_bf16 v[96:99], v[64:67], a[196:199], v[96:99]
    v_pk_mul_f32 v[210:211], v[210:211], v[222:223]
    v_cvt_pk_bf16_f32 v204, v204, v205
    v_cvt_pk_bf16_f32 v205, v206, v207
    v_cvt_pk_bf16_f32 v206, v208, v209
    v_cvt_pk_bf16_f32 v207, v210, v211
    s_nop 1
    v_mfma_f32_16x16x32_bf16 v[104:107], v[64:67], a[212:215], v[104:107]
    v_permlane16_swap_b32 v204, v206
    v_permlane16_swap_b32 v205, v207
    buffer_store_dwordx4 v[204:207], v17, s[24:27], s38 offen offset:128
    v_accvgpr_read_b32 v212, a56
    v_accvgpr_read_b32 v213, a57
    v_accvgpr_read_b32 v214, a58
    s_waitcnt lgkmcnt(1)
    v_mfma_f32_16x16x32_bf16 v[80:83], v[68:71], a[168:171], v[80:83]
    v_accvgpr_read_b32 v215, a59
    v_accvgpr_read_b32 v216, a60
    v_accvgpr_read_b32 v217, a61
    v_accvgpr_read_b32 v218, a62
    v_accvgpr_read_b32 v219, a63
    v_pk_mul_f32 v[212:213], v[212:213], v[222:223]
    s_nop 1
    v_mfma_f32_16x16x32_bf16 v[88:91], v[68:71], a[184:187], v[88:91]
    v_pk_mul_f32 v[214:215], v[214:215], v[222:223]
    v_pk_mul_f32 v[216:217], v[216:217], v[222:223]
    v_pk_mul_f32 v[218:219], v[218:219], v[222:223]
    v_cvt_pk_bf16_f32 v212, v212, v213
    v_cvt_pk_bf16_f32 v213, v214, v215
    v_cvt_pk_bf16_f32 v214, v216, v217
    v_mfma_f32_16x16x32_bf16 v[96:99], v[68:71], a[200:203], v[96:99]
    v_cvt_pk_bf16_f32 v215, v218, v219
    s_nop 1
    v_permlane16_swap_b32 v212, v214
    v_permlane16_swap_b32 v213, v215
    buffer_store_dwordx4 v[212:215], v17, s[24:27], s38 offen offset:192
    s_add_u32 s38, s32, 8192
    v_mfma_f32_16x16x32_bf16 v[104:107], v[68:71], a[216:219], v[104:107]
    v_accvgpr_read_b32 v156, a64
    v_accvgpr_read_b32 v157, a65
    v_accvgpr_read_b32 v158, a66
    v_accvgpr_read_b32 v159, a67
    v_accvgpr_read_b32 v160, a68
    v_accvgpr_read_b32 v161, a69
    s_waitcnt lgkmcnt(0)
    v_mfma_f32_16x16x32_bf16 v[80:83], v[72:75], a[172:175], v[80:83]
    v_accvgpr_read_b32 v162, a70
    v_accvgpr_read_b32 v163, a71
    v_pk_mul_f32 v[156:157], v[156:157], v[224:225]
    v_pk_mul_f32 v[158:159], v[158:159], v[224:225]
    v_pk_mul_f32 v[160:161], v[160:161], v[224:225]
    v_pk_mul_f32 v[162:163], v[162:163], v[224:225]
    s_nop 1
    v_mfma_f32_16x16x32_bf16 v[88:91], v[72:75], a[188:191], v[88:91]
    v_cvt_pk_bf16_f32 v156, v156, v157
    v_cvt_pk_bf16_f32 v157, v158, v159
    v_cvt_pk_bf16_f32 v158, v160, v161
    v_cvt_pk_bf16_f32 v159, v162, v163
    s_nop 1
    v_permlane16_swap_b32 v156, v158
    v_mfma_f32_16x16x32_bf16 v[96:99], v[72:75], a[204:207], v[96:99]
    v_permlane16_swap_b32 v157, v159
    buffer_store_dwordx4 v[156:159], v17, s[24:27], s38 offen offset:0
    v_accvgpr_read_b32 v164, a72
    v_accvgpr_read_b32 v165, a73
    v_accvgpr_read_b32 v166, a74
    v_accvgpr_read_b32 v167, a75
    v_mfma_f32_16x16x32_bf16 v[104:107], v[72:75], a[220:223], v[104:107]
    v_accvgpr_read_b32 v168, a76
    v_accvgpr_read_b32 v169, a77
    v_accvgpr_read_b32 v170, a78
    v_accvgpr_read_b32 v171, a79
    v_pk_mul_f32 v[164:165], v[164:165], v[224:225]
    v_pk_mul_f32 v[166:167], v[166:167], v[224:225]
    v_pk_mul_f32 v[168:169], v[168:169], v[224:225]
    s_nop 7
    v_max3_f32 v236, v76, v77, v78
    v_max3_f32 v237, v79, v80, v81
    v_max3_f32 v236, v236, v82, v83
    v_max_f32 v236, v236, v237
    v_max3_f32 v238, v84, v85, v86
    v_max3_f32 v239, v87, v88, v89
    v_max3_f32 v238, v238, v90, v91
    v_max_f32 v238, v238, v239
    v_max3_f32 v240, v92, v93, v94
    v_max3_f32 v241, v95, v96, v97
    v_max3_f32 v240, v240, v98, v99
    v_max_f32 v240, v240, v241
    v_max3_f32 v242, v100, v101, v102
    v_max3_f32 v243, v103, v104, v105
    v_max3_f32 v242, v242, v106, v107
    v_max_f32 v242, v242, v243
    v_mov_b32 v237, v236
    v_mov_b32 v239, v238
    v_mov_b32 v241, v240
    v_mov_b32 v243, v242
    s_nop 1
    v_permlane16_swap_b32 v236, v237
    v_permlane16_swap_b32 v238, v239
    v_permlane16_swap_b32 v240, v241
    v_permlane16_swap_b32 v242, v243
    v_max_f32 v236, v236, v237
    v_mov_b32 v237, v236
    v_max_f32 v238, v238, v239
    v_mov_b32 v239, v238
    v_max_f32 v240, v240, v241
    v_mov_b32 v241, v240
    v_max_f32 v242, v242, v243
    v_mov_b32 v243, v242
    s_nop 1
    v_permlane32_swap_b32 v236, v237
    v_permlane32_swap_b32 v238, v239
    v_permlane32_swap_b32 v240, v241
    v_permlane32_swap_b32 v242, v243
    v_max_f32 v236, v236, v237
    v_max_f32 v238, v238, v239
    v_max_f32 v240, v240, v241
    v_max_f32 v242, v242, v243
    v_sub_f32 v24, 0, v236
    v_sub_f32 v25, 0, v236
    v_sub_f32 v26, 0, v236
    v_sub_f32 v27, 0, v236
    v_sub_f32 v28, 0, v238
    v_sub_f32 v29, 0, v238
    v_sub_f32 v30, 0, v238
    v_sub_f32 v31, 0, v238
    v_sub_f32 v32, 0, v240
    v_sub_f32 v33, 0, v240
    v_sub_f32 v34, 0, v240
    v_sub_f32 v35, 0, v240
    v_sub_f32 v36, 0, v242
    v_sub_f32 v37, 0, v242
    v_sub_f32 v38, 0, v242
    v_sub_f32 v39, 0, v242
    s_nop 1
    ds_read_b128 v[44:47], v4 offset:8192
    ds_read_b128 v[48:51], v5 offset:8192
    ds_read_b128 v[52:55], v6 offset:8192
    s_waitcnt lgkmcnt(2)
    v_mfma_f32_16x16x32_bf16 v[116:119], v[44:47], a[160:163], v[24:27]
    ds_read_b128 v[56:59], v7 offset:8192
    v_pk_mul_f32 v[170:171], v[170:171], v[224:225]
    v_cvt_pk_bf16_f32 v164, v164, v165
    v_cvt_pk_bf16_f32 v165, v166, v167
    v_cvt_pk_bf16_f32 v166, v168, v169
    v_cvt_pk_bf16_f32 v167, v170, v171
    s_nop 1
    v_mfma_f32_16x16x32_bf16 v[124:127], v[44:47], a[176:179], v[28:31]
    v_permlane16_swap_b32 v164, v166
    v_permlane16_swap_b32 v165, v167
    buffer_store_dwordx4 v[164:167], v17, s[24:27], s38 offen offset:64
    v_accvgpr_read_b32 v172, a80
    v_accvgpr_read_b32 v173, a81
    v_accvgpr_read_b32 v174, a82
    v_accvgpr_read_b32 v175, a83
    v_mfma_f32_16x16x32_bf16 v[132:135], v[44:47], a[192:195], v[32:35]
    v_accvgpr_read_b32 v176, a84
    v_accvgpr_read_b32 v177, a85
    v_accvgpr_read_b32 v178, a86
    v_accvgpr_read_b32 v179, a87
    v_pk_mul_f32 v[172:173], v[172:173], v[224:225]
    v_pk_mul_f32 v[174:175], v[174:175], v[224:225]
    v_pk_mul_f32 v[176:177], v[176:177], v[224:225]
    s_nop 1
    v_mfma_f32_16x16x32_bf16 v[140:143], v[44:47], a[208:211], v[36:39]
    v_pk_mul_f32 v[178:179], v[178:179], v[224:225]
    v_cvt_pk_bf16_f32 v172, v172, v173
    v_cvt_pk_bf16_f32 v173, v174, v175
    v_cvt_pk_bf16_f32 v174, v176, v177
    v_cvt_pk_bf16_f32 v175, v178, v179
    s_nop 1
    v_permlane16_swap_b32 v172, v174
    s_waitcnt lgkmcnt(2)
    v_mfma_f32_16x16x32_bf16 v[116:119], v[48:51], a[164:167], v[116:119]
    ds_read_b128 v[60:63], v4 offset:12288
    v_permlane16_swap_b32 v173, v175
    buffer_store_dwordx4 v[172:175], v17, s[24:27], s38 offen offset:128
    v_accvgpr_read_b32 v180, a88
    v_accvgpr_read_b32 v181, a89
    v_accvgpr_read_b32 v182, a90
    v_accvgpr_read_b32 v183, a91
    v_accvgpr_read_b32 v184, a92
    s_nop 0
    v_mfma_f32_16x16x32_bf16 v[124:127], v[48:51], a[180:183], v[124:127]
    v_accvgpr_read_b32 v185, a93
    v_accvgpr_read_b32 v186, a94
    v_accvgpr_read_b32 v187, a95
    v_pk_mul_f32 v[180:181], v[180:181], v[224:225]
    v_pk_mul_f32 v[182:183], v[182:183], v[224:225]
    v_pk_mul_f32 v[184:185], v[184:185], v[224:225]
    v_pk_mul_f32 v[186:187], v[186:187], v[224:225]
    s_nop 1
    v_mfma_f32_16x16x32_bf16 v[132:135], v[48:51], a[196:199], v[132:135]
    v_cvt_pk_bf16_f32 v180, v180, v181
    v_cvt_pk_bf16_f32 v181, v182, v183
    v_cvt_pk_bf16_f32 v182, v184, v185
    v_cvt_pk_bf16_f32 v183, v186, v187
    s_nop 1
    v_permlane16_swap_b32 v180, v182
    v_mfma_f32_16x16x32_bf16 v[140:143], v[48:51], a[212:215], v[140:143]
    v_permlane16_swap_b32 v181, v183
    buffer_store_dwordx4 v[180:183], v17, s[24:27], s38 offen offset:192
    s_add_u32 s38, s32, 12288
    v_accvgpr_read_b32 v188, a96
    v_accvgpr_read_b32 v189, a97
    v_accvgpr_read_b32 v190, a98
    v_accvgpr_read_b32 v191, a99
    s_waitcnt lgkmcnt(2)
    v_mfma_f32_16x16x32_bf16 v[116:119], v[52:55], a[168:171], v[116:119]
    ds_read_b128 v[64:67], v5 offset:12288
    v_accvgpr_read_b32 v192, a100
    v_accvgpr_read_b32 v193, a101
    v_accvgpr_read_b32 v194, a102
    v_accvgpr_read_b32 v195, a103
    v_pk_mul_f32 v[188:189], v[188:189], v[226:227]
    v_pk_mul_f32 v[190:191], v[190:191], v[226:227]
    v_pk_mul_f32 v[192:193], v[192:193], v[226:227]
    s_nop 1
    v_mfma_f32_16x16x32_bf16 v[124:127], v[52:55], a[184:187], v[124:127]
    v_pk_mul_f32 v[194:195], v[194:195], v[226:227]
    v_cvt_pk_bf16_f32 v188, v188, v189
    v_cvt_pk_bf16_f32 v189, v190, v191
    v_cvt_pk_bf16_f32 v190, v192, v193
    v_cvt_pk_bf16_f32 v191, v194, v195
    s_nop 1
    v_permlane16_swap_b32 v188, v190
    v_mfma_f32_16x16x32_bf16 v[132:135], v[52:55], a[200:203], v[132:135]
    v_permlane16_swap_b32 v189, v191
    buffer_store_dwordx4 v[188:191], v17, s[24:27], s38 offen offset:0
    v_accvgpr_read_b32 v196, a104
    v_accvgpr_read_b32 v197, a105
    v_accvgpr_read_b32 v198, a106
    v_accvgpr_read_b32 v199, a107
    v_accvgpr_read_b32 v200, a108
    v_mfma_f32_16x16x32_bf16 v[140:143], v[52:55], a[216:219], v[140:143]
    v_accvgpr_read_b32 v201, a109
    v_accvgpr_read_b32 v202, a110
    v_accvgpr_read_b32 v203, a111
    v_pk_mul_f32 v[196:197], v[196:197], v[226:227]
    v_pk_mul_f32 v[198:199], v[198:199], v[226:227]
    v_pk_mul_f32 v[200:201], v[200:201], v[226:227]
    v_pk_mul_f32 v[202:203], v[202:203], v[226:227]
    s_waitcnt lgkmcnt(2)
    s_nop 0
    v_mfma_f32_16x16x32_bf16 v[116:119], v[56:59], a[172:175], v[116:119]
    ds_read_b128 v[68:71], v6 offset:12288
    v_cvt_pk_bf16_f32 v196, v196, v197
    v_cvt_pk_bf16_f32 v197, v198, v199
    v_cvt_pk_bf16_f32 v198, v200, v201
    v_cvt_pk_bf16_f32 v199, v202, v203
    s_nop 1
    v_permlane16_swap_b32 v196, v198
    v_mfma_f32_16x16x32_bf16 v[124:127], v[56:59], a[188:191], v[124:127]
    v_permlane16_swap_b32 v197, v199
    buffer_store_dwordx4 v[196:199], v17, s[24:27], s38 offen offset:64
    v_accvgpr_read_b32 v204, a112
    v_accvgpr_read_b32 v205, a113
    v_accvgpr_read_b32 v206, a114
    v_accvgpr_read_b32 v207, a115
    v_accvgpr_read_b32 v208, a116
    s_nop 0
    v_mfma_f32_16x16x32_bf16 v[132:135], v[56:59], a[204:207], v[132:135]
    v_accvgpr_read_b32 v209, a117
    v_accvgpr_read_b32 v210, a118
    v_accvgpr_read_b32 v211, a119
    v_pk_mul_f32 v[204:205], v[204:205], v[226:227]
    v_pk_mul_f32 v[206:207], v[206:207], v[226:227]
    v_pk_mul_f32 v[208:209], v[208:209], v[226:227]
    v_pk_mul_f32 v[210:211], v[210:211], v[226:227]
    s_nop 1
    v_mfma_f32_16x16x32_bf16 v[140:143], v[56:59], a[220:223], v[140:143]
    v_cvt_pk_bf16_f32 v204, v204, v205
    v_cvt_pk_bf16_f32 v205, v206, v207
    v_cvt_pk_bf16_f32 v206, v208, v209
    v_cvt_pk_bf16_f32 v207, v210, v211
    s_nop 1
    v_permlane16_swap_b32 v204, v206
    v_permlane16_swap_b32 v205, v207
    s_waitcnt lgkmcnt(2)
    v_mfma_f32_16x16x32_bf16 v[120:123], v[60:63], a[160:163], v[24:27]
    ds_read_b128 v[72:75], v7 offset:12288
    buffer_store_dwordx4 v[204:207], v17, s[24:27], s38 offen offset:128
    v_accvgpr_read_b32 v212, a120
    v_accvgpr_read_b32 v213, a121
    v_accvgpr_read_b32 v214, a122
    v_accvgpr_read_b32 v215, a123
    v_accvgpr_read_b32 v216, a124
    v_accvgpr_read_b32 v217, a125
    v_mfma_f32_16x16x32_bf16 v[128:131], v[60:63], a[176:179], v[28:31]
    v_accvgpr_read_b32 v218, a126
    v_accvgpr_read_b32 v219, a127
    v_pk_mul_f32 v[212:213], v[212:213], v[226:227]
    v_pk_mul_f32 v[214:215], v[214:215], v[226:227]
    v_pk_mul_f32 v[216:217], v[216:217], v[226:227]
    v_pk_mul_f32 v[218:219], v[218:219], v[226:227]
    v_cvt_pk_bf16_f32 v212, v212, v213
    s_nop 0
    v_mfma_f32_16x16x32_bf16 v[136:139], v[60:63], a[192:195], v[32:35]
    v_cvt_pk_bf16_f32 v213, v214, v215
    v_cvt_pk_bf16_f32 v214, v216, v217
    v_cvt_pk_bf16_f32 v215, v218, v219
    s_nop 1
    v_permlane16_swap_b32 v212, v214
    v_permlane16_swap_b32 v213, v215
    buffer_store_dwordx4 v[212:215], v17, s[24:27], s38 offen offset:192
    v_mfma_f32_16x16x32_bf16 v[144:147], v[60:63], a[208:211], v[36:39]
    v_mfma_f32_32x32x16_bf16 a[0:15], v[252:255], v[252:255], 0
    v_mfma_f32_32x32x16_bf16 a[16:31], v[252:255], v[252:255], 0
    v_mfma_f32_32x32x16_bf16 a[32:47], v[252:255], v[252:255], 0
    v_mfma_f32_32x32x16_bf16 a[48:63], v[252:255], v[252:255], 0
    v_mfma_f32_32x32x16_bf16 a[64:79], v[252:255], v[252:255], 0
    v_mfma_f32_32x32x16_bf16 a[80:95], v[252:255], v[252:255], 0
    s_waitcnt lgkmcnt(2)
    v_mfma_f32_16x16x32_bf16 v[120:123], v[64:67], a[164:167], v[120:123]
    v_mfma_f32_32x32x16_bf16 a[96:111], v[252:255], v[252:255], 0
    v_mfma_f32_32x32x16_bf16 a[112:127], v[252:255], v[252:255], 0
    v_mfma_f32_32x32x16_bf16 a[240:255], v[252:255], v[252:255], 0
    v_sub_f32 v76, v76, v236
    v_sub_f32 v77, v77, v236
    v_sub_f32 v78, v78, v236
    v_sub_f32 v79, v79, v236
    v_mfma_f32_16x16x32_bf16 v[128:131], v[64:67], a[180:183], v[128:131]
    v_sub_f32 v80, v80, v236
    v_sub_f32 v81, v81, v236
    v_sub_f32 v82, v82, v236
    v_sub_f32 v83, v83, v236
    v_sub_f32 v84, v84, v238
    v_sub_f32 v85, v85, v238
    v_sub_f32 v86, v86, v238
    v_mfma_f32_16x16x32_bf16 v[136:139], v[64:67], a[196:199], v[136:139]
    v_sub_f32 v87, v87, v238
    v_sub_f32 v88, v88, v238
    v_sub_f32 v89, v89, v238
    v_sub_f32 v90, v90, v238
    v_sub_f32 v91, v91, v238
    v_sub_f32 v92, v92, v240
    v_sub_f32 v93, v93, v240
    v_mfma_f32_16x16x32_bf16 v[144:147], v[64:67], a[212:215], v[144:147]
    v_sub_f32 v94, v94, v240
    v_sub_f32 v95, v95, v240
    v_sub_f32 v96, v96, v240
    v_sub_f32 v97, v97, v240
    v_sub_f32 v98, v98, v240
    v_sub_f32 v99, v99, v240
    v_sub_f32 v100, v100, v242
    s_waitcnt lgkmcnt(1)
    v_mfma_f32_16x16x32_bf16 v[120:123], v[68:71], a[168:171], v[120:123]
    v_sub_f32 v101, v101, v242
    v_sub_f32 v102, v102, v242
    v_sub_f32 v103, v103, v242
    v_sub_f32 v104, v104, v242
    v_sub_f32 v105, v105, v242
    v_sub_f32 v106, v106, v242
    v_sub_f32 v107, v107, v242
    v_mfma_f32_16x16x32_bf16 v[128:131], v[68:71], a[184:187], v[128:131]
    v_exp_f32 v76, v76
    v_exp_f32 v77, v77
    v_exp_f32 v78, v78
    v_exp_f32 v79, v79
    v_exp_f32 v80, v80
    v_cvt_pk_bf16_f32 v76, v76, v77
    v_mfma_f32_16x16x32_bf16 v[136:139], v[68:71], a[200:203], v[136:139]
    v_cvt_pk_bf16_f32 v77, v78, v79
    v_exp_f32 v81, v81
    v_exp_f32 v82, v82
    v_exp_f32 v83, v83
    v_cvt_pk_bf16_f32 v78, v80, v81
    v_cvt_pk_bf16_f32 v79, v82, v83
    v_exp_f32 v84, v84
    v_mfma_f32_16x16x32_bf16 v[144:147], v[68:71], a[216:219], v[144:147]
    v_exp_f32 v85, v85
    v_exp_f32 v86, v86
    v_exp_f32 v87, v87
    v_exp_f32 v88, v88
    v_cvt_pk_bf16_f32 v84, v84, v85
    v_cvt_pk_bf16_f32 v85, v86, v87
    v_exp_f32 v89, v89
    s_waitcnt lgkmcnt(0)
    v_mfma_f32_16x16x32_bf16 v[120:123], v[72:75], a[172:175], v[120:123]
    v_exp_f32 v90, v90
    v_exp_f32 v91, v91
    v_cvt_pk_bf16_f32 v86, v88, v89
    v_cvt_pk_bf16_f32 v87, v90, v91
    v_exp_f32 v92, v92
    v_exp_f32 v93, v93
    v_exp_f32 v94, v94
    v_mfma_f32_16x16x32_bf16 v[128:131], v[72:75], a[188:191], v[128:131]
    v_exp_f32 v95, v95
    v_exp_f32 v96, v96
    v_cvt_pk_bf16_f32 v92, v92, v93
    v_cvt_pk_bf16_f32 v93, v94, v95
    v_exp_f32 v97, v97
    v_exp_f32 v98, v98
    v_exp_f32 v99, v99
    v_mfma_f32_16x16x32_bf16 v[136:139], v[72:75], a[204:207], v[136:139]
    v_cvt_pk_bf16_f32 v94, v96, v97
    v_cvt_pk_bf16_f32 v95, v98, v99
    v_exp_f32 v100, v100
    v_exp_f32 v101, v101
    v_exp_f32 v102, v102
    v_exp_f32 v103, v103
    v_exp_f32 v104, v104
    v_mfma_f32_16x16x32_bf16 v[144:147], v[72:75], a[220:223], v[144:147]
    v_cvt_pk_bf16_f32 v100, v100, v101
    v_cvt_pk_bf16_f32 v101, v102, v103
    v_exp_f32 v105, v105
    v_exp_f32 v106, v106
    v_exp_f32 v107, v107
    v_cvt_pk_bf16_f32 v102, v104, v105
    v_cvt_pk_bf16_f32 v103, v106, v107
    ds_read_b64_tr_b16 v[44:45], v8 offset:0
    ds_read_b64_tr_b16 v[46:47], v8 offset:4096
    ds_read_b64_tr_b16 v[48:49], v9 offset:0
    ds_read_b64_tr_b16 v[50:51], v9 offset:4096
    s_mov_b32 s32, s44
    s_mov_b32 s30, s45
    s_mov_b32 s45, 0x40000000
    s_mov_b32 s46, 1
    s_branch L_c4_go
L_c4_tail2:
    s_waitcnt lgkmcnt(2)
    v_mfma_f32_16x16x32_bf16 a[0:3], v[44:47], v[76:79], a[0:3]
    ds_read_b64_tr_b16 v[52:53], v10 offset:0
    ds_read_b64_tr_b16 v[54:55], v10 offset:4096
    v_mfma_f32_16x16x32_bf16 a[32:35], v[44:47], v[84:87], a[32:35]
    v_mfma_f32_16x16x32_bf16 a[64:67], v[44:47], v[92:95], a[64:67]
    v_exp_f32 v116, v116
    v_mfma_f32_16x16x32_bf16 a[96:99], v[44:47], v[100:103], a[96:99]
    v_exp_f32 v117, v117
    s_waitcnt lgkmcnt(2)
    v_mfma_f32_16x16x32_bf16 a[4:7], v[48:51], v[76:79], a[4:7]
    ds_read_b64_tr_b16 v[56:57], v11 offset:0
    ds_read_b64_tr_b16 v[58:59], v11 offset:4096
    v_mfma_f32_16x16x32_bf16 a[36:39], v[48:51], v[84:87], a[36:39]
    v_exp_f32 v118, v118
    v_mfma_f32_16x16x32_bf16 a[68:71], v[48:51], v[92:95], a[68:71]
    v_exp_f32 v119, v119
    v_mfma_f32_16x16x32_bf16 a[100:103], v[48:51], v[100:103], a[100:103]
    s_waitcnt lgkmcnt(2)
    v_mfma_f32_16x16x32_bf16 a[8:11], v[52:55], v[76:79], a[8:11]
    ds_read_b64_tr_b16 v[60:61], v12 offset:0
    ds_read_b64_tr_b16 v[62:63], v12 offset:4096
    v_mfma_f32_16x16x32_bf16 a[40:43], v[52:55], v[84:87], a[40:43]
    v_exp_f32 v120, v120
    v_mfma_f32_16x16x32_bf16 a[72:75], v[52:55], v[92:95], a[72:75]
    v_cvt_pk_bf16_f32 v116, v116, v117
    v_cvt_pk_bf16_f32 v117, v118, v119
    v_mfma_f32_16x16x32_bf16 a[104:107], v[52:55], v[100:103], a[104:107]
    v_exp_f32 v121, v121
    s_waitcnt lgkmcnt(2)
    v_mfma_f32_16x16x32_bf16 a[12:15], v[56:59], v[76:79], a[12:15]
    ds_read_b64_tr_b16 v[64:65], v13 offset:0
    ds_read_b64_tr_b16 v[66:67], v13 offset:4096
    v_mfma_f32_16x16x32_bf16 a[44:47], v[56:59], v[84:87], a[44:47]
    v_exp_f32 v122, v122
    v_mfma_f32_16x16x32_bf16 a[76:79], v[56:59], v[92:95], a[76:79]
    v_mfma_f32_16x16x32_bf16 a[108:111], v[56:59], v[100:103], a[108:111]
    v_exp_f32 v123, v123
    s_waitcnt lgkmcnt(2)
    v_mfma_f32_16x16x32_bf16 a[16:19], v[60:63], v[76:79], a[16:19]
    ds_read_b64_tr_b16 v[68:69], v14 offset:0
    ds_read_b64_tr_b16 v[70:71], v14 offset:4096
    v_mfma_f32_16x16x32_bf16 a[48:51], v[60:63], v[84:87], a[48:51]
    v_cvt_pk_bf16_f32 v118, v120, v121
    v_cvt_pk_bf16_f32 v119, v122, v123
    v_mfma_f32_16x16x32_bf16 a[80:83], v[60:63], v[92:95], a[80:83]
    v_exp_f32 v124, v124
    v_mfma_f32_16x16x32_bf16 a[112:115], v[60:63], v[100:103], a[112:115]
    v_exp_f32 v125, v125
    s_waitcnt lgkmcnt(2)
    v_mfma_f32_16x16x32_bf16 a[20:23], v[64:67], v[76:79], a[20:23]
    ds_read_b64_tr_b16 v[72:73], v15 offset:0
    ds_read_b64_tr_b16 v[74:75], v15 offset:4096
    v_mfma_f32_16x16x32_bf16 a[52:55], v[64:67], v[84:87], a[52:55]
    v_mfma_f32_16x16x32_bf16 a[84:87], v[64:67], v[92:95], a[84:87]
    v_exp_f32 v126, v126
    v_mfma_f32_16x16x32_bf16 a[116:119], v[64:67], v[100:103], a[116:119]
    v_exp_f32 v127, v127
    s_waitcnt lgkmcnt(2)
    v_mfma_f32_16x16x32_bf16 a[24:27], v[68:71], v[76:79], a[24:27]
    ds_read_b128 v[44:47], v4 offset:16384
    ds_read_b128 v[48:51], v5 offset:16384
    v_mfma_f32_16x16x32_bf16 a[56:59], v[68:71], v[84:87], a[56:59]
    v_exp_f32 v128, v128
    v_mfma_f32_16x16x32_bf16 a[88:91], v[68:71], v[92:95], a[88:91]
    v_cvt_pk_bf16_f32 v124, v124, v125
    v_cvt_pk_bf16_f32 v125, v126, v127
    v_mfma_f32_16x16x32_bf16 a[120:123], v[68:71], v[100:103], a[120:123]
    s_waitcnt lgkmcnt(2)
    v_mfma_f32_16x16x32_bf16 a[28:31], v[72:75], v[76:79], a[28:31]
    v_exp_f32 v129, v129
    v_mfma_f32_16x16x32_bf16 a[60:63], v[72:75], v[84:87], a[60:63]
    v_exp_f32 v130, v130
    v_mfma_f32_16x16x32_bf16 a[92:95], v[72:75], v[92:95], a[92:95]
    v_exp_f32 v131, v131
    v_mfma_f32_16x16x32_bf16 a[124:127], v[72:75], v[100:103], a[124:127]
    v_cvt_pk_bf16_f32 v126, v128, v129
    v_cvt_pk_bf16_f32 v127, v130, v131
    v_mfma_f32_16x16x32_bf16 a[240:243], v[248:251], v[76:79], a[240:243]
    v_mfma_f32_16x16x32_bf16 a[244:247], v[248:251], v[84:87], a[244:247]
    v_exp_f32 v132, v132
    s_waitcnt vmcnt(8)
    s_barrier
    v_mfma_f32_16x16x32_bf16 a[248:251], v[248:251], v[92:95], a[248:251]
    s_add_u32 m0, s34, 49152
    s_nop 0
    buffer_load_dwordx4 v1, s[16:19], s33 offen lds
    v_mfma_f32_16x16x32_bf16 a[252:255], v[248:251], v[100:103], a[252:255]
    buffer_load_dwordx4 v2, s[16:19], s33 offen offset:1024 lds
    s_waitcnt lgkmcnt(1)
    v_mfma_f32_16x16x32_bf16 v[76:79], v[44:47], a[160:163], v[24:27]
    ds_read_b128 v[52:55], v6 offset:16384
    ds_read_b128 v[56:59], v7 offset:16384
    v_mfma_f32_16x16x32_bf16 v[84:87], v[44:47], a[176:179], v[28:31]
    s_add_u32 m0, s34, 114688
    s_nop 0
    buffer_load_dwordx4 v1, s[20:23], s33 offen lds
    v_mfma_f32_16x16x32_bf16 v[92:95], v[44:47], a[192:195], v[32:35]
    buffer_load_dwordx4 v2, s[20:23], s33 offen offset:1024 lds
    s_add_u32 s33, s33, 8192
    v_mfma_f32_16x16x32_bf16 v[100:103], v[44:47], a[208:211], v[36:39]
    v_exp_f32 v133, v133
    s_waitcnt lgkmcnt(2)
    v_mfma_f32_16x16x32_bf16 v[76:79], v[48:51], a[164:167], v[76:79]
    v_exp_f32 v134, v134
    v_mfma_f32_16x16x32_bf16 v[84:87], v[48:51], a[180:183], v[84:87]
    v_exp_f32 v135, v135
    v_mfma_f32_16x16x32_bf16 v[92:95], v[48:51], a[196:199], v[92:95]
    v_mfma_f32_16x16x32_bf16 v[100:103], v[48:51], a[212:215], v[100:103]
    v_exp_f32 v136, v136
    s_waitcnt lgkmcnt(1)
    v_mfma_f32_16x16x32_bf16 v[76:79], v[52:55], a[168:171], v[76:79]
    ds_read_b128 v[60:63], v4 offset:20480
    ds_read_b128 v[64:67], v5 offset:20480
    v_mfma_f32_16x16x32_bf16 v[84:87], v[52:55], a[184:187], v[84:87]
    v_cvt_pk_bf16_f32 v132, v132, v133
    v_cvt_pk_bf16_f32 v133, v134, v135
    v_mfma_f32_16x16x32_bf16 v[92:95], v[52:55], a[200:203], v[92:95]
    v_exp_f32 v137, v137
    v_mfma_f32_16x16x32_bf16 v[100:103], v[52:55], a[216:219], v[100:103]
    v_exp_f32 v138, v138
    s_waitcnt lgkmcnt(2)
    v_mfma_f32_16x16x32_bf16 v[76:79], v[56:59], a[172:175], v[76:79]
    v_mfma_f32_16x16x32_bf16 v[84:87], v[56:59], a[188:191], v[84:87]
    v_exp_f32 v139, v139
    v_mfma_f32_16x16x32_bf16 v[92:95], v[56:59], a[204:207], v[92:95]
    v_cvt_pk_bf16_f32 v134, v136, v137
    v_cvt_pk_bf16_f32 v135, v138, v139
    v_mfma_f32_16x16x32_bf16 v[100:103], v[56:59], a[220:223], v[100:103]
    v_exp_f32 v140, v140
    s_waitcnt lgkmcnt(1)
    v_mfma_f32_16x16x32_bf16 v[80:83], v[60:63], a[160:163], v[24:27]
    ds_read_b128 v[68:71], v6 offset:20480
    ds_read_b128 v[72:75], v7 offset:20480
    v_mfma_f32_16x16x32_bf16 v[88:91], v[60:63], a[176:179], v[28:31]
    v_exp_f32 v141, v141
    v_mfma_f32_16x16x32_bf16 v[96:99], v[60:63], a[192:195], v[32:35]
    v_mfma_f32_16x16x32_bf16 v[104:107], v[60:63], a[208:211], v[36:39]
    v_exp_f32 v142, v142
    s_waitcnt lgkmcnt(2)
    v_mfma_f32_16x16x32_bf16 v[80:83], v[64:67], a[164:167], v[80:83]
    v_exp_f32 v143, v143
    v_mfma_f32_16x16x32_bf16 v[88:91], v[64:67], a[180:183], v[88:91]
    v_exp_f32 v144, v144
    v_mfma_f32_16x16x32_bf16 v[96:99], v[64:67], a[196:199], v[96:99]
    v_cvt_pk_bf16_f32 v140, v140, v141
    v_cvt_pk_bf16_f32 v141, v142, v143
    v_mfma_f32_16x16x32_bf16 v[104:107], v[64:67], a[212:215], v[104:107]
    s_waitcnt lgkmcnt(1)
    v_mfma_f32_16x16x32_bf16 v[80:83], v[68:71], a[168:171], v[80:83]
    ds_read_b64_tr_b16 v[44:45], v8 offset:8192
    ds_read_b64_tr_b16 v[46:47], v8 offset:12288
    v_mfma_f32_16x16x32_bf16 v[88:91], v[68:71], a[184:187], v[88:91]
    v_exp_f32 v145, v145
    v_mfma_f32_16x16x32_bf16 v[96:99], v[68:71], a[200:203], v[96:99]
    v_exp_f32 v146, v146
    v_mfma_f32_16x16x32_bf16 v[104:107], v[68:71], a[216:219], v[104:107]
    v_exp_f32 v147, v147
    s_waitcnt lgkmcnt(2)
    v_mfma_f32_16x16x32_bf16 v[80:83], v[72:75], a[172:175], v[80:83]
    ds_read_b64_tr_b16 v[48:49], v9 offset:8192
    ds_read_b64_tr_b16 v[50:51], v9 offset:12288
    v_mfma_f32_16x16x32_bf16 v[88:91], v[72:75], a[188:191], v[88:91]
    v_cvt_pk_bf16_f32 v142, v144, v145
    v_cvt_pk_bf16_f32 v143, v146, v147
    v_mfma_f32_16x16x32_bf16 v[96:99], v[72:75], a[204:207], v[96:99]
    v_mfma_f32_16x16x32_bf16 v[104:107], v[72:75], a[220:223], v[104:107]
    s_waitcnt lgkmcnt(2)
    v_mfma_f32_16x16x32_bf16 a[0:3], v[44:47], v[116:119], a[0:3]
    ds_read_b64_tr_b16 v[52:53], v10 offset:8192
    ds_read_b64_tr_b16 v[54:55], v10 offset:12288
    v_mfma_f32_16x16x32_bf16 a[32:35], v[44:47], v[124:127], a[32:35]
    v_mfma_f32_16x16x32_bf16 a[64:67], v[44:47], v[132:135], a[64:67]
    v_exp_f32 v76, v76
    v_mfma_f32_16x16x32_bf16 a[96:99], v[44:47], v[140:143], a[96:99]
    v_exp_f32 v77, v77
    s_waitcnt lgkmcnt(2)
    v_mfma_f32_16x16x32_bf16 a[4:7], v[48:51], v[116:119], a[4:7]
    ds_read_b64_tr_b16 v[56:57], v11 offset:8192
    ds_read_b64_tr_b16 v[58:59], v11 offset:12288
    v_mfma_f32_16x16x32_bf16 a[36:39], v[48:51], v[124:127], a[36:39]
    v_exp_f32 v78, v78
    v_mfma_f32_16x16x32_bf16 a[68:71], v[48:51], v[132:135], a[68:71]
    v_exp_f32 v79, v79
    v_mfma_f32_16x16x32_bf16 a[100:103], v[48:51], v[140:143], a[100:103]
    s_waitcnt lgkmcnt(2)
    v_mfma_f32_16x16x32_bf16 a[8:11], v[52:55], v[116:119], a[8:11]
    ds_read_b64_tr_b16 v[60:61], v12 offset:8192
    ds_read_b64_tr_b16 v[62:63], v12 offset:12288
    v_mfma_f32_16x16x32_bf16 a[40:43], v[52:55], v[124:127], a[40:43]
    v_exp_f32 v80, v80
    v_mfma_f32_16x16x32_bf16 a[72:75], v[52:55], v[132:135], a[72:75]
    v_cvt_pk_bf16_f32 v76, v76, v77
    v_cvt_pk_bf16_f32 v77, v78, v79
    v_mfma_f32_16x16x32_bf16 a[104:107], v[52:55], v[140:143], a[104:107]
    v_exp_f32 v81, v81
    s_waitcnt lgkmcnt(2)
    v_mfma_f32_16x16x32_bf16 a[12:15], v[56:59], v[116:119], a[12:15]
    ds_read_b64_tr_b16 v[64:65], v13 offset:8192
    ds_read_b64_tr_b16 v[66:67], v13 offset:12288
    v_mfma_f32_16x16x32_bf16 a[44:47], v[56:59], v[124:127], a[44:47]
    v_exp_f32 v82, v82
    v_mfma_f32_16x16x32_bf16 a[76:79], v[56:59], v[132:135], a[76:79]
    v_mfma_f32_16x16x32_bf16 a[108:111], v[56:59], v[140:143], a[108:111]
    v_exp_f32 v83, v83
    s_waitcnt lgkmcnt(2)
    v_mfma_f32_16x16x32_bf16 a[16:19], v[60:63], v[116:119], a[16:19]
    ds_read_b64_tr_b16 v[68:69], v14 offset:8192
    ds_read_b64_tr_b16 v[70:71], v14 offset:12288
    v_mfma_f32_16x16x32_bf16 a[48:51], v[60:63], v[124:127], a[48:51]
    v_cvt_pk_bf16_f32 v78, v80, v81
    v_cvt_pk_bf16_f32 v79, v82, v83
    v_mfma_f32_16x16x32_bf16 a[80:83], v[60:63], v[132:135], a[80:83]
    v_exp_f32 v84, v84
    v_mfma_f32_16x16x32_bf16 a[112:115], v[60:63], v[140:143], a[112:115]
    v_exp_f32 v85, v85
    s_waitcnt lgkmcnt(2)
    v_mfma_f32_16x16x32_bf16 a[20:23], v[64:67], v[116:119], a[20:23]
    ds_read_b64_tr_b16 v[72:73], v15 offset:8192
    ds_read_b64_tr_b16 v[74:75], v15 offset:12288
    v_mfma_f32_16x16x32_bf16 a[52:55], v[64:67], v[124:127], a[52:55]
    v_mfma_f32_16x16x32_bf16 a[84:87], v[64:67], v[132:135], a[84:87]
    v_exp_f32 v86, v86
    v_mfma_f32_16x16x32_bf16 a[116:119], v[64:67], v[140:143], a[116:119]
    v_exp_f32 v87, v87
    s_waitcnt lgkmcnt(2)
    v_mfma_f32_16x16x32_bf16 a[24:27], v[68:71], v[116:119], a[24:27]
    ds_read_b128 v[44:47], v4 offset:24576
    ds_read_b128 v[48:51], v5 offset:24576
    v_mfma_f32_16x16x32_bf16 a[56:59], v[68:71], v[124:127], a[56:59]
    v_exp_f32 v88, v88
    s_nop 1
    v_mfma_f32_16x16x32_bf16 a[88:91], v[68:71], v[132:135], a[88:91]
    v_cvt_pk_bf16_f32 v84, v84, v85
    v_cvt_pk_bf16_f32 v85, v86, v87
    v_mfma_f32_16x16x32_bf16 a[120:123], v[68:71], v[140:143], a[120:123]
    s_waitcnt lgkmcnt(2)
    v_mfma_f32_16x16x32_bf16 a[28:31], v[72:75], v[116:119], a[28:31]
    v_exp_f32 v89, v89
    v_mfma_f32_16x16x32_bf16 a[60:63], v[72:75], v[124:127], a[60:63]
    v_exp_f32 v90, v90
    v_mfma_f32_16x16x32_bf16 a[92:95], v[72:75], v[132:135], a[92:95]
    v_exp_f32 v91, v91
    v_mfma_f32_16x16x32_bf16 a[124:127], v[72:75], v[140:143], a[124:127]
    v_cvt_pk_bf16_f32 v86, v88, v89
    v_cvt_pk_bf16_f32 v87, v90, v91
    v_mfma_f32_16x16x32_bf16 a[240:243], v[248:251], v[116:119], a[240:243]
    v_mfma_f32_16x16x32_bf16 a[244:247], v[248:251], v[124:127], a[244:247]
    v_exp_f32 v92, v92
    s_waitcnt vmcnt(8)
    s_barrier
    v_mfma_f32_16x16x32_bf16 a[248:251], v[248:251], v[132:135], a[248:251]
    s_add_u32 m0, s34, 57344
    s_nop 0
    buffer_load_dwordx4 v1, s[16:19], s33 offen lds
    v_mfma_f32_16x16x32_bf16 a[252:255], v[248:251], v[140:143], a[252:255]
    buffer_load_dwordx4 v2, s[16:19], s33 offen offset:1024 lds
    s_waitcnt lgkmcnt(1)
    v_mfma_f32_16x16x32_bf16 v[116:119], v[44:47], a[160:163], v[24:27]
    ds_read_b128 v[52:55], v6 offset:24576
    ds_read_b128 v[56:59], v7 offset:24576
    v_mfma_f32_16x16x32_bf16 v[124:127], v[44:47], a[176:179], v[28:31]
    s_add_u32 m0, s34, 122880
    s_nop 0
    buffer_load_dwordx4 v1, s[20:23], s33 offen lds
    v_mfma_f32_16x16x32_bf16 v[132:135], v[44:47], a[192:195], v[32:35]
    buffer_load_dwordx4 v2, s[20:23], s33 offen offset:1024 lds
    s_add_u32 s33, s33, 8192
    v_mfma_f32_16x16x32_bf16 v[140:143], v[44:47], a[208:211], v[36:39]
    v_exp_f32 v93, v93
    s_waitcnt lgkmcnt(2)
    v_mfma_f32_16x16x32_bf16 v[116:119], v[48:51], a[164:167], v[116:119]
    v_exp_f32 v94, v94
    v_mfma_f32_16x16x32_bf16 v[124:127], v[48:51], a[180:183], v[124:127]
    v_exp_f32 v95, v95
    v_mfma_f32_16x16x32_bf16 v[132:135], v[48:51], a[196:199], v[132:135]
    v_mfma_f32_16x16x32_bf16 v[140:143], v[48:51], a[212:215], v[140:143]
    v_exp_f32 v96, v96
    s_waitcnt lgkmcnt(1)
    v_mfma_f32_16x16x32_bf16 v[116:119], v[52:55], a[168:171], v[116:119]
    ds_read_b128 v[60:63], v4 offset:28672
    ds_read_b128 v[64:67], v5 offset:28672
    v_mfma_f32_16x16x32_bf16 v[124:127], v[52:55], a[184:187], v[124:127]
    v_cvt_pk_bf16_f32 v92, v92, v93
    v_cvt_pk_bf16_f32 v93, v94, v95
    v_mfma_f32_16x16x32_bf16 v[132:135], v[52:55], a[200:203], v[132:135]
    v_exp_f32 v97, v97
    v_mfma_f32_16x16x32_bf16 v[140:143], v[52:55], a[216:219], v[140:143]
    v_exp_f32 v98, v98
    s_waitcnt lgkmcnt(2)
    v_mfma_f32_16x16x32_bf16 v[116:119], v[56:59], a[172:175], v[116:119]
    v_mfma_f32_16x16x32_bf16 v[124:127], v[56:59], a[188:191], v[124:127]
    v_exp_f32 v99, v99
    v_mfma_f32_16x16x32_bf16 v[132:135], v[56:59], a[204:207], v[132:135]
    v_cvt_pk_bf16_f32 v94, v96, v97
    v_cvt_pk_bf16_f32 v95, v98, v99
    v_mfma_f32_16x16x32_bf16 v[140:143], v[56:59], a[220:223], v[140:143]
    v_exp_f32 v100, v100
    s_waitcnt lgkmcnt(1)
    v_mfma_f32_16x16x32_bf16 v[120:123], v[60:63], a[160:163], v[24:27]
    ds_read_b128 v[68:71], v6 offset:28672
    ds_read_b128 v[72:75], v7 offset:28672
    v_mfma_f32_16x16x32_bf16 v[128:131], v[60:63], a[176:179], v[28:31]
    v_exp_f32 v101, v101
    v_mfma_f32_16x16x32_bf16 v[136:139], v[60:63], a[192:195], v[32:35]
    v_mfma_f32_16x16x32_bf16 v[144:147], v[60:63], a[208:211], v[36:39]
    v_exp_f32 v102, v102
    s_waitcnt lgkmcnt(2)
    v_mfma_f32_16x16x32_bf16 v[120:123], v[64:67], a[164:167], v[120:123]
    v_exp_f32 v103, v103
    v_mfma_f32_16x16x32_bf16 v[128:131], v[64:67], a[180:183], v[128:131]
    v_exp_f32 v104, v104
    v_mfma_f32_16x16x32_bf16 v[136:139], v[64:67], a[196:199], v[136:139]
    v_cvt_pk_bf16_f32 v100, v100, v101
    v_cvt_pk_bf16_f32 v101, v102, v103
    v_mfma_f32_16x16x32_bf16 v[144:147], v[64:67], a[212:215], v[144:147]
    s_waitcnt lgkmcnt(1)
    v_mfma_f32_16x16x32_bf16 v[120:123], v[68:71], a[168:171], v[120:123]
    ds_read_b64_tr_b16 v[44:45], v8 offset:16384
    ds_read_b64_tr_b16 v[46:47], v8 offset:20480
    v_mfma_f32_16x16x32_bf16 v[128:131], v[68:71], a[184:187], v[128:131]
    v_exp_f32 v105, v105
    v_mfma_f32_16x16x32_bf16 v[136:139], v[68:71], a[200:203], v[136:139]
    v_exp_f32 v106, v106
    v_mfma_f32_16x16x32_bf16 v[144:147], v[68:71], a[216:219], v[144:147]
    v_exp_f32 v107, v107
    s_waitcnt lgkmcnt(2)
    v_mfma_f32_16x16x32_bf16 v[120:123], v[72:75], a[172:175], v[120:123]
    ds_read_b64_tr_b16 v[48:49], v9 offset:16384
    ds_read_b64_tr_b16 v[50:51], v9 offset:20480
    v_mfma_f32_16x16x32_bf16 v[128:131], v[72:75], a[188:191], v[128:131]
    v_cvt_pk_bf16_f32 v102, v104, v105
    v_cvt_pk_bf16_f32 v103, v106, v107
    v_mfma_f32_16x16x32_bf16 v[136:139], v[72:75], a[204:207], v[136:139]
    v_mfma_f32_16x16x32_bf16 v[144:147], v[72:75], a[220:223], v[144:147]
    s_waitcnt lgkmcnt(2)
    v_mfma_f32_16x16x32_bf16 a[0:3], v[44:47], v[76:79], a[0:3]
    ds_read_b64_tr_b16 v[52:53], v10 offset:16384
    ds_read_b64_tr_b16 v[54:55], v10 offset:20480
    v_mfma_f32_16x16x32_bf16 a[32:35], v[44:47], v[84:87], a[32:35]
    v_mfma_f32_16x16x32_bf16 a[64:67], v[44:47], v[92:95], a[64:67]
    v_exp_f32 v116, v116
    v_mfma_f32_16x16x32_bf16 a[96:99], v[44:47], v[100:103], a[96:99]
    v_exp_f32 v117, v117
    s_waitcnt lgkmcnt(2)
    v_mfma_f32_16x16x32_bf16 a[4:7], v[48:51], v[76:79], a[4:7]
    ds_read_b64_tr_b16 v[56:57], v11 offset:16384
    ds_read_b64_tr_b16 v[58:59], v11 offset:20480
    v_mfma_f32_16x16x32_bf16 a[36:39], v[48:51], v[84:87], a[36:39]
    v_exp_f32 v118, v118
    v_mfma_f32_16x16x32_bf16 a[68:71], v[48:51], v[92:95], a[68:71]
    v_mfma_f32_16x16x32_bf16 a[100:103], v[48:51], v[100:103], a[100:103]
    v_exp_f32 v119, v119
    s_waitcnt lgkmcnt(2)
    v_mfma_f32_16x16x32_bf16 a[8:11], v[52:55], v[76:79], a[8:11]
    ds_read_b64_tr_b16 v[60:61], v12 offset:16384
    ds_read_b64_tr_b16 v[62:63], v12 offset:20480
    v_mfma_f32_16x16x32_bf16 a[40:43], v[52:55], v[84:87], a[40:43]
    v_exp_f32 v120, v120
    v_mfma_f32_16x16x32_bf16 a[72:75], v[52:55], v[92:95], a[72:75]
    v_cvt_pk_bf16_f32 v116, v116, v117
    v_cvt_pk_bf16_f32 v117, v118, v119
    v_mfma_f32_16x16x32_bf16 a[104:107], v[52:55], v[100:103], a[104:107]
    s_waitcnt lgkmcnt(2)
    v_mfma_f32_16x16x32_bf16 a[12:15], v[56:59], v[76:79], a[12:15]
    ds_read_b64_tr_b16 v[64:65], v13 offset:16384
    ds_read_b64_tr_b16 v[66:67], v13 offset:20480
    v_mfma_f32_16x16x32_bf16 a[44:47], v[56:59], v[84:87], a[44:47]
    v_exp_f32 v121, v121
    v_mfma_f32_16x16x32_bf16 a[76:79], v[56:59], v[92:95], a[76:79]
    v_exp_f32 v122, v122
    v_mfma_f32_16x16x32_bf16 a[108:111], v[56:59], v[100:103], a[108:111]
    v_exp_f32 v123, v123
    s_waitcnt lgkmcnt(2)
    v_mfma_f32_16x16x32_bf16 a[16:19], v[60:63], v[76:79], a[16:19]
    ds_read_b64_tr_b16 v[68:69], v14 offset:16384
    ds_read_b64_tr_b16 v[70:71], v14 offset:20480
    v_mfma_f32_16x16x32_bf16 a[48:51], v[60:63], v[84:87], a[48:51]
    v_mfma_f32_16x16x32_bf16 a[80:83], v[60:63], v[92:95], a[80:83]
    v_cvt_pk_bf16_f32 v118, v120, v121
    v_cvt_pk_bf16_f32 v119, v122, v123
    v_mfma_f32_16x16x32_bf16 a[112:115], v[60:63], v[100:103], a[112:115]
    v_exp_f32 v124, v124
    s_waitcnt lgkmcnt(2)
    v_mfma_f32_16x16x32_bf16 a[20:23], v[64:67], v[76:79], a[20:23]
    ds_read_b64_tr_b16 v[72:73], v15 offset:16384
    ds_read_b64_tr_b16 v[74:75], v15 offset:20480
    v_mfma_f32_16x16x32_bf16 a[52:55], v[64:67], v[84:87], a[52:55]
    v_exp_f32 v125, v125
    v_mfma_f32_16x16x32_bf16 a[84:87], v[64:67], v[92:95], a[84:87]
    v_mfma_f32_16x16x32_bf16 a[116:119], v[64:67], v[100:103], a[116:119]
    v_exp_f32 v126, v126
    s_waitcnt lgkmcnt(2)
    v_mfma_f32_16x16x32_bf16 a[24:27], v[68:71], v[76:79], a[24:27]
    ds_read_b128 v[44:47], v4 offset:32768
    ds_read_b128 v[48:51], v5 offset:32768
    v_mfma_f32_16x16x32_bf16 a[56:59], v[68:71], v[84:87], a[56:59]
    v_exp_f32 v127, v127
    v_mfma_f32_16x16x32_bf16 a[88:91], v[68:71], v[92:95], a[88:91]
    v_exp_f32 v128, v128
    v_mfma_f32_16x16x32_bf16 a[120:123], v[68:71], v[100:103], a[120:123]
    s_waitcnt lgkmcnt(2)
    v_mfma_f32_16x16x32_bf16 a[28:31], v[72:75], v[76:79], a[28:31]
    v_cvt_pk_bf16_f32 v124, v124, v125
    v_cvt_pk_bf16_f32 v125, v126, v127
    v_mfma_f32_16x16x32_bf16 a[60:63], v[72:75], v[84:87], a[60:63]
    v_exp_f32 v129, v129
    v_mfma_f32_16x16x32_bf16 a[92:95], v[72:75], v[92:95], a[92:95]
    v_exp_f32 v130, v130
    v_mfma_f32_16x16x32_bf16 a[124:127], v[72:75], v[100:103], a[124:127]
    v_mfma_f32_16x16x32_bf16 a[240:243], v[248:251], v[76:79], a[240:243]
    v_exp_f32 v131, v131
    v_mfma_f32_16x16x32_bf16 a[244:247], v[248:251], v[84:87], a[244:247]
    v_cvt_pk_bf16_f32 v126, v128, v129
    v_cvt_pk_bf16_f32 v127, v130, v131
    s_waitcnt vmcnt(8)
    s_barrier
    v_mfma_f32_16x16x32_bf16 a[248:251], v[248:251], v[92:95], a[248:251]
    v_mfma_f32_16x16x32_bf16 a[252:255], v[248:251], v[100:103], a[252:255]
    v_exp_f32 v132, v132
    s_waitcnt lgkmcnt(1)
    v_mfma_f32_16x16x32_bf16 v[76:79], v[44:47], a[160:163], v[24:27]
    ds_read_b128 v[52:55], v6 offset:32768
    ds_read_b128 v[56:59], v7 offset:32768
    v_mfma_f32_16x16x32_bf16 v[84:87], v[44:47], a[176:179], v[28:31]
    v_exp_f32 v133, v133
    v_mfma_f32_16x16x32_bf16 v[92:95], v[44:47], a[192:195], v[32:35]
    v_exp_f32 v134, v134
    v_mfma_f32_16x16x32_bf16 v[100:103], v[44:47], a[208:211], v[36:39]
    s_waitcnt lgkmcnt(2)
    v_mfma_f32_16x16x32_bf16 v[76:79], v[48:51], a[164:167], v[76:79]
    v_exp_f32 v135, v135
    v_mfma_f32_16x16x32_bf16 v[84:87], v[48:51], a[180:183], v[84:87]
    v_exp_f32 v136, v136
    v_mfma_f32_16x16x32_bf16 v[92:95], v[48:51], a[196:199], v[92:95]
    v_cvt_pk_bf16_f32 v132, v132, v133
    v_cvt_pk_bf16_f32 v133, v134, v135
    v_mfma_f32_16x16x32_bf16 v[100:103], v[48:51], a[212:215], v[100:103]
    s_waitcnt lgkmcnt(1)
    v_mfma_f32_16x16x32_bf16 v[76:79], v[52:55], a[168:171], v[76:79]
    ds_read_b128 v[60:63], v4 offset:36864
    ds_read_b128 v[64:67], v5 offset:36864
    v_mfma_f32_16x16x32_bf16 v[84:87], v[52:55], a[184:187], v[84:87]
    v_exp_f32 v137, v137
    v_mfma_f32_16x16x32_bf16 v[92:95], v[52:55], a[200:203], v[92:95]
    v_exp_f32 v138, v138
    v_mfma_f32_16x16x32_bf16 v[100:103], v[52:55], a[216:219], v[100:103]
    v_exp_f32 v139, v139
    s_waitcnt lgkmcnt(2)
    v_mfma_f32_16x16x32_bf16 v[76:79], v[56:59], a[172:175], v[76:79]
    v_mfma_f32_16x16x32_bf16 v[84:87], v[56:59], a[188:191], v[84:87]
    v_cvt_pk_bf16_f32 v134, v136, v137
    v_cvt_pk_bf16_f32 v135, v138, v139
    v_mfma_f32_16x16x32_bf16 v[92:95], v[56:59], a[204:207], v[92:95]
    v_exp_f32 v140, v140
    v_mfma_f32_16x16x32_bf16 v[100:103], v[56:59], a[220:223], v[100:103]
    v_exp_f32 v141, v141
    s_waitcnt lgkmcnt(1)
    v_mfma_f32_16x16x32_bf16 v[80:83], v[60:63], a[160:163], v[24:27]
    ds_read_b128 v[68:71], v6 offset:36864
    ds_read_b128 v[72:75], v7 offset:36864
    v_mfma_f32_16x16x32_bf16 v[88:91], v[60:63], a[176:179], v[28:31]
    v_mfma_f32_16x16x32_bf16 v[96:99], v[60:63], a[192:195], v[32:35]
    v_exp_f32 v142, v142
    v_mfma_f32_16x16x32_bf16 v[104:107], v[60:63], a[208:211], v[36:39]
    v_exp_f32 v143, v143
    s_waitcnt lgkmcnt(2)
    v_mfma_f32_16x16x32_bf16 v[80:83], v[64:67], a[164:167], v[80:83]
    v_exp_f32 v144, v144
    v_mfma_f32_16x16x32_bf16 v[88:91], v[64:67], a[180:183], v[88:91]
    v_mfma_f32_16x16x32_bf16 v[96:99], v[64:67], a[196:199], v[96:99]
    v_cvt_pk_bf16_f32 v140, v140, v141
    v_cvt_pk_bf16_f32 v141, v142, v143
    v_mfma_f32_16x16x32_bf16 v[104:107], v[64:67], a[212:215], v[104:107]
    v_exp_f32 v145, v145
    s_waitcnt lgkmcnt(1)
    v_mfma_f32_16x16x32_bf16 v[80:83], v[68:71], a[168:171], v[80:83]
    ds_read_b64_tr_b16 v[44:45], v8 offset:24576
    ds_read_b64_tr_b16 v[46:47], v8 offset:28672
    v_mfma_f32_16x16x32_bf16 v[88:91], v[68:71], a[184:187], v[88:91]
    v_exp_f32 v146, v146
    v_mfma_f32_16x16x32_bf16 v[96:99], v[68:71], a[200:203], v[96:99]
    v_mfma_f32_16x16x32_bf16 v[104:107], v[68:71], a[216:219], v[104:107]
    v_exp_f32 v147, v147
    s_waitcnt lgkmcnt(2)
    v_mfma_f32_16x16x32_bf16 v[80:83], v[72:75], a[172:175], v[80:83]
    ds_read_b64_tr_b16 v[48:49], v9 offset:24576
    ds_read_b64_tr_b16 v[50:51], v9 offset:28672
    v_mfma_f32_16x16x32_bf16 v[88:91], v[72:75], a[188:191], v[88:91]
    v_cvt_pk_bf16_f32 v142, v144, v145
    v_cvt_pk_bf16_f32 v143, v146, v147
    v_mfma_f32_16x16x32_bf16 v[96:99], v[72:75], a[204:207], v[96:99]
    v_mfma_f32_16x16x32_bf16 v[104:107], v[72:75], a[220:223], v[104:107]
    s_waitcnt lgkmcnt(2)
    v_mfma_f32_16x16x32_bf16 a[0:3], v[44:47], v[116:119], a[0:3]
    ds_read_b64_tr_b16 v[52:53], v10 offset:24576
    ds_read_b64_tr_b16 v[54:55], v10 offset:28672
    v_mfma_f32_16x16x32_bf16 a[32:35], v[44:47], v[124:127], a[32:35]
    v_mfma_f32_16x16x32_bf16 a[64:67], v[44:47], v[132:135], a[64:67]
    v_exp_f32 v76, v76
    v_mfma_f32_16x16x32_bf16 a[96:99], v[44:47], v[140:143], a[96:99]
    v_exp_f32 v77, v77
    s_waitcnt lgkmcnt(2)
    v_mfma_f32_16x16x32_bf16 a[4:7], v[48:51], v[116:119], a[4:7]
    ds_read_b64_tr_b16 v[56:57], v11 offset:24576
    ds_read_b64_tr_b16 v[58:59], v11 offset:28672
    v_mfma_f32_16x16x32_bf16 a[36:39], v[48:51], v[124:127], a[36:39]
    v_exp_f32 v78, v78
    v_mfma_f32_16x16x32_bf16 a[68:71], v[48:51], v[132:135], a[68:71]
    v_mfma_f32_16x16x32_bf16 a[100:103], v[48:51], v[140:143], a[100:103]
    v_exp_f32 v79, v79
    s_waitcnt lgkmcnt(2)
    v_mfma_f32_16x16x32_bf16 a[8:11], v[52:55], v[116:119], a[8:11]
    ds_read_b64_tr_b16 v[60:61], v12 offset:24576
    ds_read_b64_tr_b16 v[62:63], v12 offset:28672
    v_mfma_f32_16x16x32_bf16 a[40:43], v[52:55], v[124:127], a[40:43]
    v_exp_f32 v80, v80
    v_mfma_f32_16x16x32_bf16 a[72:75], v[52:55], v[132:135], a[72:75]
    v_cvt_pk_bf16_f32 v76, v76, v77
    v_cvt_pk_bf16_f32 v77, v78, v79
    v_mfma_f32_16x16x32_bf16 a[104:107], v[52:55], v[140:143], a[104:107]
    s_waitcnt lgkmcnt(2)
    v_mfma_f32_16x16x32_bf16 a[12:15], v[56:59], v[116:119], a[12:15]
    ds_read_b64_tr_b16 v[64:65], v13 offset:24576
    ds_read_b64_tr_b16 v[66:67], v13 offset:28672
    v_mfma_f32_16x16x32_bf16 a[44:47], v[56:59], v[124:127], a[44:47]
    v_exp_f32 v81, v81
    v_mfma_f32_16x16x32_bf16 a[76:79], v[56:59], v[132:135], a[76:79]
    v_exp_f32 v82, v82
    v_mfma_f32_16x16x32_bf16 a[108:111], v[56:59], v[140:143], a[108:111]
    v_exp_f32 v83, v83
    s_waitcnt lgkmcnt(2)
    v_mfma_f32_16x16x32_bf16 a[16:19], v[60:63], v[116:119], a[16:19]
    ds_read_b64_tr_b16 v[68:69], v14 offset:24576
    ds_read_b64_tr_b16 v[70:71], v14 offset:28672
    v_mfma_f32_16x16x32_bf16 a[48:51], v[60:63], v[124:127], a[48:51]
    v_mfma_f32_16x16x32_bf16 a[80:83], v[60:63], v[132:135], a[80:83]
    v_cvt_pk_bf16_f32 v78, v80, v81
    v_cvt_pk_bf16_f32 v79, v82, v83
    v_mfma_f32_16x16x32_bf16 a[112:115], v[60:63], v[140:143], a[112:115]
    v_exp_f32 v84, v84
    s_waitcnt lgkmcnt(2)
    v_mfma_f32_16x16x32_bf16 a[20:23], v[64:67], v[116:119], a[20:23]
    ds_read_b64_tr_b16 v[72:73], v15 offset:24576
    ds_read_b64_tr_b16 v[74:75], v15 offset:28672
    v_mfma_f32_16x16x32_bf16 a[52:55], v[64:67], v[124:127], a[52:55]
    v_exp_f32 v85, v85
    s_nop 1
    v_mfma_f32_16x16x32_bf16 a[84:87], v[64:67], v[132:135], a[84:87]
    v_mfma_f32_16x16x32_bf16 a[116:119], v[64:67], v[140:143], a[116:119]
    v_exp_f32 v86, v86
    s_waitcnt lgkmcnt(2)
    v_mfma_f32_16x16x32_bf16 a[24:27], v[68:71], v[116:119], a[24:27]
    ds_read_b128 v[44:47], v4 offset:40960
    ds_read_b128 v[48:51], v5 offset:40960
    v_mfma_f32_16x16x32_bf16 a[56:59], v[68:71], v[124:127], a[56:59]
    v_exp_f32 v87, v87
    v_mfma_f32_16x16x32_bf16 a[88:91], v[68:71], v[132:135], a[88:91]
    v_exp_f32 v88, v88
    v_mfma_f32_16x16x32_bf16 a[120:123], v[68:71], v[140:143], a[120:123]
    s_waitcnt lgkmcnt(2)
    v_mfma_f32_16x16x32_bf16 a[28:31], v[72:75], v[116:119], a[28:31]
    v_cvt_pk_bf16_f32 v84, v84, v85
    v_cvt_pk_bf16_f32 v85, v86, v87
    v_mfma_f32_16x16x32_bf16 a[60:63], v[72:75], v[124:127], a[60:63]
    v_exp_f32 v89, v89
    v_mfma_f32_16x16x32_bf16 a[92:95], v[72:75], v[132:135], a[92:95]
    v_exp_f32 v90, v90
    v_mfma_f32_16x16x32_bf16 a[124:127], v[72:75], v[140:143], a[124:127]
    v_mfma_f32_16x16x32_bf16 a[240:243], v[248:251], v[116:119], a[240:243]
    v_exp_f32 v91, v91
    v_mfma_f32_16x16x32_bf16 a[244:247], v[248:251], v[124:127], a[244:247]
    v_cvt_pk_bf16_f32 v86, v88, v89
    v_cvt_pk_bf16_f32 v87, v90, v91
    s_waitcnt vmcnt(4)
    s_barrier
    v_mfma_f32_16x16x32_bf16 a[248:251], v[248:251], v[132:135], a[248:251]
    v_mfma_f32_16x16x32_bf16 a[252:255], v[248:251], v[140:143], a[252:255]
    v_exp_f32 v92, v92
    s_waitcnt lgkmcnt(1)
    v_mfma_f32_16x16x32_bf16 v[116:119], v[44:47], a[160:163], v[24:27]
    ds_read_b128 v[52:55], v6 offset:40960
    ds_read_b128 v[56:59], v7 offset:40960
    v_mfma_f32_16x16x32_bf16 v[124:127], v[44:47], a[176:179], v[28:31]
    v_exp_f32 v93, v93
    v_mfma_f32_16x16x32_bf16 v[132:135], v[44:47], a[192:195], v[32:35]
    v_exp_f32 v94, v94
    v_mfma_f32_16x16x32_bf16 v[140:143], v[44:47], a[208:211], v[36:39]
    s_waitcnt lgkmcnt(2)
    v_mfma_f32_16x16x32_bf16 v[116:119], v[48:51], a[164:167], v[116:119]
    v_exp_f32 v95, v95
    v_mfma_f32_16x16x32_bf16 v[124:127], v[48:51], a[180:183], v[124:127]
    v_exp_f32 v96, v96
    v_mfma_f32_16x16x32_bf16 v[132:135], v[48:51], a[196:199], v[132:135]
    v_cvt_pk_bf16_f32 v92, v92, v93
    v_cvt_pk_bf16_f32 v93, v94, v95
    v_mfma_f32_16x16x32_bf16 v[140:143], v[48:51], a[212:215], v[140:143]
    s_waitcnt lgkmcnt(1)
    v_mfma_f32_16x16x32_bf16 v[116:119], v[52:55], a[168:171], v[116:119]
    ds_read_b128 v[60:63], v4 offset:45056
    ds_read_b128 v[64:67], v5 offset:45056
    v_mfma_f32_16x16x32_bf16 v[124:127], v[52:55], a[184:187], v[124:127]
    v_exp_f32 v97, v97
    v_mfma_f32_16x16x32_bf16 v[132:135], v[52:55], a[200:203], v[132:135]
    v_exp_f32 v98, v98
    v_mfma_f32_16x16x32_bf16 v[140:143], v[52:55], a[216:219], v[140:143]
    v_exp_f32 v99, v99
    s_waitcnt lgkmcnt(2)
    v_mfma_f32_16x16x32_bf16 v[116:119], v[56:59], a[172:175], v[116:119]
    v_mfma_f32_16x16x32_bf16 v[124:127], v[56:59], a[188:191], v[124:127]
    v_cvt_pk_bf16_f32 v94, v96, v97
    v_cvt_pk_bf16_f32 v95, v98, v99
    v_mfma_f32_16x16x32_bf16 v[132:135], v[56:59], a[204:207], v[132:135]
    v_exp_f32 v100, v100
    v_mfma_f32_16x16x32_bf16 v[140:143], v[56:59], a[220:223], v[140:143]
    v_exp_f32 v101, v101
    s_waitcnt lgkmcnt(1)
    v_mfma_f32_16x16x32_bf16 v[120:123], v[60:63], a[160:163], v[24:27]
    ds_read_b128 v[68:71], v6 offset:45056
    ds_read_b128 v[72:75], v7 offset:45056
    v_mfma_f32_16x16x32_bf16 v[128:131], v[60:63], a[176:179], v[28:31]
    v_mfma_f32_16x16x32_bf16 v[136:139], v[60:63], a[192:195], v[32:35]
    v_exp_f32 v102, v102
    v_mfma_f32_16x16x32_bf16 v[144:147], v[60:63], a[208:211], v[36:39]
    v_exp_f32 v103, v103
    s_waitcnt lgkmcnt(2)
    v_mfma_f32_16x16x32_bf16 v[120:123], v[64:67], a[164:167], v[120:123]
    v_exp_f32 v104, v104
    v_mfma_f32_16x16x32_bf16 v[128:131], v[64:67], a[180:183], v[128:131]
    v_mfma_f32_16x16x32_bf16 v[136:139], v[64:67], a[196:199], v[136:139]
    v_cvt_pk_bf16_f32 v100, v100, v101
    v_cvt_pk_bf16_f32 v101, v102, v103
    v_mfma_f32_16x16x32_bf16 v[144:147], v[64:67], a[212:215], v[144:147]
    v_exp_f32 v105, v105
    s_waitcnt lgkmcnt(1)
    v_mfma_f32_16x16x32_bf16 v[120:123], v[68:71], a[168:171], v[120:123]
    ds_read_b64_tr_b16 v[44:45], v8 offset:32768
    ds_read_b64_tr_b16 v[46:47], v8 offset:36864
    v_mfma_f32_16x16x32_bf16 v[128:131], v[68:71], a[184:187], v[128:131]
    v_exp_f32 v106, v106
    v_mfma_f32_16x16x32_bf16 v[136:139], v[68:71], a[200:203], v[136:139]
    v_mfma_f32_16x16x32_bf16 v[144:147], v[68:71], a[216:219], v[144:147]
    v_exp_f32 v107, v107
    s_waitcnt lgkmcnt(2)
    v_mfma_f32_16x16x32_bf16 v[120:123], v[72:75], a[172:175], v[120:123]
    ds_read_b64_tr_b16 v[48:49], v9 offset:32768
    ds_read_b64_tr_b16 v[50:51], v9 offset:36864
    v_mfma_f32_16x16x32_bf16 v[128:131], v[72:75], a[188:191], v[128:131]
    v_cvt_pk_bf16_f32 v102, v104, v105
    v_cvt_pk_bf16_f32 v103, v106, v107
    v_mfma_f32_16x16x32_bf16 v[136:139], v[72:75], a[204:207], v[136:139]
    v_mfma_f32_16x16x32_bf16 v[144:147], v[72:75], a[220:223], v[144:147]
    s_waitcnt lgkmcnt(2)
    v_mfma_f32_16x16x32_bf16 a[0:3], v[44:47], v[76:79], a[0:3]
    ds_read_b64_tr_b16 v[52:53], v10 offset:32768
    ds_read_b64_tr_b16 v[54:55], v10 offset:36864
    v_mfma_f32_16x16x32_bf16 a[32:35], v[44:47], v[84:87], a[32:35]
    v_mfma_f32_16x16x32_bf16 a[64:67], v[44:47], v[92:95], a[64:67]
    v_exp_f32 v116, v116
    v_mfma_f32_16x16x32_bf16 a[96:99], v[44:47], v[100:103], a[96:99]
    v_exp_f32 v117, v117
    s_waitcnt lgkmcnt(2)
    v_mfma_f32_16x16x32_bf16 a[4:7], v[48:51], v[76:79], a[4:7]
    ds_read_b64_tr_b16 v[56:57], v11 offset:32768
    ds_read_b64_tr_b16 v[58:59], v11 offset:36864
    v_mfma_f32_16x16x32_bf16 a[36:39], v[48:51], v[84:87], a[36:39]
    v_exp_f32 v118, v118
    v_mfma_f32_16x16x32_bf16 a[68:71], v[48:51], v[92:95], a[68:71]
    v_mfma_f32_16x16x32_bf16 a[100:103], v[48:51], v[100:103], a[100:103]
    v_exp_f32 v119, v119
    s_waitcnt lgkmcnt(2)
    v_mfma_f32_16x16x32_bf16 a[8:11], v[52:55], v[76:79], a[8:11]
    ds_read_b64_tr_b16 v[60:61], v12 offset:32768
    ds_read_b64_tr_b16 v[62:63], v12 offset:36864
    v_mfma_f32_16x16x32_bf16 a[40:43], v[52:55], v[84:87], a[40:43]
    v_exp_f32 v120, v120
    v_mfma_f32_16x16x32_bf16 a[72:75], v[52:55], v[92:95], a[72:75]
    v_cvt_pk_bf16_f32 v116, v116, v117
    v_cvt_pk_bf16_f32 v117, v118, v119
    v_mfma_f32_16x16x32_bf16 a[104:107], v[52:55], v[100:103], a[104:107]
    s_waitcnt lgkmcnt(2)
    v_mfma_f32_16x16x32_bf16 a[12:15], v[56:59], v[76:79], a[12:15]
    ds_read_b64_tr_b16 v[64:65], v13 offset:32768
    ds_read_b64_tr_b16 v[66:67], v13 offset:36864
    v_mfma_f32_16x16x32_bf16 a[44:47], v[56:59], v[84:87], a[44:47]
    v_exp_f32 v121, v121
    v_mfma_f32_16x16x32_bf16 a[76:79], v[56:59], v[92:95], a[76:79]
    v_exp_f32 v122, v122
    v_mfma_f32_16x16x32_bf16 a[108:111], v[56:59], v[100:103], a[108:111]
    v_exp_f32 v123, v123
    s_waitcnt lgkmcnt(2)
    v_mfma_f32_16x16x32_bf16 a[16:19], v[60:63], v[76:79], a[16:19]
    ds_read_b64_tr_b16 v[68:69], v14 offset:32768
    ds_read_b64_tr_b16 v[70:71], v14 offset:36864
    v_mfma_f32_16x16x32_bf16 a[48:51], v[60:63], v[84:87], a[48:51]
    v_mfma_f32_16x16x32_bf16 a[80:83], v[60:63], v[92:95], a[80:83]
    v_cvt_pk_bf16_f32 v118, v120, v121
    v_cvt_pk_bf16_f32 v119, v122, v123
    v_mfma_f32_16x16x32_bf16 a[112:115], v[60:63], v[100:103], a[112:115]
    v_exp_f32 v124, v124
    s_waitcnt lgkmcnt(2)
    v_mfma_f32_16x16x32_bf16 a[20:23], v[64:67], v[76:79], a[20:23]
    ds_read_b64_tr_b16 v[72:73], v15 offset:32768
    ds_read_b64_tr_b16 v[74:75], v15 offset:36864
    v_mfma_f32_16x16x32_bf16 a[52:55], v[64:67], v[84:87], a[52:55]
    v_exp_f32 v125, v125
    v_mfma_f32_16x16x32_bf16 a[84:87], v[64:67], v[92:95], a[84:87]
    v_mfma_f32_16x16x32_bf16 a[116:119], v[64:67], v[100:103], a[116:119]
    v_exp_f32 v126, v126
    s_waitcnt lgkmcnt(2)
    v_mfma_f32_16x16x32_bf16 a[24:27], v[68:71], v[76:79], a[24:27]
    ds_read_b128 v[44:47], v4 offset:49152
    ds_read_b128 v[48:51], v5 offset:49152
    v_mfma_f32_16x16x32_bf16 a[56:59], v[68:71], v[84:87], a[56:59]
    v_exp_f32 v127, v127
    v_mfma_f32_16x16x32_bf16 a[88:91], v[68:71], v[92:95], a[88:91]
    v_exp_f32 v128, v128
    v_mfma_f32_16x16x32_bf16 a[120:123], v[68:71], v[100:103], a[120:123]
    s_waitcnt lgkmcnt(2)
    v_mfma_f32_16x16x32_bf16 a[28:31], v[72:75], v[76:79], a[28:31]
    v_cvt_pk_bf16_f32 v124, v124, v125
    v_cvt_pk_bf16_f32 v125, v126, v127
    v_mfma_f32_16x16x32_bf16 a[60:63], v[72:75], v[84:87], a[60:63]
    v_exp_f32 v129, v129
    v_mfma_f32_16x16x32_bf16 a[92:95], v[72:75], v[92:95], a[92:95]
    v_exp_f32 v130, v130
    v_mfma_f32_16x16x32_bf16 a[124:127], v[72:75], v[100:103], a[124:127]
    v_mfma_f32_16x16x32_bf16 a[240:243], v[248:251], v[76:79], a[240:243]
    v_exp_f32 v131, v131
    v_mfma_f32_16x16x32_bf16 a[244:247], v[248:251], v[84:87], a[244:247]
    v_cvt_pk_bf16_f32 v126, v128, v129
    v_cvt_pk_bf16_f32 v127, v130, v131
    s_waitcnt vmcnt(0)
    s_barrier
    v_mfma_f32_16x16x32_bf16 a[248:251], v[248:251], v[92:95], a[248:251]
    v_mfma_f32_16x16x32_bf16 a[252:255], v[248:251], v[100:103], a[252:255]
    v_exp_f32 v132, v132
    s_waitcnt lgkmcnt(1)
    v_mfma_f32_16x16x32_bf16 v[76:79], v[44:47], a[160:163], v[24:27]
    ds_read_b128 v[52:55], v6 offset:49152
    ds_read_b128 v[56:59], v7 offset:49152
    v_mfma_f32_16x16x32_bf16 v[84:87], v[44:47], a[176:179], v[28:31]
    v_exp_f32 v133, v133
    v_mfma_f32_16x16x32_bf16 v[92:95], v[44:47], a[192:195], v[32:35]
    v_exp_f32 v134, v134
    v_mfma_f32_16x16x32_bf16 v[100:103], v[44:47], a[208:211], v[36:39]
    s_waitcnt lgkmcnt(2)
    v_mfma_f32_16x16x32_bf16 v[76:79], v[48:51], a[164:167], v[76:79]
    v_exp_f32 v135, v135
    v_mfma_f32_16x16x32_bf16 v[84:87], v[48:51], a[180:183], v[84:87]
    v_exp_f32 v136, v136
    v_mfma_f32_16x16x32_bf16 v[92:95], v[48:51], a[196:199], v[92:95]
    v_cvt_pk_bf16_f32 v132, v132, v133
    v_cvt_pk_bf16_f32 v133, v134, v135
    v_mfma_f32_16x16x32_bf16 v[100:103], v[48:51], a[212:215], v[100:103]
    s_waitcnt lgkmcnt(1)
    v_mfma_f32_16x16x32_bf16 v[76:79], v[52:55], a[168:171], v[76:79]
    ds_read_b128 v[60:63], v4 offset:53248
    ds_read_b128 v[64:67], v5 offset:53248
    v_mfma_f32_16x16x32_bf16 v[84:87], v[52:55], a[184:187], v[84:87]
    v_exp_f32 v137, v137
    v_mfma_f32_16x16x32_bf16 v[92:95], v[52:55], a[200:203], v[92:95]
    v_exp_f32 v138, v138
    v_mfma_f32_16x16x32_bf16 v[100:103], v[52:55], a[216:219], v[100:103]
    v_exp_f32 v139, v139
    s_waitcnt lgkmcnt(2)
    v_mfma_f32_16x16x32_bf16 v[76:79], v[56:59], a[172:175], v[76:79]
    v_mfma_f32_16x16x32_bf16 v[84:87], v[56:59], a[188:191], v[84:87]
    v_cvt_pk_bf16_f32 v134, v136, v137
    v_cvt_pk_bf16_f32 v135, v138, v139
    v_mfma_f32_16x16x32_bf16 v[92:95], v[56:59], a[204:207], v[92:95]
    v_exp_f32 v140, v140
    v_mfma_f32_16x16x32_bf16 v[100:103], v[56:59], a[220:223], v[100:103]
    v_exp_f32 v141, v141
    s_waitcnt lgkmcnt(1)
    v_mfma_f32_16x16x32_bf16 v[80:83], v[60:63], a[160:163], v[24:27]
    ds_read_b128 v[68:71], v6 offset:53248
    ds_read_b128 v[72:75], v7 offset:53248
    v_mfma_f32_16x16x32_bf16 v[88:91], v[60:63], a[176:179], v[28:31]
    v_mfma_f32_16x16x32_bf16 v[96:99], v[60:63], a[192:195], v[32:35]
    v_exp_f32 v142, v142
    v_mfma_f32_16x16x32_bf16 v[104:107], v[60:63], a[208:211], v[36:39]
    v_exp_f32 v143, v143
    s_waitcnt lgkmcnt(2)
    v_mfma_f32_16x16x32_bf16 v[80:83], v[64:67], a[164:167], v[80:83]
    v_exp_f32 v144, v144
    v_mfma_f32_16x16x32_bf16 v[88:91], v[64:67], a[180:183], v[88:91]
    v_mfma_f32_16x16x32_bf16 v[96:99], v[64:67], a[196:199], v[96:99]
    v_cvt_pk_bf16_f32 v140, v140, v141
    v_cvt_pk_bf16_f32 v141, v142, v143
    v_mfma_f32_16x16x32_bf16 v[104:107], v[64:67], a[212:215], v[104:107]
    v_exp_f32 v145, v145
    s_waitcnt lgkmcnt(1)
    v_mfma_f32_16x16x32_bf16 v[80:83], v[68:71], a[168:171], v[80:83]
    ds_read_b64_tr_b16 v[44:45], v8 offset:40960
    ds_read_b64_tr_b16 v[46:47], v8 offset:45056
    v_mfma_f32_16x16x32_bf16 v[88:91], v[68:71], a[184:187], v[88:91]
    v_exp_f32 v146, v146
    v_mfma_f32_16x16x32_bf16 v[96:99], v[68:71], a[200:203], v[96:99]
    v_mfma_f32_16x16x32_bf16 v[104:107], v[68:71], a[216:219], v[104:107]
    v_exp_f32 v147, v147
    s_waitcnt lgkmcnt(2)
    v_mfma_f32_16x16x32_bf16 v[80:83], v[72:75], a[172:175], v[80:83]
    ds_read_b64_tr_b16 v[48:49], v9 offset:40960
    ds_read_b64_tr_b16 v[50:51], v9 offset:45056
    v_mfma_f32_16x16x32_bf16 v[88:91], v[72:75], a[188:191], v[88:91]
    v_cvt_pk_bf16_f32 v142, v144, v145
    v_cvt_pk_bf16_f32 v143, v146, v147
    v_mfma_f32_16x16x32_bf16 v[96:99], v[72:75], a[204:207], v[96:99]
    v_mfma_f32_16x16x32_bf16 v[104:107], v[72:75], a[220:223], v[104:107]
    s_waitcnt lgkmcnt(2)
    v_mfma_f32_16x16x32_bf16 a[0:3], v[44:47], v[116:119], a[0:3]
    ds_read_b64_tr_b16 v[52:53], v10 offset:40960
    ds_read_b64_tr_b16 v[54:55], v10 offset:45056
    v_mfma_f32_16x16x32_bf16 a[32:35], v[44:47], v[124:127], a[32:35]
    v_mfma_f32_16x16x32_bf16 a[64:67], v[44:47], v[132:135], a[64:67]
    v_exp_f32 v76, v76
    v_mfma_f32_16x16x32_bf16 a[96:99], v[44:47], v[140:143], a[96:99]
    v_exp_f32 v77, v77
    s_waitcnt lgkmcnt(2)
    v_mfma_f32_16x16x32_bf16 a[4:7], v[48:51], v[116:119], a[4:7]
    ds_read_b64_tr_b16 v[56:57], v11 offset:40960
    ds_read_b64_tr_b16 v[58:59], v11 offset:45056
    v_mfma_f32_16x16x32_bf16 a[36:39], v[48:51], v[124:127], a[36:39]
    v_exp_f32 v78, v78
    v_mfma_f32_16x16x32_bf16 a[68:71], v[48:51], v[132:135], a[68:71]
    v_mfma_f32_16x16x32_bf16 a[100:103], v[48:51], v[140:143], a[100:103]
    v_exp_f32 v79, v79
    s_waitcnt lgkmcnt(2)
    v_mfma_f32_16x16x32_bf16 a[8:11], v[52:55], v[116:119], a[8:11]
    ds_read_b64_tr_b16 v[60:61], v12 offset:40960
    ds_read_b64_tr_b16 v[62:63], v12 offset:45056
    v_mfma_f32_16x16x32_bf16 a[40:43], v[52:55], v[124:127], a[40:43]
    v_exp_f32 v80, v80
    v_mfma_f32_16x16x32_bf16 a[72:75], v[52:55], v[132:135], a[72:75]
    v_cvt_pk_bf16_f32 v76, v76, v77
    v_cvt_pk_bf16_f32 v77, v78, v79
    v_mfma_f32_16x16x32_bf16 a[104:107], v[52:55], v[140:143], a[104:107]
    s_waitcnt lgkmcnt(2)
    v_mfma_f32_16x16x32_bf16 a[12:15], v[56:59], v[116:119], a[12:15]
    ds_read_b64_tr_b16 v[64:65], v13 offset:40960
    ds_read_b64_tr_b16 v[66:67], v13 offset:45056
    v_mfma_f32_16x16x32_bf16 a[44:47], v[56:59], v[124:127], a[44:47]
    v_exp_f32 v81, v81
    v_mfma_f32_16x16x32_bf16 a[76:79], v[56:59], v[132:135], a[76:79]
    v_exp_f32 v82, v82
    v_mfma_f32_16x16x32_bf16 a[108:111], v[56:59], v[140:143], a[108:111]
    v_exp_f32 v83, v83
    s_waitcnt lgkmcnt(2)
    v_mfma_f32_16x16x32_bf16 a[16:19], v[60:63], v[116:119], a[16:19]
    ds_read_b64_tr_b16 v[68:69], v14 offset:40960
    ds_read_b64_tr_b16 v[70:71], v14 offset:45056
    v_mfma_f32_16x16x32_bf16 a[48:51], v[60:63], v[124:127], a[48:51]
    v_mfma_f32_16x16x32_bf16 a[80:83], v[60:63], v[132:135], a[80:83]
    v_cvt_pk_bf16_f32 v78, v80, v81
    v_cvt_pk_bf16_f32 v79, v82, v83
    v_mfma_f32_16x16x32_bf16 a[112:115], v[60:63], v[140:143], a[112:115]
    v_exp_f32 v84, v84
    s_waitcnt lgkmcnt(2)
    v_mfma_f32_16x16x32_bf16 a[20:23], v[64:67], v[116:119], a[20:23]
    ds_read_b64_tr_b16 v[72:73], v15 offset:40960
    ds_read_b64_tr_b16 v[74:75], v15 offset:45056
    v_mfma_f32_16x16x32_bf16 a[52:55], v[64:67], v[124:127], a[52:55]
    v_exp_f32 v85, v85
    s_nop 1
    v_mfma_f32_16x16x32_bf16 a[84:87], v[64:67], v[132:135], a[84:87]
    v_mfma_f32_16x16x32_bf16 a[116:119], v[64:67], v[140:143], a[116:119]
    v_exp_f32 v86, v86
    s_waitcnt lgkmcnt(2)
    v_mfma_f32_16x16x32_bf16 a[24:27], v[68:71], v[116:119], a[24:27]
    ds_read_b128 v[44:47], v4 offset:57344
    ds_read_b128 v[48:51], v5 offset:57344
    v_mfma_f32_16x16x32_bf16 a[56:59], v[68:71], v[124:127], a[56:59]
    v_exp_f32 v87, v87
    v_mfma_f32_16x16x32_bf16 a[88:91], v[68:71], v[132:135], a[88:91]
    v_exp_f32 v88, v88
    v_mfma_f32_16x16x32_bf16 a[120:123], v[68:71], v[140:143], a[120:123]
    s_waitcnt lgkmcnt(2)
    v_mfma_f32_16x16x32_bf16 a[28:31], v[72:75], v[116:119], a[28:31]
    v_cvt_pk_bf16_f32 v84, v84, v85
    v_cvt_pk_bf16_f32 v85, v86, v87
    v_mfma_f32_16x16x32_bf16 a[60:63], v[72:75], v[124:127], a[60:63]
    v_exp_f32 v89, v89
    v_mfma_f32_16x16x32_bf16 a[92:95], v[72:75], v[132:135], a[92:95]
    v_exp_f32 v90, v90
    v_mfma_f32_16x16x32_bf16 a[124:127], v[72:75], v[140:143], a[124:127]
    v_mfma_f32_16x16x32_bf16 a[240:243], v[248:251], v[116:119], a[240:243]
    v_exp_f32 v91, v91
    v_mfma_f32_16x16x32_bf16 a[244:247], v[248:251], v[124:127], a[244:247]
    v_cvt_pk_bf16_f32 v86, v88, v89
    v_cvt_pk_bf16_f32 v87, v90, v91
    s_barrier
    v_mfma_f32_16x16x32_bf16 a[248:251], v[248:251], v[132:135], a[248:251]
    v_mfma_f32_16x16x32_bf16 a[252:255], v[248:251], v[140:143], a[252:255]
    v_exp_f32 v92, v92
    s_waitcnt lgkmcnt(1)
    v_mfma_f32_16x16x32_bf16 v[116:119], v[44:47], a[160:163], v[24:27]
    ds_read_b128 v[52:55], v6 offset:57344
    ds_read_b128 v[56:59], v7 offset:57344
    v_mfma_f32_16x16x32_bf16 v[124:127], v[44:47], a[176:179], v[28:31]
    v_exp_f32 v93, v93
    v_mfma_f32_16x16x32_bf16 v[132:135], v[44:47], a[192:195], v[32:35]
    v_exp_f32 v94, v94
    v_mfma_f32_16x16x32_bf16 v[140:143], v[44:47], a[208:211], v[36:39]
    s_waitcnt lgkmcnt(2)
    v_mfma_f32_16x16x32_bf16 v[116:119], v[48:51], a[164:167], v[116:119]
    v_exp_f32 v95, v95
    v_mfma_f32_16x16x32_bf16 v[124:127], v[48:51], a[180:183], v[124:127]
    v_exp_f32 v96, v96
    v_mfma_f32_16x16x32_bf16 v[132:135], v[48:51], a[196:199], v[132:135]
    v_cvt_pk_bf16_f32 v92, v92, v93
    v_cvt_pk_bf16_f32 v93, v94, v95
    v_mfma_f32_16x16x32_bf16 v[140:143], v[48:51], a[212:215], v[140:143]
    s_waitcnt lgkmcnt(1)
    v_mfma_f32_16x16x32_bf16 v[116:119], v[52:55], a[168:171], v[116:119]
    ds_read_b128 v[60:63], v4 offset:61440
    ds_read_b128 v[64:67], v5 offset:61440
    v_mfma_f32_16x16x32_bf16 v[124:127], v[52:55], a[184:187], v[124:127]
    v_exp_f32 v97, v97
    v_mfma_f32_16x16x32_bf16 v[132:135], v[52:55], a[200:203], v[132:135]
    v_exp_f32 v98, v98
    v_mfma_f32_16x16x32_bf16 v[140:143], v[52:55], a[216:219], v[140:143]
    v_exp_f32 v99, v99
    s_waitcnt lgkmcnt(2)
    v_mfma_f32_16x16x32_bf16 v[116:119], v[56:59], a[172:175], v[116:119]
    v_mfma_f32_16x16x32_bf16 v[124:127], v[56:59], a[188:191], v[124:127]
    v_cvt_pk_bf16_f32 v94, v96, v97
    v_cvt_pk_bf16_f32 v95, v98, v99
    v_mfma_f32_16x16x32_bf16 v[132:135], v[56:59], a[204:207], v[132:135]
    v_exp_f32 v100, v100
    v_mfma_f32_16x16x32_bf16 v[140:143], v[56:59], a[220:223], v[140:143]
    v_exp_f32 v101, v101
    s_waitcnt lgkmcnt(1)
    v_mfma_f32_16x16x32_bf16 v[120:123], v[60:63], a[160:163], v[24:27]
    ds_read_b128 v[68:71], v6 offset:61440
    ds_read_b128 v[72:75], v7 offset:61440
    v_mfma_f32_16x16x32_bf16 v[128:131], v[60:63], a[176:179], v[28:31]
    v_mfma_f32_16x16x32_bf16 v[136:139], v[60:63], a[192:195], v[32:35]
    v_exp_f32 v102, v102
    v_mfma_f32_16x16x32_bf16 v[144:147], v[60:63], a[208:211], v[36:39]
    v_exp_f32 v103, v103
    s_waitcnt lgkmcnt(2)
    v_mfma_f32_16x16x32_bf16 v[120:123], v[64:67], a[164:167], v[120:123]
    v_exp_f32 v104, v104
    v_mfma_f32_16x16x32_bf16 v[128:131], v[64:67], a[180:183], v[128:131]
    v_mfma_f32_16x16x32_bf16 v[136:139], v[64:67], a[196:199], v[136:139]
    v_cvt_pk_bf16_f32 v100, v100, v101
    v_cvt_pk_bf16_f32 v101, v102, v103
    v_mfma_f32_16x16x32_bf16 v[144:147], v[64:67], a[212:215], v[144:147]
    v_exp_f32 v105, v105
    s_waitcnt lgkmcnt(1)
    v_mfma_f32_16x16x32_bf16 v[120:123], v[68:71], a[168:171], v[120:123]
    ds_read_b64_tr_b16 v[44:45], v8 offset:49152
    ds_read_b64_tr_b16 v[46:47], v8 offset:53248
    v_mfma_f32_16x16x32_bf16 v[128:131], v[68:71], a[184:187], v[128:131]
    v_exp_f32 v106, v106
    v_mfma_f32_16x16x32_bf16 v[136:139], v[68:71], a[200:203], v[136:139]
    v_mfma_f32_16x16x32_bf16 v[144:147], v[68:71], a[216:219], v[144:147]
    v_exp_f32 v107, v107
    s_waitcnt lgkmcnt(2)
    v_mfma_f32_16x16x32_bf16 v[120:123], v[72:75], a[172:175], v[120:123]
    ds_read_b64_tr_b16 v[48:49], v9 offset:49152
    ds_read_b64_tr_b16 v[50:51], v9 offset:53248
    v_mfma_f32_16x16x32_bf16 v[128:131], v[72:75], a[188:191], v[128:131]
    v_cvt_pk_bf16_f32 v102, v104, v105
    v_cvt_pk_bf16_f32 v103, v106, v107
    v_mfma_f32_16x16x32_bf16 v[136:139], v[72:75], a[204:207], v[136:139]
    v_mfma_f32_16x16x32_bf16 v[144:147], v[72:75], a[220:223], v[144:147]
    s_waitcnt lgkmcnt(2)
    v_mfma_f32_16x16x32_bf16 a[0:3], v[44:47], v[76:79], a[0:3]
    ds_read_b64_tr_b16 v[52:53], v10 offset:49152
    ds_read_b64_tr_b16 v[54:55], v10 offset:53248
    v_mfma_f32_16x16x32_bf16 a[32:35], v[44:47], v[84:87], a[32:35]
    v_mfma_f32_16x16x32_bf16 a[64:67], v[44:47], v[92:95], a[64:67]
    v_exp_f32 v116, v116
    v_exp_f32 v117, v117
    v_mfma_f32_16x16x32_bf16 a[96:99], v[44:47], v[100:103], a[96:99]
    v_exp_f32 v118, v118
    v_exp_f32 v119, v119
    s_waitcnt lgkmcnt(2)
    v_mfma_f32_16x16x32_bf16 a[4:7], v[48:51], v[76:79], a[4:7]
    ds_read_b64_tr_b16 v[56:57], v11 offset:49152
    ds_read_b64_tr_b16 v[58:59], v11 offset:53248
    v_mfma_f32_16x16x32_bf16 a[36:39], v[48:51], v[84:87], a[36:39]
    v_exp_f32 v120, v120
    v_mfma_f32_16x16x32_bf16 a[68:71], v[48:51], v[92:95], a[68:71]
    v_cvt_pk_bf16_f32 v116, v116, v117
    v_cvt_pk_bf16_f32 v117, v118, v119
    v_exp_f32 v121, v121
    v_mfma_f32_16x16x32_bf16 a[100:103], v[48:51], v[100:103], a[100:103]
    v_exp_f32 v122, v122
    s_waitcnt lgkmcnt(2)
    v_mfma_f32_16x16x32_bf16 a[8:11], v[52:55], v[76:79], a[8:11]
    ds_read_b64_tr_b16 v[60:61], v12 offset:49152
    ds_read_b64_tr_b16 v[62:63], v12 offset:53248
    v_mfma_f32_16x16x32_bf16 a[40:43], v[52:55], v[84:87], a[40:43]
    v_exp_f32 v123, v123
    v_cvt_pk_bf16_f32 v118, v120, v121
    v_cvt_pk_bf16_f32 v119, v122, v123
    v_mfma_f32_16x16x32_bf16 a[72:75], v[52:55], v[92:95], a[72:75]
    v_exp_f32 v124, v124
    v_mfma_f32_16x16x32_bf16 a[104:107], v[52:55], v[100:103], a[104:107]
    v_exp_f32 v125, v125
    v_exp_f32 v126, v126
    s_waitcnt lgkmcnt(2)
    v_mfma_f32_16x16x32_bf16 a[12:15], v[56:59], v[76:79], a[12:15]
    ds_read_b64_tr_b16 v[64:65], v13 offset:49152
    ds_read_b64_tr_b16 v[66:67], v13 offset:53248
    v_mfma_f32_16x16x32_bf16 a[44:47], v[56:59], v[84:87], a[44:47]
    v_exp_f32 v127, v127
    v_mfma_f32_16x16x32_bf16 a[76:79], v[56:59], v[92:95], a[76:79]
    v_exp_f32 v128, v128
    v_cvt_pk_bf16_f32 v124, v124, v125
    v_cvt_pk_bf16_f32 v125, v126, v127
    v_mfma_f32_16x16x32_bf16 a[108:111], v[56:59], v[100:103], a[108:111]
    v_exp_f32 v129, v129
    s_waitcnt lgkmcnt(2)
    v_mfma_f32_16x16x32_bf16 a[16:19], v[60:63], v[76:79], a[16:19]
    ds_read_b64_tr_b16 v[68:69], v14 offset:49152
    ds_read_b64_tr_b16 v[70:71], v14 offset:53248
    v_mfma_f32_16x16x32_bf16 a[48:51], v[60:63], v[84:87], a[48:51]
    v_exp_f32 v130, v130
    v_exp_f32 v131, v131
    v_mfma_f32_16x16x32_bf16 a[80:83], v[60:63], v[92:95], a[80:83]
    v_cvt_pk_bf16_f32 v126, v128, v129
    v_cvt_pk_bf16_f32 v127, v130, v131
    v_mfma_f32_16x16x32_bf16 a[112:115], v[60:63], v[100:103], a[112:115]
    v_exp_f32 v132, v132
    v_exp_f32 v133, v133
    s_waitcnt lgkmcnt(2)
    v_mfma_f32_16x16x32_bf16 a[20:23], v[64:67], v[76:79], a[20:23]
    ds_read_b64_tr_b16 v[72:73], v15 offset:49152
    ds_read_b64_tr_b16 v[74:75], v15 offset:53248
    v_mfma_f32_16x16x32_bf16 a[52:55], v[64:67], v[84:87], a[52:55]
    v_exp_f32 v134, v134
    v_exp_f32 v135, v135
    v_mfma_f32_16x16x32_bf16 a[84:87], v[64:67], v[92:95], a[84:87]
    v_exp_f32 v136, v136
    v_mfma_f32_16x16x32_bf16 a[116:119], v[64:67], v[100:103], a[116:119]
    v_cvt_pk_bf16_f32 v132, v132, v133
    v_cvt_pk_bf16_f32 v133, v134, v135
    v_exp_f32 v137, v137
    s_waitcnt lgkmcnt(2)
    v_mfma_f32_16x16x32_bf16 a[24:27], v[68:71], v[76:79], a[24:27]
    ds_read_b64_tr_b16 v[44:45], v8 offset:57344
    ds_read_b64_tr_b16 v[46:47], v8 offset:61440
    v_mfma_f32_16x16x32_bf16 a[56:59], v[68:71], v[84:87], a[56:59]
    v_exp_f32 v138, v138
    v_mfma_f32_16x16x32_bf16 a[88:91], v[68:71], v[92:95], a[88:91]
    v_exp_f32 v139, v139
    v_cvt_pk_bf16_f32 v134, v136, v137
    v_cvt_pk_bf16_f32 v135, v138, v139
    v_mfma_f32_16x16x32_bf16 a[120:123], v[68:71], v[100:103], a[120:123]
    v_exp_f32 v140, v140
    s_waitcnt lgkmcnt(2)
    v_mfma_f32_16x16x32_bf16 a[28:31], v[72:75], v[76:79], a[28:31]
    ds_read_b64_tr_b16 v[48:49], v9 offset:57344
    ds_read_b64_tr_b16 v[50:51], v9 offset:61440
    v_mfma_f32_16x16x32_bf16 a[60:63], v[72:75], v[84:87], a[60:63]
    v_exp_f32 v141, v141
    v_exp_f32 v142, v142
    v_mfma_f32_16x16x32_bf16 a[92:95], v[72:75], v[92:95], a[92:95]
    v_exp_f32 v143, v143
    v_mfma_f32_16x16x32_bf16 a[124:127], v[72:75], v[100:103], a[124:127]
    v_exp_f32 v144, v144
    v_cvt_pk_bf16_f32 v140, v140, v141
    v_cvt_pk_bf16_f32 v141, v142, v143
    v_mfma_f32_16x16x32_bf16 a[240:243], v[248:251], v[76:79], a[240:243]
    v_exp_f32 v145, v145
    v_mfma_f32_16x16x32_bf16 a[244:247], v[248:251], v[84:87], a[244:247]
    v_exp_f32 v146, v146
    v_exp_f32 v147, v147
    v_mfma_f32_16x16x32_bf16 a[248:251], v[248:251], v[92:95], a[248:251]
    v_cvt_pk_bf16_f32 v142, v144, v145
    v_cvt_pk_bf16_f32 v143, v146, v147
    v_mfma_f32_16x16x32_bf16 a[252:255], v[248:251], v[100:103], a[252:255]
    s_nop 1
    v_mfma_f32_16x16x32_bf16 a[240:243], v[248:251], v[116:119], a[240:243]
    v_mfma_f32_16x16x32_bf16 a[244:247], v[248:251], v[124:127], a[244:247]
    v_mfma_f32_16x16x32_bf16 a[248:251], v[248:251], v[132:135], a[248:251]
    v_mfma_f32_16x16x32_bf16 a[252:255], v[248:251], v[140:143], a[252:255]
    s_nop 7
    v_accvgpr_read_b32 v236, a240
    v_accvgpr_read_b32 v237, a244
    v_accvgpr_read_b32 v238, a248
    v_accvgpr_read_b32 v239, a252
    v_cmp_nge_f32 s[42:43], s40, v236
    v_cmp_nge_f32 s[48:49], s40, v237
    s_nop 1
    s_or_b64 s[42:43], s[42:43], s[48:49]
    v_cmp_nge_f32 s[48:49], s40, v238
    s_nop 1
    s_or_b64 s[42:43], s[42:43], s[48:49]
    v_cmp_nge_f32 s[48:49], s40, v239
    s_nop 1
    s_or_b64 s[42:43], s[42:43], s[48:49]
    s_nop 1
    s_cmp_lg_u64 s[42:43], 0
    s_cselect_b32 s38, 1, 0
    v_mov_b32 v246, s38
    ds_write_b32 v18, v246
    s_waitcnt lgkmcnt(0)
    s_barrier
    ds_read_b128 v[240:243], v19
    s_waitcnt lgkmcnt(0)
    v_or3_b32 v240, v240, v241, v242
    v_or_b32 v240, v240, v243
    s_nop 0
    v_readfirstlane_b32 s38, v240
    s_nop 1
    s_cmp_lg_u32 s38, 0
    s_cbranch_scc1 L_c4_fallback
    s_waitcnt lgkmcnt(2)
    v_mfma_f32_16x16x32_bf16 a[0:3], v[44:47], v[116:119], a[0:3]
    ds_read_b64_tr_b16 v[52:53], v10 offset:57344
    ds_read_b64_tr_b16 v[54:55], v10 offset:61440
    v_mfma_f32_16x16x32_bf16 a[32:35], v[44:47], v[124:127], a[32:35]
    v_mfma_f32_16x16x32_bf16 a[64:67], v[44:47], v[132:135], a[64:67]
    v_mfma_f32_16x16x32_bf16 a[96:99], v[44:47], v[140:143], a[96:99]
    s_waitcnt lgkmcnt(2)
    v_mfma_f32_16x16x32_bf16 a[4:7], v[48:51], v[116:119], a[4:7]
    ds_read_b64_tr_b16 v[56:57], v11 offset:57344
    ds_read_b64_tr_b16 v[58:59], v11 offset:61440
    v_mfma_f32_16x16x32_bf16 a[36:39], v[48:51], v[124:127], a[36:39]
    v_mfma_f32_16x16x32_bf16 a[68:71], v[48:51], v[132:135], a[68:71]
    v_mfma_f32_16x16x32_bf16 a[100:103], v[48:51], v[140:143], a[100:103]
    s_waitcnt lgkmcnt(2)
    v_mfma_f32_16x16x32_bf16 a[8:11], v[52:55], v[116:119], a[8:11]
    ds_read_b64_tr_b16 v[60:61], v12 offset:57344
    ds_read_b64_tr_b16 v[62:63], v12 offset:61440
    v_mfma_f32_16x16x32_bf16 a[40:43], v[52:55], v[124:127], a[40:43]
    v_mfma_f32_16x16x32_bf16 a[72:75], v[52:55], v[132:135], a[72:75]
    v_mfma_f32_16x16x32_bf16 a[104:107], v[52:55], v[140:143], a[104:107]
    s_waitcnt lgkmcnt(2)
    v_mfma_f32_16x16x32_bf16 a[12:15], v[56:59], v[116:119], a[12:15]
    ds_read_b64_tr_b16 v[64:65], v13 offset:57344
    ds_read_b64_tr_b16 v[66:67], v13 offset:61440
    v_mfma_f32_16x16x32_bf16 a[44:47], v[56:59], v[124:127], a[44:47]
    v_mfma_f32_16x16x32_bf16 a[76:79], v[56:59], v[132:135], a[76:79]
    v_mfma_f32_16x16x32_bf16 a[108:111], v[56:59], v[140:143], a[108:111]
    s_waitcnt lgkmcnt(2)
    v_mfma_f32_16x16x32_bf16 a[16:19], v[60:63], v[116:119], a[16:19]
    ds_read_b64_tr_b16 v[68:69], v14 offset:57344
    ds_read_b64_tr_b16 v[70:71], v14 offset:61440
    v_mfma_f32_16x16x32_bf16 a[48:51], v[60:63], v[124:127], a[48:51]
    v_mfma_f32_16x16x32_bf16 a[80:83], v[60:63], v[132:135], a[80:83]
    v_mfma_f32_16x16x32_bf16 a[112:115], v[60:63], v[140:143], a[112:115]
    s_waitcnt lgkmcnt(2)
    v_mfma_f32_16x16x32_bf16 a[20:23], v[64:67], v[116:119], a[20:23]
    ds_read_b64_tr_b16 v[72:73], v15 offset:57344
    ds_read_b64_tr_b16 v[74:75], v15 offset:61440
    v_mfma_f32_16x16x32_bf16 a[52:55], v[64:67], v[124:127], a[52:55]
    v_mfma_f32_16x16x32_bf16 a[84:87], v[64:67], v[132:135], a[84:87]
    v_mfma_f32_16x16x32_bf16 a[116:119], v[64:67], v[140:143], a[116:119]
    s_waitcnt lgkmcnt(2)
    v_mfma_f32_16x16x32_bf16 a[24:27], v[68:71], v[116:119], a[24:27]
    v_mfma_f32_16x16x32_bf16 a[56:59], v[68:71], v[124:127], a[56:59]
    v_mfma_f32_16x16x32_bf16 a[88:91], v[68:71], v[132:135], a[88:91]
    v_mfma_f32_16x16x32_bf16 a[120:123], v[68:71], v[140:143], a[120:123]
    s_waitcnt lgkmcnt(0)
    v_mfma_f32_16x16x32_bf16 a[28:31], v[72:75], v[116:119], a[28:31]
    v_mfma_f32_16x16x32_bf16 a[60:63], v[72:75], v[124:127], a[60:63]
    v_mfma_f32_16x16x32_bf16 a[92:95], v[72:75], v[132:135], a[92:95]
    v_mfma_f32_16x16x32_bf16 a[124:127], v[72:75], v[140:143], a[124:127]
L_c4_fin:
    s_nop 7
    v_accvgpr_read_b32 v221, a240
    v_accvgpr_read_b32 v223, a244
    v_accvgpr_read_b32 v225, a248
    v_accvgpr_read_b32 v227, a252
    v_rcp_f32 v220, v221
    v_rcp_f32 v222, v223
    v_rcp_f32 v224, v225
    v_rcp_f32 v226, v227
    s_nop 0
    v_mov_b32 v221, v220
    v_mov_b32 v223, v222
    v_mov_b32 v225, v224
    v_mov_b32 v227, v226
    s_nop 0
    s_add_u32 s38, s32, 0
    v_accvgpr_read_b32 v156, a0
    v_accvgpr_read_b32 v157, a1
    v_accvgpr_read_b32 v158, a2
    v_accvgpr_read_b32 v159, a3
    v_accvgpr_read_b32 v160, a4
    v_accvgpr_read_b32 v161, a5
    v_accvgpr_read_b32 v162, a6
    v_accvgpr_read_b32 v163, a7
    v_pk_mul_f32 v[156:157], v[156:157], v[220:221]
    v_pk_mul_f32 v[158:159], v[158:159], v[220:221]
    v_pk_mul_f32 v[160:161], v[160:161], v[220:221]
    v_pk_mul_f32 v[162:163], v[162:163], v[220:221]
    v_cvt_pk_bf16_f32 v156, v156, v157
    v_cvt_pk_bf16_f32 v157, v158, v159
    v_cvt_pk_bf16_f32 v158, v160, v161
    v_cvt_pk_bf16_f32 v159, v162, v163
    s_nop 1
    v_permlane16_swap_b32 v156, v158
    v_permlane16_swap_b32 v157, v159
    buffer_store_dwordx4 v[156:159], v17, s[24:27], s38 offen offset:0
    v_accvgpr_read_b32 v164, a8
    v_accvgpr_read_b32 v165, a9
    v_accvgpr_read_b32 v166, a10
    v_accvgpr_read_b32 v167, a11
    v_accvgpr_read_b32 v168, a12
    v_accvgpr_read_b32 v169, a13
    v_accvgpr_read_b32 v170, a14
    v_accvgpr_read_b32 v171, a15
    v_pk_mul_f32 v[164:165], v[164:165], v[220:221]
    v_pk_mul_f32 v[166:167], v[166:167], v[220:221]
    v_pk_mul_f32 v[168:169], v[168:169], v[220:221]
    v_pk_mul_f32 v[170:171], v[170:171], v[220:221]
    v_cvt_pk_bf16_f32 v164, v164, v165
    v_cvt_pk_bf16_f32 v165, v166, v167
    v_cvt_pk_bf16_f32 v166, v168, v169
    v_cvt_pk_bf16_f32 v167, v170, v171
    s_nop 1
    v_permlane16_swap_b32 v164, v166
    v_permlane16_swap_b32 v165, v167
    buffer_store_dwordx4 v[164:167], v17, s[24:27], s38 offen offset:64
    v_accvgpr_read_b32 v172, a16
    v_accvgpr_read_b32 v173, a17
    v_accvgpr_read_b32 v174, a18
    v_accvgpr_read_b32 v175, a19
    v_accvgpr_read_b32 v176, a20
    v_accvgpr_read_b32 v177, a21
    v_accvgpr_read_b32 v178, a22
    v_accvgpr_read_b32 v179, a23
    v_pk_mul_f32 v[172:173], v[172:173], v[220:221]
    v_pk_mul_f32 v[174:175], v[174:175], v[220:221]
    v_pk_mul_f32 v[176:177], v[176:177], v[220:221]
    v_pk_mul_f32 v[178:179], v[178:179], v[220:221]
    v_cvt_pk_bf16_f32 v172, v172, v173
    v_cvt_pk_bf16_f32 v173, v174, v175
    v_cvt_pk_bf16_f32 v174, v176, v177
    v_cvt_pk_bf16_f32 v175, v178, v179
    s_nop 1
    v_permlane16_swap_b32 v172, v174
    v_permlane16_swap_b32 v173, v175
    buffer_store_dwordx4 v[172:175], v17, s[24:27], s38 offen offset:128
    v_accvgpr_read_b32 v180, a24
    v_accvgpr_read_b32 v181, a25
    v_accvgpr_read_b32 v182, a26
    v_accvgpr_read_b32 v183, a27
    v_accvgpr_read_b32 v184, a28
    v_accvgpr_read_b32 v185, a29
    v_accvgpr_read_b32 v186, a30
    v_accvgpr_read_b32 v187, a31
    v_pk_mul_f32 v[180:181], v[180:181], v[220:221]
    v_pk_mul_f32 v[182:183], v[182:183], v[220:221]
    v_pk_mul_f32 v[184:185], v[184:185], v[220:221]
    v_pk_mul_f32 v[186:187], v[186:187], v[220:221]
    v_cvt_pk_bf16_f32 v180, v180, v181
    v_cvt_pk_bf16_f32 v181, v182, v183
    v_cvt_pk_bf16_f32 v182, v184, v185
    v_cvt_pk_bf16_f32 v183, v186, v187
    s_nop 1
    v_permlane16_swap_b32 v180, v182
    v_permlane16_swap_b32 v181, v183
    buffer_store_dwordx4 v[180:183], v17, s[24:27], s38 offen offset:192
    s_add_u32 s38, s32, 4096
    v_accvgpr_read_b32 v188, a32
    v_accvgpr_read_b32 v189, a33
    v_accvgpr_read_b32 v190, a34
    v_accvgpr_read_b32 v191, a35
    v_accvgpr_read_b32 v192, a36
    v_accvgpr_read_b32 v193, a37
    v_accvgpr_read_b32 v194, a38
    v_accvgpr_read_b32 v195, a39
    v_pk_mul_f32 v[188:189], v[188:189], v[222:223]
    v_pk_mul_f32 v[190:191], v[190:191], v[222:223]
    v_pk_mul_f32 v[192:193], v[192:193], v[222:223]
    v_pk_mul_f32 v[194:195], v[194:195], v[222:223]
    v_cvt_pk_bf16_f32 v188, v188, v189
    v_cvt_pk_bf16_f32 v189, v190, v191
    v_cvt_pk_bf16_f32 v190, v192, v193
    v_cvt_pk_bf16_f32 v191, v194, v195
    s_nop 1
    v_permlane16_swap_b32 v188, v190
    v_permlane16_swap_b32 v189, v191
    buffer_store_dwordx4 v[188:191], v17, s[24:27], s38 offen offset:0
    v_accvgpr_read_b32 v196, a40
    v_accvgpr_read_b32 v197, a41
    v_accvgpr_read_b32 v198, a42
    v_accvgpr_read_b32 v199, a43
    v_accvgpr_read_b32 v200, a44
    v_accvgpr_read_b32 v201, a45
    v_accvgpr_read_b32 v202, a46
    v_accvgpr_read_b32 v203, a47
    v_pk_mul_f32 v[196:197], v[196:197], v[222:223]
    v_pk_mul_f32 v[198:199], v[198:199], v[222:223]
    v_pk_mul_f32 v[200:201], v[200:201], v[222:223]
    v_pk_mul_f32 v[202:203], v[202:203], v[222:223]
    v_cvt_pk_bf16_f32 v196, v196, v197
    v_cvt_pk_bf16_f32 v197, v198, v199
    v_cvt_pk_bf16_f32 v198, v200, v201
    v_cvt_pk_bf16_f32 v199, v202, v203
    s_nop 1
    v_permlane16_swap_b32 v196, v198
    v_permlane16_swap_b32 v197, v199
    buffer_store_dwordx4 v[196:199], v17, s[24:27], s38 offen offset:64
    v_accvgpr_read_b32 v204, a48
    v_accvgpr_read_b32 v205, a49
    v_accvgpr_read_b32 v206, a50
    v_accvgpr_read_b32 v207, a51
    v_accvgpr_read_b32 v208, a52
    v_accvgpr_read_b32 v209, a53
    v_accvgpr_read_b32 v210, a54
    v_accvgpr_read_b32 v211, a55
    v_pk_mul_f32 v[204:205], v[204:205], v[222:223]
    v_pk_mul_f32 v[206:207], v[206:207], v[222:223]
    v_pk_mul_f32 v[208:209], v[208:209], v[222:223]
    v_pk_mul_f32 v[210:211], v[210:211], v[222:223]
    v_cvt_pk_bf16_f32 v204, v204, v205
    v_cvt_pk_bf16_f32 v205, v206, v207
    v_cvt_pk_bf16_f32 v206, v208, v209
    v_cvt_pk_bf16_f32 v207, v210, v211
    s_nop 1
    v_permlane16_swap_b32 v204, v206
    v_permlane16_swap_b32 v205, v207
    buffer_store_dwordx4 v[204:207], v17, s[24:27], s38 offen offset:128
    v_accvgpr_read_b32 v212, a56
    v_accvgpr_read_b32 v213, a57
    v_accvgpr_read_b32 v214, a58
    v_accvgpr_read_b32 v215, a59
    v_accvgpr_read_b32 v216, a60
    v_accvgpr_read_b32 v217, a61
    v_accvgpr_read_b32 v218, a62
    v_accvgpr_read_b32 v219, a63
    v_pk_mul_f32 v[212:213], v[212:213], v[222:223]
    v_pk_mul_f32 v[214:215], v[214:215], v[222:223]
    v_pk_mul_f32 v[216:217], v[216:217], v[222:223]
    v_pk_mul_f32 v[218:219], v[218:219], v[222:223]
    v_cvt_pk_bf16_f32 v212, v212, v213
    v_cvt_pk_bf16_f32 v213, v214, v215
    v_cvt_pk_bf16_f32 v214, v216, v217
    v_cvt_pk_bf16_f32 v215, v218, v219
    s_nop 1
    v_permlane16_swap_b32 v212, v214
    v_permlane16_swap_b32 v213, v215
    buffer_store_dwordx4 v[212:215], v17, s[24:27], s38 offen offset:192
    s_add_u32 s38, s32, 8192
    v_accvgpr_read_b32 v156, a64
    v_accvgpr_read_b32 v157, a65
    v_accvgpr_read_b32 v158, a66
    v_accvgpr_read_b32 v159, a67
    v_accvgpr_read_b32 v160, a68
    v_accvgpr_read_b32 v161, a69
    v_accvgpr_read_b32 v162, a70
    v_accvgpr_read_b32 v163, a71
    v_pk_mul_f32 v[156:157], v[156:157], v[224:225]
    v_pk_mul_f32 v[158:159], v[158:159], v[224:225]
    v_pk_mul_f32 v[160:161], v[160:161], v[224:225]
    v_pk_mul_f32 v[162:163], v[162:163], v[224:225]
    v_cvt_pk_bf16_f32 v156, v156, v157
    v_cvt_pk_bf16_f32 v157, v158, v159
    v_cvt_pk_bf16_f32 v158, v160, v161
    v_cvt_pk_bf16_f32 v159, v162, v163
    s_nop 1
    v_permlane16_swap_b32 v156, v158
    v_permlane16_swap_b32 v157, v159
    buffer_store_dwordx4 v[156:159], v17, s[24:27], s38 offen offset:0
    v_accvgpr_read_b32 v164, a72
    v_accvgpr_read_b32 v165, a73
    v_accvgpr_read_b32 v166, a74
    v_accvgpr_read_b32 v167, a75
    v_accvgpr_read_b32 v168, a76
    v_accvgpr_read_b32 v169, a77
    v_accvgpr_read_b32 v170, a78
    v_accvgpr_read_b32 v171, a79
    v_pk_mul_f32 v[164:165], v[164:165], v[224:225]
    v_pk_mul_f32 v[166:167], v[166:167], v[224:225]
    v_pk_mul_f32 v[168:169], v[168:169], v[224:225]
    v_pk_mul_f32 v[170:171], v[170:171], v[224:225]
    v_cvt_pk_bf16_f32 v164, v164, v165
    v_cvt_pk_bf16_f32 v165, v166, v167
    v_cvt_pk_bf16_f32 v166, v168, v169
    v_cvt_pk_bf16_f32 v167, v170, v171
    s_nop 1
    v_permlane16_swap_b32 v164, v166
    v_permlane16_swap_b32 v165, v167
    buffer_store_dwordx4 v[164:167], v17, s[24:27], s38 offen offset:64
    v_accvgpr_read_b32 v172, a80
    v_accvgpr_read_b32 v173, a81
    v_accvgpr_read_b32 v174, a82
    v_accvgpr_read_b32 v175, a83
    v_accvgpr_read_b32 v176, a84
    v_accvgpr_read_b32 v177, a85
    v_accvgpr_read_b32 v178, a86
    v_accvgpr_read_b32 v179, a87
    v_pk_mul_f32 v[172:173], v[172:173], v[224:225]
    v_pk_mul_f32 v[174:175], v[174:175], v[224:225]
    v_pk_mul_f32 v[176:177], v[176:177], v[224:225]
    v_pk_mul_f32 v[178:179], v[178:179], v[224:225]
    v_cvt_pk_bf16_f32 v172, v172, v173
    v_cvt_pk_bf16_f32 v173, v174, v175
    v_cvt_pk_bf16_f32 v174, v176, v177
    v_cvt_pk_bf16_f32 v175, v178, v179
    s_nop 1
    v_permlane16_swap_b32 v172, v174
    v_permlane16_swap_b32 v173, v175
    buffer_store_dwordx4 v[172:175], v17, s[24:27], s38 offen offset:128
    v_accvgpr_read_b32 v180, a88
    v_accvgpr_read_b32 v181, a89
    v_accvgpr_read_b32 v182, a90
    v_accvgpr_read_b32 v183, a91
    v_accvgpr_read_b32 v184, a92
    v_accvgpr_read_b32 v185, a93
    v_accvgpr_read_b32 v186, a94
    v_accvgpr_read_b32 v187, a95
    v_pk_mul_f32 v[180:181], v[180:181], v[224:225]
    v_pk_mul_f32 v[182:183], v[182:183], v[224:225]
    v_pk_mul_f32 v[184:185], v[184:185], v[224:225]
    v_pk_mul_f32 v[186:187], v[186:187], v[224:225]
    v_cvt_pk_bf16_f32 v180, v180, v181
    v_cvt_pk_bf16_f32 v181, v182, v183
    v_cvt_pk_bf16_f32 v182, v184, v185
    v_cvt_pk_bf16_f32 v183, v186, v187
    s_nop 1
    v_permlane16_swap_b32 v180, v182
    v_permlane16_swap_b32 v181, v183
    buffer_store_dwordx4 v[180:183], v17, s[24:27], s38 offen offset:192
    s_add_u32 s38, s32, 12288
    v_accvgpr_read_b32 v188, a96
    v_accvgpr_read_b32 v189, a97
    v_accvgpr_read_b32 v190, a98
    v_accvgpr_read_b32 v191, a99
    v_accvgpr_read_b32 v192, a100
    v_accvgpr_read_b32 v193, a101
    v_accvgpr_read_b32 v194, a102
    v_accvgpr_read_b32 v195, a103
    v_pk_mul_f32 v[188:189], v[188:189], v[226:227]
    v_pk_mul_f32 v[190:191], v[190:191], v[226:227]
    v_pk_mul_f32 v[192:193], v[192:193], v[226:227]
    v_pk_mul_f32 v[194:195], v[194:195], v[226:227]
    v_cvt_pk_bf16_f32 v188, v188, v189
    v_cvt_pk_bf16_f32 v189, v190, v191
    v_cvt_pk_bf16_f32 v190, v192, v193
    v_cvt_pk_bf16_f32 v191, v194, v195
    s_nop 1
    v_permlane16_swap_b32 v188, v190
    v_permlane16_swap_b32 v189, v191
    buffer_store_dwordx4 v[188:191], v17, s[24:27], s38 offen offset:0
    v_accvgpr_read_b32 v196, a104
    v_accvgpr_read_b32 v197, a105
    v_accvgpr_read_b32 v198, a106
    v_accvgpr_read_b32 v199, a107
    v_accvgpr_read_b32 v200, a108
    v_accvgpr_read_b32 v201, a109
    v_accvgpr_read_b32 v202, a110
    v_accvgpr_read_b32 v203, a111
    v_pk_mul_f32 v[196:197], v[196:197], v[226:227]
    v_pk_mul_f32 v[198:199], v[198:199], v[226:227]
    v_pk_mul_f32 v[200:201], v[200:201], v[226:227]
    v_pk_mul_f32 v[202:203], v[202:203], v[226:227]
    v_cvt_pk_bf16_f32 v196, v196, v197
    v_cvt_pk_bf16_f32 v197, v198, v199
    v_cvt_pk_bf16_f32 v198, v200, v201
    v_cvt_pk_bf16_f32 v199, v202, v203
    s_nop 1
    v_permlane16_swap_b32 v196, v198
    v_permlane16_swap_b32 v197, v199
    buffer_store_dwordx4 v[196:199], v17, s[24:27], s38 offen offset:64
    v_accvgpr_read_b32 v204, a112
    v_accvgpr_read_b32 v205, a113
    v_accvgpr_read_b32 v206, a114
    v_accvgpr_read_b32 v207, a115
    v_accvgpr_read_b32 v208, a116
    v_accvgpr_read_b32 v209, a117
    v_accvgpr_read_b32 v210, a118
    v_accvgpr_read_b32 v211, a119
    v_pk_mul_f32 v[204:205], v[204:205], v[226:227]
    v_pk_mul_f32 v[206:207], v[206:207], v[226:227]
    v_pk_mul_f32 v[208:209], v[208:209], v[226:227]
    v_pk_mul_f32 v[210:211], v[210:211], v[226:227]
    v_cvt_pk_bf16_f32 v204, v204, v205
    v_cvt_pk_bf16_f32 v205, v206, v207
    v_cvt_pk_bf16_f32 v206, v208, v209
    v_cvt_pk_bf16_f32 v207, v210, v211
    s_nop 1
    v_permlane16_swap_b32 v204, v206
    v_permlane16_swap_b32 v205, v207
    buffer_store_dwordx4 v[204:207], v17, s[24:27], s38 offen offset:128
    v_accvgpr_read_b32 v212, a120
    v_accvgpr_read_b32 v213, a121
    v_accvgpr_read_b32 v214, a122
    v_accvgpr_read_b32 v215, a123
    v_accvgpr_read_b32 v216, a124
    v_accvgpr_read_b32 v217, a125
    v_accvgpr_read_b32 v218, a126
    v_accvgpr_read_b32 v219, a127
    v_pk_mul_f32 v[212:213], v[212:213], v[226:227]
    v_pk_mul_f32 v[214:215], v[214:215], v[226:227]
    v_pk_mul_f32 v[216:217], v[216:217], v[226:227]
    v_pk_mul_f32 v[218:219], v[218:219], v[226:227]
    v_cvt_pk_bf16_f32 v212, v212, v213
    v_cvt_pk_bf16_f32 v213, v214, v215
    v_cvt_pk_bf16_f32 v214, v216, v217
    v_cvt_pk_bf16_f32 v215, v218, v219
    s_nop 1
    v_permlane16_swap_b32 v212, v214
    v_permlane16_swap_b32 v213, v215
    buffer_store_dwordx4 v[212:215], v17, s[24:27], s38 offen offset:192
    s_endpgm
L_c4_fallback:
    s_waitcnt vmcnt(0)
    s_waitcnt lgkmcnt(0)
    s_barrier
    s_mov_b32 s33, s30
    s_mov_b32 s35, 0
    v_mov_b32 v24, 0xff800000
    v_mov_b32 v28, 0xff800000
    v_mov_b32 v32, 0xff800000
    v_mov_b32 v36, 0xff800000
    v_mfma_f32_32x32x16_bf16 a[0:15], v[252:255], v[252:255], 0
    v_mfma_f32_32x32x16_bf16 a[16:31], v[252:255], v[252:255], 0
    v_mfma_f32_32x32x16_bf16 a[32:47], v[252:255], v[252:255], 0
    v_mfma_f32_32x32x16_bf16 a[48:63], v[252:255], v[252:255], 0
    v_mfma_f32_32x32x16_bf16 a[64:79], v[252:255], v[252:255], 0
    v_mfma_f32_32x32x16_bf16 a[80:95], v[252:255], v[252:255], 0
    v_mfma_f32_32x32x16_bf16 a[96:111], v[252:255], v[252:255], 0
    v_mfma_f32_32x32x16_bf16 a[112:127], v[252:255], v[252:255], 0
    v_mfma_f32_32x32x16_bf16 a[240:255], v[252:255], v[252:255], 0
L_c4_fbloop:
    s_add_u32 m0, s34, 0
    s_nop 0
    buffer_load_dwordx4 v1, s[16:19], s33 offen lds
    buffer_load_dwordx4 v2, s[16:19], s33 offen offset:1024 lds
    s_add_u32 m0, s34, 65536
    s_nop 0
    buffer_load_dwordx4 v1, s[20:23], s33 offen lds
    buffer_load_dwordx4 v2, s[20:23], s33 offen offset:1024 lds
    s_add_u32 s33, s33, 8192
    s_waitcnt vmcnt(0)
    s_barrier
    ds_read_b128 v[44:47], v4 offset:0
    ds_read_b128 v[48:51], v5 offset:0
    ds_read_b128 v[52:55], v6 offset:0
    s_waitcnt lgkmcnt(2)
    v_mfma_f32_16x16x32_bf16 v[76:79], v[44:47], a[160:163], 0
    ds_read_b128 v[56:59], v7 offset:0
    v_mfma_f32_16x16x32_bf16 v[84:87], v[44:47], a[176:179], 0
    v_mfma_f32_16x16x32_bf16 v[92:95], v[44:47], a[192:195], 0
    v_mfma_f32_16x16x32_bf16 v[100:103], v[44:47], a[208:211], 0
    s_waitcnt lgkmcnt(2)
    v_mfma_f32_16x16x32_bf16 v[76:79], v[48:51], a[164:167], v[76:79]
    ds_read_b128 v[60:63], v4 offset:4096
    v_mfma_f32_16x16x32_bf16 v[84:87], v[48:51], a[180:183], v[84:87]
    v_mfma_f32_16x16x32_bf16 v[92:95], v[48:51], a[196:199], v[92:95]
    v_mfma_f32_16x16x32_bf16 v[100:103], v[48:51], a[212:215], v[100:103]
    s_waitcnt lgkmcnt(2)
    v_mfma_f32_16x16x32_bf16 v[76:79], v[52:55], a[168:171], v[76:79]
    ds_read_b128 v[64:67], v5 offset:4096
    v_mfma_f32_16x16x32_bf16 v[84:87], v[52:55], a[184:187], v[84:87]
    v_mfma_f32_16x16x32_bf16 v[92:95], v[52:55], a[200:203], v[92:95]
    v_mfma_f32_16x16x32_bf16 v[100:103], v[52:55], a[216:219], v[100:103]
    s_waitcnt lgkmcnt(2)
    v_mfma_f32_16x16x32_bf16 v[76:79], v[56:59], a[172:175], v[76:79]
    ds_read_b128 v[68:71], v6 offset:4096
    v_mfma_f32_16x16x32_bf16 v[84:87], v[56:59], a[188:191], v[84:87]
    v_mfma_f32_16x16x32_bf16 v[92:95], v[56:59], a[204:207], v[92:95]
    v_mfma_f32_16x16x32_bf16 v[100:103], v[56:59], a[220:223], v[100:103]
    s_waitcnt lgkmcnt(2)
    v_mfma_f32_16x16x32_bf16 v[80:83], v[60:63], a[160:163], 0
    ds_read_b128 v[72:75], v7 offset:4096
    v_mfma_f32_16x16x32_bf16 v[88:91], v[60:63], a[176:179], 0
    v_mfma_f32_16x16x32_bf16 v[96:99], v[60:63], a[192:195], 0
    v_mfma_f32_16x16x32_bf16 v[104:107], v[60:63], a[208:211], 0
    s_waitcnt lgkmcnt(2)
    v_mfma_f32_16x16x32_bf16 v[80:83], v[64:67], a[164:167], v[80:83]
    v_mfma_f32_16x16x32_bf16 v[88:91], v[64:67], a[180:183], v[88:91]
    v_mfma_f32_16x16x32_bf16 v[96:99], v[64:67], a[196:199], v[96:99]
    v_mfma_f32_16x16x32_bf16 v[104:107], v[64:67], a[212:215], v[104:107]
    s_waitcnt lgkmcnt(1)
    v_mfma_f32_16x16x32_bf16 v[80:83], v[68:71], a[168:171], v[80:83]
    v_mfma_f32_16x16x32_bf16 v[88:91], v[68:71], a[184:187], v[88:91]
    v_mfma_f32_16x16x32_bf16 v[96:99], v[68:71], a[200:203], v[96:99]
    v_mfma_f32_16x16x32_bf16 v[104:107], v[68:71], a[216:219], v[104:107]
    s_waitcnt lgkmcnt(0)
    v_mfma_f32_16x16x32_bf16 v[80:83], v[72:75], a[172:175], v[80:83]
    v_mfma_f32_16x16x32_bf16 v[88:91], v[72:75], a[188:191], v[88:91]
    v_mfma_f32_16x16x32_bf16 v[96:99], v[72:75], a[204:207], v[96:99]
    v_mfma_f32_16x16x32_bf16 v[104:107], v[72:75], a[220:223], v[104:107]
    s_nop 7
    v_max3_f32 v236, v76, v77, v78
    v_max3_f32 v237, v79, v80, v81
    v_max3_f32 v236, v236, v82, v83
    v_max_f32 v236, v236, v237
    v_max3_f32 v238, v84, v85, v86
    v_max3_f32 v239, v87, v88, v89
    v_max3_f32 v238, v238, v90, v91
    v_max_f32 v238, v238, v239
    v_max3_f32 v240, v92, v93, v94
    v_max3_f32 v241, v95, v96, v97
    v_max3_f32 v240, v240, v98, v99
    v_max_f32 v240, v240, v241
    v_max3_f32 v242, v100, v101, v102
    v_max3_f32 v243, v103, v104, v105
    v_max3_f32 v242, v242, v106, v107
    v_max_f32 v242, v242, v243
    v_mov_b32 v237, v236
    v_mov_b32 v239, v238
    v_mov_b32 v241, v240
    v_mov_b32 v243, v242
    s_nop 1
    v_permlane16_swap_b32 v236, v237
    v_permlane16_swap_b32 v238, v239
    v_permlane16_swap_b32 v240, v241
    v_permlane16_swap_b32 v242, v243
    v_max_f32 v236, v236, v237
    v_mov_b32 v237, v236
    v_max_f32 v238, v238, v239
    v_mov_b32 v239, v238
    v_max_f32 v240, v240, v241
    v_mov_b32 v241, v240
    v_max_f32 v242, v242, v243
    v_mov_b32 v243, v242
    s_nop 1
    v_permlane32_swap_b32 v236, v237
    v_permlane32_swap_b32 v238, v239
    v_permlane32_swap_b32 v240, v241
    v_permlane32_swap_b32 v242, v243
    v_max_f32 v236, v236, v237
    v_max_f32 v238, v238, v239
    v_max_f32 v240, v240, v241
    v_max_f32 v242, v242, v243
    v_max_f32 v236, v236, v24
    v_sub_f32 v25, v24, v236
    v_exp_f32 v25, v25
    v_mov_b32 v24, v236
    v_accvgpr_read_b32 v116, a240
    v_mul_f32 v116, v116, v25
    v_accvgpr_write_b32 a240, v116
    v_accvgpr_read_b32 v117, a241
    v_mul_f32 v117, v117, v25
    v_accvgpr_write_b32 a241, v117
    v_accvgpr_read_b32 v118, a242
    v_mul_f32 v118, v118, v25
    v_accvgpr_write_b32 a242, v118
    v_accvgpr_read_b32 v119, a243
    v_mul_f32 v119, v119, v25
    v_accvgpr_write_b32 a243, v119
    v_accvgpr_read_b32 v116, a0
    v_mul_f32 v116, v116, v25
    v_accvgpr_write_b32 a0, v116
    v_accvgpr_read_b32 v117, a1
    v_mul_f32 v117, v117, v25
    v_accvgpr_write_b32 a1, v117
    v_accvgpr_read_b32 v118, a2
    v_mul_f32 v118, v118, v25
    v_accvgpr_write_b32 a2, v118
    v_accvgpr_read_b32 v119, a3
    v_mul_f32 v119, v119, v25
    v_accvgpr_write_b32 a3, v119
    v_accvgpr_read_b32 v120, a4
    v_mul_f32 v120, v120, v25
    v_accvgpr_write_b32 a4, v120
    v_accvgpr_read_b32 v121, a5
    v_mul_f32 v121, v121, v25
    v_accvgpr_write_b32 a5, v121
    v_accvgpr_read_b32 v122, a6
    v_mul_f32 v122, v122, v25
    v_accvgpr_write_b32 a6, v122
    v_accvgpr_read_b32 v123, a7
    v_mul_f32 v123, v123, v25
    v_accvgpr_write_b32 a7, v123
    v_accvgpr_read_b32 v124, a8
    v_mul_f32 v124, v124, v25
    v_accvgpr_write_b32 a8, v124
    v_accvgpr_read_b32 v125, a9
    v_mul_f32 v125, v125, v25
    v_accvgpr_write_b32 a9, v125
    v_accvgpr_read_b32 v126, a10
    v_mul_f32 v126, v126, v25
    v_accvgpr_write_b32 a10, v126
    v_accvgpr_read_b32 v127, a11
    v_mul_f32 v127, v127, v25
    v_accvgpr_write_b32 a11, v127
    v_accvgpr_read_b32 v128, a12
    v_mul_f32 v128, v128, v25
    v_accvgpr_write_b32 a12, v128
    v_accvgpr_read_b32 v129, a13
    v_mul_f32 v129, v129, v25
    v_accvgpr_write_b32 a13, v129
    v_accvgpr_read_b32 v130, a14
    v_mul_f32 v130, v130, v25
    v_accvgpr_write_b32 a14, v130
    v_accvgpr_read_b32 v131, a15
    v_mul_f32 v131, v131, v25
    v_accvgpr_write_b32 a15, v131
    v_accvgpr_read_b32 v132, a16
    v_mul_f32 v132, v132, v25
    v_accvgpr_write_b32 a16, v132
    v_accvgpr_read_b32 v133, a17
    v_mul_f32 v133, v133, v25
    v_accvgpr_write_b32 a17, v133
    v_accvgpr_read_b32 v134, a18
    v_mul_f32 v134, v134, v25
    v_accvgpr_write_b32 a18, v134
    v_accvgpr_read_b32 v135, a19
    v_mul_f32 v135, v135, v25
    v_accvgpr_write_b32 a19, v135
    v_accvgpr_read_b32 v136, a20
    v_mul_f32 v136, v136, v25
    v_accvgpr_write_b32 a20, v136
    v_accvgpr_read_b32 v137, a21
    v_mul_f32 v137, v137, v25
    v_accvgpr_write_b32 a21, v137
    v_accvgpr_read_b32 v138, a22
    v_mul_f32 v138, v138, v25
    v_accvgpr_write_b32 a22, v138
    v_accvgpr_read_b32 v139, a23
    v_mul_f32 v139, v139, v25
    v_accvgpr_write_b32 a23, v139
    v_accvgpr_read_b32 v140, a24
    v_mul_f32 v140, v140, v25
    v_accvgpr_write_b32 a24, v140
    v_accvgpr_read_b32 v141, a25
    v_mul_f32 v141, v141, v25
    v_accvgpr_write_b32 a25, v141
    v_accvgpr_read_b32 v142, a26
    v_mul_f32 v142, v142, v25
    v_accvgpr_write_b32 a26, v142
    v_accvgpr_read_b32 v143, a27
    v_mul_f32 v143, v143, v25
    v_accvgpr_write_b32 a27, v143
    v_accvgpr_read_b32 v144, a28
    v_mul_f32 v144, v144, v25
    v_accvgpr_write_b32 a28, v144
    v_accvgpr_read_b32 v145, a29
    v_mul_f32 v145, v145, v25
    v_accvgpr_write_b32 a29, v145
    v_accvgpr_read_b32 v146, a30
    v_mul_f32 v146, v146, v25
    v_accvgpr_write_b32 a30, v146
    v_accvgpr_read_b32 v147, a31
    v_mul_f32 v147, v147, v25
    v_accvgpr_write_b32 a31, v147
    v_sub_f32 v76, v76, v236
    v_sub_f32 v77, v77, v236
    v_sub_f32 v78, v78, v236
    v_sub_f32 v79, v79, v236
    v_sub_f32 v80, v80, v236
    v_sub_f32 v81, v81, v236
    v_sub_f32 v82, v82, v236
    v_sub_f32 v83, v83, v236
    v_max_f32 v238, v238, v28
    v_sub_f32 v29, v28, v238
    v_exp_f32 v29, v29
    v_mov_b32 v28, v238
    v_accvgpr_read_b32 v116, a244
    v_mul_f32 v116, v116, v29
    v_accvgpr_write_b32 a244, v116
    v_accvgpr_read_b32 v117, a245
    v_mul_f32 v117, v117, v29
    v_accvgpr_write_b32 a245, v117
    v_accvgpr_read_b32 v118, a246
    v_mul_f32 v118, v118, v29
    v_accvgpr_write_b32 a246, v118
    v_accvgpr_read_b32 v119, a247
    v_mul_f32 v119, v119, v29
    v_accvgpr_write_b32 a247, v119
    v_accvgpr_read_b32 v116, a32
    v_mul_f32 v116, v116, v29
    v_accvgpr_write_b32 a32, v116
    v_accvgpr_read_b32 v117, a33
    v_mul_f32 v117, v117, v29
    v_accvgpr_write_b32 a33, v117
    v_accvgpr_read_b32 v118, a34
    v_mul_f32 v118, v118, v29
    v_accvgpr_write_b32 a34, v118
    v_accvgpr_read_b32 v119, a35
    v_mul_f32 v119, v119, v29
    v_accvgpr_write_b32 a35, v119
    v_accvgpr_read_b32 v120, a36
    v_mul_f32 v120, v120, v29
    v_accvgpr_write_b32 a36, v120
    v_accvgpr_read_b32 v121, a37
    v_mul_f32 v121, v121, v29
    v_accvgpr_write_b32 a37, v121
    v_accvgpr_read_b32 v122, a38
    v_mul_f32 v122, v122, v29
    v_accvgpr_write_b32 a38, v122
    v_accvgpr_read_b32 v123, a39
    v_mul_f32 v123, v123, v29
    v_accvgpr_write_b32 a39, v123
    v_accvgpr_read_b32 v124, a40
    v_mul_f32 v124, v124, v29
    v_accvgpr_write_b32 a40, v124
    v_accvgpr_read_b32 v125, a41
    v_mul_f32 v125, v125, v29
    v_accvgpr_write_b32 a41, v125
    v_accvgpr_read_b32 v126, a42
    v_mul_f32 v126, v126, v29
    v_accvgpr_write_b32 a42, v126
    v_accvgpr_read_b32 v127, a43
    v_mul_f32 v127, v127, v29
    v_accvgpr_write_b32 a43, v127
    v_accvgpr_read_b32 v128, a44
    v_mul_f32 v128, v128, v29
    v_accvgpr_write_b32 a44, v128
    v_accvgpr_read_b32 v129, a45
    v_mul_f32 v129, v129, v29
    v_accvgpr_write_b32 a45, v129
    v_accvgpr_read_b32 v130, a46
    v_mul_f32 v130, v130, v29
    v_accvgpr_write_b32 a46, v130
    v_accvgpr_read_b32 v131, a47
    v_mul_f32 v131, v131, v29
    v_accvgpr_write_b32 a47, v131
    v_accvgpr_read_b32 v132, a48
    v_mul_f32 v132, v132, v29
    v_accvgpr_write_b32 a48, v132
    v_accvgpr_read_b32 v133, a49
    v_mul_f32 v133, v133, v29
    v_accvgpr_write_b32 a49, v133
    v_accvgpr_read_b32 v134, a50
    v_mul_f32 v134, v134, v29
    v_accvgpr_write_b32 a50, v134
    v_accvgpr_read_b32 v135, a51
    v_mul_f32 v135, v135, v29
    v_accvgpr_write_b32 a51, v135
    v_accvgpr_read_b32 v136, a52
    v_mul_f32 v136, v136, v29
    v_accvgpr_write_b32 a52, v136
    v_accvgpr_read_b32 v137, a53
    v_mul_f32 v137, v137, v29
    v_accvgpr_write_b32 a53, v137
    v_accvgpr_read_b32 v138, a54
    v_mul_f32 v138, v138, v29
    v_accvgpr_write_b32 a54, v138
    v_accvgpr_read_b32 v139, a55
    v_mul_f32 v139, v139, v29
    v_accvgpr_write_b32 a55, v139
    v_accvgpr_read_b32 v140, a56
    v_mul_f32 v140, v140, v29
    v_accvgpr_write_b32 a56, v140
    v_accvgpr_read_b32 v141, a57
    v_mul_f32 v141, v141, v29
    v_accvgpr_write_b32 a57, v141
    v_accvgpr_read_b32 v142, a58
    v_mul_f32 v142, v142, v29
    v_accvgpr_write_b32 a58, v142
    v_accvgpr_read_b32 v143, a59
    v_mul_f32 v143, v143, v29
    v_accvgpr_write_b32 a59, v143
    v_accvgpr_read_b32 v144, a60
    v_mul_f32 v144, v144, v29
    v_accvgpr_write_b32 a60, v144
    v_accvgpr_read_b32 v145, a61
    v_mul_f32 v145, v145, v29
    v_accvgpr_write_b32 a61, v145
    v_accvgpr_read_b32 v146, a62
    v_mul_f32 v146, v146, v29
    v_accvgpr_write_b32 a62, v146
    v_accvgpr_read_b32 v147, a63
    v_mul_f32 v147, v147, v29
    v_accvgpr_write_b32 a63, v147
    v_sub_f32 v84, v84, v238
    v_sub_f32 v85, v85, v238
    v_sub_f32 v86, v86, v238
    v_sub_f32 v87, v87, v238
    v_sub_f32 v88, v88, v238
    v_sub_f32 v89, v89, v238
    v_sub_f32 v90, v90, v238
    v_sub_f32 v91, v91, v238
    v_max_f32 v240, v240, v32
    v_sub_f32 v33, v32, v240
    v_exp_f32 v33, v33
    v_mov_b32 v32, v240
    v_accvgpr_read_b32 v116, a248
    v_mul_f32 v116, v116, v33
    v_accvgpr_write_b32 a248, v116
    v_accvgpr_read_b32 v117, a249
    v_mul_f32 v117, v117, v33
    v_accvgpr_write_b32 a249, v117
    v_accvgpr_read_b32 v118, a250
    v_mul_f32 v118, v118, v33
    v_accvgpr_write_b32 a250, v118
    v_accvgpr_read_b32 v119, a251
    v_mul_f32 v119, v119, v33
    v_accvgpr_write_b32 a251, v119
    v_accvgpr_read_b32 v116, a64
    v_mul_f32 v116, v116, v33
    v_accvgpr_write_b32 a64, v116
    v_accvgpr_read_b32 v117, a65
    v_mul_f32 v117, v117, v33
    v_accvgpr_write_b32 a65, v117
    v_accvgpr_read_b32 v118, a66
    v_mul_f32 v118, v118, v33
    v_accvgpr_write_b32 a66, v118
    v_accvgpr_read_b32 v119, a67
    v_mul_f32 v119, v119, v33
    v_accvgpr_write_b32 a67, v119
    v_accvgpr_read_b32 v120, a68
    v_mul_f32 v120, v120, v33
    v_accvgpr_write_b32 a68, v120
    v_accvgpr_read_b32 v121, a69
    v_mul_f32 v121, v121, v33
    v_accvgpr_write_b32 a69, v121
    v_accvgpr_read_b32 v122, a70
    v_mul_f32 v122, v122, v33
    v_accvgpr_write_b32 a70, v122
    v_accvgpr_read_b32 v123, a71
    v_mul_f32 v123, v123, v33
    v_accvgpr_write_b32 a71, v123
    v_accvgpr_read_b32 v124, a72
    v_mul_f32 v124, v124, v33
    v_accvgpr_write_b32 a72, v124
    v_accvgpr_read_b32 v125, a73
    v_mul_f32 v125, v125, v33
    v_accvgpr_write_b32 a73, v125
    v_accvgpr_read_b32 v126, a74
    v_mul_f32 v126, v126, v33
    v_accvgpr_write_b32 a74, v126
    v_accvgpr_read_b32 v127, a75
    v_mul_f32 v127, v127, v33
    v_accvgpr_write_b32 a75, v127
    v_accvgpr_read_b32 v128, a76
    v_mul_f32 v128, v128, v33
    v_accvgpr_write_b32 a76, v128
    v_accvgpr_read_b32 v129, a77
    v_mul_f32 v129, v129, v33
    v_accvgpr_write_b32 a77, v129
    v_accvgpr_read_b32 v130, a78
    v_mul_f32 v130, v130, v33
    v_accvgpr_write_b32 a78, v130
    v_accvgpr_read_b32 v131, a79
    v_mul_f32 v131, v131, v33
    v_accvgpr_write_b32 a79, v131
    v_accvgpr_read_b32 v132, a80
    v_mul_f32 v132, v132, v33
    v_accvgpr_write_b32 a80, v132
    v_accvgpr_read_b32 v133, a81
    v_mul_f32 v133, v133, v33
    v_accvgpr_write_b32 a81, v133
    v_accvgpr_read_b32 v134, a82
    v_mul_f32 v134, v134, v33
    v_accvgpr_write_b32 a82, v134
    v_accvgpr_read_b32 v135, a83
    v_mul_f32 v135, v135, v33
    v_accvgpr_write_b32 a83, v135
    v_accvgpr_read_b32 v136, a84
    v_mul_f32 v136, v136, v33
    v_accvgpr_write_b32 a84, v136
    v_accvgpr_read_b32 v137, a85
    v_mul_f32 v137, v137, v33
    v_accvgpr_write_b32 a85, v137
    v_accvgpr_read_b32 v138, a86
    v_mul_f32 v138, v138, v33
    v_accvgpr_write_b32 a86, v138
    v_accvgpr_read_b32 v139, a87
    v_mul_f32 v139, v139, v33
    v_accvgpr_write_b32 a87, v139
    v_accvgpr_read_b32 v140, a88
    v_mul_f32 v140, v140, v33
    v_accvgpr_write_b32 a88, v140
    v_accvgpr_read_b32 v141, a89
    v_mul_f32 v141, v141, v33
    v_accvgpr_write_b32 a89, v141
    v_accvgpr_read_b32 v142, a90
    v_mul_f32 v142, v142, v33
    v_accvgpr_write_b32 a90, v142
    v_accvgpr_read_b32 v143, a91
    v_mul_f32 v143, v143, v33
    v_accvgpr_write_b32 a91, v143
    v_accvgpr_read_b32 v144, a92
    v_mul_f32 v144, v144, v33
    v_accvgpr_write_b32 a92, v144
    v_accvgpr_read_b32 v145, a93
    v_mul_f32 v145, v145, v33
    v_accvgpr_write_b32 a93, v145
    v_accvgpr_read_b32 v146, a94
    v_mul_f32 v146, v146, v33
    v_accvgpr_write_b32 a94, v146
    v_accvgpr_read_b32 v147, a95
    v_mul_f32 v147, v147, v33
    v_accvgpr_write_b32 a95, v147
    v_sub_f32 v92, v92, v240
    v_sub_f32 v93, v93, v240
    v_sub_f32 v94, v94, v240
    v_sub_f32 v95, v95, v240
    v_sub_f32 v96, v96, v240
    v_sub_f32 v97, v97, v240
    v_sub_f32 v98, v98, v240
    v_sub_f32 v99, v99, v240
    v_max_f32 v242, v242, v36
    v_sub_f32 v37, v36, v242
    v_exp_f32 v37, v37
    v_mov_b32 v36, v242
    v_accvgpr_read_b32 v116, a252
    v_mul_f32 v116, v116, v37
    v_accvgpr_write_b32 a252, v116
    v_accvgpr_read_b32 v117, a253
    v_mul_f32 v117, v117, v37
    v_accvgpr_write_b32 a253, v117
    v_accvgpr_read_b32 v118, a254
    v_mul_f32 v118, v118, v37
    v_accvgpr_write_b32 a254, v118
    v_accvgpr_read_b32 v119, a255
    v_mul_f32 v119, v119, v37
    v_accvgpr_write_b32 a255, v119
    v_accvgpr_read_b32 v116, a96
    v_mul_f32 v116, v116, v37
    v_accvgpr_write_b32 a96, v116
    v_accvgpr_read_b32 v117, a97
    v_mul_f32 v117, v117, v37
    v_accvgpr_write_b32 a97, v117
    v_accvgpr_read_b32 v118, a98
    v_mul_f32 v118, v118, v37
    v_accvgpr_write_b32 a98, v118
    v_accvgpr_read_b32 v119, a99
    v_mul_f32 v119, v119, v37
    v_accvgpr_write_b32 a99, v119
    v_accvgpr_read_b32 v120, a100
    v_mul_f32 v120, v120, v37
    v_accvgpr_write_b32 a100, v120
    v_accvgpr_read_b32 v121, a101
    v_mul_f32 v121, v121, v37
    v_accvgpr_write_b32 a101, v121
    v_accvgpr_read_b32 v122, a102
    v_mul_f32 v122, v122, v37
    v_accvgpr_write_b32 a102, v122
    v_accvgpr_read_b32 v123, a103
    v_mul_f32 v123, v123, v37
    v_accvgpr_write_b32 a103, v123
    v_accvgpr_read_b32 v124, a104
    v_mul_f32 v124, v124, v37
    v_accvgpr_write_b32 a104, v124
    v_accvgpr_read_b32 v125, a105
    v_mul_f32 v125, v125, v37
    v_accvgpr_write_b32 a105, v125
    v_accvgpr_read_b32 v126, a106
    v_mul_f32 v126, v126, v37
    v_accvgpr_write_b32 a106, v126
    v_accvgpr_read_b32 v127, a107
    v_mul_f32 v127, v127, v37
    v_accvgpr_write_b32 a107, v127
    v_accvgpr_read_b32 v128, a108
    v_mul_f32 v128, v128, v37
    v_accvgpr_write_b32 a108, v128
    v_accvgpr_read_b32 v129, a109
    v_mul_f32 v129, v129, v37
    v_accvgpr_write_b32 a109, v129
    v_accvgpr_read_b32 v130, a110
    v_mul_f32 v130, v130, v37
    v_accvgpr_write_b32 a110, v130
    v_accvgpr_read_b32 v131, a111
    v_mul_f32 v131, v131, v37
    v_accvgpr_write_b32 a111, v131
    v_accvgpr_read_b32 v132, a112
    v_mul_f32 v132, v132, v37
    v_accvgpr_write_b32 a112, v132
    v_accvgpr_read_b32 v133, a113
    v_mul_f32 v133, v133, v37
    v_accvgpr_write_b32 a113, v133
    v_accvgpr_read_b32 v134, a114
    v_mul_f32 v134, v134, v37
    v_accvgpr_write_b32 a114, v134
    v_accvgpr_read_b32 v135, a115
    v_mul_f32 v135, v135, v37
    v_accvgpr_write_b32 a115, v135
    v_accvgpr_read_b32 v136, a116
    v_mul_f32 v136, v136, v37
    v_accvgpr_write_b32 a116, v136
    v_accvgpr_read_b32 v137, a117
    v_mul_f32 v137, v137, v37
    v_accvgpr_write_b32 a117, v137
    v_accvgpr_read_b32 v138, a118
    v_mul_f32 v138, v138, v37
    v_accvgpr_write_b32 a118, v138
    v_accvgpr_read_b32 v139, a119
    v_mul_f32 v139, v139, v37
    v_accvgpr_write_b32 a119, v139
    v_accvgpr_read_b32 v140, a120
    v_mul_f32 v140, v140, v37
    v_accvgpr_write_b32 a120, v140
    v_accvgpr_read_b32 v141, a121
    v_mul_f32 v141, v141, v37
    v_accvgpr_write_b32 a121, v141
    v_accvgpr_read_b32 v142, a122
    v_mul_f32 v142, v142, v37
    v_accvgpr_write_b32 a122, v142
    v_accvgpr_read_b32 v143, a123
    v_mul_f32 v143, v143, v37
    v_accvgpr_write_b32 a123, v143
    v_accvgpr_read_b32 v144, a124
    v_mul_f32 v144, v144, v37
    v_accvgpr_write_b32 a124, v144
    v_accvgpr_read_b32 v145, a125
    v_mul_f32 v145, v145, v37
    v_accvgpr_write_b32 a125, v145
    v_accvgpr_read_b32 v146, a126
    v_mul_f32 v146, v146, v37
    v_accvgpr_write_b32 a126, v146
    v_accvgpr_read_b32 v147, a127
    v_mul_f32 v147, v147, v37
    v_accvgpr_write_b32 a127, v147
    v_sub_f32 v100, v100, v242
    v_sub_f32 v101, v101, v242
    v_sub_f32 v102, v102, v242
    v_sub_f32 v103, v103, v242
    v_sub_f32 v104, v104, v242
    v_sub_f32 v105, v105, v242
    v_sub_f32 v106, v106, v242
    v_sub_f32 v107, v107, v242
    v_exp_f32 v76, v76
    v_exp_f32 v77, v77
    v_exp_f32 v78, v78
    v_exp_f32 v79, v79
    v_exp_f32 v80, v80
    v_cvt_pk_bf16_f32 v76, v76, v77
    v_cvt_pk_bf16_f32 v77, v78, v79
    v_exp_f32 v81, v81
    v_exp_f32 v82, v82
    v_exp_f32 v83, v83
    v_cvt_pk_bf16_f32 v78, v80, v81
    v_cvt_pk_bf16_f32 v79, v82, v83
    v_exp_f32 v84, v84
    v_exp_f32 v85, v85
    v_exp_f32 v86, v86
    v_exp_f32 v87, v87
    v_exp_f32 v88, v88
    v_cvt_pk_bf16_f32 v84, v84, v85
    v_cvt_pk_bf16_f32 v85, v86, v87
    v_exp_f32 v89, v89
    v_exp_f32 v90, v90
    v_exp_f32 v91, v91
    v_cvt_pk_bf16_f32 v86, v88, v89
    v_cvt_pk_bf16_f32 v87, v90, v91
    v_exp_f32 v92, v92
    v_exp_f32 v93, v93
    v_exp_f32 v94, v94
    v_exp_f32 v95, v95
    v_exp_f32 v96, v96
    v_cvt_pk_bf16_f32 v92, v92, v93
    v_cvt_pk_bf16_f32 v93, v94, v95
    v_exp_f32 v97, v97
    v_exp_f32 v98, v98
    v_exp_f32 v99, v99
    v_cvt_pk_bf16_f32 v94, v96, v97
    v_cvt_pk_bf16_f32 v95, v98, v99
    v_exp_f32 v100, v100
    v_exp_f32 v101, v101
    v_exp_f32 v102, v102
    v_exp_f32 v103, v103
    v_exp_f32 v104, v104
    v_cvt_pk_bf16_f32 v100, v100, v101
    v_cvt_pk_bf16_f32 v101, v102, v103
    v_exp_f32 v105, v105
    v_exp_f32 v106, v106
    v_exp_f32 v107, v107
    v_cvt_pk_bf16_f32 v102, v104, v105
    v_cvt_pk_bf16_f32 v103, v106, v107
    s_nop 1
    ds_read_b64_tr_b16 v[44:45], v8 offset:0
    ds_read_b64_tr_b16 v[46:47], v8 offset:4096
    s_waitcnt lgkmcnt(0)
    v_mfma_f32_16x16x32_bf16 a[0:3], v[44:47], v[76:79], a[0:3]
    v_mfma_f32_16x16x32_bf16 a[32:35], v[44:47], v[84:87], a[32:35]
    v_mfma_f32_16x16x32_bf16 a[64:67], v[44:47], v[92:95], a[64:67]
    v_mfma_f32_16x16x32_bf16 a[96:99], v[44:47], v[100:103], a[96:99]
    ds_read_b64_tr_b16 v[48:49], v9 offset:0
    ds_read_b64_tr_b16 v[50:51], v9 offset:4096
    s_waitcnt lgkmcnt(0)
    v_mfma_f32_16x16x32_bf16 a[4:7], v[48:51], v[76:79], a[4:7]
    v_mfma_f32_16x16x32_bf16 a[36:39], v[48:51], v[84:87], a[36:39]
    v_mfma_f32_16x16x32_bf16 a[68:71], v[48:51], v[92:95], a[68:71]
    v_mfma_f32_16x16x32_bf16 a[100:103], v[48:51], v[100:103], a[100:103]
    ds_read_b64_tr_b16 v[52:53], v10 offset:0
    ds_read_b64_tr_b16 v[54:55], v10 offset:4096
    s_waitcnt lgkmcnt(0)
    v_mfma_f32_16x16x32_bf16 a[8:11], v[52:55], v[76:79], a[8:11]
    v_mfma_f32_16x16x32_bf16 a[40:43], v[52:55], v[84:87], a[40:43]
    v_mfma_f32_16x16x32_bf16 a[72:75], v[52:55], v[92:95], a[72:75]
    v_mfma_f32_16x16x32_bf16 a[104:107], v[52:55], v[100:103], a[104:107]
    ds_read_b64_tr_b16 v[56:57], v11 offset:0
    ds_read_b64_tr_b16 v[58:59], v11 offset:4096
    s_waitcnt lgkmcnt(0)
    v_mfma_f32_16x16x32_bf16 a[12:15], v[56:59], v[76:79], a[12:15]
    v_mfma_f32_16x16x32_bf16 a[44:47], v[56:59], v[84:87], a[44:47]
    v_mfma_f32_16x16x32_bf16 a[76:79], v[56:59], v[92:95], a[76:79]
    v_mfma_f32_16x16x32_bf16 a[108:111], v[56:59], v[100:103], a[108:111]
    ds_read_b64_tr_b16 v[60:61], v12 offset:0
    ds_read_b64_tr_b16 v[62:63], v12 offset:4096
    s_waitcnt lgkmcnt(0)
    v_mfma_f32_16x16x32_bf16 a[16:19], v[60:63], v[76:79], a[16:19]
    v_mfma_f32_16x16x32_bf16 a[48:51], v[60:63], v[84:87], a[48:51]
    v_mfma_f32_16x16x32_bf16 a[80:83], v[60:63], v[92:95], a[80:83]
    v_mfma_f32_16x16x32_bf16 a[112:115], v[60:63], v[100:103], a[112:115]
    ds_read_b64_tr_b16 v[64:65], v13 offset:0
    ds_read_b64_tr_b16 v[66:67], v13 offset:4096
    s_waitcnt lgkmcnt(0)
    v_mfma_f32_16x16x32_bf16 a[20:23], v[64:67], v[76:79], a[20:23]
    v_mfma_f32_16x16x32_bf16 a[52:55], v[64:67], v[84:87], a[52:55]
    v_mfma_f32_16x16x32_bf16 a[84:87], v[64:67], v[92:95], a[84:87]
    v_mfma_f32_16x16x32_bf16 a[116:119], v[64:67], v[100:103], a[116:119]
    ds_read_b64_tr_b16 v[68:69], v14 offset:0
    ds_read_b64_tr_b16 v[70:71], v14 offset:4096
    s_waitcnt lgkmcnt(0)
    v_mfma_f32_16x16x32_bf16 a[24:27], v[68:71], v[76:79], a[24:27]
    v_mfma_f32_16x16x32_bf16 a[56:59], v[68:71], v[84:87], a[56:59]
    v_mfma_f32_16x16x32_bf16 a[88:91], v[68:71], v[92:95], a[88:91]
    v_mfma_f32_16x16x32_bf16 a[120:123], v[68:71], v[100:103], a[120:123]
    ds_read_b64_tr_b16 v[72:73], v15 offset:0
    ds_read_b64_tr_b16 v[74:75], v15 offset:4096
    s_waitcnt lgkmcnt(0)
    v_mfma_f32_16x16x32_bf16 a[28:31], v[72:75], v[76:79], a[28:31]
    v_mfma_f32_16x16x32_bf16 a[60:63], v[72:75], v[84:87], a[60:63]
    v_mfma_f32_16x16x32_bf16 a[92:95], v[72:75], v[92:95], a[92:95]
    v_mfma_f32_16x16x32_bf16 a[124:127], v[72:75], v[100:103], a[124:127]
    v_mfma_f32_16x16x32_bf16 a[240:243], v[248:251], v[76:79], a[240:243]
    v_mfma_f32_16x16x32_bf16 a[244:247], v[248:251], v[84:87], a[244:247]
    v_mfma_f32_16x16x32_bf16 a[248:251], v[248:251], v[92:95], a[248:251]
    v_mfma_f32_16x16x32_bf16 a[252:255], v[248:251], v[100:103], a[252:255]
    s_barrier
    s_add_u32 s35, s35, 1
    s_cmp_lt_u32 s35, 32
    s_cbranch_scc1 L_c4_fbloop
    s_nop 7
    s_mov_b32 s33, s45
    s_add_u32 m0, s34, 0
    s_nop 0
    buffer_load_dwordx4 v1, s[16:19], s33 offen lds
    buffer_load_dwordx4 v2, s[16:19], s33 offen offset:1024 lds
    s_add_u32 m0, s34, 65536
    s_nop 0
    buffer_load_dwordx4 v1, s[20:23], s33 offen lds
    buffer_load_dwordx4 v2, s[20:23], s33 offen offset:1024 lds
    s_add_u32 s33, s33, 8192
    s_add_u32 m0, s34, 8192
    s_nop 0
    buffer_load_dwordx4 v1, s[16:19], s33 offen lds
    buffer_load_dwordx4 v2, s[16:19], s33 offen offset:1024 lds
    s_add_u32 m0, s34, 73728
    s_nop 0
    buffer_load_dwordx4 v1, s[20:23], s33 offen lds
    buffer_load_dwordx4 v2, s[20:23], s33 offen offset:1024 lds
    s_add_u32 s33, s33, 8192
    s_add_u32 m0, s34, 16384
    s_nop 0
    buffer_load_dwordx4 v1, s[16:19], s33 offen lds
    buffer_load_dwordx4 v2, s[16:19], s33 offen offset:1024 lds
    s_add_u32 m0, s34, 81920
    s_nop 0
    buffer_load_dwordx4 v1, s[20:23], s33 offen lds
    buffer_load_dwordx4 v2, s[20:23], s33 offen offset:1024 lds
    s_add_u32 s33, s33, 8192
    s_add_u32 m0, s34, 24576
    s_nop 0
    buffer_load_dwordx4 v1, s[16:19], s33 offen lds
    buffer_load_dwordx4 v2, s[16:19], s33 offen offset:1024 lds
    s_add_u32 m0, s34, 90112
    s_nop 0
    buffer_load_dwordx4 v1, s[20:23], s33 offen lds
    buffer_load_dwordx4 v2, s[20:23], s33 offen offset:1024 lds
    s_add_u32 s33, s33, 8192
    s_add_u32 m0, s34, 32768
    s_nop 0
    buffer_load_dwordx4 v1, s[16:19], s33 offen lds
    buffer_load_dwordx4 v2, s[16:19], s33 offen offset:1024 lds
    s_add_u32 m0, s34, 98304
    s_nop 0
    buffer_load_dwordx4 v1, s[20:23], s33 offen lds
    buffer_load_dwordx4 v2, s[20:23], s33 offen offset:1024 lds
    s_add_u32 s33, s33, 8192
    s_add_u32 m0, s34, 40960
    s_nop 0
    buffer_load_dwordx4 v1, s[16:19], s33 offen lds
    buffer_load_dwordx4 v2, s[16:19], s33 offen offset:1024 lds
    s_add_u32 m0, s34, 106496
    s_nop 0
    buffer_load_dwordx4 v1, s[20:23], s33 offen lds
    buffer_load_dwordx4 v2, s[20:23], s33 offen offset:1024 lds
    s_add_u32 s33, s33, 8192
    v_accvgpr_write_b32 a160, v156
    v_accvgpr_write_b32 a161, v157
    v_accvgpr_write_b32 a162, v158
    v_accvgpr_write_b32 a163, v159
    v_accvgpr_write_b32 a164, v160
    v_accvgpr_write_b32 a165, v161
    v_accvgpr_write_b32 a166, v162
    v_accvgpr_write_b32 a167, v163
    v_accvgpr_write_b32 a168, v164
    v_accvgpr_write_b32 a169, v165
    v_accvgpr_write_b32 a170, v166
    v_accvgpr_write_b32 a171, v167
    v_accvgpr_write_b32 a172, v168
    v_accvgpr_write_b32 a173, v169
    v_accvgpr_write_b32 a174, v170
    v_accvgpr_write_b32 a175, v171
    v_accvgpr_write_b32 a176, v172
    v_accvgpr_write_b32 a177, v173
    v_accvgpr_write_b32 a178, v174
    v_accvgpr_write_b32 a179, v175
    v_accvgpr_write_b32 a180, v176
    v_accvgpr_write_b32 a181, v177
    v_accvgpr_write_b32 a182, v178
    v_accvgpr_write_b32 a183, v179
    v_accvgpr_write_b32 a184, v180
    v_accvgpr_write_b32 a185, v181
    v_accvgpr_write_b32 a186, v182
    v_accvgpr_write_b32 a187, v183
    v_accvgpr_write_b32 a188, v184
    v_accvgpr_write_b32 a189, v185
    v_accvgpr_write_b32 a190, v186
    v_accvgpr_write_b32 a191, v187
    v_accvgpr_write_b32 a192, v188
    v_accvgpr_write_b32 a193, v189
    v_accvgpr_write_b32 a194, v190
    v_accvgpr_write_b32 a195, v191
    v_accvgpr_write_b32 a196, v192
    v_accvgpr_write_b32 a197, v193
    v_accvgpr_write_b32 a198, v194
    v_accvgpr_write_b32 a199, v195
    v_accvgpr_write_b32 a200, v196
    v_accvgpr_write_b32 a201, v197
    v_accvgpr_write_b32 a202, v198
    v_accvgpr_write_b32 a203, v199
    v_accvgpr_write_b32 a204, v200
    v_accvgpr_write_b32 a205, v201
    v_accvgpr_write_b32 a206, v202
    v_accvgpr_write_b32 a207, v203
    v_accvgpr_write_b32 a208, v204
    v_accvgpr_write_b32 a209, v205
    v_accvgpr_write_b32 a210, v206
    v_accvgpr_write_b32 a211, v207
    v_accvgpr_write_b32 a212, v208
    v_accvgpr_write_b32 a213, v209
    v_accvgpr_write_b32 a214, v210
    v_accvgpr_write_b32 a215, v211
    v_accvgpr_write_b32 a216, v212
    v_accvgpr_write_b32 a217, v213
    v_accvgpr_write_b32 a218, v214
    v_accvgpr_write_b32 a219, v215
    v_accvgpr_write_b32 a220, v216
    v_accvgpr_write_b32 a221, v217
    v_accvgpr_write_b32 a222, v218
    v_accvgpr_write_b32 a223, v219
    s_waitcnt vmcnt(0)
    s_barrier
    s_cmp_eq_u32 s46, 0
    s_cbranch_scc1 L_c4_bnd
    s_branch L_c4_fin
L_exit:
    s_endpgm
.section .rodata,"a"
.p2align 6
.amdhsa_kernel standalone__gqa_softmax__near_ridge_kernel
  .amdhsa_next_free_vgpr 512
  .amdhsa_next_free_sgpr 102
  .amdhsa_accum_offset 256
  .amdhsa_group_segment_fixed_size 0
  .amdhsa_kernarg_size 48
  .amdhsa_user_sgpr_count 2
  .amdhsa_user_sgpr_kernarg_segment_ptr 1
  .amdhsa_system_sgpr_workgroup_id_x 1
.end_amdhsa_kernel
```
